```python
import torch

def _softmax(x, axis=-1):
    return torch.softmax(x, dim=axis)

def _gelu(x):
    return torch.nn.functional.gelu(x, approximate='tanh')

def _silu(x):
    return torch.nn.functional.silu(x)

def _sigmoid(x):
    return torch.sigmoid(x)

def _layernorm(x, axis=-1, eps=1e-05):
    m = x.mean(dim=axis, keepdim=True)
    v = x.var(dim=axis, keepdim=True, unbiased=False)
    return (x - m) / torch.sqrt(v + eps)

def _scatter_add(tgt, idx, src, axis=0):
    return tgt.clone().index_add_(axis, idx, src)

def _segment_sum(src, seg, n):
    out = torch.zeros((n,) + src.shape[1:], dtype=src.dtype)
    return out.index_add_(0, seg, src)

def _pad(x, pw):
    flat = tuple((v for pair in reversed(pw) for v in pair))
    return torch.nn.functional.pad(x, flat)
kernel_name = 'gated_mix__memory_aug_recurrent_mem_tr__glu_gated_geglu__prompt'

def setup_inputs():

    _w = lambda a: (lambda t: t.to(torch.bfloat16) if t.is_floating_point() else t)(torch.as_tensor(a))

    def _A_setup():
        B, S, Dm = (1, 2048, 640)
        H, Dh = (32, 192)
        M, seg = (8, 32)
        seg = min(seg, S)
        S = S // seg * seg
        return {'x': _w((lambda *s: torch.randn(*s, dtype=torch.bfloat16) * 0.05)(B, S, Dm)), 'mem0': _w((lambda *s: torch.randn(*s, dtype=torch.bfloat16) * 0.4)(B, M, Dm)), 'Wq': _w((lambda *s: torch.randn(*s, dtype=torch.bfloat16) * 6.4)(Dm, H, Dh) * Dm ** (-0.5)), 'Wk': _w((lambda *s: torch.randn(*s, dtype=torch.bfloat16) * 6.4)(Dm, H, Dh) * Dm ** (-0.5)), 'Wv': _w((lambda *s: torch.randn(*s, dtype=torch.bfloat16) * 0.4)(Dm, H, Dh) * Dm ** (-0.5)), 'Wo': _w((lambda *s: torch.randn(*s, dtype=torch.bfloat16) * 0.4)(H, Dh, Dm) * (H * Dh) ** (-0.5)), 'seg_len': seg}
    _A_in = _A_setup()

    def _B_setup():
        B, S, Dm, Df = (1, 2048, 640, 1536)
        return {'x': _w((lambda *s: torch.randn(*s, dtype=torch.bfloat16) * 0.05)(B, S, Dm)), 'w_gate': _w((lambda *s: torch.randn(*s, dtype=torch.bfloat16) * 1.6)(Dm, Df) * Dm ** (-0.5)), 'w_up': _w((lambda *s: torch.randn(*s, dtype=torch.bfloat16) * 1.6)(Dm, Df) * Dm ** (-0.5)), 'w_down': _w((lambda *s: torch.randn(*s, dtype=torch.bfloat16) * 1.6)(Df, Dm) * Df ** (-0.5))}
    _B_in = _B_setup()
    return {'A_x': _A_in['x'], 'A_mem0': _A_in['mem0'], 'A_Wq': _A_in['Wq'], 'A_Wk': _A_in['Wk'], 'A_Wv': _A_in['Wv'], 'A_Wo': _A_in['Wo'], 'A_seg_len': _A_in['seg_len'], 'B_x': _B_in['x'], 'B_w_gate': _B_in['w_gate'], 'B_w_up': _B_in['w_up'], 'B_w_down': _B_in['w_down'], 'gate_w': _w((lambda *s: torch.randn(*s, dtype=torch.bfloat16) * 0.05)(640) * 16.0)}

def reference(A_x, A_mem0, A_Wq, A_Wk, A_Wv, A_Wo, A_seg_len, B_x, B_w_gate, B_w_up, B_w_down, gate_w):

    def _A_ref(x, mem0, Wq, Wk, Wv, Wo, seg_len):
        B, S, Dm = x.shape
        H, Dh = (Wq.shape[1], Wq.shape[2])
        M = mem0.shape[1]
        scale = Dh ** (-0.5)
        n_seg = S // seg_len
        L = M + seg_len
        idx = torch.arange(L)
        mask = (idx[:, None] < M) | (idx[:, None] >= idx[None, :])
        mem = mem0
        outs = []
        for s in range(n_seg):
            xs = x[:, s * seg_len:(s + 1) * seg_len, :].clone()
            h = torch.concatenate([mem, xs], axis=1)
            q = torch.einsum('btd,dhe->bhte', h, Wq)
            k = torch.einsum('btd,dhe->bhte', h, Wk)
            v = torch.einsum('btd,dhe->bhte', h, Wv)
            scores = torch.einsum('bhqe,bhke->bhqk', q, k) * scale
            scores = torch.where(mask[None, None], scores, -1000000000.0)
            p = _softmax(scores, axis=-1)
            o = torch.einsum('bhqk,bhke->bhqe', p, v)
            o = torch.einsum('bhte,hed->btd', o, Wo)
            mem = o[:, :M, :].clone()
            outs.append(o[:, M:, :])
        return torch.concatenate(outs, axis=1)

    def _B_ref(x, w_gate, w_up, w_down):
        g = torch.einsum('bsd,df->bsf', x, w_gate)
        u = torch.einsum('bsd,df->bsf', x, w_up)
        h = _gelu(g) * u
        return torch.einsum('bsf,fd->bsd', h, w_down)
    x = A_x
    g = _sigmoid((x * gate_w).sum(-1, keepdims=True))
    a = _A_ref(x, A_mem0, A_Wq, A_Wk, A_Wv, A_Wo, A_seg_len)
    b = _B_ref(x, B_w_gate, B_w_up, B_w_down)
    return g * a + (1 - g) * b
```

```asm
; @launch grid=(256,1,1) block=(256,1,1) lds=163840
.amdgcn_target "amdgcn-amd-amdhsa--gfx950"
.text
.globl gated_mix__memory_aug_recurrent_mem_tr__glu_gated_geglu__prompt_kernel
.p2align 8
.type gated_mix__memory_aug_recurrent_mem_tr__glu_gated_geglu__prompt_kernel,@function
gated_mix__memory_aug_recurrent_mem_tr__glu_gated_geglu__prompt_kernel:
    s_cmp_ge_u32 s2, 256
    s_cbranch_scc1 L_end
    s_load_dwordx16 s[8:23], s[0:1], 0
    s_load_dwordx8 s[24:31], s[0:1], 64
    s_load_dwordx4 s[32:35], s[0:1], 96
    s_load_dwordx2 s[36:37], s[0:1], 112
    v_lshrrev_b32 v1, 6, v0
    v_and_b32 v0, 63, v0
    v_readfirstlane_b32 s3, v1
    s_mov_b32 s6, 0
    s_mov_b32 s5, 0
    s_and_b32 s64, s2, 7
    s_lshr_b32 s65, s2, 3
    s_waitcnt lgkmcnt(0)
    s_mov_b32 s40, s36
    s_mov_b32 s41, s37
    s_mov_b32 s42, 0x10000000
    s_mov_b32 s43, 0x20000
    s_mov_b32 s44, s8
    s_mov_b32 s45, s9
    s_mov_b32 s46, 0x280000
    s_mov_b32 s47, 0x20000
    s_mov_b32 s60, s34
    s_mov_b32 s61, s35
    s_mov_b32 s62, 0x100
    s_mov_b32 s63, 0x20000
    s_mov_b32 s56, s32
    s_mov_b32 s57, s33
    s_mov_b32 s58, 0x280000
    s_mov_b32 s59, 0x20000
    s_add_u32 s38, s36, 0x3fffff
    s_and_b32 s38, s38, 0xffe00000
    s_sub_u32 s38, s38, s36
    s_add_u32 s39, s38, 0x200000
    s_cmp_eq_u32 s64, 0
    s_cbranch_scc1 L_xcd0
    s_cmp_eq_u32 s64, 1
    s_cbranch_scc1 L_xcd1
    s_cmp_eq_u32 s64, 2
    s_cbranch_scc1 L_xcd2
    s_cmp_eq_u32 s64, 3
    s_cbranch_scc1 L_xcd3
    s_cmp_eq_u32 s64, 4
    s_cbranch_scc1 L_xcd4
    s_cmp_eq_u32 s64, 5
    s_cbranch_scc1 L_xcd5
    s_cmp_eq_u32 s64, 6
    s_cbranch_scc1 L_xcd6
    s_cmp_eq_u32 s64, 7
    s_cbranch_scc1 L_xcd7
L_xcd0:
    s_add_u32 s4, s65, 0
    s_cmp_lt_u32 s65, 32
    s_cbranch_scc1 L_P
    s_branch L_IDLE
L_xcd1:
    s_add_u32 s4, s65, 0
    s_cmp_lt_u32 s65, 20
    s_cbranch_scc1 L_O
    s_add_u32 s4, s65, -20
    s_cmp_lt_u32 s65, 30
    s_cbranch_scc1 L_X
    s_add_u32 s4, s65, -30
    s_cmp_lt_u32 s65, 32
    s_cbranch_scc1 L_G
    s_branch L_IDLE
L_xcd2:
    s_add_u32 s4, s65, 0
    s_cmp_lt_u32 s65, 32
    s_cbranch_scc1 L_V
    s_branch L_IDLE
L_xcd3:
    s_add_u32 s4, s65, 20
    s_cmp_lt_u32 s65, 20
    s_cbranch_scc1 L_O
    s_add_u32 s4, s65, -10
    s_cmp_lt_u32 s65, 30
    s_cbranch_scc1 L_X
    s_add_u32 s4, s65, -28
    s_cmp_lt_u32 s65, 32
    s_cbranch_scc1 L_G
    s_branch L_IDLE
L_xcd4:
    s_add_u32 s4, s65, 0
    s_cmp_lt_u32 s65, 6
    s_cbranch_scc1 L_BA
    s_add_u32 s4, s65, 18
    s_cmp_lt_u32 s65, 12
    s_cbranch_scc1 L_BA
    s_add_u32 s4, s65, 36
    s_cmp_lt_u32 s65, 18
    s_cbranch_scc1 L_BA
    s_add_u32 s4, s65, -18
    s_cmp_lt_u32 s65, 26
    s_cbranch_scc1 L_BU
    s_add_u32 s4, s65, -26
    s_cmp_lt_u32 s65, 29
    s_cbranch_scc1 L_GU
    s_add_u32 s4, s65, -29
    s_cmp_lt_u32 s65, 31
    s_cbranch_scc1 L_D
    s_add_u32 s4, s65, -27
    s_cmp_lt_u32 s65, 32
    s_cbranch_scc1 L_G
    s_branch L_IDLE
L_xcd5:
    s_add_u32 s4, s65, 6
    s_cmp_lt_u32 s65, 6
    s_cbranch_scc1 L_BA
    s_add_u32 s4, s65, 24
    s_cmp_lt_u32 s65, 12
    s_cbranch_scc1 L_BA
    s_add_u32 s4, s65, 42
    s_cmp_lt_u32 s65, 18
    s_cbranch_scc1 L_BA
    s_add_u32 s4, s65, -10
    s_cmp_lt_u32 s65, 26
    s_cbranch_scc1 L_BU
    s_add_u32 s4, s65, -23
    s_cmp_lt_u32 s65, 29
    s_cbranch_scc1 L_GU
    s_add_u32 s4, s65, -27
    s_cmp_lt_u32 s65, 31
    s_cbranch_scc1 L_D
    s_add_u32 s4, s65, -26
    s_cmp_lt_u32 s65, 32
    s_cbranch_scc1 L_G
    s_branch L_IDLE
L_xcd6:
    s_add_u32 s4, s65, 12
    s_cmp_lt_u32 s65, 6
    s_cbranch_scc1 L_BA
    s_add_u32 s4, s65, 30
    s_cmp_lt_u32 s65, 12
    s_cbranch_scc1 L_BA
    s_add_u32 s4, s65, 48
    s_cmp_lt_u32 s65, 18
    s_cbranch_scc1 L_BA
    s_add_u32 s4, s65, -2
    s_cmp_lt_u32 s65, 26
    s_cbranch_scc1 L_BU
    s_add_u32 s4, s65, -20
    s_cmp_lt_u32 s65, 29
    s_cbranch_scc1 L_GU
    s_add_u32 s4, s65, -25
    s_cmp_lt_u32 s65, 31
    s_cbranch_scc1 L_D
    s_add_u32 s4, s65, -25
    s_cmp_lt_u32 s65, 32
    s_cbranch_scc1 L_G
    s_branch L_IDLE
L_xcd7:
    s_add_u32 s4, s65, 18
    s_cmp_lt_u32 s65, 6
    s_cbranch_scc1 L_BA
    s_add_u32 s4, s65, 36
    s_cmp_lt_u32 s65, 12
    s_cbranch_scc1 L_BA
    s_add_u32 s4, s65, 54
    s_cmp_lt_u32 s65, 18
    s_cbranch_scc1 L_BA
    s_add_u32 s4, s65, 6
    s_cmp_lt_u32 s65, 26
    s_cbranch_scc1 L_BU
    s_add_u32 s4, s65, -17
    s_cmp_lt_u32 s65, 29
    s_cbranch_scc1 L_GU
    s_add_u32 s4, s65, -23
    s_cmp_lt_u32 s65, 31
    s_cbranch_scc1 L_D
    s_add_u32 s4, s65, -24
    s_cmp_lt_u32 s65, 32
    s_cbranch_scc1 L_G
    s_branch L_IDLE
L_IDLE:
    v_mov_b32 v2, s3
    v_or_b32 v2, v2, v0
    v_cmp_eq_u32 vcc, 0, v2
    v_mov_b32 v2, 0x80000000
    s_nop 0
    v_cndmask_b32_e64 v2, v2, 0, vcc
    s_waitcnt vmcnt(0)
    s_barrier
    v_mov_b32 v3, 1
    buffer_atomic_add v3, v2, s[60:63], 0 offen sc1
    s_endpgm
L_BA:
    s_getpc_b64 s[96:97]
L_pc_1:
    s_lshl_b32 s98, s3, 10
    v_lshl_add_u32 v250, v0, 4, s98
    v_mov_b32 v251, s97
    v_add_co_u32 v250, vcc, s96, v250
    s_nop 1
    v_addc_co_u32 v251, vcc, 0, v251, vcc
    global_load_dwordx4 v[252:255], v[250:251], off
    v_add_co_u32 v250, vcc, 0x1000, v250
    s_nop 1
    v_addc_co_u32 v251, vcc, 0, v251, vcc
    global_load_dwordx4 v[252:255], v[250:251], off
    v_add_co_u32 v250, vcc, 0x1000, v250
    s_nop 1
    v_addc_co_u32 v251, vcc, 0, v251, vcc
    s_lshl_b32 s7, s4, 2
    s_add_u32 s7, s7, s3
    s_mul_i32 s79, s7, 171
    s_lshr_b32 s79, s79, 14
    s_mul_i32 s80, s79, 96
    s_sub_u32 s7, s7, s80
    s_mul_i32 s80, s7, 171
    s_lshr_b32 s80, s80, 9
    s_mul_i32 s81, s80, 3
    s_sub_u32 s81, s7, s81
    s_cmp_eq_u32 s79, 1
    s_cselect_b32 s20, s14, s12
    s_cselect_b32 s21, s15, s13
    s_cmp_eq_u32 s79, 2
    s_cselect_b32 s20, s16, s20
    s_cselect_b32 s21, s17, s21
    s_mov_b32 s48, s20
    s_mov_b32 s49, s21
    s_mov_b32 s50, 0x780000
    s_mov_b32 s51, 0x20000
    s_mul_i32 s71, s79, 0x1800000
    s_add_u32 s71, s71, 0x2000000
    s_mov_b32 s70, s4
    s_lshl_b32 s70, s70, 7
    v_and_b32 v1, 15, v0
    v_lshrrev_b32 v2, 4, v0
    v_lshrrev_b32 v3, 2, v1
    v_and_b32 v4, 3, v0
    v_mov_b32 v5, s3
    v_or_b32 v5, v5, v0
    v_cmp_eq_u32 vcc, 0, v5
    v_mov_b32 v5, 0x80000000
    s_nop 0
    v_cndmask_b32_e64 v5, v5, 0, vcc
    v_mov_b32 v6, 0
    buffer_store_dword v6, v5, s[40:43], s70 offen sc1
    s_waitcnt vmcnt(0)
    s_barrier
    v_mov_b32 v6, 1
    buffer_atomic_add v6, v5, s[60:63], 0 offen sc1
    s_mul_i32 s7, s3, 640
    s_add_u32 s7, s7, 0
    v_add_u32 v6, s7, v0
    v_mul_u32_u24 v7, 1639, v6
    v_lshrrev_b32 v7, 17, v7
    v_mul_u32_u24 v8, 80, v7
    v_sub_u32 v8, v6, v8
    v_and_b32 v6, 7, v7
    v_lshlrev_b32 v6, 1, v6
    v_xor_b32 v8, v8, v6
    v_mul_u32_u24 v7, 1280, v7
    v_lshl_add_u32 v14, v8, 4, v7
    s_mul_i32 s7, s3, 640
    s_add_u32 s7, s7, 64
    v_add_u32 v6, s7, v0
    v_mul_u32_u24 v7, 1639, v6
    v_lshrrev_b32 v7, 17, v7
    v_mul_u32_u24 v8, 80, v7
    v_sub_u32 v8, v6, v8
    v_and_b32 v6, 7, v7
    v_lshlrev_b32 v6, 1, v6
    v_xor_b32 v8, v8, v6
    v_mul_u32_u24 v7, 1280, v7
    v_lshl_add_u32 v15, v8, 4, v7
    s_mul_i32 s7, s3, 640
    s_add_u32 s7, s7, 128
    v_add_u32 v6, s7, v0
    v_mul_u32_u24 v7, 1639, v6
    v_lshrrev_b32 v7, 17, v7
    v_mul_u32_u24 v8, 80, v7
    v_sub_u32 v8, v6, v8
    v_and_b32 v6, 7, v7
    v_lshlrev_b32 v6, 1, v6
    v_xor_b32 v8, v8, v6
    v_mul_u32_u24 v7, 1280, v7
    v_lshl_add_u32 v16, v8, 4, v7
    s_mul_i32 s7, s3, 640
    s_add_u32 s7, s7, 192
    v_add_u32 v6, s7, v0
    v_mul_u32_u24 v7, 1639, v6
    v_lshrrev_b32 v7, 17, v7
    v_mul_u32_u24 v8, 80, v7
    v_sub_u32 v8, v6, v8
    v_and_b32 v6, 7, v7
    v_lshlrev_b32 v6, 1, v6
    v_xor_b32 v8, v8, v6
    v_mul_u32_u24 v7, 1280, v7
    v_lshl_add_u32 v17, v8, 4, v7
    s_mul_i32 s7, s3, 640
    s_add_u32 s7, s7, 256
    v_add_u32 v6, s7, v0
    v_mul_u32_u24 v7, 1639, v6
    v_lshrrev_b32 v7, 17, v7
    v_mul_u32_u24 v8, 80, v7
    v_sub_u32 v8, v6, v8
    v_and_b32 v6, 7, v7
    v_lshlrev_b32 v6, 1, v6
    v_xor_b32 v8, v8, v6
    v_mul_u32_u24 v7, 1280, v7
    v_lshl_add_u32 v18, v8, 4, v7
    s_mul_i32 s7, s3, 640
    s_add_u32 s7, s7, 320
    v_add_u32 v6, s7, v0
    v_mul_u32_u24 v7, 1639, v6
    v_lshrrev_b32 v7, 17, v7
    v_mul_u32_u24 v8, 80, v7
    v_sub_u32 v8, v6, v8
    v_and_b32 v6, 7, v7
    v_lshlrev_b32 v6, 1, v6
    v_xor_b32 v8, v8, v6
    v_mul_u32_u24 v7, 1280, v7
    v_lshl_add_u32 v19, v8, 4, v7
    s_mul_i32 s7, s3, 640
    s_add_u32 s7, s7, 384
    v_add_u32 v6, s7, v0
    v_mul_u32_u24 v7, 1639, v6
    v_lshrrev_b32 v7, 17, v7
    v_mul_u32_u24 v8, 80, v7
    v_sub_u32 v8, v6, v8
    v_and_b32 v6, 7, v7
    v_lshlrev_b32 v6, 1, v6
    v_xor_b32 v8, v8, v6
    v_mul_u32_u24 v7, 1280, v7
    v_lshl_add_u32 v20, v8, 4, v7
    s_mul_i32 s7, s3, 640
    s_add_u32 s7, s7, 448
    v_add_u32 v6, s7, v0
    v_mul_u32_u24 v7, 1639, v6
    v_lshrrev_b32 v7, 17, v7
    v_mul_u32_u24 v8, 80, v7
    v_sub_u32 v8, v6, v8
    v_and_b32 v6, 7, v7
    v_lshlrev_b32 v6, 1, v6
    v_xor_b32 v8, v8, v6
    v_mul_u32_u24 v7, 1280, v7
    v_lshl_add_u32 v21, v8, 4, v7
    s_mul_i32 s7, s3, 640
    s_add_u32 s7, s7, 512
    v_add_u32 v6, s7, v0
    v_mul_u32_u24 v7, 1639, v6
    v_lshrrev_b32 v7, 17, v7
    v_mul_u32_u24 v8, 80, v7
    v_sub_u32 v8, v6, v8
    v_and_b32 v6, 7, v7
    v_lshlrev_b32 v6, 1, v6
    v_xor_b32 v8, v8, v6
    v_mul_u32_u24 v7, 1280, v7
    v_lshl_add_u32 v22, v8, 4, v7
    s_mul_i32 s7, s3, 640
    s_add_u32 s7, s7, 576
    v_add_u32 v6, s7, v0
    v_mul_u32_u24 v7, 1639, v6
    v_lshrrev_b32 v7, 17, v7
    v_mul_u32_u24 v8, 80, v7
    v_sub_u32 v8, v6, v8
    v_and_b32 v6, 7, v7
    v_lshlrev_b32 v6, 1, v6
    v_xor_b32 v8, v8, v6
    v_mul_u32_u24 v7, 1280, v7
    v_lshl_add_u32 v23, v8, 4, v7
    s_mul_i32 s76, s3, 10240
    s_mov_b32 s74, 0
    s_add_u32 m0, s76, 0
    s_nop 0
    buffer_load_dwordx4 v14, s[44:47], s74 offen lds
    s_add_u32 m0, s76, 1024
    s_nop 0
    buffer_load_dwordx4 v15, s[44:47], s74 offen lds
    s_add_u32 m0, s76, 2048
    s_nop 0
    buffer_load_dwordx4 v16, s[44:47], s74 offen lds
    s_add_u32 m0, s76, 3072
    s_nop 0
    buffer_load_dwordx4 v17, s[44:47], s74 offen lds
    s_add_u32 m0, s76, 4096
    s_nop 0
    buffer_load_dwordx4 v18, s[44:47], s74 offen lds
    s_add_u32 m0, s76, 5120
    s_nop 0
    buffer_load_dwordx4 v19, s[44:47], s74 offen lds
    s_add_u32 m0, s76, 6144
    s_nop 0
    buffer_load_dwordx4 v20, s[44:47], s74 offen lds
    s_add_u32 m0, s76, 7168
    s_nop 0
    buffer_load_dwordx4 v21, s[44:47], s74 offen lds
    s_add_u32 m0, s76, 8192
    s_nop 0
    buffer_load_dwordx4 v22, s[44:47], s74 offen lds
    s_add_u32 m0, s76, 9216
    s_nop 0
    buffer_load_dwordx4 v23, s[44:47], s74 offen lds
    v_and_b32 v6, 7, v1
    v_lshlrev_b32 v6, 1, v6
    v_add_u32 v7, 0, v2
    v_xor_b32 v7, v7, v6
    v_mul_u32_u24 v6, 1280, v1
    v_lshl_add_u32 v24, v7, 4, v6
    v_and_b32 v6, 7, v1
    v_lshlrev_b32 v6, 1, v6
    v_add_u32 v7, 4, v2
    v_xor_b32 v7, v7, v6
    v_mul_u32_u24 v6, 1280, v1
    v_lshl_add_u32 v25, v7, 4, v6
    v_and_b32 v6, 7, v1
    v_lshlrev_b32 v6, 1, v6
    v_add_u32 v7, 8, v2
    v_xor_b32 v7, v7, v6
    v_mul_u32_u24 v6, 1280, v1
    v_lshl_add_u32 v26, v7, 4, v6
    v_and_b32 v6, 7, v1
    v_lshlrev_b32 v6, 1, v6
    v_add_u32 v7, 12, v2
    v_xor_b32 v7, v7, v6
    v_mul_u32_u24 v6, 1280, v1
    v_lshl_add_u32 v27, v7, 4, v6
    s_cmp_ge_u32 s4, 24
    s_cbranch_scc1 L_ng_2
L_ng_2:
    s_mul_i32 s72, s3, 30720
    s_add_u32 s72, s72, 40960
    v_lshl_add_u32 v8, v2, 3, v3
    v_lshrrev_b32 v6, 3, v0
    v_and_b32 v7, 7, v0
    v_mul_u32_u24 v6, 12288, v6
    v_lshl_add_u32 v9, v7, 4, v6
    v_add_u32 v10, 98304, v9
    v_add_u32 v11, 196608, v9
    v_add_u32 v12, 294912, v9
    s_mul_i32 s73, s80, 384
    s_lshl_b32 s7, s81, 7
    s_add_u32 s73, s73, s7
    v_lshlrev_b32 v6, 7, v8
    v_lshl_add_u32 v13, v4, 3, v6
    v_add_u32 v13, s72, v13
    s_add_u32 m0, s72, 0
    s_nop 0
    buffer_load_dwordx4 v9, s[48:51], s73 offen lds
    s_add_u32 m0, s72, 1024
    s_nop 0
    buffer_load_dwordx4 v10, s[48:51], s73 offen lds
    s_add_u32 m0, s72, 2048
    s_nop 0
    buffer_load_dwordx4 v11, s[48:51], s73 offen lds
    s_add_u32 m0, s72, 3072
    s_nop 0
    buffer_load_dwordx4 v12, s[48:51], s73 offen lds
    s_add_u32 s73, s73, 393216
    s_add_u32 m0, s72, 4096
    s_nop 0
    buffer_load_dwordx4 v9, s[48:51], s73 offen lds
    s_add_u32 m0, s72, 5120
    s_nop 0
    buffer_load_dwordx4 v10, s[48:51], s73 offen lds
    s_add_u32 m0, s72, 6144
    s_nop 0
    buffer_load_dwordx4 v11, s[48:51], s73 offen lds
    s_add_u32 m0, s72, 7168
    s_nop 0
    buffer_load_dwordx4 v12, s[48:51], s73 offen lds
    s_add_u32 s73, s73, 393216
    s_add_u32 m0, s72, 8192
    s_nop 0
    buffer_load_dwordx4 v9, s[48:51], s73 offen lds
    s_add_u32 m0, s72, 9216
    s_nop 0
    buffer_load_dwordx4 v10, s[48:51], s73 offen lds
    s_add_u32 m0, s72, 10240
    s_nop 0
    buffer_load_dwordx4 v11, s[48:51], s73 offen lds
    s_add_u32 m0, s72, 11264
    s_nop 0
    buffer_load_dwordx4 v12, s[48:51], s73 offen lds
    s_add_u32 s73, s73, 393216
    s_add_u32 m0, s72, 12288
    s_nop 0
    buffer_load_dwordx4 v9, s[48:51], s73 offen lds
    s_add_u32 m0, s72, 13312
    s_nop 0
    buffer_load_dwordx4 v10, s[48:51], s73 offen lds
    s_add_u32 m0, s72, 14336
    s_nop 0
    buffer_load_dwordx4 v11, s[48:51], s73 offen lds
    s_add_u32 m0, s72, 15360
    s_nop 0
    buffer_load_dwordx4 v12, s[48:51], s73 offen lds
    s_add_u32 s73, s73, 393216
    s_add_u32 m0, s72, 16384
    s_nop 0
    buffer_load_dwordx4 v9, s[48:51], s73 offen lds
    s_add_u32 m0, s72, 17408
    s_nop 0
    buffer_load_dwordx4 v10, s[48:51], s73 offen lds
    s_add_u32 m0, s72, 18432
    s_nop 0
    buffer_load_dwordx4 v11, s[48:51], s73 offen lds
    s_add_u32 m0, s72, 19456
    s_nop 0
    buffer_load_dwordx4 v12, s[48:51], s73 offen lds
    s_add_u32 s73, s73, 393216
    s_add_u32 m0, s72, 20480
    s_nop 0
    buffer_load_dwordx4 v9, s[48:51], s73 offen lds
    s_add_u32 m0, s72, 21504
    s_nop 0
    buffer_load_dwordx4 v10, s[48:51], s73 offen lds
    s_add_u32 m0, s72, 22528
    s_nop 0
    buffer_load_dwordx4 v11, s[48:51], s73 offen lds
    s_add_u32 m0, s72, 23552
    s_nop 0
    buffer_load_dwordx4 v12, s[48:51], s73 offen lds
    s_add_u32 s73, s73, 393216
    s_add_u32 m0, s72, 24576
    s_nop 0
    buffer_load_dwordx4 v9, s[48:51], s73 offen lds
    s_add_u32 m0, s72, 25600
    s_nop 0
    buffer_load_dwordx4 v10, s[48:51], s73 offen lds
    s_add_u32 m0, s72, 26624
    s_nop 0
    buffer_load_dwordx4 v11, s[48:51], s73 offen lds
    s_add_u32 m0, s72, 27648
    s_nop 0
    buffer_load_dwordx4 v12, s[48:51], s73 offen lds
    s_add_u32 s73, s73, 393216
    s_waitcnt vmcnt(24)
    ds_read_b64_tr_b16 a[0:1], v13 offset:0
    ds_read_b64_tr_b16 a[2:3], v13 offset:512
    ds_read_b64_tr_b16 a[4:5], v13 offset:32
    ds_read_b64_tr_b16 a[6:7], v13 offset:544
    ds_read_b64_tr_b16 a[8:9], v13 offset:64
    ds_read_b64_tr_b16 a[10:11], v13 offset:576
    ds_read_b64_tr_b16 a[12:13], v13 offset:96
    ds_read_b64_tr_b16 a[14:15], v13 offset:608
    s_waitcnt lgkmcnt(0)
    s_add_u32 m0, s72, 0
    s_nop 0
    buffer_load_dwordx4 v9, s[48:51], s73 offen lds
    s_add_u32 m0, s72, 1024
    s_nop 0
    buffer_load_dwordx4 v10, s[48:51], s73 offen lds
    s_add_u32 m0, s72, 2048
    s_nop 0
    buffer_load_dwordx4 v11, s[48:51], s73 offen lds
    s_add_u32 m0, s72, 3072
    s_nop 0
    buffer_load_dwordx4 v12, s[48:51], s73 offen lds
    s_add_u32 s73, s73, 393216
    s_waitcnt vmcnt(24)
    ds_read_b64_tr_b16 a[16:17], v13 offset:4096
    ds_read_b64_tr_b16 a[18:19], v13 offset:4608
    ds_read_b64_tr_b16 a[20:21], v13 offset:4128
    ds_read_b64_tr_b16 a[22:23], v13 offset:4640
    ds_read_b64_tr_b16 a[24:25], v13 offset:4160
    ds_read_b64_tr_b16 a[26:27], v13 offset:4672
    ds_read_b64_tr_b16 a[28:29], v13 offset:4192
    ds_read_b64_tr_b16 a[30:31], v13 offset:4704
    s_waitcnt lgkmcnt(0)
    s_add_u32 m0, s72, 4096
    s_nop 0
    buffer_load_dwordx4 v9, s[48:51], s73 offen lds
    s_add_u32 m0, s72, 5120
    s_nop 0
    buffer_load_dwordx4 v10, s[48:51], s73 offen lds
    s_add_u32 m0, s72, 6144
    s_nop 0
    buffer_load_dwordx4 v11, s[48:51], s73 offen lds
    s_add_u32 m0, s72, 7168
    s_nop 0
    buffer_load_dwordx4 v12, s[48:51], s73 offen lds
    s_add_u32 s73, s73, 393216
    s_waitcnt vmcnt(24)
    ds_read_b64_tr_b16 a[32:33], v13 offset:8192
    ds_read_b64_tr_b16 a[34:35], v13 offset:8704
    ds_read_b64_tr_b16 a[36:37], v13 offset:8224
    ds_read_b64_tr_b16 a[38:39], v13 offset:8736
    ds_read_b64_tr_b16 a[40:41], v13 offset:8256
    ds_read_b64_tr_b16 a[42:43], v13 offset:8768
    ds_read_b64_tr_b16 a[44:45], v13 offset:8288
    ds_read_b64_tr_b16 a[46:47], v13 offset:8800
    s_waitcnt lgkmcnt(0)
    s_add_u32 m0, s72, 8192
    s_nop 0
    buffer_load_dwordx4 v9, s[48:51], s73 offen lds
    s_add_u32 m0, s72, 9216
    s_nop 0
    buffer_load_dwordx4 v10, s[48:51], s73 offen lds
    s_add_u32 m0, s72, 10240
    s_nop 0
    buffer_load_dwordx4 v11, s[48:51], s73 offen lds
    s_add_u32 m0, s72, 11264
    s_nop 0
    buffer_load_dwordx4 v12, s[48:51], s73 offen lds
    s_add_u32 s73, s73, 393216
    s_waitcnt vmcnt(24)
    ds_read_b64_tr_b16 a[48:49], v13 offset:12288
    ds_read_b64_tr_b16 a[50:51], v13 offset:12800
    ds_read_b64_tr_b16 a[52:53], v13 offset:12320
    ds_read_b64_tr_b16 a[54:55], v13 offset:12832
    ds_read_b64_tr_b16 a[56:57], v13 offset:12352
    ds_read_b64_tr_b16 a[58:59], v13 offset:12864
    ds_read_b64_tr_b16 a[60:61], v13 offset:12384
    ds_read_b64_tr_b16 a[62:63], v13 offset:12896
    s_waitcnt lgkmcnt(0)
    s_add_u32 m0, s72, 12288
    s_nop 0
    buffer_load_dwordx4 v9, s[48:51], s73 offen lds
    s_add_u32 m0, s72, 13312
    s_nop 0
    buffer_load_dwordx4 v10, s[48:51], s73 offen lds
    s_add_u32 m0, s72, 14336
    s_nop 0
    buffer_load_dwordx4 v11, s[48:51], s73 offen lds
    s_add_u32 m0, s72, 15360
    s_nop 0
    buffer_load_dwordx4 v12, s[48:51], s73 offen lds
    s_add_u32 s73, s73, 393216
    s_waitcnt vmcnt(24)
    ds_read_b64_tr_b16 a[64:65], v13 offset:16384
    ds_read_b64_tr_b16 a[66:67], v13 offset:16896
    ds_read_b64_tr_b16 a[68:69], v13 offset:16416
    ds_read_b64_tr_b16 a[70:71], v13 offset:16928
    ds_read_b64_tr_b16 a[72:73], v13 offset:16448
    ds_read_b64_tr_b16 a[74:75], v13 offset:16960
    ds_read_b64_tr_b16 a[76:77], v13 offset:16480
    ds_read_b64_tr_b16 a[78:79], v13 offset:16992
    s_waitcnt lgkmcnt(0)
    s_add_u32 m0, s72, 16384
    s_nop 0
    buffer_load_dwordx4 v9, s[48:51], s73 offen lds
    s_add_u32 m0, s72, 17408
    s_nop 0
    buffer_load_dwordx4 v10, s[48:51], s73 offen lds
    s_add_u32 m0, s72, 18432
    s_nop 0
    buffer_load_dwordx4 v11, s[48:51], s73 offen lds
    s_add_u32 m0, s72, 19456
    s_nop 0
    buffer_load_dwordx4 v12, s[48:51], s73 offen lds
    s_add_u32 s73, s73, 393216
    s_waitcnt vmcnt(24)
    ds_read_b64_tr_b16 a[80:81], v13 offset:20480
    ds_read_b64_tr_b16 a[82:83], v13 offset:20992
    ds_read_b64_tr_b16 a[84:85], v13 offset:20512
    ds_read_b64_tr_b16 a[86:87], v13 offset:21024
    ds_read_b64_tr_b16 a[88:89], v13 offset:20544
    ds_read_b64_tr_b16 a[90:91], v13 offset:21056
    ds_read_b64_tr_b16 a[92:93], v13 offset:20576
    ds_read_b64_tr_b16 a[94:95], v13 offset:21088
    s_waitcnt lgkmcnt(0)
    s_add_u32 m0, s72, 20480
    s_nop 0
    buffer_load_dwordx4 v9, s[48:51], s73 offen lds
    s_add_u32 m0, s72, 21504
    s_nop 0
    buffer_load_dwordx4 v10, s[48:51], s73 offen lds
    s_add_u32 m0, s72, 22528
    s_nop 0
    buffer_load_dwordx4 v11, s[48:51], s73 offen lds
    s_add_u32 m0, s72, 23552
    s_nop 0
    buffer_load_dwordx4 v12, s[48:51], s73 offen lds
    s_add_u32 s73, s73, 393216
    s_waitcnt vmcnt(24)
    ds_read_b64_tr_b16 a[96:97], v13 offset:24576
    ds_read_b64_tr_b16 a[98:99], v13 offset:25088
    ds_read_b64_tr_b16 a[100:101], v13 offset:24608
    ds_read_b64_tr_b16 a[102:103], v13 offset:25120
    ds_read_b64_tr_b16 a[104:105], v13 offset:24640
    ds_read_b64_tr_b16 a[106:107], v13 offset:25152
    ds_read_b64_tr_b16 a[108:109], v13 offset:24672
    ds_read_b64_tr_b16 a[110:111], v13 offset:25184
    s_waitcnt lgkmcnt(0)
    s_add_u32 m0, s72, 24576
    s_nop 0
    buffer_load_dwordx4 v9, s[48:51], s73 offen lds
    s_add_u32 m0, s72, 25600
    s_nop 0
    buffer_load_dwordx4 v10, s[48:51], s73 offen lds
    s_add_u32 m0, s72, 26624
    s_nop 0
    buffer_load_dwordx4 v11, s[48:51], s73 offen lds
    s_add_u32 m0, s72, 27648
    s_nop 0
    buffer_load_dwordx4 v12, s[48:51], s73 offen lds
    s_add_u32 s73, s73, 393216
    s_waitcnt vmcnt(24)
    ds_read_b64_tr_b16 a[112:113], v13 offset:0
    ds_read_b64_tr_b16 a[114:115], v13 offset:512
    ds_read_b64_tr_b16 a[116:117], v13 offset:32
    ds_read_b64_tr_b16 a[118:119], v13 offset:544
    ds_read_b64_tr_b16 a[120:121], v13 offset:64
    ds_read_b64_tr_b16 a[122:123], v13 offset:576
    ds_read_b64_tr_b16 a[124:125], v13 offset:96
    ds_read_b64_tr_b16 a[126:127], v13 offset:608
    s_waitcnt lgkmcnt(0)
    s_add_u32 m0, s72, 0
    s_nop 0
    buffer_load_dwordx4 v9, s[48:51], s73 offen lds
    s_add_u32 m0, s72, 1024
    s_nop 0
    buffer_load_dwordx4 v10, s[48:51], s73 offen lds
    s_add_u32 m0, s72, 2048
    s_nop 0
    buffer_load_dwordx4 v11, s[48:51], s73 offen lds
    s_add_u32 m0, s72, 3072
    s_nop 0
    buffer_load_dwordx4 v12, s[48:51], s73 offen lds
    s_add_u32 s73, s73, 393216
    s_waitcnt vmcnt(24)
    ds_read_b64_tr_b16 a[128:129], v13 offset:4096
    ds_read_b64_tr_b16 a[130:131], v13 offset:4608
    ds_read_b64_tr_b16 a[132:133], v13 offset:4128
    ds_read_b64_tr_b16 a[134:135], v13 offset:4640
    ds_read_b64_tr_b16 a[136:137], v13 offset:4160
    ds_read_b64_tr_b16 a[138:139], v13 offset:4672
    ds_read_b64_tr_b16 a[140:141], v13 offset:4192
    ds_read_b64_tr_b16 a[142:143], v13 offset:4704
    s_waitcnt lgkmcnt(0)
    s_add_u32 m0, s72, 4096
    s_nop 0
    buffer_load_dwordx4 v9, s[48:51], s73 offen lds
    s_add_u32 m0, s72, 5120
    s_nop 0
    buffer_load_dwordx4 v10, s[48:51], s73 offen lds
    s_add_u32 m0, s72, 6144
    s_nop 0
    buffer_load_dwordx4 v11, s[48:51], s73 offen lds
    s_add_u32 m0, s72, 7168
    s_nop 0
    buffer_load_dwordx4 v12, s[48:51], s73 offen lds
    s_add_u32 s73, s73, 393216
    s_waitcnt vmcnt(24)
    ds_read_b64_tr_b16 a[144:145], v13 offset:8192
    ds_read_b64_tr_b16 a[146:147], v13 offset:8704
    ds_read_b64_tr_b16 a[148:149], v13 offset:8224
    ds_read_b64_tr_b16 a[150:151], v13 offset:8736
    ds_read_b64_tr_b16 a[152:153], v13 offset:8256
    ds_read_b64_tr_b16 a[154:155], v13 offset:8768
    ds_read_b64_tr_b16 a[156:157], v13 offset:8288
    ds_read_b64_tr_b16 a[158:159], v13 offset:8800
    s_waitcnt lgkmcnt(0)
    s_add_u32 m0, s72, 8192
    s_nop 0
    buffer_load_dwordx4 v9, s[48:51], s73 offen lds
    s_add_u32 m0, s72, 9216
    s_nop 0
    buffer_load_dwordx4 v10, s[48:51], s73 offen lds
    s_add_u32 m0, s72, 10240
    s_nop 0
    buffer_load_dwordx4 v11, s[48:51], s73 offen lds
    s_add_u32 m0, s72, 11264
    s_nop 0
    buffer_load_dwordx4 v12, s[48:51], s73 offen lds
    s_add_u32 s73, s73, 393216
    s_waitcnt vmcnt(24)
    ds_read_b64_tr_b16 a[160:161], v13 offset:12288
    ds_read_b64_tr_b16 a[162:163], v13 offset:12800
    ds_read_b64_tr_b16 a[164:165], v13 offset:12320
    ds_read_b64_tr_b16 a[166:167], v13 offset:12832
    ds_read_b64_tr_b16 a[168:169], v13 offset:12352
    ds_read_b64_tr_b16 a[170:171], v13 offset:12864
    ds_read_b64_tr_b16 a[172:173], v13 offset:12384
    ds_read_b64_tr_b16 a[174:175], v13 offset:12896
    s_waitcnt lgkmcnt(0)
    s_add_u32 m0, s72, 12288
    s_nop 0
    buffer_load_dwordx4 v9, s[48:51], s73 offen lds
    s_add_u32 m0, s72, 13312
    s_nop 0
    buffer_load_dwordx4 v10, s[48:51], s73 offen lds
    s_add_u32 m0, s72, 14336
    s_nop 0
    buffer_load_dwordx4 v11, s[48:51], s73 offen lds
    s_add_u32 m0, s72, 15360
    s_nop 0
    buffer_load_dwordx4 v12, s[48:51], s73 offen lds
    s_add_u32 s73, s73, 393216
    s_waitcnt vmcnt(24)
    ds_read_b64_tr_b16 a[176:177], v13 offset:16384
    ds_read_b64_tr_b16 a[178:179], v13 offset:16896
    ds_read_b64_tr_b16 a[180:181], v13 offset:16416
    ds_read_b64_tr_b16 a[182:183], v13 offset:16928
    ds_read_b64_tr_b16 a[184:185], v13 offset:16448
    ds_read_b64_tr_b16 a[186:187], v13 offset:16960
    ds_read_b64_tr_b16 a[188:189], v13 offset:16480
    ds_read_b64_tr_b16 a[190:191], v13 offset:16992
    s_waitcnt lgkmcnt(0)
    s_add_u32 m0, s72, 16384
    s_nop 0
    buffer_load_dwordx4 v9, s[48:51], s73 offen lds
    s_add_u32 m0, s72, 17408
    s_nop 0
    buffer_load_dwordx4 v10, s[48:51], s73 offen lds
    s_add_u32 m0, s72, 18432
    s_nop 0
    buffer_load_dwordx4 v11, s[48:51], s73 offen lds
    s_add_u32 m0, s72, 19456
    s_nop 0
    buffer_load_dwordx4 v12, s[48:51], s73 offen lds
    s_add_u32 s73, s73, 393216
    s_waitcnt vmcnt(24)
    ds_read_b64_tr_b16 a[192:193], v13 offset:20480
    ds_read_b64_tr_b16 a[194:195], v13 offset:20992
    ds_read_b64_tr_b16 a[196:197], v13 offset:20512
    ds_read_b64_tr_b16 a[198:199], v13 offset:21024
    ds_read_b64_tr_b16 a[200:201], v13 offset:20544
    ds_read_b64_tr_b16 a[202:203], v13 offset:21056
    ds_read_b64_tr_b16 a[204:205], v13 offset:20576
    ds_read_b64_tr_b16 a[206:207], v13 offset:21088
    s_waitcnt lgkmcnt(0)
    s_add_u32 m0, s72, 20480
    s_nop 0
    buffer_load_dwordx4 v9, s[48:51], s73 offen lds
    s_add_u32 m0, s72, 21504
    s_nop 0
    buffer_load_dwordx4 v10, s[48:51], s73 offen lds
    s_add_u32 m0, s72, 22528
    s_nop 0
    buffer_load_dwordx4 v11, s[48:51], s73 offen lds
    s_add_u32 m0, s72, 23552
    s_nop 0
    buffer_load_dwordx4 v12, s[48:51], s73 offen lds
    s_add_u32 s73, s73, 393216
    s_waitcnt vmcnt(24)
    ds_read_b64_tr_b16 a[208:209], v13 offset:24576
    ds_read_b64_tr_b16 a[210:211], v13 offset:25088
    ds_read_b64_tr_b16 a[212:213], v13 offset:24608
    ds_read_b64_tr_b16 a[214:215], v13 offset:25120
    ds_read_b64_tr_b16 a[216:217], v13 offset:24640
    ds_read_b64_tr_b16 a[218:219], v13 offset:25152
    ds_read_b64_tr_b16 a[220:221], v13 offset:24672
    ds_read_b64_tr_b16 a[222:223], v13 offset:25184
    s_waitcnt vmcnt(20)
    ds_read_b64_tr_b16 a[224:225], v13 offset:0
    ds_read_b64_tr_b16 a[226:227], v13 offset:512
    ds_read_b64_tr_b16 a[228:229], v13 offset:32
    ds_read_b64_tr_b16 a[230:231], v13 offset:544
    ds_read_b64_tr_b16 a[232:233], v13 offset:64
    ds_read_b64_tr_b16 a[234:235], v13 offset:576
    ds_read_b64_tr_b16 a[236:237], v13 offset:96
    ds_read_b64_tr_b16 a[238:239], v13 offset:608
    s_waitcnt vmcnt(16)
    ds_read_b64_tr_b16 a[240:241], v13 offset:4096
    ds_read_b64_tr_b16 a[242:243], v13 offset:4608
    ds_read_b64_tr_b16 a[244:245], v13 offset:4128
    ds_read_b64_tr_b16 a[246:247], v13 offset:4640
    ds_read_b64_tr_b16 a[248:249], v13 offset:4160
    ds_read_b64_tr_b16 a[250:251], v13 offset:4672
    ds_read_b64_tr_b16 a[252:253], v13 offset:4192
    ds_read_b64_tr_b16 a[254:255], v13 offset:4704
    s_waitcnt vmcnt(12)
    ds_read_b64_tr_b16 v[192:193], v13 offset:8192
    ds_read_b64_tr_b16 v[194:195], v13 offset:8704
    ds_read_b64_tr_b16 v[196:197], v13 offset:8224
    ds_read_b64_tr_b16 v[198:199], v13 offset:8736
    ds_read_b64_tr_b16 v[200:201], v13 offset:8256
    ds_read_b64_tr_b16 v[202:203], v13 offset:8768
    ds_read_b64_tr_b16 v[204:205], v13 offset:8288
    ds_read_b64_tr_b16 v[206:207], v13 offset:8800
    s_waitcnt vmcnt(8)
    ds_read_b64_tr_b16 v[208:209], v13 offset:12288
    ds_read_b64_tr_b16 v[210:211], v13 offset:12800
    ds_read_b64_tr_b16 v[212:213], v13 offset:12320
    ds_read_b64_tr_b16 v[214:215], v13 offset:12832
    ds_read_b64_tr_b16 v[216:217], v13 offset:12352
    ds_read_b64_tr_b16 v[218:219], v13 offset:12864
    ds_read_b64_tr_b16 v[220:221], v13 offset:12384
    ds_read_b64_tr_b16 v[222:223], v13 offset:12896
    s_waitcnt vmcnt(4)
    ds_read_b64_tr_b16 v[224:225], v13 offset:16384
    ds_read_b64_tr_b16 v[226:227], v13 offset:16896
    ds_read_b64_tr_b16 v[228:229], v13 offset:16416
    ds_read_b64_tr_b16 v[230:231], v13 offset:16928
    ds_read_b64_tr_b16 v[232:233], v13 offset:16448
    ds_read_b64_tr_b16 v[234:235], v13 offset:16960
    ds_read_b64_tr_b16 v[236:237], v13 offset:16480
    ds_read_b64_tr_b16 v[238:239], v13 offset:16992
    s_waitcnt vmcnt(0)
    ds_read_b64_tr_b16 v[240:241], v13 offset:20480
    ds_read_b64_tr_b16 v[242:243], v13 offset:20992
    ds_read_b64_tr_b16 v[244:245], v13 offset:20512
    ds_read_b64_tr_b16 v[246:247], v13 offset:21024
    ds_read_b64_tr_b16 v[248:249], v13 offset:20544
    ds_read_b64_tr_b16 v[250:251], v13 offset:21056
    ds_read_b64_tr_b16 v[252:253], v13 offset:20576
    ds_read_b64_tr_b16 v[254:255], v13 offset:21088
    s_waitcnt lgkmcnt(0)
    s_mul_i32 s7, s80, 12288
    s_add_u32 s71, s71, s7
    s_lshl_b32 s7, s81, 12
    s_add_u32 s71, s71, s7
    v_lshlrev_b32 v28, 4, v0
    s_mov_b32 s75, 0
    s_mov_b32 s85, 40960
    s_waitcnt vmcnt(0)
    s_barrier
    s_add_u32 s76, s76, 40960
    s_add_u32 s74, s74, 40960
    s_add_u32 m0, s76, 0
    s_nop 0
    buffer_load_dwordx4 v14, s[44:47], s74 offen lds
    s_add_u32 m0, s76, 1024
    s_nop 0
    buffer_load_dwordx4 v15, s[44:47], s74 offen lds
    s_add_u32 m0, s76, 2048
    s_nop 0
    buffer_load_dwordx4 v16, s[44:47], s74 offen lds
    s_add_u32 m0, s76, 3072
    s_nop 0
    buffer_load_dwordx4 v17, s[44:47], s74 offen lds
    s_add_u32 m0, s76, 4096
    s_nop 0
    buffer_load_dwordx4 v18, s[44:47], s74 offen lds
    s_add_u32 m0, s76, 5120
    s_nop 0
    buffer_load_dwordx4 v19, s[44:47], s74 offen lds
    s_add_u32 m0, s76, 6144
    s_nop 0
    buffer_load_dwordx4 v20, s[44:47], s74 offen lds
    s_add_u32 m0, s76, 7168
    s_nop 0
    buffer_load_dwordx4 v21, s[44:47], s74 offen lds
    s_add_u32 m0, s76, 8192
    s_nop 0
    buffer_load_dwordx4 v22, s[44:47], s74 offen lds
    s_add_u32 m0, s76, 9216
    s_nop 0
    buffer_load_dwordx4 v23, s[44:47], s74 offen lds
    s_mov_b32 s89, 0x40000000
.p2align 6
L_ba_loop_3:
    s_cmp_eq_u32 s75, 1
    s_cselect_b32 s7, -81920, s85
    s_add_u32 s76, s76, s7
    s_add_u32 s74, s74, 40960
    ds_read_b128 v[72:75], v24 offset:0
    ds_read_b128 v[76:79], v24 offset:20480
    ds_read_b128 v[80:83], v25 offset:0
    ds_read_b128 v[84:87], v25 offset:20480
    ds_read_b128 v[88:91], v26 offset:0
    ds_read_b128 v[92:95], v26 offset:20480
    ds_read_b128 v[96:99], v27 offset:0
    ds_read_b128 v[100:103], v27 offset:20480
    s_waitcnt lgkmcnt(6)
    v_mfma_f32_16x16x32_bf16 v[32:35], a[0:3], v[72:75], 0
    v_cvt_pk_bf16_f32 v136, v104, v105
    v_mfma_f32_16x16x32_bf16 v[36:39], a[0:3], v[76:79], 0
    v_cvt_pk_bf16_f32 v137, v106, v107
    v_mfma_f32_16x16x32_bf16 v[40:43], a[4:7], v[72:75], 0
    v_cvt_pk_bf16_f32 v138, v112, v113
    v_mfma_f32_16x16x32_bf16 v[44:47], a[4:7], v[76:79], 0
    v_cvt_pk_bf16_f32 v139, v114, v115
    v_mfma_f32_16x16x32_bf16 v[48:51], a[8:11], v[72:75], 0
    buffer_store_dwordx4 v[136:139], v28, s[40:43], s89 offen offset:0 sc1
    v_mfma_f32_16x16x32_bf16 v[52:55], a[8:11], v[76:79], 0
    v_cvt_pk_bf16_f32 v140, v108, v109
    v_mfma_f32_16x16x32_bf16 v[56:59], a[12:15], v[72:75], 0
    v_cvt_pk_bf16_f32 v141, v110, v111
    v_mfma_f32_16x16x32_bf16 v[60:63], a[12:15], v[76:79], 0
    v_cvt_pk_bf16_f32 v142, v116, v117
    ds_read_b128 v[72:75], v24 offset:256
    ds_read_b128 v[76:79], v24 offset:20736
    s_waitcnt lgkmcnt(6)
    v_mfma_f32_16x16x32_bf16 v[32:35], a[16:19], v[80:83], v[32:35]
    v_cvt_pk_bf16_f32 v143, v118, v119
    v_mfma_f32_16x16x32_bf16 v[36:39], a[16:19], v[84:87], v[36:39]
    buffer_store_dwordx4 v[140:143], v28, s[40:43], s89 offen offset:1024 sc1
    v_mfma_f32_16x16x32_bf16 v[40:43], a[20:23], v[80:83], v[40:43]
    v_cvt_pk_bf16_f32 v144, v120, v121
    v_mfma_f32_16x16x32_bf16 v[44:47], a[20:23], v[84:87], v[44:47]
    v_cvt_pk_bf16_f32 v145, v122, v123
    v_mfma_f32_16x16x32_bf16 v[48:51], a[24:27], v[80:83], v[48:51]
    v_cvt_pk_bf16_f32 v146, v128, v129
    v_mfma_f32_16x16x32_bf16 v[52:55], a[24:27], v[84:87], v[52:55]
    v_cvt_pk_bf16_f32 v147, v130, v131
    v_mfma_f32_16x16x32_bf16 v[56:59], a[28:31], v[80:83], v[56:59]
    buffer_store_dwordx4 v[144:147], v28, s[40:43], s89 offen offset:2048 sc1
    v_mfma_f32_16x16x32_bf16 v[60:63], a[28:31], v[84:87], v[60:63]
    v_cvt_pk_bf16_f32 v148, v124, v125
    ds_read_b128 v[80:83], v25 offset:256
    ds_read_b128 v[84:87], v25 offset:20736
    s_waitcnt lgkmcnt(6)
    v_mfma_f32_16x16x32_bf16 v[32:35], a[32:35], v[88:91], v[32:35]
    v_cvt_pk_bf16_f32 v149, v126, v127
    v_mfma_f32_16x16x32_bf16 v[36:39], a[32:35], v[92:95], v[36:39]
    v_cvt_pk_bf16_f32 v150, v132, v133
    v_mfma_f32_16x16x32_bf16 v[40:43], a[36:39], v[88:91], v[40:43]
    v_cvt_pk_bf16_f32 v151, v134, v135
    v_mfma_f32_16x16x32_bf16 v[44:47], a[36:39], v[92:95], v[44:47]
    buffer_store_dwordx4 v[148:151], v28, s[40:43], s89 offen offset:3072 sc1
    v_mfma_f32_16x16x32_bf16 v[48:51], a[40:43], v[88:91], v[48:51]
    v_mfma_f32_16x16x32_bf16 v[52:55], a[40:43], v[92:95], v[52:55]
    v_mfma_f32_16x16x32_bf16 v[56:59], a[44:47], v[88:91], v[56:59]
    v_mfma_f32_16x16x32_bf16 v[60:63], a[44:47], v[92:95], v[60:63]
    ds_read_b128 v[88:91], v26 offset:256
    ds_read_b128 v[92:95], v26 offset:20736
    s_waitcnt lgkmcnt(6)
    v_mfma_f32_16x16x32_bf16 v[32:35], a[48:51], v[96:99], v[32:35]
    v_mfma_f32_16x16x32_bf16 v[36:39], a[48:51], v[100:103], v[36:39]
    v_mfma_f32_16x16x32_bf16 v[40:43], a[52:55], v[96:99], v[40:43]
    v_mfma_f32_16x16x32_bf16 v[44:47], a[52:55], v[100:103], v[44:47]
    v_mfma_f32_16x16x32_bf16 v[48:51], a[56:59], v[96:99], v[48:51]
    v_mfma_f32_16x16x32_bf16 v[52:55], a[56:59], v[100:103], v[52:55]
    v_mfma_f32_16x16x32_bf16 v[56:59], a[60:63], v[96:99], v[56:59]
    v_mfma_f32_16x16x32_bf16 v[60:63], a[60:63], v[100:103], v[60:63]
    ds_read_b128 v[96:99], v27 offset:256
    ds_read_b128 v[100:103], v27 offset:20736
    s_waitcnt lgkmcnt(6)
    v_mfma_f32_16x16x32_bf16 v[32:35], a[64:67], v[72:75], v[32:35]
    v_mfma_f32_16x16x32_bf16 v[36:39], a[64:67], v[76:79], v[36:39]
    v_mfma_f32_16x16x32_bf16 v[40:43], a[68:71], v[72:75], v[40:43]
    v_mfma_f32_16x16x32_bf16 v[44:47], a[68:71], v[76:79], v[44:47]
    v_mfma_f32_16x16x32_bf16 v[48:51], a[72:75], v[72:75], v[48:51]
    v_mfma_f32_16x16x32_bf16 v[52:55], a[72:75], v[76:79], v[52:55]
    v_mfma_f32_16x16x32_bf16 v[56:59], a[76:79], v[72:75], v[56:59]
    v_mfma_f32_16x16x32_bf16 v[60:63], a[76:79], v[76:79], v[60:63]
    ds_read_b128 v[72:75], v24 offset:512
    ds_read_b128 v[76:79], v24 offset:20992
    s_waitcnt lgkmcnt(6)
    v_mfma_f32_16x16x32_bf16 v[32:35], a[80:83], v[80:83], v[32:35]
    v_mfma_f32_16x16x32_bf16 v[36:39], a[80:83], v[84:87], v[36:39]
    v_mfma_f32_16x16x32_bf16 v[40:43], a[84:87], v[80:83], v[40:43]
    v_mfma_f32_16x16x32_bf16 v[44:47], a[84:87], v[84:87], v[44:47]
    v_mfma_f32_16x16x32_bf16 v[48:51], a[88:91], v[80:83], v[48:51]
    v_mfma_f32_16x16x32_bf16 v[52:55], a[88:91], v[84:87], v[52:55]
    v_mfma_f32_16x16x32_bf16 v[56:59], a[92:95], v[80:83], v[56:59]
    v_mfma_f32_16x16x32_bf16 v[60:63], a[92:95], v[84:87], v[60:63]
    ds_read_b128 v[80:83], v25 offset:512
    ds_read_b128 v[84:87], v25 offset:20992
    s_waitcnt lgkmcnt(6)
    v_mfma_f32_16x16x32_bf16 v[32:35], a[96:99], v[88:91], v[32:35]
    v_mfma_f32_16x16x32_bf16 v[36:39], a[96:99], v[92:95], v[36:39]
    v_mfma_f32_16x16x32_bf16 v[40:43], a[100:103], v[88:91], v[40:43]
    v_mfma_f32_16x16x32_bf16 v[44:47], a[100:103], v[92:95], v[44:47]
    v_mfma_f32_16x16x32_bf16 v[48:51], a[104:107], v[88:91], v[48:51]
    v_mfma_f32_16x16x32_bf16 v[52:55], a[104:107], v[92:95], v[52:55]
    v_mfma_f32_16x16x32_bf16 v[56:59], a[108:111], v[88:91], v[56:59]
    v_mfma_f32_16x16x32_bf16 v[60:63], a[108:111], v[92:95], v[60:63]
    ds_read_b128 v[88:91], v26 offset:512
    ds_read_b128 v[92:95], v26 offset:20992
    s_waitcnt lgkmcnt(6)
    v_mfma_f32_16x16x32_bf16 v[32:35], a[112:115], v[96:99], v[32:35]
    v_mfma_f32_16x16x32_bf16 v[36:39], a[112:115], v[100:103], v[36:39]
    v_mfma_f32_16x16x32_bf16 v[40:43], a[116:119], v[96:99], v[40:43]
    v_mfma_f32_16x16x32_bf16 v[44:47], a[116:119], v[100:103], v[44:47]
    v_mfma_f32_16x16x32_bf16 v[48:51], a[120:123], v[96:99], v[48:51]
    v_mfma_f32_16x16x32_bf16 v[52:55], a[120:123], v[100:103], v[52:55]
    v_mfma_f32_16x16x32_bf16 v[56:59], a[124:127], v[96:99], v[56:59]
    v_mfma_f32_16x16x32_bf16 v[60:63], a[124:127], v[100:103], v[60:63]
    s_waitcnt vmcnt(0)
    s_barrier
    v_mov_b32 v8, s5
    buffer_store_dword v8, v5, s[40:43], s70 offen sc1
    ds_read_b128 v[96:99], v27 offset:512
    ds_read_b128 v[100:103], v27 offset:20992
    s_waitcnt lgkmcnt(6)
    v_mfma_f32_16x16x32_bf16 v[32:35], a[128:131], v[72:75], v[32:35]
    v_mfma_f32_16x16x32_bf16 v[36:39], a[128:131], v[76:79], v[36:39]
    v_mfma_f32_16x16x32_bf16 v[40:43], a[132:135], v[72:75], v[40:43]
    v_mfma_f32_16x16x32_bf16 v[44:47], a[132:135], v[76:79], v[44:47]
    s_add_u32 m0, s76, 0
    s_nop 0
    buffer_load_dwordx4 v14, s[44:47], s74 offen lds
    v_mfma_f32_16x16x32_bf16 v[48:51], a[136:139], v[72:75], v[48:51]
    v_mfma_f32_16x16x32_bf16 v[52:55], a[136:139], v[76:79], v[52:55]
    v_mfma_f32_16x16x32_bf16 v[56:59], a[140:143], v[72:75], v[56:59]
    v_mfma_f32_16x16x32_bf16 v[60:63], a[140:143], v[76:79], v[60:63]
    ds_read_b128 v[72:75], v24 offset:768
    ds_read_b128 v[76:79], v24 offset:21248
    s_waitcnt lgkmcnt(6)
    v_mfma_f32_16x16x32_bf16 v[32:35], a[144:147], v[80:83], v[32:35]
    v_mfma_f32_16x16x32_bf16 v[36:39], a[144:147], v[84:87], v[36:39]
    v_mfma_f32_16x16x32_bf16 v[40:43], a[148:151], v[80:83], v[40:43]
    v_mfma_f32_16x16x32_bf16 v[44:47], a[148:151], v[84:87], v[44:47]
    s_add_u32 m0, s76, 1024
    s_nop 0
    buffer_load_dwordx4 v15, s[44:47], s74 offen lds
    v_mfma_f32_16x16x32_bf16 v[48:51], a[152:155], v[80:83], v[48:51]
    v_mfma_f32_16x16x32_bf16 v[52:55], a[152:155], v[84:87], v[52:55]
    v_mfma_f32_16x16x32_bf16 v[56:59], a[156:159], v[80:83], v[56:59]
    v_mfma_f32_16x16x32_bf16 v[60:63], a[156:159], v[84:87], v[60:63]
    ds_read_b128 v[80:83], v25 offset:768
    ds_read_b128 v[84:87], v25 offset:21248
    s_waitcnt lgkmcnt(6)
    v_mfma_f32_16x16x32_bf16 v[32:35], a[160:163], v[88:91], v[32:35]
    v_mfma_f32_16x16x32_bf16 v[36:39], a[160:163], v[92:95], v[36:39]
    v_mfma_f32_16x16x32_bf16 v[40:43], a[164:167], v[88:91], v[40:43]
    v_mfma_f32_16x16x32_bf16 v[44:47], a[164:167], v[92:95], v[44:47]
    s_add_u32 m0, s76, 2048
    s_nop 0
    buffer_load_dwordx4 v16, s[44:47], s74 offen lds
    v_mfma_f32_16x16x32_bf16 v[48:51], a[168:171], v[88:91], v[48:51]
    v_mfma_f32_16x16x32_bf16 v[52:55], a[168:171], v[92:95], v[52:55]
    v_mfma_f32_16x16x32_bf16 v[56:59], a[172:175], v[88:91], v[56:59]
    v_mfma_f32_16x16x32_bf16 v[60:63], a[172:175], v[92:95], v[60:63]
    ds_read_b128 v[88:91], v26 offset:768
    ds_read_b128 v[92:95], v26 offset:21248
    s_waitcnt lgkmcnt(6)
    v_mfma_f32_16x16x32_bf16 v[32:35], a[176:179], v[96:99], v[32:35]
    v_mfma_f32_16x16x32_bf16 v[36:39], a[176:179], v[100:103], v[36:39]
    v_mfma_f32_16x16x32_bf16 v[40:43], a[180:183], v[96:99], v[40:43]
    v_mfma_f32_16x16x32_bf16 v[44:47], a[180:183], v[100:103], v[44:47]
    s_add_u32 m0, s76, 3072
    s_nop 0
    buffer_load_dwordx4 v17, s[44:47], s74 offen lds
    v_mfma_f32_16x16x32_bf16 v[48:51], a[184:187], v[96:99], v[48:51]
    v_mfma_f32_16x16x32_bf16 v[52:55], a[184:187], v[100:103], v[52:55]
    v_mfma_f32_16x16x32_bf16 v[56:59], a[188:191], v[96:99], v[56:59]
    v_mfma_f32_16x16x32_bf16 v[60:63], a[188:191], v[100:103], v[60:63]
    ds_read_b128 v[96:99], v27 offset:768
    ds_read_b128 v[100:103], v27 offset:21248
    s_waitcnt lgkmcnt(6)
    v_mfma_f32_16x16x32_bf16 v[32:35], a[192:195], v[72:75], v[32:35]
    v_mfma_f32_16x16x32_bf16 v[36:39], a[192:195], v[76:79], v[36:39]
    v_mfma_f32_16x16x32_bf16 v[40:43], a[196:199], v[72:75], v[40:43]
    v_mfma_f32_16x16x32_bf16 v[44:47], a[196:199], v[76:79], v[44:47]
    s_add_u32 m0, s76, 4096
    s_nop 0
    buffer_load_dwordx4 v18, s[44:47], s74 offen lds
    v_mfma_f32_16x16x32_bf16 v[48:51], a[200:203], v[72:75], v[48:51]
    v_mfma_f32_16x16x32_bf16 v[52:55], a[200:203], v[76:79], v[52:55]
    v_mfma_f32_16x16x32_bf16 v[56:59], a[204:207], v[72:75], v[56:59]
    v_mfma_f32_16x16x32_bf16 v[60:63], a[204:207], v[76:79], v[60:63]
    ds_read_b128 v[72:75], v24 offset:1024
    ds_read_b128 v[76:79], v24 offset:21504
    s_waitcnt lgkmcnt(6)
    v_mfma_f32_16x16x32_bf16 v[32:35], a[208:211], v[80:83], v[32:35]
    v_mfma_f32_16x16x32_bf16 v[36:39], a[208:211], v[84:87], v[36:39]
    v_mfma_f32_16x16x32_bf16 v[40:43], a[212:215], v[80:83], v[40:43]
    v_mfma_f32_16x16x32_bf16 v[44:47], a[212:215], v[84:87], v[44:47]
    s_add_u32 m0, s76, 5120
    s_nop 0
    buffer_load_dwordx4 v19, s[44:47], s74 offen lds
    v_mfma_f32_16x16x32_bf16 v[48:51], a[216:219], v[80:83], v[48:51]
    v_mfma_f32_16x16x32_bf16 v[52:55], a[216:219], v[84:87], v[52:55]
    v_mfma_f32_16x16x32_bf16 v[56:59], a[220:223], v[80:83], v[56:59]
    v_mfma_f32_16x16x32_bf16 v[60:63], a[220:223], v[84:87], v[60:63]
    ds_read_b128 v[80:83], v25 offset:1024
    ds_read_b128 v[84:87], v25 offset:21504
    s_waitcnt lgkmcnt(6)
    v_mfma_f32_16x16x32_bf16 v[32:35], a[224:227], v[88:91], v[32:35]
    v_mfma_f32_16x16x32_bf16 v[36:39], a[224:227], v[92:95], v[36:39]
    v_mfma_f32_16x16x32_bf16 v[40:43], a[228:231], v[88:91], v[40:43]
    v_mfma_f32_16x16x32_bf16 v[44:47], a[228:231], v[92:95], v[44:47]
    s_add_u32 m0, s76, 6144
    s_nop 0
    buffer_load_dwordx4 v20, s[44:47], s74 offen lds
    v_mfma_f32_16x16x32_bf16 v[48:51], a[232:235], v[88:91], v[48:51]
    v_mfma_f32_16x16x32_bf16 v[52:55], a[232:235], v[92:95], v[52:55]
    v_mfma_f32_16x16x32_bf16 v[56:59], a[236:239], v[88:91], v[56:59]
    v_mfma_f32_16x16x32_bf16 v[60:63], a[236:239], v[92:95], v[60:63]
    ds_read_b128 v[88:91], v26 offset:1024
    ds_read_b128 v[92:95], v26 offset:21504
    s_waitcnt lgkmcnt(6)
    v_mfma_f32_16x16x32_bf16 v[32:35], a[240:243], v[96:99], v[32:35]
    v_mfma_f32_16x16x32_bf16 v[36:39], a[240:243], v[100:103], v[36:39]
    v_mfma_f32_16x16x32_bf16 v[40:43], a[244:247], v[96:99], v[40:43]
    v_mfma_f32_16x16x32_bf16 v[44:47], a[244:247], v[100:103], v[44:47]
    s_add_u32 m0, s76, 7168
    s_nop 0
    buffer_load_dwordx4 v21, s[44:47], s74 offen lds
    v_mfma_f32_16x16x32_bf16 v[48:51], a[248:251], v[96:99], v[48:51]
    v_mfma_f32_16x16x32_bf16 v[52:55], a[248:251], v[100:103], v[52:55]
    v_mfma_f32_16x16x32_bf16 v[56:59], a[252:255], v[96:99], v[56:59]
    v_mfma_f32_16x16x32_bf16 v[60:63], a[252:255], v[100:103], v[60:63]
    ds_read_b128 v[96:99], v27 offset:1024
    ds_read_b128 v[100:103], v27 offset:21504
    s_waitcnt lgkmcnt(6)
    v_mfma_f32_16x16x32_bf16 v[32:35], v[192:195], v[72:75], v[32:35]
    v_mfma_f32_16x16x32_bf16 v[36:39], v[192:195], v[76:79], v[36:39]
    v_mfma_f32_16x16x32_bf16 v[40:43], v[196:199], v[72:75], v[40:43]
    v_mfma_f32_16x16x32_bf16 v[44:47], v[196:199], v[76:79], v[44:47]
    s_add_u32 m0, s76, 8192
    s_nop 0
    buffer_load_dwordx4 v22, s[44:47], s74 offen lds
    v_mfma_f32_16x16x32_bf16 v[48:51], v[200:203], v[72:75], v[48:51]
    v_mfma_f32_16x16x32_bf16 v[52:55], v[200:203], v[76:79], v[52:55]
    v_mfma_f32_16x16x32_bf16 v[56:59], v[204:207], v[72:75], v[56:59]
    v_mfma_f32_16x16x32_bf16 v[60:63], v[204:207], v[76:79], v[60:63]
    s_waitcnt lgkmcnt(4)
    v_mfma_f32_16x16x32_bf16 v[32:35], v[208:211], v[80:83], v[32:35]
    v_mfma_f32_16x16x32_bf16 v[36:39], v[208:211], v[84:87], v[36:39]
    v_mfma_f32_16x16x32_bf16 v[40:43], v[212:215], v[80:83], v[40:43]
    v_mfma_f32_16x16x32_bf16 v[44:47], v[212:215], v[84:87], v[44:47]
    s_add_u32 m0, s76, 9216
    s_nop 0
    buffer_load_dwordx4 v23, s[44:47], s74 offen lds
    v_mfma_f32_16x16x32_bf16 v[48:51], v[216:219], v[80:83], v[48:51]
    v_mfma_f32_16x16x32_bf16 v[52:55], v[216:219], v[84:87], v[52:55]
    v_mfma_f32_16x16x32_bf16 v[56:59], v[220:223], v[80:83], v[56:59]
    v_mfma_f32_16x16x32_bf16 v[60:63], v[220:223], v[84:87], v[60:63]
    s_waitcnt lgkmcnt(2)
    v_mfma_f32_16x16x32_bf16 v[32:35], v[224:227], v[88:91], v[32:35]
    v_mfma_f32_16x16x32_bf16 v[36:39], v[224:227], v[92:95], v[36:39]
    v_mfma_f32_16x16x32_bf16 v[40:43], v[228:231], v[88:91], v[40:43]
    v_mfma_f32_16x16x32_bf16 v[44:47], v[228:231], v[92:95], v[44:47]
    v_mfma_f32_16x16x32_bf16 v[48:51], v[232:235], v[88:91], v[48:51]
    v_mfma_f32_16x16x32_bf16 v[52:55], v[232:235], v[92:95], v[52:55]
    v_mfma_f32_16x16x32_bf16 v[56:59], v[236:239], v[88:91], v[56:59]
    v_mfma_f32_16x16x32_bf16 v[60:63], v[236:239], v[92:95], v[60:63]
    s_waitcnt lgkmcnt(0)
    v_mfma_f32_16x16x32_bf16 v[32:35], v[240:243], v[96:99], v[32:35]
    v_mfma_f32_16x16x32_bf16 v[36:39], v[240:243], v[100:103], v[36:39]
    v_mfma_f32_16x16x32_bf16 v[40:43], v[244:247], v[96:99], v[40:43]
    v_mfma_f32_16x16x32_bf16 v[44:47], v[244:247], v[100:103], v[44:47]
    v_mfma_f32_16x16x32_bf16 v[48:51], v[248:251], v[96:99], v[48:51]
    v_mfma_f32_16x16x32_bf16 v[52:55], v[248:251], v[100:103], v[52:55]
    v_mfma_f32_16x16x32_bf16 v[56:59], v[252:255], v[96:99], v[56:59]
    v_mfma_f32_16x16x32_bf16 v[60:63], v[252:255], v[100:103], v[60:63]
    s_cmp_eq_u32 s75, 2
    s_cselect_b32 s7, -81920, s85
    s_cselect_b32 s75, -1, s75
    s_add_u32 s75, s75, 1
    v_add_u32 v24, s7, v24
    v_add_u32 v25, s7, v25
    v_add_u32 v26, s7, v26
    v_add_u32 v27, s7, v27
    s_mov_b32 s89, s71
    s_add_u32 s71, s71, 393216
    s_add_u32 s5, s5, 1
    s_barrier
    s_cmp_eq_u32 s75, 1
    s_cselect_b32 s7, -81920, s85
    s_add_u32 s76, s76, s7
    s_add_u32 s74, s74, 40960
    ds_read_b128 v[72:75], v24 offset:0
    ds_read_b128 v[76:79], v24 offset:20480
    ds_read_b128 v[80:83], v25 offset:0
    ds_read_b128 v[84:87], v25 offset:20480
    ds_read_b128 v[88:91], v26 offset:0
    ds_read_b128 v[92:95], v26 offset:20480
    ds_read_b128 v[96:99], v27 offset:0
    ds_read_b128 v[100:103], v27 offset:20480
    s_waitcnt lgkmcnt(6)
    v_mfma_f32_16x16x32_bf16 v[104:107], a[0:3], v[72:75], 0
    v_cvt_pk_bf16_f32 v136, v32, v33
    v_mfma_f32_16x16x32_bf16 v[108:111], a[0:3], v[76:79], 0
    v_cvt_pk_bf16_f32 v137, v34, v35
    v_mfma_f32_16x16x32_bf16 v[112:115], a[4:7], v[72:75], 0
    v_cvt_pk_bf16_f32 v138, v40, v41
    v_mfma_f32_16x16x32_bf16 v[116:119], a[4:7], v[76:79], 0
    v_cvt_pk_bf16_f32 v139, v42, v43
    v_mfma_f32_16x16x32_bf16 v[120:123], a[8:11], v[72:75], 0
    buffer_store_dwordx4 v[136:139], v28, s[40:43], s89 offen offset:0 sc1
    v_mfma_f32_16x16x32_bf16 v[124:127], a[8:11], v[76:79], 0
    v_cvt_pk_bf16_f32 v140, v36, v37
    v_mfma_f32_16x16x32_bf16 v[128:131], a[12:15], v[72:75], 0
    v_cvt_pk_bf16_f32 v141, v38, v39
    v_mfma_f32_16x16x32_bf16 v[132:135], a[12:15], v[76:79], 0
    v_cvt_pk_bf16_f32 v142, v44, v45
    ds_read_b128 v[72:75], v24 offset:256
    ds_read_b128 v[76:79], v24 offset:20736
    s_waitcnt lgkmcnt(6)
    v_mfma_f32_16x16x32_bf16 v[104:107], a[16:19], v[80:83], v[104:107]
    v_cvt_pk_bf16_f32 v143, v46, v47
    v_mfma_f32_16x16x32_bf16 v[108:111], a[16:19], v[84:87], v[108:111]
    buffer_store_dwordx4 v[140:143], v28, s[40:43], s89 offen offset:1024 sc1
    v_mfma_f32_16x16x32_bf16 v[112:115], a[20:23], v[80:83], v[112:115]
    v_cvt_pk_bf16_f32 v144, v48, v49
    v_mfma_f32_16x16x32_bf16 v[116:119], a[20:23], v[84:87], v[116:119]
    v_cvt_pk_bf16_f32 v145, v50, v51
    v_mfma_f32_16x16x32_bf16 v[120:123], a[24:27], v[80:83], v[120:123]
    v_cvt_pk_bf16_f32 v146, v56, v57
    v_mfma_f32_16x16x32_bf16 v[124:127], a[24:27], v[84:87], v[124:127]
    v_cvt_pk_bf16_f32 v147, v58, v59
    v_mfma_f32_16x16x32_bf16 v[128:131], a[28:31], v[80:83], v[128:131]
    buffer_store_dwordx4 v[144:147], v28, s[40:43], s89 offen offset:2048 sc1
    v_mfma_f32_16x16x32_bf16 v[132:135], a[28:31], v[84:87], v[132:135]
    v_cvt_pk_bf16_f32 v148, v52, v53
    ds_read_b128 v[80:83], v25 offset:256
    ds_read_b128 v[84:87], v25 offset:20736
    s_waitcnt lgkmcnt(6)
    v_mfma_f32_16x16x32_bf16 v[104:107], a[32:35], v[88:91], v[104:107]
    v_cvt_pk_bf16_f32 v149, v54, v55
    v_mfma_f32_16x16x32_bf16 v[108:111], a[32:35], v[92:95], v[108:111]
    v_cvt_pk_bf16_f32 v150, v60, v61
    v_mfma_f32_16x16x32_bf16 v[112:115], a[36:39], v[88:91], v[112:115]
    v_cvt_pk_bf16_f32 v151, v62, v63
    v_mfma_f32_16x16x32_bf16 v[116:119], a[36:39], v[92:95], v[116:119]
    buffer_store_dwordx4 v[148:151], v28, s[40:43], s89 offen offset:3072 sc1
    v_mfma_f32_16x16x32_bf16 v[120:123], a[40:43], v[88:91], v[120:123]
    v_mfma_f32_16x16x32_bf16 v[124:127], a[40:43], v[92:95], v[124:127]
    v_mfma_f32_16x16x32_bf16 v[128:131], a[44:47], v[88:91], v[128:131]
    v_mfma_f32_16x16x32_bf16 v[132:135], a[44:47], v[92:95], v[132:135]
    ds_read_b128 v[88:91], v26 offset:256
    ds_read_b128 v[92:95], v26 offset:20736
    s_waitcnt lgkmcnt(6)
    v_mfma_f32_16x16x32_bf16 v[104:107], a[48:51], v[96:99], v[104:107]
    v_mfma_f32_16x16x32_bf16 v[108:111], a[48:51], v[100:103], v[108:111]
    v_mfma_f32_16x16x32_bf16 v[112:115], a[52:55], v[96:99], v[112:115]
    v_mfma_f32_16x16x32_bf16 v[116:119], a[52:55], v[100:103], v[116:119]
    v_mfma_f32_16x16x32_bf16 v[120:123], a[56:59], v[96:99], v[120:123]
    v_mfma_f32_16x16x32_bf16 v[124:127], a[56:59], v[100:103], v[124:127]
    v_mfma_f32_16x16x32_bf16 v[128:131], a[60:63], v[96:99], v[128:131]
    v_mfma_f32_16x16x32_bf16 v[132:135], a[60:63], v[100:103], v[132:135]
    ds_read_b128 v[96:99], v27 offset:256
    ds_read_b128 v[100:103], v27 offset:20736
    s_waitcnt lgkmcnt(6)
    v_mfma_f32_16x16x32_bf16 v[104:107], a[64:67], v[72:75], v[104:107]
    v_mfma_f32_16x16x32_bf16 v[108:111], a[64:67], v[76:79], v[108:111]
    v_mfma_f32_16x16x32_bf16 v[112:115], a[68:71], v[72:75], v[112:115]
    v_mfma_f32_16x16x32_bf16 v[116:119], a[68:71], v[76:79], v[116:119]
    v_mfma_f32_16x16x32_bf16 v[120:123], a[72:75], v[72:75], v[120:123]
    v_mfma_f32_16x16x32_bf16 v[124:127], a[72:75], v[76:79], v[124:127]
    v_mfma_f32_16x16x32_bf16 v[128:131], a[76:79], v[72:75], v[128:131]
    v_mfma_f32_16x16x32_bf16 v[132:135], a[76:79], v[76:79], v[132:135]
    ds_read_b128 v[72:75], v24 offset:512
    ds_read_b128 v[76:79], v24 offset:20992
    s_waitcnt lgkmcnt(6)
    v_mfma_f32_16x16x32_bf16 v[104:107], a[80:83], v[80:83], v[104:107]
    v_mfma_f32_16x16x32_bf16 v[108:111], a[80:83], v[84:87], v[108:111]
    v_mfma_f32_16x16x32_bf16 v[112:115], a[84:87], v[80:83], v[112:115]
    v_mfma_f32_16x16x32_bf16 v[116:119], a[84:87], v[84:87], v[116:119]
    v_mfma_f32_16x16x32_bf16 v[120:123], a[88:91], v[80:83], v[120:123]
    v_mfma_f32_16x16x32_bf16 v[124:127], a[88:91], v[84:87], v[124:127]
    v_mfma_f32_16x16x32_bf16 v[128:131], a[92:95], v[80:83], v[128:131]
    v_mfma_f32_16x16x32_bf16 v[132:135], a[92:95], v[84:87], v[132:135]
    ds_read_b128 v[80:83], v25 offset:512
    ds_read_b128 v[84:87], v25 offset:20992
    s_waitcnt lgkmcnt(6)
    v_mfma_f32_16x16x32_bf16 v[104:107], a[96:99], v[88:91], v[104:107]
    v_mfma_f32_16x16x32_bf16 v[108:111], a[96:99], v[92:95], v[108:111]
    v_mfma_f32_16x16x32_bf16 v[112:115], a[100:103], v[88:91], v[112:115]
    v_mfma_f32_16x16x32_bf16 v[116:119], a[100:103], v[92:95], v[116:119]
    v_mfma_f32_16x16x32_bf16 v[120:123], a[104:107], v[88:91], v[120:123]
    v_mfma_f32_16x16x32_bf16 v[124:127], a[104:107], v[92:95], v[124:127]
    v_mfma_f32_16x16x32_bf16 v[128:131], a[108:111], v[88:91], v[128:131]
    v_mfma_f32_16x16x32_bf16 v[132:135], a[108:111], v[92:95], v[132:135]
    ds_read_b128 v[88:91], v26 offset:512
    ds_read_b128 v[92:95], v26 offset:20992
    s_waitcnt lgkmcnt(6)
    v_mfma_f32_16x16x32_bf16 v[104:107], a[112:115], v[96:99], v[104:107]
    v_mfma_f32_16x16x32_bf16 v[108:111], a[112:115], v[100:103], v[108:111]
    v_mfma_f32_16x16x32_bf16 v[112:115], a[116:119], v[96:99], v[112:115]
    v_mfma_f32_16x16x32_bf16 v[116:119], a[116:119], v[100:103], v[116:119]
    v_mfma_f32_16x16x32_bf16 v[120:123], a[120:123], v[96:99], v[120:123]
    v_mfma_f32_16x16x32_bf16 v[124:127], a[120:123], v[100:103], v[124:127]
    v_mfma_f32_16x16x32_bf16 v[128:131], a[124:127], v[96:99], v[128:131]
    v_mfma_f32_16x16x32_bf16 v[132:135], a[124:127], v[100:103], v[132:135]
    s_waitcnt vmcnt(0)
    s_barrier
    v_mov_b32 v8, s5
    buffer_store_dword v8, v5, s[40:43], s70 offen sc1
    ds_read_b128 v[96:99], v27 offset:512
    ds_read_b128 v[100:103], v27 offset:20992
    s_waitcnt lgkmcnt(6)
    v_mfma_f32_16x16x32_bf16 v[104:107], a[128:131], v[72:75], v[104:107]
    v_mfma_f32_16x16x32_bf16 v[108:111], a[128:131], v[76:79], v[108:111]
    v_mfma_f32_16x16x32_bf16 v[112:115], a[132:135], v[72:75], v[112:115]
    v_mfma_f32_16x16x32_bf16 v[116:119], a[132:135], v[76:79], v[116:119]
    s_add_u32 m0, s76, 0
    s_nop 0
    buffer_load_dwordx4 v14, s[44:47], s74 offen lds
    v_mfma_f32_16x16x32_bf16 v[120:123], a[136:139], v[72:75], v[120:123]
    v_mfma_f32_16x16x32_bf16 v[124:127], a[136:139], v[76:79], v[124:127]
    v_mfma_f32_16x16x32_bf16 v[128:131], a[140:143], v[72:75], v[128:131]
    v_mfma_f32_16x16x32_bf16 v[132:135], a[140:143], v[76:79], v[132:135]
    ds_read_b128 v[72:75], v24 offset:768
    ds_read_b128 v[76:79], v24 offset:21248
    s_waitcnt lgkmcnt(6)
    v_mfma_f32_16x16x32_bf16 v[104:107], a[144:147], v[80:83], v[104:107]
    v_mfma_f32_16x16x32_bf16 v[108:111], a[144:147], v[84:87], v[108:111]
    v_mfma_f32_16x16x32_bf16 v[112:115], a[148:151], v[80:83], v[112:115]
    v_mfma_f32_16x16x32_bf16 v[116:119], a[148:151], v[84:87], v[116:119]
    s_add_u32 m0, s76, 1024
    s_nop 0
    buffer_load_dwordx4 v15, s[44:47], s74 offen lds
    v_mfma_f32_16x16x32_bf16 v[120:123], a[152:155], v[80:83], v[120:123]
    v_mfma_f32_16x16x32_bf16 v[124:127], a[152:155], v[84:87], v[124:127]
    v_mfma_f32_16x16x32_bf16 v[128:131], a[156:159], v[80:83], v[128:131]
    v_mfma_f32_16x16x32_bf16 v[132:135], a[156:159], v[84:87], v[132:135]
    ds_read_b128 v[80:83], v25 offset:768
    ds_read_b128 v[84:87], v25 offset:21248
    s_waitcnt lgkmcnt(6)
    v_mfma_f32_16x16x32_bf16 v[104:107], a[160:163], v[88:91], v[104:107]
    v_mfma_f32_16x16x32_bf16 v[108:111], a[160:163], v[92:95], v[108:111]
    v_mfma_f32_16x16x32_bf16 v[112:115], a[164:167], v[88:91], v[112:115]
    v_mfma_f32_16x16x32_bf16 v[116:119], a[164:167], v[92:95], v[116:119]
    s_add_u32 m0, s76, 2048
    s_nop 0
    buffer_load_dwordx4 v16, s[44:47], s74 offen lds
    v_mfma_f32_16x16x32_bf16 v[120:123], a[168:171], v[88:91], v[120:123]
    v_mfma_f32_16x16x32_bf16 v[124:127], a[168:171], v[92:95], v[124:127]
    v_mfma_f32_16x16x32_bf16 v[128:131], a[172:175], v[88:91], v[128:131]
    v_mfma_f32_16x16x32_bf16 v[132:135], a[172:175], v[92:95], v[132:135]
    ds_read_b128 v[88:91], v26 offset:768
    ds_read_b128 v[92:95], v26 offset:21248
    s_waitcnt lgkmcnt(6)
    v_mfma_f32_16x16x32_bf16 v[104:107], a[176:179], v[96:99], v[104:107]
    v_mfma_f32_16x16x32_bf16 v[108:111], a[176:179], v[100:103], v[108:111]
    v_mfma_f32_16x16x32_bf16 v[112:115], a[180:183], v[96:99], v[112:115]
    v_mfma_f32_16x16x32_bf16 v[116:119], a[180:183], v[100:103], v[116:119]
    s_add_u32 m0, s76, 3072
    s_nop 0
    buffer_load_dwordx4 v17, s[44:47], s74 offen lds
    v_mfma_f32_16x16x32_bf16 v[120:123], a[184:187], v[96:99], v[120:123]
    v_mfma_f32_16x16x32_bf16 v[124:127], a[184:187], v[100:103], v[124:127]
    v_mfma_f32_16x16x32_bf16 v[128:131], a[188:191], v[96:99], v[128:131]
    v_mfma_f32_16x16x32_bf16 v[132:135], a[188:191], v[100:103], v[132:135]
    ds_read_b128 v[96:99], v27 offset:768
    ds_read_b128 v[100:103], v27 offset:21248
    s_waitcnt lgkmcnt(6)
    v_mfma_f32_16x16x32_bf16 v[104:107], a[192:195], v[72:75], v[104:107]
    v_mfma_f32_16x16x32_bf16 v[108:111], a[192:195], v[76:79], v[108:111]
    v_mfma_f32_16x16x32_bf16 v[112:115], a[196:199], v[72:75], v[112:115]
    v_mfma_f32_16x16x32_bf16 v[116:119], a[196:199], v[76:79], v[116:119]
    s_add_u32 m0, s76, 4096
    s_nop 0
    buffer_load_dwordx4 v18, s[44:47], s74 offen lds
    v_mfma_f32_16x16x32_bf16 v[120:123], a[200:203], v[72:75], v[120:123]
    v_mfma_f32_16x16x32_bf16 v[124:127], a[200:203], v[76:79], v[124:127]
    v_mfma_f32_16x16x32_bf16 v[128:131], a[204:207], v[72:75], v[128:131]
    v_mfma_f32_16x16x32_bf16 v[132:135], a[204:207], v[76:79], v[132:135]
    ds_read_b128 v[72:75], v24 offset:1024
    ds_read_b128 v[76:79], v24 offset:21504
    s_waitcnt lgkmcnt(6)
    v_mfma_f32_16x16x32_bf16 v[104:107], a[208:211], v[80:83], v[104:107]
    v_mfma_f32_16x16x32_bf16 v[108:111], a[208:211], v[84:87], v[108:111]
    v_mfma_f32_16x16x32_bf16 v[112:115], a[212:215], v[80:83], v[112:115]
    v_mfma_f32_16x16x32_bf16 v[116:119], a[212:215], v[84:87], v[116:119]
    s_add_u32 m0, s76, 5120
    s_nop 0
    buffer_load_dwordx4 v19, s[44:47], s74 offen lds
    v_mfma_f32_16x16x32_bf16 v[120:123], a[216:219], v[80:83], v[120:123]
    v_mfma_f32_16x16x32_bf16 v[124:127], a[216:219], v[84:87], v[124:127]
    v_mfma_f32_16x16x32_bf16 v[128:131], a[220:223], v[80:83], v[128:131]
    v_mfma_f32_16x16x32_bf16 v[132:135], a[220:223], v[84:87], v[132:135]
    ds_read_b128 v[80:83], v25 offset:1024
    ds_read_b128 v[84:87], v25 offset:21504
    s_waitcnt lgkmcnt(6)
    v_mfma_f32_16x16x32_bf16 v[104:107], a[224:227], v[88:91], v[104:107]
    v_mfma_f32_16x16x32_bf16 v[108:111], a[224:227], v[92:95], v[108:111]
    v_mfma_f32_16x16x32_bf16 v[112:115], a[228:231], v[88:91], v[112:115]
    v_mfma_f32_16x16x32_bf16 v[116:119], a[228:231], v[92:95], v[116:119]
    s_add_u32 m0, s76, 6144
    s_nop 0
    buffer_load_dwordx4 v20, s[44:47], s74 offen lds
    v_mfma_f32_16x16x32_bf16 v[120:123], a[232:235], v[88:91], v[120:123]
    v_mfma_f32_16x16x32_bf16 v[124:127], a[232:235], v[92:95], v[124:127]
    v_mfma_f32_16x16x32_bf16 v[128:131], a[236:239], v[88:91], v[128:131]
    v_mfma_f32_16x16x32_bf16 v[132:135], a[236:239], v[92:95], v[132:135]
    ds_read_b128 v[88:91], v26 offset:1024
    ds_read_b128 v[92:95], v26 offset:21504
    s_waitcnt lgkmcnt(6)
    v_mfma_f32_16x16x32_bf16 v[104:107], a[240:243], v[96:99], v[104:107]
    v_mfma_f32_16x16x32_bf16 v[108:111], a[240:243], v[100:103], v[108:111]
    v_mfma_f32_16x16x32_bf16 v[112:115], a[244:247], v[96:99], v[112:115]
    v_mfma_f32_16x16x32_bf16 v[116:119], a[244:247], v[100:103], v[116:119]
    s_add_u32 m0, s76, 7168
    s_nop 0
    buffer_load_dwordx4 v21, s[44:47], s74 offen lds
    v_mfma_f32_16x16x32_bf16 v[120:123], a[248:251], v[96:99], v[120:123]
    v_mfma_f32_16x16x32_bf16 v[124:127], a[248:251], v[100:103], v[124:127]
    v_mfma_f32_16x16x32_bf16 v[128:131], a[252:255], v[96:99], v[128:131]
    v_mfma_f32_16x16x32_bf16 v[132:135], a[252:255], v[100:103], v[132:135]
    ds_read_b128 v[96:99], v27 offset:1024
    ds_read_b128 v[100:103], v27 offset:21504
    s_waitcnt lgkmcnt(6)
    v_mfma_f32_16x16x32_bf16 v[104:107], v[192:195], v[72:75], v[104:107]
    v_mfma_f32_16x16x32_bf16 v[108:111], v[192:195], v[76:79], v[108:111]
    v_mfma_f32_16x16x32_bf16 v[112:115], v[196:199], v[72:75], v[112:115]
    v_mfma_f32_16x16x32_bf16 v[116:119], v[196:199], v[76:79], v[116:119]
    s_add_u32 m0, s76, 8192
    s_nop 0
    buffer_load_dwordx4 v22, s[44:47], s74 offen lds
    v_mfma_f32_16x16x32_bf16 v[120:123], v[200:203], v[72:75], v[120:123]
    v_mfma_f32_16x16x32_bf16 v[124:127], v[200:203], v[76:79], v[124:127]
    v_mfma_f32_16x16x32_bf16 v[128:131], v[204:207], v[72:75], v[128:131]
    v_mfma_f32_16x16x32_bf16 v[132:135], v[204:207], v[76:79], v[132:135]
    s_waitcnt lgkmcnt(4)
    v_mfma_f32_16x16x32_bf16 v[104:107], v[208:211], v[80:83], v[104:107]
    v_mfma_f32_16x16x32_bf16 v[108:111], v[208:211], v[84:87], v[108:111]
    v_mfma_f32_16x16x32_bf16 v[112:115], v[212:215], v[80:83], v[112:115]
    v_mfma_f32_16x16x32_bf16 v[116:119], v[212:215], v[84:87], v[116:119]
    s_add_u32 m0, s76, 9216
    s_nop 0
    buffer_load_dwordx4 v23, s[44:47], s74 offen lds
    v_mfma_f32_16x16x32_bf16 v[120:123], v[216:219], v[80:83], v[120:123]
    v_mfma_f32_16x16x32_bf16 v[124:127], v[216:219], v[84:87], v[124:127]
    v_mfma_f32_16x16x32_bf16 v[128:131], v[220:223], v[80:83], v[128:131]
    v_mfma_f32_16x16x32_bf16 v[132:135], v[220:223], v[84:87], v[132:135]
    s_waitcnt lgkmcnt(2)
    v_mfma_f32_16x16x32_bf16 v[104:107], v[224:227], v[88:91], v[104:107]
    v_mfma_f32_16x16x32_bf16 v[108:111], v[224:227], v[92:95], v[108:111]
    v_mfma_f32_16x16x32_bf16 v[112:115], v[228:231], v[88:91], v[112:115]
    v_mfma_f32_16x16x32_bf16 v[116:119], v[228:231], v[92:95], v[116:119]
    v_mfma_f32_16x16x32_bf16 v[120:123], v[232:235], v[88:91], v[120:123]
    v_mfma_f32_16x16x32_bf16 v[124:127], v[232:235], v[92:95], v[124:127]
    v_mfma_f32_16x16x32_bf16 v[128:131], v[236:239], v[88:91], v[128:131]
    v_mfma_f32_16x16x32_bf16 v[132:135], v[236:239], v[92:95], v[132:135]
    s_waitcnt lgkmcnt(0)
    v_mfma_f32_16x16x32_bf16 v[104:107], v[240:243], v[96:99], v[104:107]
    v_mfma_f32_16x16x32_bf16 v[108:111], v[240:243], v[100:103], v[108:111]
    v_mfma_f32_16x16x32_bf16 v[112:115], v[244:247], v[96:99], v[112:115]
    v_mfma_f32_16x16x32_bf16 v[116:119], v[244:247], v[100:103], v[116:119]
    v_mfma_f32_16x16x32_bf16 v[120:123], v[248:251], v[96:99], v[120:123]
    v_mfma_f32_16x16x32_bf16 v[124:127], v[248:251], v[100:103], v[124:127]
    v_mfma_f32_16x16x32_bf16 v[128:131], v[252:255], v[96:99], v[128:131]
    v_mfma_f32_16x16x32_bf16 v[132:135], v[252:255], v[100:103], v[132:135]
    s_cmp_eq_u32 s75, 2
    s_cselect_b32 s7, -81920, s85
    s_cselect_b32 s75, -1, s75
    s_add_u32 s75, s75, 1
    v_add_u32 v24, s7, v24
    v_add_u32 v25, s7, v25
    v_add_u32 v26, s7, v26
    v_add_u32 v27, s7, v27
    s_mov_b32 s89, s71
    s_add_u32 s71, s71, 393216
    s_add_u32 s5, s5, 1
    s_barrier
    s_cmp_lt_u32 s5, 64
    s_cbranch_scc1 L_ba_loop_3
    s_nop 7
    v_cvt_pk_bf16_f32 v136, v104, v105
    v_cvt_pk_bf16_f32 v137, v106, v107
    v_cvt_pk_bf16_f32 v138, v112, v113
    v_cvt_pk_bf16_f32 v139, v114, v115
    buffer_store_dwordx4 v[136:139], v28, s[40:43], s89 offen offset:0 sc1
    v_cvt_pk_bf16_f32 v140, v108, v109
    v_cvt_pk_bf16_f32 v141, v110, v111
    v_cvt_pk_bf16_f32 v142, v116, v117
    v_cvt_pk_bf16_f32 v143, v118, v119
    buffer_store_dwordx4 v[140:143], v28, s[40:43], s89 offen offset:1024 sc1
    v_cvt_pk_bf16_f32 v144, v120, v121
    v_cvt_pk_bf16_f32 v145, v122, v123
    v_cvt_pk_bf16_f32 v146, v128, v129
    v_cvt_pk_bf16_f32 v147, v130, v131
    buffer_store_dwordx4 v[144:147], v28, s[40:43], s89 offen offset:2048 sc1
    v_cvt_pk_bf16_f32 v148, v124, v125
    v_cvt_pk_bf16_f32 v149, v126, v127
    v_cvt_pk_bf16_f32 v150, v132, v133
    v_cvt_pk_bf16_f32 v151, v134, v135
    buffer_store_dwordx4 v[148:151], v28, s[40:43], s89 offen offset:3072 sc1
    s_waitcnt vmcnt(0)
    s_barrier
    v_mov_b32 v6, s5
    buffer_store_dword v6, v5, s[40:43], s70 offen sc1
    s_endpgm
L_GU:
    s_getpc_b64 s[96:97]
L_pc_4:
    s_lshl_b32 s98, s3, 10
    v_lshl_add_u32 v250, v0, 4, s98
    v_mov_b32 v251, s97
    v_add_co_u32 v250, vcc, s96, v250
    s_nop 1
    v_addc_co_u32 v251, vcc, 0, v251, vcc
    global_load_dwordx4 v[252:255], v[250:251], off
    v_add_co_u32 v250, vcc, 0x1000, v250
    s_nop 1
    v_addc_co_u32 v251, vcc, 0, v251, vcc
    global_load_dwordx4 v[252:255], v[250:251], off
    v_add_co_u32 v250, vcc, 0x1000, v250
    s_nop 1
    v_addc_co_u32 v251, vcc, 0, v251, vcc
    global_load_dwordx4 v[252:255], v[250:251], off
    v_add_co_u32 v250, vcc, 0x1000, v250
    s_nop 1
    v_addc_co_u32 v251, vcc, 0, v251, vcc
    s_mov_b32 s48, s24
    s_mov_b32 s49, s25
    s_mov_b32 s50, 0x1e0000
    s_mov_b32 s51, 0x20000
    s_mov_b32 s52, s26
    s_mov_b32 s53, s27
    s_mov_b32 s54, 0x1e0000
    s_mov_b32 s55, 0x20000
    s_add_u32 s70, s4, 104
    s_lshl_b32 s70, s70, 7
    v_and_b32 v1, 15, v0
    v_lshrrev_b32 v2, 4, v0
    v_lshrrev_b32 v3, 2, v1
    v_and_b32 v4, 3, v0
    v_mov_b32 v5, s3
    v_or_b32 v5, v5, v0
    v_cmp_eq_u32 vcc, 0, v5
    v_mov_b32 v5, 0x80000000
    s_nop 0
    v_cndmask_b32_e64 v5, v5, 0, vcc
    v_mov_b32 v6, 0
    buffer_store_dword v6, v5, s[40:43], s70 offen sc1
    s_waitcnt vmcnt(0)
    s_barrier
    v_mov_b32 v6, 1
    buffer_atomic_add v6, v5, s[60:63], 0 offen sc1
    s_mul_i32 s7, s3, 640
    s_add_u32 s7, s7, 0
    v_add_u32 v6, s7, v0
    v_mul_u32_u24 v7, 1639, v6
    v_lshrrev_b32 v7, 17, v7
    v_mul_u32_u24 v8, 80, v7
    v_sub_u32 v8, v6, v8
    v_and_b32 v6, 7, v7
    v_lshlrev_b32 v6, 1, v6
    v_xor_b32 v8, v8, v6
    v_mul_u32_u24 v7, 1280, v7
    v_lshl_add_u32 v14, v8, 4, v7
    s_mul_i32 s7, s3, 640
    s_add_u32 s7, s7, 64
    v_add_u32 v6, s7, v0
    v_mul_u32_u24 v7, 1639, v6
    v_lshrrev_b32 v7, 17, v7
    v_mul_u32_u24 v8, 80, v7
    v_sub_u32 v8, v6, v8
    v_and_b32 v6, 7, v7
    v_lshlrev_b32 v6, 1, v6
    v_xor_b32 v8, v8, v6
    v_mul_u32_u24 v7, 1280, v7
    v_lshl_add_u32 v15, v8, 4, v7
    s_mul_i32 s7, s3, 640
    s_add_u32 s7, s7, 128
    v_add_u32 v6, s7, v0
    v_mul_u32_u24 v7, 1639, v6
    v_lshrrev_b32 v7, 17, v7
    v_mul_u32_u24 v8, 80, v7
    v_sub_u32 v8, v6, v8
    v_and_b32 v6, 7, v7
    v_lshlrev_b32 v6, 1, v6
    v_xor_b32 v8, v8, v6
    v_mul_u32_u24 v7, 1280, v7
    v_lshl_add_u32 v16, v8, 4, v7
    s_mul_i32 s7, s3, 640
    s_add_u32 s7, s7, 192
    v_add_u32 v6, s7, v0
    v_mul_u32_u24 v7, 1639, v6
    v_lshrrev_b32 v7, 17, v7
    v_mul_u32_u24 v8, 80, v7
    v_sub_u32 v8, v6, v8
    v_and_b32 v6, 7, v7
    v_lshlrev_b32 v6, 1, v6
    v_xor_b32 v8, v8, v6
    v_mul_u32_u24 v7, 1280, v7
    v_lshl_add_u32 v17, v8, 4, v7
    s_mul_i32 s7, s3, 640
    s_add_u32 s7, s7, 256
    v_add_u32 v6, s7, v0
    v_mul_u32_u24 v7, 1639, v6
    v_lshrrev_b32 v7, 17, v7
    v_mul_u32_u24 v8, 80, v7
    v_sub_u32 v8, v6, v8
    v_and_b32 v6, 7, v7
    v_lshlrev_b32 v6, 1, v6
    v_xor_b32 v8, v8, v6
    v_mul_u32_u24 v7, 1280, v7
    v_lshl_add_u32 v18, v8, 4, v7
    s_mul_i32 s7, s3, 640
    s_add_u32 s7, s7, 320
    v_add_u32 v6, s7, v0
    v_mul_u32_u24 v7, 1639, v6
    v_lshrrev_b32 v7, 17, v7
    v_mul_u32_u24 v8, 80, v7
    v_sub_u32 v8, v6, v8
    v_and_b32 v6, 7, v7
    v_lshlrev_b32 v6, 1, v6
    v_xor_b32 v8, v8, v6
    v_mul_u32_u24 v7, 1280, v7
    v_lshl_add_u32 v19, v8, 4, v7
    s_mul_i32 s7, s3, 640
    s_add_u32 s7, s7, 384
    v_add_u32 v6, s7, v0
    v_mul_u32_u24 v7, 1639, v6
    v_lshrrev_b32 v7, 17, v7
    v_mul_u32_u24 v8, 80, v7
    v_sub_u32 v8, v6, v8
    v_and_b32 v6, 7, v7
    v_lshlrev_b32 v6, 1, v6
    v_xor_b32 v8, v8, v6
    v_mul_u32_u24 v7, 1280, v7
    v_lshl_add_u32 v20, v8, 4, v7
    s_mul_i32 s7, s3, 640
    s_add_u32 s7, s7, 448
    v_add_u32 v6, s7, v0
    v_mul_u32_u24 v7, 1639, v6
    v_lshrrev_b32 v7, 17, v7
    v_mul_u32_u24 v8, 80, v7
    v_sub_u32 v8, v6, v8
    v_and_b32 v6, 7, v7
    v_lshlrev_b32 v6, 1, v6
    v_xor_b32 v8, v8, v6
    v_mul_u32_u24 v7, 1280, v7
    v_lshl_add_u32 v21, v8, 4, v7
    s_mul_i32 s7, s3, 640
    s_add_u32 s7, s7, 512
    v_add_u32 v6, s7, v0
    v_mul_u32_u24 v7, 1639, v6
    v_lshrrev_b32 v7, 17, v7
    v_mul_u32_u24 v8, 80, v7
    v_sub_u32 v8, v6, v8
    v_and_b32 v6, 7, v7
    v_lshlrev_b32 v6, 1, v6
    v_xor_b32 v8, v8, v6
    v_mul_u32_u24 v7, 1280, v7
    v_lshl_add_u32 v22, v8, 4, v7
    s_mul_i32 s7, s3, 640
    s_add_u32 s7, s7, 576
    v_add_u32 v6, s7, v0
    v_mul_u32_u24 v7, 1639, v6
    v_lshrrev_b32 v7, 17, v7
    v_mul_u32_u24 v8, 80, v7
    v_sub_u32 v8, v6, v8
    v_and_b32 v6, 7, v7
    v_lshlrev_b32 v6, 1, v6
    v_xor_b32 v8, v8, v6
    v_mul_u32_u24 v7, 1280, v7
    v_lshl_add_u32 v23, v8, 4, v7
    s_mul_i32 s76, s3, 10240
    s_mov_b32 s74, 0
    s_add_u32 m0, s76, 0
    s_nop 0
    buffer_load_dwordx4 v14, s[44:47], s74 offen lds
    s_add_u32 m0, s76, 1024
    s_nop 0
    buffer_load_dwordx4 v15, s[44:47], s74 offen lds
    s_add_u32 m0, s76, 2048
    s_nop 0
    buffer_load_dwordx4 v16, s[44:47], s74 offen lds
    s_add_u32 m0, s76, 3072
    s_nop 0
    buffer_load_dwordx4 v17, s[44:47], s74 offen lds
    s_add_u32 m0, s76, 4096
    s_nop 0
    buffer_load_dwordx4 v18, s[44:47], s74 offen lds
    s_add_u32 m0, s76, 5120
    s_nop 0
    buffer_load_dwordx4 v19, s[44:47], s74 offen lds
    s_add_u32 m0, s76, 6144
    s_nop 0
    buffer_load_dwordx4 v20, s[44:47], s74 offen lds
    s_add_u32 m0, s76, 7168
    s_nop 0
    buffer_load_dwordx4 v21, s[44:47], s74 offen lds
    s_add_u32 m0, s76, 8192
    s_nop 0
    buffer_load_dwordx4 v22, s[44:47], s74 offen lds
    s_add_u32 m0, s76, 9216
    s_nop 0
    buffer_load_dwordx4 v23, s[44:47], s74 offen lds
    v_and_b32 v6, 7, v1
    v_lshlrev_b32 v6, 1, v6
    v_add_u32 v7, 0, v2
    v_xor_b32 v7, v7, v6
    v_mul_u32_u24 v6, 1280, v1
    v_lshl_add_u32 v24, v7, 4, v6
    v_and_b32 v6, 7, v1
    v_lshlrev_b32 v6, 1, v6
    v_add_u32 v7, 4, v2
    v_xor_b32 v7, v7, v6
    v_mul_u32_u24 v6, 1280, v1
    v_lshl_add_u32 v25, v7, 4, v6
    v_and_b32 v6, 7, v1
    v_lshlrev_b32 v6, 1, v6
    v_add_u32 v7, 8, v2
    v_xor_b32 v7, v7, v6
    v_mul_u32_u24 v6, 1280, v1
    v_lshl_add_u32 v26, v7, 4, v6
    v_and_b32 v6, 7, v1
    v_lshlrev_b32 v6, 1, v6
    v_add_u32 v7, 12, v2
    v_xor_b32 v7, v7, v6
    v_mul_u32_u24 v6, 1280, v1
    v_lshl_add_u32 v27, v7, 4, v6
    s_mul_i32 s72, s3, 30720
    s_add_u32 s72, s72, 40960
    v_lshl_add_u32 v8, v2, 3, v3
    v_lshrrev_b32 v6, 2, v0
    v_mul_u32_u24 v6, 3072, v6
    v_lshl_add_u32 v9, v4, 4, v6
    v_add_u32 v10, 49152, v9
    s_lshl_b32 s73, s4, 8
    s_lshl_b32 s7, s3, 6
    s_add_u32 s73, s73, s7
    v_lshlrev_b32 v6, 6, v8
    v_and_b32 v7, 1, v4
    v_lshl_add_u32 v6, v7, 3, v6
    v_lshrrev_b32 v7, 1, v4
    v_lshl_add_u32 v6, v7, 11, v6
    v_add_u32 v13, s72, v6
    s_add_u32 m0, s72, 0
    s_nop 0
    buffer_load_dwordx4 v9, s[48:51], s73 offen lds
    s_add_u32 m0, s72, 1024
    s_nop 0
    buffer_load_dwordx4 v10, s[48:51], s73 offen lds
    s_add_u32 m0, s72, 2048
    s_nop 0
    buffer_load_dwordx4 v9, s[52:55], s73 offen lds
    s_add_u32 m0, s72, 3072
    s_nop 0
    buffer_load_dwordx4 v10, s[52:55], s73 offen lds
    s_add_u32 s73, s73, 98304
    s_add_u32 m0, s72, 4096
    s_nop 0
    buffer_load_dwordx4 v9, s[48:51], s73 offen lds
    s_add_u32 m0, s72, 5120
    s_nop 0
    buffer_load_dwordx4 v10, s[48:51], s73 offen lds
    s_add_u32 m0, s72, 6144
    s_nop 0
    buffer_load_dwordx4 v9, s[52:55], s73 offen lds
    s_add_u32 m0, s72, 7168
    s_nop 0
    buffer_load_dwordx4 v10, s[52:55], s73 offen lds
    s_add_u32 s73, s73, 98304
    s_add_u32 m0, s72, 8192
    s_nop 0
    buffer_load_dwordx4 v9, s[48:51], s73 offen lds
    s_add_u32 m0, s72, 9216
    s_nop 0
    buffer_load_dwordx4 v10, s[48:51], s73 offen lds
    s_add_u32 m0, s72, 10240
    s_nop 0
    buffer_load_dwordx4 v9, s[52:55], s73 offen lds
    s_add_u32 m0, s72, 11264
    s_nop 0
    buffer_load_dwordx4 v10, s[52:55], s73 offen lds
    s_add_u32 s73, s73, 98304
    s_add_u32 m0, s72, 12288
    s_nop 0
    buffer_load_dwordx4 v9, s[48:51], s73 offen lds
    s_add_u32 m0, s72, 13312
    s_nop 0
    buffer_load_dwordx4 v10, s[48:51], s73 offen lds
    s_add_u32 m0, s72, 14336
    s_nop 0
    buffer_load_dwordx4 v9, s[52:55], s73 offen lds
    s_add_u32 m0, s72, 15360
    s_nop 0
    buffer_load_dwordx4 v10, s[52:55], s73 offen lds
    s_add_u32 s73, s73, 98304
    s_add_u32 m0, s72, 16384
    s_nop 0
    buffer_load_dwordx4 v9, s[48:51], s73 offen lds
    s_add_u32 m0, s72, 17408
    s_nop 0
    buffer_load_dwordx4 v10, s[48:51], s73 offen lds
    s_add_u32 m0, s72, 18432
    s_nop 0
    buffer_load_dwordx4 v9, s[52:55], s73 offen lds
    s_add_u32 m0, s72, 19456
    s_nop 0
    buffer_load_dwordx4 v10, s[52:55], s73 offen lds
    s_add_u32 s73, s73, 98304
    s_add_u32 m0, s72, 20480
    s_nop 0
    buffer_load_dwordx4 v9, s[48:51], s73 offen lds
    s_add_u32 m0, s72, 21504
    s_nop 0
    buffer_load_dwordx4 v10, s[48:51], s73 offen lds
    s_add_u32 m0, s72, 22528
    s_nop 0
    buffer_load_dwordx4 v9, s[52:55], s73 offen lds
    s_add_u32 m0, s72, 23552
    s_nop 0
    buffer_load_dwordx4 v10, s[52:55], s73 offen lds
    s_add_u32 s73, s73, 98304
    s_add_u32 m0, s72, 24576
    s_nop 0
    buffer_load_dwordx4 v9, s[48:51], s73 offen lds
    s_add_u32 m0, s72, 25600
    s_nop 0
    buffer_load_dwordx4 v10, s[48:51], s73 offen lds
    s_add_u32 m0, s72, 26624
    s_nop 0
    buffer_load_dwordx4 v9, s[52:55], s73 offen lds
    s_add_u32 m0, s72, 27648
    s_nop 0
    buffer_load_dwordx4 v10, s[52:55], s73 offen lds
    s_add_u32 s73, s73, 98304
    s_waitcnt vmcnt(24)
    ds_read_b64_tr_b16 a[0:1], v13 offset:0
    ds_read_b64_tr_b16 a[2:3], v13 offset:256
    ds_read_b64_tr_b16 a[4:5], v13 offset:16
    ds_read_b64_tr_b16 a[6:7], v13 offset:272
    ds_read_b64_tr_b16 a[8:9], v13 offset:32
    ds_read_b64_tr_b16 a[10:11], v13 offset:288
    ds_read_b64_tr_b16 a[12:13], v13 offset:48
    ds_read_b64_tr_b16 a[14:15], v13 offset:304
    s_waitcnt lgkmcnt(0)
    s_add_u32 m0, s72, 0
    s_nop 0
    buffer_load_dwordx4 v9, s[48:51], s73 offen lds
    s_add_u32 m0, s72, 1024
    s_nop 0
    buffer_load_dwordx4 v10, s[48:51], s73 offen lds
    s_add_u32 m0, s72, 2048
    s_nop 0
    buffer_load_dwordx4 v9, s[52:55], s73 offen lds
    s_add_u32 m0, s72, 3072
    s_nop 0
    buffer_load_dwordx4 v10, s[52:55], s73 offen lds
    s_add_u32 s73, s73, 98304
    s_waitcnt vmcnt(24)
    ds_read_b64_tr_b16 a[16:17], v13 offset:4096
    ds_read_b64_tr_b16 a[18:19], v13 offset:4352
    ds_read_b64_tr_b16 a[20:21], v13 offset:4112
    ds_read_b64_tr_b16 a[22:23], v13 offset:4368
    ds_read_b64_tr_b16 a[24:25], v13 offset:4128
    ds_read_b64_tr_b16 a[26:27], v13 offset:4384
    ds_read_b64_tr_b16 a[28:29], v13 offset:4144
    ds_read_b64_tr_b16 a[30:31], v13 offset:4400
    s_waitcnt lgkmcnt(0)
    s_add_u32 m0, s72, 4096
    s_nop 0
    buffer_load_dwordx4 v9, s[48:51], s73 offen lds
    s_add_u32 m0, s72, 5120
    s_nop 0
    buffer_load_dwordx4 v10, s[48:51], s73 offen lds
    s_add_u32 m0, s72, 6144
    s_nop 0
    buffer_load_dwordx4 v9, s[52:55], s73 offen lds
    s_add_u32 m0, s72, 7168
    s_nop 0
    buffer_load_dwordx4 v10, s[52:55], s73 offen lds
    s_add_u32 s73, s73, 98304
    s_waitcnt vmcnt(24)
    ds_read_b64_tr_b16 a[32:33], v13 offset:8192
    ds_read_b64_tr_b16 a[34:35], v13 offset:8448
    ds_read_b64_tr_b16 a[36:37], v13 offset:8208
    ds_read_b64_tr_b16 a[38:39], v13 offset:8464
    ds_read_b64_tr_b16 a[40:41], v13 offset:8224
    ds_read_b64_tr_b16 a[42:43], v13 offset:8480
    ds_read_b64_tr_b16 a[44:45], v13 offset:8240
    ds_read_b64_tr_b16 a[46:47], v13 offset:8496
    s_waitcnt lgkmcnt(0)
    s_add_u32 m0, s72, 8192
    s_nop 0
    buffer_load_dwordx4 v9, s[48:51], s73 offen lds
    s_add_u32 m0, s72, 9216
    s_nop 0
    buffer_load_dwordx4 v10, s[48:51], s73 offen lds
    s_add_u32 m0, s72, 10240
    s_nop 0
    buffer_load_dwordx4 v9, s[52:55], s73 offen lds
    s_add_u32 m0, s72, 11264
    s_nop 0
    buffer_load_dwordx4 v10, s[52:55], s73 offen lds
    s_add_u32 s73, s73, 98304
    s_waitcnt vmcnt(24)
    ds_read_b64_tr_b16 a[48:49], v13 offset:12288
    ds_read_b64_tr_b16 a[50:51], v13 offset:12544
    ds_read_b64_tr_b16 a[52:53], v13 offset:12304
    ds_read_b64_tr_b16 a[54:55], v13 offset:12560
    ds_read_b64_tr_b16 a[56:57], v13 offset:12320
    ds_read_b64_tr_b16 a[58:59], v13 offset:12576
    ds_read_b64_tr_b16 a[60:61], v13 offset:12336
    ds_read_b64_tr_b16 a[62:63], v13 offset:12592
    s_waitcnt lgkmcnt(0)
    s_add_u32 m0, s72, 12288
    s_nop 0
    buffer_load_dwordx4 v9, s[48:51], s73 offen lds
    s_add_u32 m0, s72, 13312
    s_nop 0
    buffer_load_dwordx4 v10, s[48:51], s73 offen lds
    s_add_u32 m0, s72, 14336
    s_nop 0
    buffer_load_dwordx4 v9, s[52:55], s73 offen lds
    s_add_u32 m0, s72, 15360
    s_nop 0
    buffer_load_dwordx4 v10, s[52:55], s73 offen lds
    s_add_u32 s73, s73, 98304
    s_waitcnt vmcnt(24)
    ds_read_b64_tr_b16 a[64:65], v13 offset:16384
    ds_read_b64_tr_b16 a[66:67], v13 offset:16640
    ds_read_b64_tr_b16 a[68:69], v13 offset:16400
    ds_read_b64_tr_b16 a[70:71], v13 offset:16656
    ds_read_b64_tr_b16 a[72:73], v13 offset:16416
    ds_read_b64_tr_b16 a[74:75], v13 offset:16672
    ds_read_b64_tr_b16 a[76:77], v13 offset:16432
    ds_read_b64_tr_b16 a[78:79], v13 offset:16688
    s_waitcnt lgkmcnt(0)
    s_add_u32 m0, s72, 16384
    s_nop 0
    buffer_load_dwordx4 v9, s[48:51], s73 offen lds
    s_add_u32 m0, s72, 17408
    s_nop 0
    buffer_load_dwordx4 v10, s[48:51], s73 offen lds
    s_add_u32 m0, s72, 18432
    s_nop 0
    buffer_load_dwordx4 v9, s[52:55], s73 offen lds
    s_add_u32 m0, s72, 19456
    s_nop 0
    buffer_load_dwordx4 v10, s[52:55], s73 offen lds
    s_add_u32 s73, s73, 98304
    s_waitcnt vmcnt(24)
    ds_read_b64_tr_b16 a[80:81], v13 offset:20480
    ds_read_b64_tr_b16 a[82:83], v13 offset:20736
    ds_read_b64_tr_b16 a[84:85], v13 offset:20496
    ds_read_b64_tr_b16 a[86:87], v13 offset:20752
    ds_read_b64_tr_b16 a[88:89], v13 offset:20512
    ds_read_b64_tr_b16 a[90:91], v13 offset:20768
    ds_read_b64_tr_b16 a[92:93], v13 offset:20528
    ds_read_b64_tr_b16 a[94:95], v13 offset:20784
    s_waitcnt lgkmcnt(0)
    s_add_u32 m0, s72, 20480
    s_nop 0
    buffer_load_dwordx4 v9, s[48:51], s73 offen lds
    s_add_u32 m0, s72, 21504
    s_nop 0
    buffer_load_dwordx4 v10, s[48:51], s73 offen lds
    s_add_u32 m0, s72, 22528
    s_nop 0
    buffer_load_dwordx4 v9, s[52:55], s73 offen lds
    s_add_u32 m0, s72, 23552
    s_nop 0
    buffer_load_dwordx4 v10, s[52:55], s73 offen lds
    s_add_u32 s73, s73, 98304
    s_waitcnt vmcnt(24)
    ds_read_b64_tr_b16 a[96:97], v13 offset:24576
    ds_read_b64_tr_b16 a[98:99], v13 offset:24832
    ds_read_b64_tr_b16 a[100:101], v13 offset:24592
    ds_read_b64_tr_b16 a[102:103], v13 offset:24848
    ds_read_b64_tr_b16 a[104:105], v13 offset:24608
    ds_read_b64_tr_b16 a[106:107], v13 offset:24864
    ds_read_b64_tr_b16 a[108:109], v13 offset:24624
    ds_read_b64_tr_b16 a[110:111], v13 offset:24880
    s_waitcnt lgkmcnt(0)
    s_add_u32 m0, s72, 24576
    s_nop 0
    buffer_load_dwordx4 v9, s[48:51], s73 offen lds
    s_add_u32 m0, s72, 25600
    s_nop 0
    buffer_load_dwordx4 v10, s[48:51], s73 offen lds
    s_add_u32 m0, s72, 26624
    s_nop 0
    buffer_load_dwordx4 v9, s[52:55], s73 offen lds
    s_add_u32 m0, s72, 27648
    s_nop 0
    buffer_load_dwordx4 v10, s[52:55], s73 offen lds
    s_add_u32 s73, s73, 98304
    s_waitcnt vmcnt(24)
    ds_read_b64_tr_b16 a[112:113], v13 offset:0
    ds_read_b64_tr_b16 a[114:115], v13 offset:256
    ds_read_b64_tr_b16 a[116:117], v13 offset:16
    ds_read_b64_tr_b16 a[118:119], v13 offset:272
    ds_read_b64_tr_b16 a[120:121], v13 offset:32
    ds_read_b64_tr_b16 a[122:123], v13 offset:288
    ds_read_b64_tr_b16 a[124:125], v13 offset:48
    ds_read_b64_tr_b16 a[126:127], v13 offset:304
    s_waitcnt lgkmcnt(0)
    s_add_u32 m0, s72, 0
    s_nop 0
    buffer_load_dwordx4 v9, s[48:51], s73 offen lds
    s_add_u32 m0, s72, 1024
    s_nop 0
    buffer_load_dwordx4 v10, s[48:51], s73 offen lds
    s_add_u32 m0, s72, 2048
    s_nop 0
    buffer_load_dwordx4 v9, s[52:55], s73 offen lds
    s_add_u32 m0, s72, 3072
    s_nop 0
    buffer_load_dwordx4 v10, s[52:55], s73 offen lds
    s_add_u32 s73, s73, 98304
    s_waitcnt vmcnt(24)
    ds_read_b64_tr_b16 a[128:129], v13 offset:4096
    ds_read_b64_tr_b16 a[130:131], v13 offset:4352
    ds_read_b64_tr_b16 a[132:133], v13 offset:4112
    ds_read_b64_tr_b16 a[134:135], v13 offset:4368
    ds_read_b64_tr_b16 a[136:137], v13 offset:4128
    ds_read_b64_tr_b16 a[138:139], v13 offset:4384
    ds_read_b64_tr_b16 a[140:141], v13 offset:4144
    ds_read_b64_tr_b16 a[142:143], v13 offset:4400
    s_waitcnt lgkmcnt(0)
    s_add_u32 m0, s72, 4096
    s_nop 0
    buffer_load_dwordx4 v9, s[48:51], s73 offen lds
    s_add_u32 m0, s72, 5120
    s_nop 0
    buffer_load_dwordx4 v10, s[48:51], s73 offen lds
    s_add_u32 m0, s72, 6144
    s_nop 0
    buffer_load_dwordx4 v9, s[52:55], s73 offen lds
    s_add_u32 m0, s72, 7168
    s_nop 0
    buffer_load_dwordx4 v10, s[52:55], s73 offen lds
    s_add_u32 s73, s73, 98304
    s_waitcnt vmcnt(24)
    ds_read_b64_tr_b16 a[144:145], v13 offset:8192
    ds_read_b64_tr_b16 a[146:147], v13 offset:8448
    ds_read_b64_tr_b16 a[148:149], v13 offset:8208
    ds_read_b64_tr_b16 a[150:151], v13 offset:8464
    ds_read_b64_tr_b16 a[152:153], v13 offset:8224
    ds_read_b64_tr_b16 a[154:155], v13 offset:8480
    ds_read_b64_tr_b16 a[156:157], v13 offset:8240
    ds_read_b64_tr_b16 a[158:159], v13 offset:8496
    s_waitcnt lgkmcnt(0)
    s_add_u32 m0, s72, 8192
    s_nop 0
    buffer_load_dwordx4 v9, s[48:51], s73 offen lds
    s_add_u32 m0, s72, 9216
    s_nop 0
    buffer_load_dwordx4 v10, s[48:51], s73 offen lds
    s_add_u32 m0, s72, 10240
    s_nop 0
    buffer_load_dwordx4 v9, s[52:55], s73 offen lds
    s_add_u32 m0, s72, 11264
    s_nop 0
    buffer_load_dwordx4 v10, s[52:55], s73 offen lds
    s_add_u32 s73, s73, 98304
    s_waitcnt vmcnt(24)
    ds_read_b64_tr_b16 a[160:161], v13 offset:12288
    ds_read_b64_tr_b16 a[162:163], v13 offset:12544
    ds_read_b64_tr_b16 a[164:165], v13 offset:12304
    ds_read_b64_tr_b16 a[166:167], v13 offset:12560
    ds_read_b64_tr_b16 a[168:169], v13 offset:12320
    ds_read_b64_tr_b16 a[170:171], v13 offset:12576
    ds_read_b64_tr_b16 a[172:173], v13 offset:12336
    ds_read_b64_tr_b16 a[174:175], v13 offset:12592
    s_waitcnt lgkmcnt(0)
    s_add_u32 m0, s72, 12288
    s_nop 0
    buffer_load_dwordx4 v9, s[48:51], s73 offen lds
    s_add_u32 m0, s72, 13312
    s_nop 0
    buffer_load_dwordx4 v10, s[48:51], s73 offen lds
    s_add_u32 m0, s72, 14336
    s_nop 0
    buffer_load_dwordx4 v9, s[52:55], s73 offen lds
    s_add_u32 m0, s72, 15360
    s_nop 0
    buffer_load_dwordx4 v10, s[52:55], s73 offen lds
    s_add_u32 s73, s73, 98304
    s_waitcnt vmcnt(24)
    ds_read_b64_tr_b16 a[176:177], v13 offset:16384
    ds_read_b64_tr_b16 a[178:179], v13 offset:16640
    ds_read_b64_tr_b16 a[180:181], v13 offset:16400
    ds_read_b64_tr_b16 a[182:183], v13 offset:16656
    ds_read_b64_tr_b16 a[184:185], v13 offset:16416
    ds_read_b64_tr_b16 a[186:187], v13 offset:16672
    ds_read_b64_tr_b16 a[188:189], v13 offset:16432
    ds_read_b64_tr_b16 a[190:191], v13 offset:16688
    s_waitcnt lgkmcnt(0)
    s_add_u32 m0, s72, 16384
    s_nop 0
    buffer_load_dwordx4 v9, s[48:51], s73 offen lds
    s_add_u32 m0, s72, 17408
    s_nop 0
    buffer_load_dwordx4 v10, s[48:51], s73 offen lds
    s_add_u32 m0, s72, 18432
    s_nop 0
    buffer_load_dwordx4 v9, s[52:55], s73 offen lds
    s_add_u32 m0, s72, 19456
    s_nop 0
    buffer_load_dwordx4 v10, s[52:55], s73 offen lds
    s_add_u32 s73, s73, 98304
    s_waitcnt vmcnt(24)
    ds_read_b64_tr_b16 a[192:193], v13 offset:20480
    ds_read_b64_tr_b16 a[194:195], v13 offset:20736
    ds_read_b64_tr_b16 a[196:197], v13 offset:20496
    ds_read_b64_tr_b16 a[198:199], v13 offset:20752
    ds_read_b64_tr_b16 a[200:201], v13 offset:20512
    ds_read_b64_tr_b16 a[202:203], v13 offset:20768
    ds_read_b64_tr_b16 a[204:205], v13 offset:20528
    ds_read_b64_tr_b16 a[206:207], v13 offset:20784
    s_waitcnt lgkmcnt(0)
    s_add_u32 m0, s72, 20480
    s_nop 0
    buffer_load_dwordx4 v9, s[48:51], s73 offen lds
    s_add_u32 m0, s72, 21504
    s_nop 0
    buffer_load_dwordx4 v10, s[48:51], s73 offen lds
    s_add_u32 m0, s72, 22528
    s_nop 0
    buffer_load_dwordx4 v9, s[52:55], s73 offen lds
    s_add_u32 m0, s72, 23552
    s_nop 0
    buffer_load_dwordx4 v10, s[52:55], s73 offen lds
    s_add_u32 s73, s73, 98304
    s_waitcnt vmcnt(24)
    ds_read_b64_tr_b16 a[208:209], v13 offset:24576
    ds_read_b64_tr_b16 a[210:211], v13 offset:24832
    ds_read_b64_tr_b16 a[212:213], v13 offset:24592
    ds_read_b64_tr_b16 a[214:215], v13 offset:24848
    ds_read_b64_tr_b16 a[216:217], v13 offset:24608
    ds_read_b64_tr_b16 a[218:219], v13 offset:24864
    ds_read_b64_tr_b16 a[220:221], v13 offset:24624
    ds_read_b64_tr_b16 a[222:223], v13 offset:24880
    s_waitcnt vmcnt(20)
    ds_read_b64_tr_b16 a[224:225], v13 offset:0
    ds_read_b64_tr_b16 a[226:227], v13 offset:256
    ds_read_b64_tr_b16 a[228:229], v13 offset:16
    ds_read_b64_tr_b16 a[230:231], v13 offset:272
    ds_read_b64_tr_b16 a[232:233], v13 offset:32
    ds_read_b64_tr_b16 a[234:235], v13 offset:288
    ds_read_b64_tr_b16 a[236:237], v13 offset:48
    ds_read_b64_tr_b16 a[238:239], v13 offset:304
    s_waitcnt vmcnt(16)
    ds_read_b64_tr_b16 a[240:241], v13 offset:4096
    ds_read_b64_tr_b16 a[242:243], v13 offset:4352
    ds_read_b64_tr_b16 a[244:245], v13 offset:4112
    ds_read_b64_tr_b16 a[246:247], v13 offset:4368
    ds_read_b64_tr_b16 a[248:249], v13 offset:4128
    ds_read_b64_tr_b16 a[250:251], v13 offset:4384
    ds_read_b64_tr_b16 a[252:253], v13 offset:4144
    ds_read_b64_tr_b16 a[254:255], v13 offset:4400
    s_waitcnt vmcnt(12)
    ds_read_b64_tr_b16 v[192:193], v13 offset:8192
    ds_read_b64_tr_b16 v[194:195], v13 offset:8448
    ds_read_b64_tr_b16 v[196:197], v13 offset:8208
    ds_read_b64_tr_b16 v[198:199], v13 offset:8464
    ds_read_b64_tr_b16 v[200:201], v13 offset:8224
    ds_read_b64_tr_b16 v[202:203], v13 offset:8480
    ds_read_b64_tr_b16 v[204:205], v13 offset:8240
    ds_read_b64_tr_b16 v[206:207], v13 offset:8496
    s_waitcnt vmcnt(8)
    ds_read_b64_tr_b16 v[208:209], v13 offset:12288
    ds_read_b64_tr_b16 v[210:211], v13 offset:12544
    ds_read_b64_tr_b16 v[212:213], v13 offset:12304
    ds_read_b64_tr_b16 v[214:215], v13 offset:12560
    ds_read_b64_tr_b16 v[216:217], v13 offset:12320
    ds_read_b64_tr_b16 v[218:219], v13 offset:12576
    ds_read_b64_tr_b16 v[220:221], v13 offset:12336
    ds_read_b64_tr_b16 v[222:223], v13 offset:12592
    s_waitcnt vmcnt(4)
    ds_read_b64_tr_b16 v[224:225], v13 offset:16384
    ds_read_b64_tr_b16 v[226:227], v13 offset:16640
    ds_read_b64_tr_b16 v[228:229], v13 offset:16400
    ds_read_b64_tr_b16 v[230:231], v13 offset:16656
    ds_read_b64_tr_b16 v[232:233], v13 offset:16416
    ds_read_b64_tr_b16 v[234:235], v13 offset:16672
    ds_read_b64_tr_b16 v[236:237], v13 offset:16432
    ds_read_b64_tr_b16 v[238:239], v13 offset:16688
    s_waitcnt vmcnt(0)
    ds_read_b64_tr_b16 v[240:241], v13 offset:20480
    ds_read_b64_tr_b16 v[242:243], v13 offset:20736
    ds_read_b64_tr_b16 v[244:245], v13 offset:20496
    ds_read_b64_tr_b16 v[246:247], v13 offset:20752
    ds_read_b64_tr_b16 v[248:249], v13 offset:20512
    ds_read_b64_tr_b16 v[250:251], v13 offset:20768
    ds_read_b64_tr_b16 v[252:253], v13 offset:20528
    ds_read_b64_tr_b16 v[254:255], v13 offset:20784
    s_waitcnt lgkmcnt(0)
    v_lshrrev_b32 v6, 5, v0
    v_mul_u32_u24 v6, 49152, v6
    v_lshl_add_u32 v6, v1, 4, v6
    v_and_b32 v7, 1, v2
    v_lshl_add_u32 v28, v7, 8, v6
    s_lshl_b32 s71, s4, 2
    s_add_u32 s71, s71, s3
    s_lshl_b32 s71, s71, 10
    s_add_u32 s71, s71, 0x1600000
    s_mov_b32 s75, 0
    s_mov_b32 s85, 40960
    s_waitcnt vmcnt(0)
    s_barrier
    s_add_u32 s76, s76, 40960
    s_add_u32 s74, s74, 40960
    s_add_u32 m0, s76, 0
    s_nop 0
    buffer_load_dwordx4 v14, s[44:47], s74 offen lds
    s_add_u32 m0, s76, 1024
    s_nop 0
    buffer_load_dwordx4 v15, s[44:47], s74 offen lds
    s_add_u32 m0, s76, 2048
    s_nop 0
    buffer_load_dwordx4 v16, s[44:47], s74 offen lds
    s_add_u32 m0, s76, 3072
    s_nop 0
    buffer_load_dwordx4 v17, s[44:47], s74 offen lds
    s_add_u32 m0, s76, 4096
    s_nop 0
    buffer_load_dwordx4 v18, s[44:47], s74 offen lds
    s_add_u32 m0, s76, 5120
    s_nop 0
    buffer_load_dwordx4 v19, s[44:47], s74 offen lds
    s_add_u32 m0, s76, 6144
    s_nop 0
    buffer_load_dwordx4 v20, s[44:47], s74 offen lds
    s_add_u32 m0, s76, 7168
    s_nop 0
    buffer_load_dwordx4 v21, s[44:47], s74 offen lds
    s_add_u32 m0, s76, 8192
    s_nop 0
    buffer_load_dwordx4 v22, s[44:47], s74 offen lds
    s_add_u32 m0, s76, 9216
    s_nop 0
    buffer_load_dwordx4 v23, s[44:47], s74 offen lds
    s_mov_b32 s89, 0x40000000
    s_mov_b32 s77, 0xc0135761
    s_mov_b32 s78, 0xbdd2d3e8
    v_mov_b32 v140, s77
.p2align 6
L_ba_loop_5:
    s_cmp_eq_u32 s75, 1
    s_cselect_b32 s7, -81920, s85
    s_add_u32 s76, s76, s7
    s_add_u32 s74, s74, 40960
    ds_read_b128 v[72:75], v24 offset:0
    ds_read_b128 v[76:79], v24 offset:20480
    ds_read_b128 v[80:83], v25 offset:0
    ds_read_b128 v[84:87], v25 offset:20480
    ds_read_b128 v[88:91], v26 offset:0
    ds_read_b128 v[92:95], v26 offset:20480
    ds_read_b128 v[96:99], v27 offset:0
    ds_read_b128 v[100:103], v27 offset:20480
    s_waitcnt lgkmcnt(6)
    v_mfma_f32_16x16x32_bf16 v[32:35], a[0:3], v[72:75], 0
    v_permlane32_swap_b32 v104, v108
    v_mfma_f32_16x16x32_bf16 v[36:39], a[0:3], v[76:79], 0
    v_permlane32_swap_b32 v105, v109
    v_mfma_f32_16x16x32_bf16 v[40:43], a[4:7], v[72:75], 0
    v_permlane32_swap_b32 v106, v110
    v_mfma_f32_16x16x32_bf16 v[44:47], a[4:7], v[76:79], 0
    v_permlane32_swap_b32 v107, v111
    v_mfma_f32_16x16x32_bf16 v[48:51], a[8:11], v[72:75], 0
    v_mul_f32 v136, v104, v104
    v_mfma_f32_16x16x32_bf16 v[52:55], a[8:11], v[76:79], 0
    v_mul_f32 v137, v105, v105
    v_mfma_f32_16x16x32_bf16 v[56:59], a[12:15], v[72:75], 0
    v_mul_f32 v138, v106, v106
    v_mfma_f32_16x16x32_bf16 v[60:63], a[12:15], v[76:79], 0
    v_mul_f32 v139, v107, v107
    ds_read_b128 v[72:75], v24 offset:256
    ds_read_b128 v[76:79], v24 offset:20736
    s_waitcnt lgkmcnt(6)
    v_mfma_f32_16x16x32_bf16 v[32:35], a[16:19], v[80:83], v[32:35]
    v_fma_f32 v136, v136, s78, v140
    v_mfma_f32_16x16x32_bf16 v[36:39], a[16:19], v[84:87], v[36:39]
    v_fma_f32 v137, v137, s78, v140
    v_mfma_f32_16x16x32_bf16 v[40:43], a[20:23], v[80:83], v[40:43]
    v_fma_f32 v138, v138, s78, v140
    v_mfma_f32_16x16x32_bf16 v[44:47], a[20:23], v[84:87], v[44:47]
    v_fma_f32 v139, v139, s78, v140
    v_mfma_f32_16x16x32_bf16 v[48:51], a[24:27], v[80:83], v[48:51]
    v_mul_f32 v136, v136, v104
    v_mfma_f32_16x16x32_bf16 v[52:55], a[24:27], v[84:87], v[52:55]
    v_mul_f32 v137, v137, v105
    v_mfma_f32_16x16x32_bf16 v[56:59], a[28:31], v[80:83], v[56:59]
    v_mul_f32 v138, v138, v106
    v_mfma_f32_16x16x32_bf16 v[60:63], a[28:31], v[84:87], v[60:63]
    v_mul_f32 v139, v139, v107
    ds_read_b128 v[80:83], v25 offset:256
    ds_read_b128 v[84:87], v25 offset:20736
    s_waitcnt lgkmcnt(6)
    v_mfma_f32_16x16x32_bf16 v[32:35], a[32:35], v[88:91], v[32:35]
    v_exp_f32 v136, v136
    v_mfma_f32_16x16x32_bf16 v[36:39], a[32:35], v[92:95], v[36:39]
    v_exp_f32 v137, v137
    v_mfma_f32_16x16x32_bf16 v[40:43], a[36:39], v[88:91], v[40:43]
    v_exp_f32 v138, v138
    v_mfma_f32_16x16x32_bf16 v[44:47], a[36:39], v[92:95], v[44:47]
    v_exp_f32 v139, v139
    v_mfma_f32_16x16x32_bf16 v[48:51], a[40:43], v[88:91], v[48:51]
    v_mul_f32 v104, v104, v108
    v_mfma_f32_16x16x32_bf16 v[52:55], a[40:43], v[92:95], v[52:55]
    v_mul_f32 v105, v105, v109
    v_mfma_f32_16x16x32_bf16 v[56:59], a[44:47], v[88:91], v[56:59]
    v_mul_f32 v106, v106, v110
    v_mfma_f32_16x16x32_bf16 v[60:63], a[44:47], v[92:95], v[60:63]
    v_mul_f32 v107, v107, v111
    ds_read_b128 v[88:91], v26 offset:256
    ds_read_b128 v[92:95], v26 offset:20736
    s_waitcnt lgkmcnt(6)
    v_mfma_f32_16x16x32_bf16 v[32:35], a[48:51], v[96:99], v[32:35]
    v_add_f32 v136, 1.0, v136
    v_mfma_f32_16x16x32_bf16 v[36:39], a[48:51], v[100:103], v[36:39]
    v_add_f32 v137, 1.0, v137
    v_mfma_f32_16x16x32_bf16 v[40:43], a[52:55], v[96:99], v[40:43]
    v_add_f32 v138, 1.0, v138
    v_mfma_f32_16x16x32_bf16 v[44:47], a[52:55], v[100:103], v[44:47]
    v_add_f32 v139, 1.0, v139
    v_mfma_f32_16x16x32_bf16 v[48:51], a[56:59], v[96:99], v[48:51]
    v_rcp_f32 v136, v136
    v_mfma_f32_16x16x32_bf16 v[52:55], a[56:59], v[100:103], v[52:55]
    v_rcp_f32 v137, v137
    v_mfma_f32_16x16x32_bf16 v[56:59], a[60:63], v[96:99], v[56:59]
    v_rcp_f32 v138, v138
    v_mfma_f32_16x16x32_bf16 v[60:63], a[60:63], v[100:103], v[60:63]
    v_rcp_f32 v139, v139
    ds_read_b128 v[96:99], v27 offset:256
    ds_read_b128 v[100:103], v27 offset:20736
    s_waitcnt lgkmcnt(6)
    v_mfma_f32_16x16x32_bf16 v[32:35], a[64:67], v[72:75], v[32:35]
    v_mul_f32 v104, v104, v136
    v_mfma_f32_16x16x32_bf16 v[36:39], a[64:67], v[76:79], v[36:39]
    v_mul_f32 v105, v105, v137
    v_mfma_f32_16x16x32_bf16 v[40:43], a[68:71], v[72:75], v[40:43]
    v_mul_f32 v106, v106, v138
    v_mfma_f32_16x16x32_bf16 v[44:47], a[68:71], v[76:79], v[44:47]
    v_mul_f32 v107, v107, v139
    v_mfma_f32_16x16x32_bf16 v[48:51], a[72:75], v[72:75], v[48:51]
    v_cvt_pk_bf16_f32 v144, v104, v105
    v_mfma_f32_16x16x32_bf16 v[52:55], a[72:75], v[76:79], v[52:55]
    v_cvt_pk_bf16_f32 v145, v106, v107
    v_mfma_f32_16x16x32_bf16 v[56:59], a[76:79], v[72:75], v[56:59]
    v_permlane32_swap_b32 v112, v116
    v_mfma_f32_16x16x32_bf16 v[60:63], a[76:79], v[76:79], v[60:63]
    v_permlane32_swap_b32 v113, v117
    ds_read_b128 v[72:75], v24 offset:512
    ds_read_b128 v[76:79], v24 offset:20992
    s_waitcnt lgkmcnt(6)
    v_mfma_f32_16x16x32_bf16 v[32:35], a[80:83], v[80:83], v[32:35]
    v_permlane32_swap_b32 v114, v118
    v_mfma_f32_16x16x32_bf16 v[36:39], a[80:83], v[84:87], v[36:39]
    v_permlane32_swap_b32 v115, v119
    v_mfma_f32_16x16x32_bf16 v[40:43], a[84:87], v[80:83], v[40:43]
    v_mul_f32 v136, v112, v112
    v_mfma_f32_16x16x32_bf16 v[44:47], a[84:87], v[84:87], v[44:47]
    v_mul_f32 v137, v113, v113
    v_mfma_f32_16x16x32_bf16 v[48:51], a[88:91], v[80:83], v[48:51]
    v_mul_f32 v138, v114, v114
    v_mfma_f32_16x16x32_bf16 v[52:55], a[88:91], v[84:87], v[52:55]
    v_mul_f32 v139, v115, v115
    v_mfma_f32_16x16x32_bf16 v[56:59], a[92:95], v[80:83], v[56:59]
    v_fma_f32 v136, v136, s78, v140
    v_mfma_f32_16x16x32_bf16 v[60:63], a[92:95], v[84:87], v[60:63]
    v_fma_f32 v137, v137, s78, v140
    s_waitcnt vmcnt(0)
    s_barrier
    s_max_i32 s7, s5, 1
    s_sub_u32 s7, s7, 1
    v_mov_b32 v8, s7
    buffer_store_dword v8, v5, s[40:43], s70 offen sc1
    ds_read_b128 v[80:83], v25 offset:512
    ds_read_b128 v[84:87], v25 offset:20992
    s_waitcnt lgkmcnt(6)
    v_mfma_f32_16x16x32_bf16 v[32:35], a[96:99], v[88:91], v[32:35]
    v_fma_f32 v138, v138, s78, v140
    v_mfma_f32_16x16x32_bf16 v[36:39], a[96:99], v[92:95], v[36:39]
    v_fma_f32 v139, v139, s78, v140
    v_mfma_f32_16x16x32_bf16 v[40:43], a[100:103], v[88:91], v[40:43]
    v_mul_f32 v136, v136, v112
    v_mfma_f32_16x16x32_bf16 v[44:47], a[100:103], v[92:95], v[44:47]
    v_mul_f32 v137, v137, v113
    v_mfma_f32_16x16x32_bf16 v[48:51], a[104:107], v[88:91], v[48:51]
    v_mul_f32 v138, v138, v114
    v_mfma_f32_16x16x32_bf16 v[52:55], a[104:107], v[92:95], v[52:55]
    v_mul_f32 v139, v139, v115
    v_mfma_f32_16x16x32_bf16 v[56:59], a[108:111], v[88:91], v[56:59]
    v_exp_f32 v136, v136
    v_mfma_f32_16x16x32_bf16 v[60:63], a[108:111], v[92:95], v[60:63]
    v_exp_f32 v137, v137
    ds_read_b128 v[88:91], v26 offset:512
    ds_read_b128 v[92:95], v26 offset:20992
    s_waitcnt lgkmcnt(6)
    v_mfma_f32_16x16x32_bf16 v[32:35], a[112:115], v[96:99], v[32:35]
    v_exp_f32 v138, v138
    v_mfma_f32_16x16x32_bf16 v[36:39], a[112:115], v[100:103], v[36:39]
    v_exp_f32 v139, v139
    v_mfma_f32_16x16x32_bf16 v[40:43], a[116:119], v[96:99], v[40:43]
    v_mul_f32 v112, v112, v116
    v_mfma_f32_16x16x32_bf16 v[44:47], a[116:119], v[100:103], v[44:47]
    v_mul_f32 v113, v113, v117
    v_mfma_f32_16x16x32_bf16 v[48:51], a[120:123], v[96:99], v[48:51]
    v_mul_f32 v114, v114, v118
    v_mfma_f32_16x16x32_bf16 v[52:55], a[120:123], v[100:103], v[52:55]
    v_mul_f32 v115, v115, v119
    v_mfma_f32_16x16x32_bf16 v[56:59], a[124:127], v[96:99], v[56:59]
    v_add_f32 v136, 1.0, v136
    v_mfma_f32_16x16x32_bf16 v[60:63], a[124:127], v[100:103], v[60:63]
    v_add_f32 v137, 1.0, v137
    ds_read_b128 v[96:99], v27 offset:512
    ds_read_b128 v[100:103], v27 offset:20992
    s_waitcnt lgkmcnt(6)
    v_mfma_f32_16x16x32_bf16 v[32:35], a[128:131], v[72:75], v[32:35]
    v_add_f32 v138, 1.0, v138
    v_mfma_f32_16x16x32_bf16 v[36:39], a[128:131], v[76:79], v[36:39]
    v_add_f32 v139, 1.0, v139
    v_mfma_f32_16x16x32_bf16 v[40:43], a[132:135], v[72:75], v[40:43]
    v_rcp_f32 v136, v136
    v_mfma_f32_16x16x32_bf16 v[44:47], a[132:135], v[76:79], v[44:47]
    s_add_u32 m0, s76, 0
    s_nop 0
    buffer_load_dwordx4 v14, s[44:47], s74 offen lds
    v_mfma_f32_16x16x32_bf16 v[48:51], a[136:139], v[72:75], v[48:51]
    v_rcp_f32 v137, v137
    v_mfma_f32_16x16x32_bf16 v[52:55], a[136:139], v[76:79], v[52:55]
    v_rcp_f32 v138, v138
    v_mfma_f32_16x16x32_bf16 v[56:59], a[140:143], v[72:75], v[56:59]
    v_rcp_f32 v139, v139
    v_mfma_f32_16x16x32_bf16 v[60:63], a[140:143], v[76:79], v[60:63]
    v_mul_f32 v112, v112, v136
    ds_read_b128 v[72:75], v24 offset:768
    ds_read_b128 v[76:79], v24 offset:21248
    s_waitcnt lgkmcnt(6)
    v_mfma_f32_16x16x32_bf16 v[32:35], a[144:147], v[80:83], v[32:35]
    v_mul_f32 v113, v113, v137
    v_mfma_f32_16x16x32_bf16 v[36:39], a[144:147], v[84:87], v[36:39]
    v_mul_f32 v114, v114, v138
    v_mfma_f32_16x16x32_bf16 v[40:43], a[148:151], v[80:83], v[40:43]
    v_mul_f32 v115, v115, v139
    v_mfma_f32_16x16x32_bf16 v[44:47], a[148:151], v[84:87], v[44:47]
    s_add_u32 m0, s76, 1024
    s_nop 0
    buffer_load_dwordx4 v15, s[44:47], s74 offen lds
    v_mfma_f32_16x16x32_bf16 v[48:51], a[152:155], v[80:83], v[48:51]
    v_cvt_pk_bf16_f32 v146, v112, v113
    v_mfma_f32_16x16x32_bf16 v[52:55], a[152:155], v[84:87], v[52:55]
    v_cvt_pk_bf16_f32 v147, v114, v115
    v_mfma_f32_16x16x32_bf16 v[56:59], a[156:159], v[80:83], v[56:59]
    buffer_store_dwordx4 v[144:147], v28, s[40:43], s89 offen offset:0 sc1
    v_mfma_f32_16x16x32_bf16 v[60:63], a[156:159], v[84:87], v[60:63]
    v_permlane32_swap_b32 v120, v124
    ds_read_b128 v[80:83], v25 offset:768
    ds_read_b128 v[84:87], v25 offset:21248
    s_waitcnt lgkmcnt(6)
    v_mfma_f32_16x16x32_bf16 v[32:35], a[160:163], v[88:91], v[32:35]
    v_permlane32_swap_b32 v121, v125
    v_mfma_f32_16x16x32_bf16 v[36:39], a[160:163], v[92:95], v[36:39]
    v_permlane32_swap_b32 v122, v126
    v_mfma_f32_16x16x32_bf16 v[40:43], a[164:167], v[88:91], v[40:43]
    v_permlane32_swap_b32 v123, v127
    v_mfma_f32_16x16x32_bf16 v[44:47], a[164:167], v[92:95], v[44:47]
    s_add_u32 m0, s76, 2048
    s_nop 0
    buffer_load_dwordx4 v16, s[44:47], s74 offen lds
    v_mfma_f32_16x16x32_bf16 v[48:51], a[168:171], v[88:91], v[48:51]
    v_mul_f32 v136, v120, v120
    v_mfma_f32_16x16x32_bf16 v[52:55], a[168:171], v[92:95], v[52:55]
    v_mul_f32 v137, v121, v121
    v_mfma_f32_16x16x32_bf16 v[56:59], a[172:175], v[88:91], v[56:59]
    v_mul_f32 v138, v122, v122
    v_mfma_f32_16x16x32_bf16 v[60:63], a[172:175], v[92:95], v[60:63]
    v_mul_f32 v139, v123, v123
    ds_read_b128 v[88:91], v26 offset:768
    ds_read_b128 v[92:95], v26 offset:21248
    s_waitcnt lgkmcnt(6)
    v_mfma_f32_16x16x32_bf16 v[32:35], a[176:179], v[96:99], v[32:35]
    v_fma_f32 v136, v136, s78, v140
    v_mfma_f32_16x16x32_bf16 v[36:39], a[176:179], v[100:103], v[36:39]
    v_fma_f32 v137, v137, s78, v140
    v_mfma_f32_16x16x32_bf16 v[40:43], a[180:183], v[96:99], v[40:43]
    v_fma_f32 v138, v138, s78, v140
    v_mfma_f32_16x16x32_bf16 v[44:47], a[180:183], v[100:103], v[44:47]
    s_add_u32 m0, s76, 3072
    s_nop 0
    buffer_load_dwordx4 v17, s[44:47], s74 offen lds
    v_mfma_f32_16x16x32_bf16 v[48:51], a[184:187], v[96:99], v[48:51]
    v_fma_f32 v139, v139, s78, v140
    v_mfma_f32_16x16x32_bf16 v[52:55], a[184:187], v[100:103], v[52:55]
    v_mul_f32 v136, v136, v120
    v_mfma_f32_16x16x32_bf16 v[56:59], a[188:191], v[96:99], v[56:59]
    v_mul_f32 v137, v137, v121
    v_mfma_f32_16x16x32_bf16 v[60:63], a[188:191], v[100:103], v[60:63]
    v_mul_f32 v138, v138, v122
    ds_read_b128 v[96:99], v27 offset:768
    ds_read_b128 v[100:103], v27 offset:21248
    s_waitcnt lgkmcnt(6)
    v_mfma_f32_16x16x32_bf16 v[32:35], a[192:195], v[72:75], v[32:35]
    v_mul_f32 v139, v139, v123
    v_mfma_f32_16x16x32_bf16 v[36:39], a[192:195], v[76:79], v[36:39]
    v_exp_f32 v136, v136
    v_mfma_f32_16x16x32_bf16 v[40:43], a[196:199], v[72:75], v[40:43]
    v_exp_f32 v137, v137
    v_mfma_f32_16x16x32_bf16 v[44:47], a[196:199], v[76:79], v[44:47]
    s_add_u32 m0, s76, 4096
    s_nop 0
    buffer_load_dwordx4 v18, s[44:47], s74 offen lds
    v_mfma_f32_16x16x32_bf16 v[48:51], a[200:203], v[72:75], v[48:51]
    v_exp_f32 v138, v138
    v_mfma_f32_16x16x32_bf16 v[52:55], a[200:203], v[76:79], v[52:55]
    v_exp_f32 v139, v139
    v_mfma_f32_16x16x32_bf16 v[56:59], a[204:207], v[72:75], v[56:59]
    v_mul_f32 v120, v120, v124
    v_mfma_f32_16x16x32_bf16 v[60:63], a[204:207], v[76:79], v[60:63]
    v_mul_f32 v121, v121, v125
    ds_read_b128 v[72:75], v24 offset:1024
    ds_read_b128 v[76:79], v24 offset:21504
    s_waitcnt lgkmcnt(6)
    v_mfma_f32_16x16x32_bf16 v[32:35], a[208:211], v[80:83], v[32:35]
    v_mul_f32 v122, v122, v126
    v_mfma_f32_16x16x32_bf16 v[36:39], a[208:211], v[84:87], v[36:39]
    v_mul_f32 v123, v123, v127
    v_mfma_f32_16x16x32_bf16 v[40:43], a[212:215], v[80:83], v[40:43]
    v_add_f32 v136, 1.0, v136
    v_mfma_f32_16x16x32_bf16 v[44:47], a[212:215], v[84:87], v[44:47]
    s_add_u32 m0, s76, 5120
    s_nop 0
    buffer_load_dwordx4 v19, s[44:47], s74 offen lds
    v_mfma_f32_16x16x32_bf16 v[48:51], a[216:219], v[80:83], v[48:51]
    v_add_f32 v137, 1.0, v137
    v_mfma_f32_16x16x32_bf16 v[52:55], a[216:219], v[84:87], v[52:55]
    v_add_f32 v138, 1.0, v138
    v_mfma_f32_16x16x32_bf16 v[56:59], a[220:223], v[80:83], v[56:59]
    v_add_f32 v139, 1.0, v139
    v_mfma_f32_16x16x32_bf16 v[60:63], a[220:223], v[84:87], v[60:63]
    v_rcp_f32 v136, v136
    ds_read_b128 v[80:83], v25 offset:1024
    ds_read_b128 v[84:87], v25 offset:21504
    s_waitcnt lgkmcnt(6)
    v_mfma_f32_16x16x32_bf16 v[32:35], a[224:227], v[88:91], v[32:35]
    v_rcp_f32 v137, v137
    v_mfma_f32_16x16x32_bf16 v[36:39], a[224:227], v[92:95], v[36:39]
    v_rcp_f32 v138, v138
    v_mfma_f32_16x16x32_bf16 v[40:43], a[228:231], v[88:91], v[40:43]
    v_rcp_f32 v139, v139
    v_mfma_f32_16x16x32_bf16 v[44:47], a[228:231], v[92:95], v[44:47]
    s_add_u32 m0, s76, 6144
    s_nop 0
    buffer_load_dwordx4 v20, s[44:47], s74 offen lds
    v_mfma_f32_16x16x32_bf16 v[48:51], a[232:235], v[88:91], v[48:51]
    v_mul_f32 v120, v120, v136
    v_mfma_f32_16x16x32_bf16 v[52:55], a[232:235], v[92:95], v[52:55]
    v_mul_f32 v121, v121, v137
    v_mfma_f32_16x16x32_bf16 v[56:59], a[236:239], v[88:91], v[56:59]
    v_mul_f32 v122, v122, v138
    v_mfma_f32_16x16x32_bf16 v[60:63], a[236:239], v[92:95], v[60:63]
    v_mul_f32 v123, v123, v139
    ds_read_b128 v[88:91], v26 offset:1024
    ds_read_b128 v[92:95], v26 offset:21504
    s_waitcnt lgkmcnt(6)
    v_mfma_f32_16x16x32_bf16 v[32:35], a[240:243], v[96:99], v[32:35]
    v_cvt_pk_bf16_f32 v148, v120, v121
    v_mfma_f32_16x16x32_bf16 v[36:39], a[240:243], v[100:103], v[36:39]
    v_cvt_pk_bf16_f32 v149, v122, v123
    v_mfma_f32_16x16x32_bf16 v[40:43], a[244:247], v[96:99], v[40:43]
    v_permlane32_swap_b32 v128, v132
    v_mfma_f32_16x16x32_bf16 v[44:47], a[244:247], v[100:103], v[44:47]
    s_add_u32 m0, s76, 7168
    s_nop 0
    buffer_load_dwordx4 v21, s[44:47], s74 offen lds
    v_mfma_f32_16x16x32_bf16 v[48:51], a[248:251], v[96:99], v[48:51]
    v_permlane32_swap_b32 v129, v133
    v_mfma_f32_16x16x32_bf16 v[52:55], a[248:251], v[100:103], v[52:55]
    v_permlane32_swap_b32 v130, v134
    v_mfma_f32_16x16x32_bf16 v[56:59], a[252:255], v[96:99], v[56:59]
    v_permlane32_swap_b32 v131, v135
    v_mfma_f32_16x16x32_bf16 v[60:63], a[252:255], v[100:103], v[60:63]
    v_mul_f32 v136, v128, v128
    ds_read_b128 v[96:99], v27 offset:1024
    ds_read_b128 v[100:103], v27 offset:21504
    s_waitcnt lgkmcnt(6)
    v_mfma_f32_16x16x32_bf16 v[32:35], v[192:195], v[72:75], v[32:35]
    v_mul_f32 v137, v129, v129
    v_mfma_f32_16x16x32_bf16 v[36:39], v[192:195], v[76:79], v[36:39]
    v_mul_f32 v138, v130, v130
    v_mfma_f32_16x16x32_bf16 v[40:43], v[196:199], v[72:75], v[40:43]
    v_mul_f32 v139, v131, v131
    v_mfma_f32_16x16x32_bf16 v[44:47], v[196:199], v[76:79], v[44:47]
    s_add_u32 m0, s76, 8192
    s_nop 0
    buffer_load_dwordx4 v22, s[44:47], s74 offen lds
    v_mfma_f32_16x16x32_bf16 v[48:51], v[200:203], v[72:75], v[48:51]
    v_fma_f32 v136, v136, s78, v140
    v_mfma_f32_16x16x32_bf16 v[52:55], v[200:203], v[76:79], v[52:55]
    v_fma_f32 v137, v137, s78, v140
    v_mfma_f32_16x16x32_bf16 v[56:59], v[204:207], v[72:75], v[56:59]
    v_fma_f32 v138, v138, s78, v140
    v_mfma_f32_16x16x32_bf16 v[60:63], v[204:207], v[76:79], v[60:63]
    v_fma_f32 v139, v139, s78, v140
    s_waitcnt lgkmcnt(4)
    v_mfma_f32_16x16x32_bf16 v[32:35], v[208:211], v[80:83], v[32:35]
    v_mul_f32 v136, v136, v128
    v_mfma_f32_16x16x32_bf16 v[36:39], v[208:211], v[84:87], v[36:39]
    v_mul_f32 v137, v137, v129
    v_mfma_f32_16x16x32_bf16 v[40:43], v[212:215], v[80:83], v[40:43]
    v_mul_f32 v138, v138, v130
    v_mfma_f32_16x16x32_bf16 v[44:47], v[212:215], v[84:87], v[44:47]
    s_add_u32 m0, s76, 9216
    s_nop 0
    buffer_load_dwordx4 v23, s[44:47], s74 offen lds
    v_mfma_f32_16x16x32_bf16 v[48:51], v[216:219], v[80:83], v[48:51]
    v_mul_f32 v139, v139, v131
    v_mfma_f32_16x16x32_bf16 v[52:55], v[216:219], v[84:87], v[52:55]
    v_exp_f32 v136, v136
    v_mfma_f32_16x16x32_bf16 v[56:59], v[220:223], v[80:83], v[56:59]
    v_exp_f32 v137, v137
    v_mfma_f32_16x16x32_bf16 v[60:63], v[220:223], v[84:87], v[60:63]
    v_exp_f32 v138, v138
    s_waitcnt lgkmcnt(2)
    v_mfma_f32_16x16x32_bf16 v[32:35], v[224:227], v[88:91], v[32:35]
    v_exp_f32 v139, v139
    v_mfma_f32_16x16x32_bf16 v[36:39], v[224:227], v[92:95], v[36:39]
    v_mul_f32 v128, v128, v132
    v_mfma_f32_16x16x32_bf16 v[40:43], v[228:231], v[88:91], v[40:43]
    v_mul_f32 v129, v129, v133
    v_mfma_f32_16x16x32_bf16 v[44:47], v[228:231], v[92:95], v[44:47]
    v_mul_f32 v130, v130, v134
    v_mfma_f32_16x16x32_bf16 v[48:51], v[232:235], v[88:91], v[48:51]
    v_mul_f32 v131, v131, v135
    v_mfma_f32_16x16x32_bf16 v[52:55], v[232:235], v[92:95], v[52:55]
    v_add_f32 v136, 1.0, v136
    v_mfma_f32_16x16x32_bf16 v[56:59], v[236:239], v[88:91], v[56:59]
    v_add_f32 v137, 1.0, v137
    v_mfma_f32_16x16x32_bf16 v[60:63], v[236:239], v[92:95], v[60:63]
    v_add_f32 v138, 1.0, v138
    s_waitcnt lgkmcnt(0)
    v_mfma_f32_16x16x32_bf16 v[32:35], v[240:243], v[96:99], v[32:35]
    v_add_f32 v139, 1.0, v139
    v_mfma_f32_16x16x32_bf16 v[36:39], v[240:243], v[100:103], v[36:39]
    v_rcp_f32 v136, v136
    v_mfma_f32_16x16x32_bf16 v[40:43], v[244:247], v[96:99], v[40:43]
    v_rcp_f32 v137, v137
    v_mfma_f32_16x16x32_bf16 v[44:47], v[244:247], v[100:103], v[44:47]
    v_rcp_f32 v138, v138
    v_mfma_f32_16x16x32_bf16 v[48:51], v[248:251], v[96:99], v[48:51]
    v_rcp_f32 v139, v139
    v_mfma_f32_16x16x32_bf16 v[52:55], v[248:251], v[100:103], v[52:55]
    v_mul_f32 v128, v128, v136
    v_mfma_f32_16x16x32_bf16 v[56:59], v[252:255], v[96:99], v[56:59]
    v_mul_f32 v129, v129, v137
    v_mfma_f32_16x16x32_bf16 v[60:63], v[252:255], v[100:103], v[60:63]
    v_mul_f32 v130, v130, v138
    v_mul_f32 v131, v131, v139
    v_cvt_pk_bf16_f32 v150, v128, v129
    v_cvt_pk_bf16_f32 v151, v130, v131
    buffer_store_dwordx4 v[148:151], v28, s[40:43], s89 offen offset:512 sc1
    s_cmp_eq_u32 s75, 2
    s_cselect_b32 s7, -81920, s85
    s_cselect_b32 s75, -1, s75
    s_add_u32 s75, s75, 1
    v_add_u32 v24, s7, v24
    v_add_u32 v25, s7, v25
    v_add_u32 v26, s7, v26
    v_add_u32 v27, s7, v27
    s_mov_b32 s89, s71
    s_add_u32 s71, s71, 98304
    s_add_u32 s5, s5, 1
    s_barrier
    s_cmp_eq_u32 s75, 1
    s_cselect_b32 s7, -81920, s85
    s_add_u32 s76, s76, s7
    s_add_u32 s74, s74, 40960
    ds_read_b128 v[72:75], v24 offset:0
    ds_read_b128 v[76:79], v24 offset:20480
    ds_read_b128 v[80:83], v25 offset:0
    ds_read_b128 v[84:87], v25 offset:20480
    ds_read_b128 v[88:91], v26 offset:0
    ds_read_b128 v[92:95], v26 offset:20480
    ds_read_b128 v[96:99], v27 offset:0
    ds_read_b128 v[100:103], v27 offset:20480
    s_waitcnt lgkmcnt(6)
    v_mfma_f32_16x16x32_bf16 v[104:107], a[0:3], v[72:75], 0
    v_permlane32_swap_b32 v32, v36
    v_mfma_f32_16x16x32_bf16 v[108:111], a[0:3], v[76:79], 0
    v_permlane32_swap_b32 v33, v37
    v_mfma_f32_16x16x32_bf16 v[112:115], a[4:7], v[72:75], 0
    v_permlane32_swap_b32 v34, v38
    v_mfma_f32_16x16x32_bf16 v[116:119], a[4:7], v[76:79], 0
    v_permlane32_swap_b32 v35, v39
    v_mfma_f32_16x16x32_bf16 v[120:123], a[8:11], v[72:75], 0
    v_mul_f32 v136, v32, v32
    v_mfma_f32_16x16x32_bf16 v[124:127], a[8:11], v[76:79], 0
    v_mul_f32 v137, v33, v33
    v_mfma_f32_16x16x32_bf16 v[128:131], a[12:15], v[72:75], 0
    v_mul_f32 v138, v34, v34
    v_mfma_f32_16x16x32_bf16 v[132:135], a[12:15], v[76:79], 0
    v_mul_f32 v139, v35, v35
    ds_read_b128 v[72:75], v24 offset:256
    ds_read_b128 v[76:79], v24 offset:20736
    s_waitcnt lgkmcnt(6)
    v_mfma_f32_16x16x32_bf16 v[104:107], a[16:19], v[80:83], v[104:107]
    v_fma_f32 v136, v136, s78, v140
    v_mfma_f32_16x16x32_bf16 v[108:111], a[16:19], v[84:87], v[108:111]
    v_fma_f32 v137, v137, s78, v140
    v_mfma_f32_16x16x32_bf16 v[112:115], a[20:23], v[80:83], v[112:115]
    v_fma_f32 v138, v138, s78, v140
    v_mfma_f32_16x16x32_bf16 v[116:119], a[20:23], v[84:87], v[116:119]
    v_fma_f32 v139, v139, s78, v140
    v_mfma_f32_16x16x32_bf16 v[120:123], a[24:27], v[80:83], v[120:123]
    v_mul_f32 v136, v136, v32
    v_mfma_f32_16x16x32_bf16 v[124:127], a[24:27], v[84:87], v[124:127]
    v_mul_f32 v137, v137, v33
    v_mfma_f32_16x16x32_bf16 v[128:131], a[28:31], v[80:83], v[128:131]
    v_mul_f32 v138, v138, v34
    v_mfma_f32_16x16x32_bf16 v[132:135], a[28:31], v[84:87], v[132:135]
    v_mul_f32 v139, v139, v35
    ds_read_b128 v[80:83], v25 offset:256
    ds_read_b128 v[84:87], v25 offset:20736
    s_waitcnt lgkmcnt(6)
    v_mfma_f32_16x16x32_bf16 v[104:107], a[32:35], v[88:91], v[104:107]
    v_exp_f32 v136, v136
    v_mfma_f32_16x16x32_bf16 v[108:111], a[32:35], v[92:95], v[108:111]
    v_exp_f32 v137, v137
    v_mfma_f32_16x16x32_bf16 v[112:115], a[36:39], v[88:91], v[112:115]
    v_exp_f32 v138, v138
    v_mfma_f32_16x16x32_bf16 v[116:119], a[36:39], v[92:95], v[116:119]
    v_exp_f32 v139, v139
    v_mfma_f32_16x16x32_bf16 v[120:123], a[40:43], v[88:91], v[120:123]
    v_mul_f32 v32, v32, v36
    v_mfma_f32_16x16x32_bf16 v[124:127], a[40:43], v[92:95], v[124:127]
    v_mul_f32 v33, v33, v37
    v_mfma_f32_16x16x32_bf16 v[128:131], a[44:47], v[88:91], v[128:131]
    v_mul_f32 v34, v34, v38
    v_mfma_f32_16x16x32_bf16 v[132:135], a[44:47], v[92:95], v[132:135]
    v_mul_f32 v35, v35, v39
    ds_read_b128 v[88:91], v26 offset:256
    ds_read_b128 v[92:95], v26 offset:20736
    s_waitcnt lgkmcnt(6)
    v_mfma_f32_16x16x32_bf16 v[104:107], a[48:51], v[96:99], v[104:107]
    v_add_f32 v136, 1.0, v136
    v_mfma_f32_16x16x32_bf16 v[108:111], a[48:51], v[100:103], v[108:111]
    v_add_f32 v137, 1.0, v137
    v_mfma_f32_16x16x32_bf16 v[112:115], a[52:55], v[96:99], v[112:115]
    v_add_f32 v138, 1.0, v138
    v_mfma_f32_16x16x32_bf16 v[116:119], a[52:55], v[100:103], v[116:119]
    v_add_f32 v139, 1.0, v139
    v_mfma_f32_16x16x32_bf16 v[120:123], a[56:59], v[96:99], v[120:123]
    v_rcp_f32 v136, v136
    v_mfma_f32_16x16x32_bf16 v[124:127], a[56:59], v[100:103], v[124:127]
    v_rcp_f32 v137, v137
    v_mfma_f32_16x16x32_bf16 v[128:131], a[60:63], v[96:99], v[128:131]
    v_rcp_f32 v138, v138
    v_mfma_f32_16x16x32_bf16 v[132:135], a[60:63], v[100:103], v[132:135]
    v_rcp_f32 v139, v139
    ds_read_b128 v[96:99], v27 offset:256
    ds_read_b128 v[100:103], v27 offset:20736
    s_waitcnt lgkmcnt(6)
    v_mfma_f32_16x16x32_bf16 v[104:107], a[64:67], v[72:75], v[104:107]
    v_mul_f32 v32, v32, v136
    v_mfma_f32_16x16x32_bf16 v[108:111], a[64:67], v[76:79], v[108:111]
    v_mul_f32 v33, v33, v137
    v_mfma_f32_16x16x32_bf16 v[112:115], a[68:71], v[72:75], v[112:115]
    v_mul_f32 v34, v34, v138
    v_mfma_f32_16x16x32_bf16 v[116:119], a[68:71], v[76:79], v[116:119]
    v_mul_f32 v35, v35, v139
    v_mfma_f32_16x16x32_bf16 v[120:123], a[72:75], v[72:75], v[120:123]
    v_cvt_pk_bf16_f32 v144, v32, v33
    v_mfma_f32_16x16x32_bf16 v[124:127], a[72:75], v[76:79], v[124:127]
    v_cvt_pk_bf16_f32 v145, v34, v35
    v_mfma_f32_16x16x32_bf16 v[128:131], a[76:79], v[72:75], v[128:131]
    v_permlane32_swap_b32 v40, v44
    v_mfma_f32_16x16x32_bf16 v[132:135], a[76:79], v[76:79], v[132:135]
    v_permlane32_swap_b32 v41, v45
    ds_read_b128 v[72:75], v24 offset:512
    ds_read_b128 v[76:79], v24 offset:20992
    s_waitcnt lgkmcnt(6)
    v_mfma_f32_16x16x32_bf16 v[104:107], a[80:83], v[80:83], v[104:107]
    v_permlane32_swap_b32 v42, v46
    v_mfma_f32_16x16x32_bf16 v[108:111], a[80:83], v[84:87], v[108:111]
    v_permlane32_swap_b32 v43, v47
    v_mfma_f32_16x16x32_bf16 v[112:115], a[84:87], v[80:83], v[112:115]
    v_mul_f32 v136, v40, v40
    v_mfma_f32_16x16x32_bf16 v[116:119], a[84:87], v[84:87], v[116:119]
    v_mul_f32 v137, v41, v41
    v_mfma_f32_16x16x32_bf16 v[120:123], a[88:91], v[80:83], v[120:123]
    v_mul_f32 v138, v42, v42
    v_mfma_f32_16x16x32_bf16 v[124:127], a[88:91], v[84:87], v[124:127]
    v_mul_f32 v139, v43, v43
    v_mfma_f32_16x16x32_bf16 v[128:131], a[92:95], v[80:83], v[128:131]
    v_fma_f32 v136, v136, s78, v140
    v_mfma_f32_16x16x32_bf16 v[132:135], a[92:95], v[84:87], v[132:135]
    v_fma_f32 v137, v137, s78, v140
    s_waitcnt vmcnt(0)
    s_barrier
    s_max_i32 s7, s5, 1
    s_sub_u32 s7, s7, 1
    v_mov_b32 v8, s7
    buffer_store_dword v8, v5, s[40:43], s70 offen sc1
    ds_read_b128 v[80:83], v25 offset:512
    ds_read_b128 v[84:87], v25 offset:20992
    s_waitcnt lgkmcnt(6)
    v_mfma_f32_16x16x32_bf16 v[104:107], a[96:99], v[88:91], v[104:107]
    v_fma_f32 v138, v138, s78, v140
    v_mfma_f32_16x16x32_bf16 v[108:111], a[96:99], v[92:95], v[108:111]
    v_fma_f32 v139, v139, s78, v140
    v_mfma_f32_16x16x32_bf16 v[112:115], a[100:103], v[88:91], v[112:115]
    v_mul_f32 v136, v136, v40
    v_mfma_f32_16x16x32_bf16 v[116:119], a[100:103], v[92:95], v[116:119]
    v_mul_f32 v137, v137, v41
    v_mfma_f32_16x16x32_bf16 v[120:123], a[104:107], v[88:91], v[120:123]
    v_mul_f32 v138, v138, v42
    v_mfma_f32_16x16x32_bf16 v[124:127], a[104:107], v[92:95], v[124:127]
    v_mul_f32 v139, v139, v43
    v_mfma_f32_16x16x32_bf16 v[128:131], a[108:111], v[88:91], v[128:131]
    v_exp_f32 v136, v136
    v_mfma_f32_16x16x32_bf16 v[132:135], a[108:111], v[92:95], v[132:135]
    v_exp_f32 v137, v137
    ds_read_b128 v[88:91], v26 offset:512
    ds_read_b128 v[92:95], v26 offset:20992
    s_waitcnt lgkmcnt(6)
    v_mfma_f32_16x16x32_bf16 v[104:107], a[112:115], v[96:99], v[104:107]
    v_exp_f32 v138, v138
    v_mfma_f32_16x16x32_bf16 v[108:111], a[112:115], v[100:103], v[108:111]
    v_exp_f32 v139, v139
    v_mfma_f32_16x16x32_bf16 v[112:115], a[116:119], v[96:99], v[112:115]
    v_mul_f32 v40, v40, v44
    v_mfma_f32_16x16x32_bf16 v[116:119], a[116:119], v[100:103], v[116:119]
    v_mul_f32 v41, v41, v45
    v_mfma_f32_16x16x32_bf16 v[120:123], a[120:123], v[96:99], v[120:123]
    v_mul_f32 v42, v42, v46
    v_mfma_f32_16x16x32_bf16 v[124:127], a[120:123], v[100:103], v[124:127]
    v_mul_f32 v43, v43, v47
    v_mfma_f32_16x16x32_bf16 v[128:131], a[124:127], v[96:99], v[128:131]
    v_add_f32 v136, 1.0, v136
    v_mfma_f32_16x16x32_bf16 v[132:135], a[124:127], v[100:103], v[132:135]
    v_add_f32 v137, 1.0, v137
    ds_read_b128 v[96:99], v27 offset:512
    ds_read_b128 v[100:103], v27 offset:20992
    s_waitcnt lgkmcnt(6)
    v_mfma_f32_16x16x32_bf16 v[104:107], a[128:131], v[72:75], v[104:107]
    v_add_f32 v138, 1.0, v138
    v_mfma_f32_16x16x32_bf16 v[108:111], a[128:131], v[76:79], v[108:111]
    v_add_f32 v139, 1.0, v139
    v_mfma_f32_16x16x32_bf16 v[112:115], a[132:135], v[72:75], v[112:115]
    v_rcp_f32 v136, v136
    v_mfma_f32_16x16x32_bf16 v[116:119], a[132:135], v[76:79], v[116:119]
    s_add_u32 m0, s76, 0
    s_nop 0
    buffer_load_dwordx4 v14, s[44:47], s74 offen lds
    v_mfma_f32_16x16x32_bf16 v[120:123], a[136:139], v[72:75], v[120:123]
    v_rcp_f32 v137, v137
    v_mfma_f32_16x16x32_bf16 v[124:127], a[136:139], v[76:79], v[124:127]
    v_rcp_f32 v138, v138
    v_mfma_f32_16x16x32_bf16 v[128:131], a[140:143], v[72:75], v[128:131]
    v_rcp_f32 v139, v139
    v_mfma_f32_16x16x32_bf16 v[132:135], a[140:143], v[76:79], v[132:135]
    v_mul_f32 v40, v40, v136
    ds_read_b128 v[72:75], v24 offset:768
    ds_read_b128 v[76:79], v24 offset:21248
    s_waitcnt lgkmcnt(6)
    v_mfma_f32_16x16x32_bf16 v[104:107], a[144:147], v[80:83], v[104:107]
    v_mul_f32 v41, v41, v137
    v_mfma_f32_16x16x32_bf16 v[108:111], a[144:147], v[84:87], v[108:111]
    v_mul_f32 v42, v42, v138
    v_mfma_f32_16x16x32_bf16 v[112:115], a[148:151], v[80:83], v[112:115]
    v_mul_f32 v43, v43, v139
    v_mfma_f32_16x16x32_bf16 v[116:119], a[148:151], v[84:87], v[116:119]
    s_add_u32 m0, s76, 1024
    s_nop 0
    buffer_load_dwordx4 v15, s[44:47], s74 offen lds
    v_mfma_f32_16x16x32_bf16 v[120:123], a[152:155], v[80:83], v[120:123]
    v_cvt_pk_bf16_f32 v146, v40, v41
    v_mfma_f32_16x16x32_bf16 v[124:127], a[152:155], v[84:87], v[124:127]
    v_cvt_pk_bf16_f32 v147, v42, v43
    v_mfma_f32_16x16x32_bf16 v[128:131], a[156:159], v[80:83], v[128:131]
    buffer_store_dwordx4 v[144:147], v28, s[40:43], s89 offen offset:0 sc1
    v_mfma_f32_16x16x32_bf16 v[132:135], a[156:159], v[84:87], v[132:135]
    v_permlane32_swap_b32 v48, v52
    ds_read_b128 v[80:83], v25 offset:768
    ds_read_b128 v[84:87], v25 offset:21248
    s_waitcnt lgkmcnt(6)
    v_mfma_f32_16x16x32_bf16 v[104:107], a[160:163], v[88:91], v[104:107]
    v_permlane32_swap_b32 v49, v53
    v_mfma_f32_16x16x32_bf16 v[108:111], a[160:163], v[92:95], v[108:111]
    v_permlane32_swap_b32 v50, v54
    v_mfma_f32_16x16x32_bf16 v[112:115], a[164:167], v[88:91], v[112:115]
    v_permlane32_swap_b32 v51, v55
    v_mfma_f32_16x16x32_bf16 v[116:119], a[164:167], v[92:95], v[116:119]
    s_add_u32 m0, s76, 2048
    s_nop 0
    buffer_load_dwordx4 v16, s[44:47], s74 offen lds
    v_mfma_f32_16x16x32_bf16 v[120:123], a[168:171], v[88:91], v[120:123]
    v_mul_f32 v136, v48, v48
    v_mfma_f32_16x16x32_bf16 v[124:127], a[168:171], v[92:95], v[124:127]
    v_mul_f32 v137, v49, v49
    v_mfma_f32_16x16x32_bf16 v[128:131], a[172:175], v[88:91], v[128:131]
    v_mul_f32 v138, v50, v50
    v_mfma_f32_16x16x32_bf16 v[132:135], a[172:175], v[92:95], v[132:135]
    v_mul_f32 v139, v51, v51
    ds_read_b128 v[88:91], v26 offset:768
    ds_read_b128 v[92:95], v26 offset:21248
    s_waitcnt lgkmcnt(6)
    v_mfma_f32_16x16x32_bf16 v[104:107], a[176:179], v[96:99], v[104:107]
    v_fma_f32 v136, v136, s78, v140
    v_mfma_f32_16x16x32_bf16 v[108:111], a[176:179], v[100:103], v[108:111]
    v_fma_f32 v137, v137, s78, v140
    v_mfma_f32_16x16x32_bf16 v[112:115], a[180:183], v[96:99], v[112:115]
    v_fma_f32 v138, v138, s78, v140
    v_mfma_f32_16x16x32_bf16 v[116:119], a[180:183], v[100:103], v[116:119]
    s_add_u32 m0, s76, 3072
    s_nop 0
    buffer_load_dwordx4 v17, s[44:47], s74 offen lds
    v_mfma_f32_16x16x32_bf16 v[120:123], a[184:187], v[96:99], v[120:123]
    v_fma_f32 v139, v139, s78, v140
    v_mfma_f32_16x16x32_bf16 v[124:127], a[184:187], v[100:103], v[124:127]
    v_mul_f32 v136, v136, v48
    v_mfma_f32_16x16x32_bf16 v[128:131], a[188:191], v[96:99], v[128:131]
    v_mul_f32 v137, v137, v49
    v_mfma_f32_16x16x32_bf16 v[132:135], a[188:191], v[100:103], v[132:135]
    v_mul_f32 v138, v138, v50
    ds_read_b128 v[96:99], v27 offset:768
    ds_read_b128 v[100:103], v27 offset:21248
    s_waitcnt lgkmcnt(6)
    v_mfma_f32_16x16x32_bf16 v[104:107], a[192:195], v[72:75], v[104:107]
    v_mul_f32 v139, v139, v51
    v_mfma_f32_16x16x32_bf16 v[108:111], a[192:195], v[76:79], v[108:111]
    v_exp_f32 v136, v136
    v_mfma_f32_16x16x32_bf16 v[112:115], a[196:199], v[72:75], v[112:115]
    v_exp_f32 v137, v137
    v_mfma_f32_16x16x32_bf16 v[116:119], a[196:199], v[76:79], v[116:119]
    s_add_u32 m0, s76, 4096
    s_nop 0
    buffer_load_dwordx4 v18, s[44:47], s74 offen lds
    v_mfma_f32_16x16x32_bf16 v[120:123], a[200:203], v[72:75], v[120:123]
    v_exp_f32 v138, v138
    v_mfma_f32_16x16x32_bf16 v[124:127], a[200:203], v[76:79], v[124:127]
    v_exp_f32 v139, v139
    v_mfma_f32_16x16x32_bf16 v[128:131], a[204:207], v[72:75], v[128:131]
    v_mul_f32 v48, v48, v52
    v_mfma_f32_16x16x32_bf16 v[132:135], a[204:207], v[76:79], v[132:135]
    v_mul_f32 v49, v49, v53
    ds_read_b128 v[72:75], v24 offset:1024
    ds_read_b128 v[76:79], v24 offset:21504
    s_waitcnt lgkmcnt(6)
    v_mfma_f32_16x16x32_bf16 v[104:107], a[208:211], v[80:83], v[104:107]
    v_mul_f32 v50, v50, v54
    v_mfma_f32_16x16x32_bf16 v[108:111], a[208:211], v[84:87], v[108:111]
    v_mul_f32 v51, v51, v55
    v_mfma_f32_16x16x32_bf16 v[112:115], a[212:215], v[80:83], v[112:115]
    v_add_f32 v136, 1.0, v136
    v_mfma_f32_16x16x32_bf16 v[116:119], a[212:215], v[84:87], v[116:119]
    s_add_u32 m0, s76, 5120
    s_nop 0
    buffer_load_dwordx4 v19, s[44:47], s74 offen lds
    v_mfma_f32_16x16x32_bf16 v[120:123], a[216:219], v[80:83], v[120:123]
    v_add_f32 v137, 1.0, v137
    v_mfma_f32_16x16x32_bf16 v[124:127], a[216:219], v[84:87], v[124:127]
    v_add_f32 v138, 1.0, v138
    v_mfma_f32_16x16x32_bf16 v[128:131], a[220:223], v[80:83], v[128:131]
    v_add_f32 v139, 1.0, v139
    v_mfma_f32_16x16x32_bf16 v[132:135], a[220:223], v[84:87], v[132:135]
    v_rcp_f32 v136, v136
    ds_read_b128 v[80:83], v25 offset:1024
    ds_read_b128 v[84:87], v25 offset:21504
    s_waitcnt lgkmcnt(6)
    v_mfma_f32_16x16x32_bf16 v[104:107], a[224:227], v[88:91], v[104:107]
    v_rcp_f32 v137, v137
    v_mfma_f32_16x16x32_bf16 v[108:111], a[224:227], v[92:95], v[108:111]
    v_rcp_f32 v138, v138
    v_mfma_f32_16x16x32_bf16 v[112:115], a[228:231], v[88:91], v[112:115]
    v_rcp_f32 v139, v139
    v_mfma_f32_16x16x32_bf16 v[116:119], a[228:231], v[92:95], v[116:119]
    s_add_u32 m0, s76, 6144
    s_nop 0
    buffer_load_dwordx4 v20, s[44:47], s74 offen lds
    v_mfma_f32_16x16x32_bf16 v[120:123], a[232:235], v[88:91], v[120:123]
    v_mul_f32 v48, v48, v136
    v_mfma_f32_16x16x32_bf16 v[124:127], a[232:235], v[92:95], v[124:127]
    v_mul_f32 v49, v49, v137
    v_mfma_f32_16x16x32_bf16 v[128:131], a[236:239], v[88:91], v[128:131]
    v_mul_f32 v50, v50, v138
    v_mfma_f32_16x16x32_bf16 v[132:135], a[236:239], v[92:95], v[132:135]
    v_mul_f32 v51, v51, v139
    ds_read_b128 v[88:91], v26 offset:1024
    ds_read_b128 v[92:95], v26 offset:21504
    s_waitcnt lgkmcnt(6)
    v_mfma_f32_16x16x32_bf16 v[104:107], a[240:243], v[96:99], v[104:107]
    v_cvt_pk_bf16_f32 v148, v48, v49
    v_mfma_f32_16x16x32_bf16 v[108:111], a[240:243], v[100:103], v[108:111]
    v_cvt_pk_bf16_f32 v149, v50, v51
    v_mfma_f32_16x16x32_bf16 v[112:115], a[244:247], v[96:99], v[112:115]
    v_permlane32_swap_b32 v56, v60
    v_mfma_f32_16x16x32_bf16 v[116:119], a[244:247], v[100:103], v[116:119]
    s_add_u32 m0, s76, 7168
    s_nop 0
    buffer_load_dwordx4 v21, s[44:47], s74 offen lds
    v_mfma_f32_16x16x32_bf16 v[120:123], a[248:251], v[96:99], v[120:123]
    v_permlane32_swap_b32 v57, v61
    v_mfma_f32_16x16x32_bf16 v[124:127], a[248:251], v[100:103], v[124:127]
    v_permlane32_swap_b32 v58, v62
    v_mfma_f32_16x16x32_bf16 v[128:131], a[252:255], v[96:99], v[128:131]
    v_permlane32_swap_b32 v59, v63
    v_mfma_f32_16x16x32_bf16 v[132:135], a[252:255], v[100:103], v[132:135]
    v_mul_f32 v136, v56, v56
    ds_read_b128 v[96:99], v27 offset:1024
    ds_read_b128 v[100:103], v27 offset:21504
    s_waitcnt lgkmcnt(6)
    v_mfma_f32_16x16x32_bf16 v[104:107], v[192:195], v[72:75], v[104:107]
    v_mul_f32 v137, v57, v57
    v_mfma_f32_16x16x32_bf16 v[108:111], v[192:195], v[76:79], v[108:111]
    v_mul_f32 v138, v58, v58
    v_mfma_f32_16x16x32_bf16 v[112:115], v[196:199], v[72:75], v[112:115]
    v_mul_f32 v139, v59, v59
    v_mfma_f32_16x16x32_bf16 v[116:119], v[196:199], v[76:79], v[116:119]
    s_add_u32 m0, s76, 8192
    s_nop 0
    buffer_load_dwordx4 v22, s[44:47], s74 offen lds
    v_mfma_f32_16x16x32_bf16 v[120:123], v[200:203], v[72:75], v[120:123]
    v_fma_f32 v136, v136, s78, v140
    v_mfma_f32_16x16x32_bf16 v[124:127], v[200:203], v[76:79], v[124:127]
    v_fma_f32 v137, v137, s78, v140
    v_mfma_f32_16x16x32_bf16 v[128:131], v[204:207], v[72:75], v[128:131]
    v_fma_f32 v138, v138, s78, v140
    v_mfma_f32_16x16x32_bf16 v[132:135], v[204:207], v[76:79], v[132:135]
    v_fma_f32 v139, v139, s78, v140
    s_waitcnt lgkmcnt(4)
    v_mfma_f32_16x16x32_bf16 v[104:107], v[208:211], v[80:83], v[104:107]
    v_mul_f32 v136, v136, v56
    v_mfma_f32_16x16x32_bf16 v[108:111], v[208:211], v[84:87], v[108:111]
    v_mul_f32 v137, v137, v57
    v_mfma_f32_16x16x32_bf16 v[112:115], v[212:215], v[80:83], v[112:115]
    v_mul_f32 v138, v138, v58
    v_mfma_f32_16x16x32_bf16 v[116:119], v[212:215], v[84:87], v[116:119]
    s_add_u32 m0, s76, 9216
    s_nop 0
    buffer_load_dwordx4 v23, s[44:47], s74 offen lds
    v_mfma_f32_16x16x32_bf16 v[120:123], v[216:219], v[80:83], v[120:123]
    v_mul_f32 v139, v139, v59
    v_mfma_f32_16x16x32_bf16 v[124:127], v[216:219], v[84:87], v[124:127]
    v_exp_f32 v136, v136
    v_mfma_f32_16x16x32_bf16 v[128:131], v[220:223], v[80:83], v[128:131]
    v_exp_f32 v137, v137
    v_mfma_f32_16x16x32_bf16 v[132:135], v[220:223], v[84:87], v[132:135]
    v_exp_f32 v138, v138
    s_waitcnt lgkmcnt(2)
    v_mfma_f32_16x16x32_bf16 v[104:107], v[224:227], v[88:91], v[104:107]
    v_exp_f32 v139, v139
    v_mfma_f32_16x16x32_bf16 v[108:111], v[224:227], v[92:95], v[108:111]
    v_mul_f32 v56, v56, v60
    v_mfma_f32_16x16x32_bf16 v[112:115], v[228:231], v[88:91], v[112:115]
    v_mul_f32 v57, v57, v61
    v_mfma_f32_16x16x32_bf16 v[116:119], v[228:231], v[92:95], v[116:119]
    v_mul_f32 v58, v58, v62
    v_mfma_f32_16x16x32_bf16 v[120:123], v[232:235], v[88:91], v[120:123]
    v_mul_f32 v59, v59, v63
    v_mfma_f32_16x16x32_bf16 v[124:127], v[232:235], v[92:95], v[124:127]
    v_add_f32 v136, 1.0, v136
    v_mfma_f32_16x16x32_bf16 v[128:131], v[236:239], v[88:91], v[128:131]
    v_add_f32 v137, 1.0, v137
    v_mfma_f32_16x16x32_bf16 v[132:135], v[236:239], v[92:95], v[132:135]
    v_add_f32 v138, 1.0, v138
    s_waitcnt lgkmcnt(0)
    v_mfma_f32_16x16x32_bf16 v[104:107], v[240:243], v[96:99], v[104:107]
    v_add_f32 v139, 1.0, v139
    v_mfma_f32_16x16x32_bf16 v[108:111], v[240:243], v[100:103], v[108:111]
    v_rcp_f32 v136, v136
    v_mfma_f32_16x16x32_bf16 v[112:115], v[244:247], v[96:99], v[112:115]
    v_rcp_f32 v137, v137
    v_mfma_f32_16x16x32_bf16 v[116:119], v[244:247], v[100:103], v[116:119]
    v_rcp_f32 v138, v138
    v_mfma_f32_16x16x32_bf16 v[120:123], v[248:251], v[96:99], v[120:123]
    v_rcp_f32 v139, v139
    v_mfma_f32_16x16x32_bf16 v[124:127], v[248:251], v[100:103], v[124:127]
    v_mul_f32 v56, v56, v136
    v_mfma_f32_16x16x32_bf16 v[128:131], v[252:255], v[96:99], v[128:131]
    v_mul_f32 v57, v57, v137
    v_mfma_f32_16x16x32_bf16 v[132:135], v[252:255], v[100:103], v[132:135]
    v_mul_f32 v58, v58, v138
    v_mul_f32 v59, v59, v139
    v_cvt_pk_bf16_f32 v150, v56, v57
    v_cvt_pk_bf16_f32 v151, v58, v59
    buffer_store_dwordx4 v[148:151], v28, s[40:43], s89 offen offset:512 sc1
    s_cmp_eq_u32 s75, 2
    s_cselect_b32 s7, -81920, s85
    s_cselect_b32 s75, -1, s75
    s_add_u32 s75, s75, 1
    v_add_u32 v24, s7, v24
    v_add_u32 v25, s7, v25
    v_add_u32 v26, s7, v26
    v_add_u32 v27, s7, v27
    s_mov_b32 s89, s71
    s_add_u32 s71, s71, 98304
    s_add_u32 s5, s5, 1
    s_barrier
    s_cmp_lt_u32 s5, 64
    s_cbranch_scc1 L_ba_loop_5
    s_nop 7
    v_permlane32_swap_b32 v104, v108
    v_permlane32_swap_b32 v105, v109
    v_permlane32_swap_b32 v106, v110
    v_permlane32_swap_b32 v107, v111
    v_mul_f32 v136, v104, v104
    v_mul_f32 v137, v105, v105
    v_mul_f32 v138, v106, v106
    v_mul_f32 v139, v107, v107
    v_fma_f32 v136, v136, s78, v140
    v_fma_f32 v137, v137, s78, v140
    v_fma_f32 v138, v138, s78, v140
    v_fma_f32 v139, v139, s78, v140
    v_mul_f32 v136, v136, v104
    v_mul_f32 v137, v137, v105
    v_mul_f32 v138, v138, v106
    v_mul_f32 v139, v139, v107
    v_exp_f32 v136, v136
    v_exp_f32 v137, v137
    v_exp_f32 v138, v138
    v_exp_f32 v139, v139
    v_mul_f32 v104, v104, v108
    v_mul_f32 v105, v105, v109
    v_mul_f32 v106, v106, v110
    v_mul_f32 v107, v107, v111
    v_add_f32 v136, 1.0, v136
    v_add_f32 v137, 1.0, v137
    v_add_f32 v138, 1.0, v138
    v_add_f32 v139, 1.0, v139
    v_rcp_f32 v136, v136
    v_rcp_f32 v137, v137
    v_rcp_f32 v138, v138
    v_rcp_f32 v139, v139
    v_mul_f32 v104, v104, v136
    v_mul_f32 v105, v105, v137
    v_mul_f32 v106, v106, v138
    v_mul_f32 v107, v107, v139
    v_cvt_pk_bf16_f32 v144, v104, v105
    v_cvt_pk_bf16_f32 v145, v106, v107
    v_permlane32_swap_b32 v112, v116
    v_permlane32_swap_b32 v113, v117
    v_permlane32_swap_b32 v114, v118
    v_permlane32_swap_b32 v115, v119
    v_mul_f32 v136, v112, v112
    v_mul_f32 v137, v113, v113
    v_mul_f32 v138, v114, v114
    v_mul_f32 v139, v115, v115
    v_fma_f32 v136, v136, s78, v140
    v_fma_f32 v137, v137, s78, v140
    v_fma_f32 v138, v138, s78, v140
    v_fma_f32 v139, v139, s78, v140
    v_mul_f32 v136, v136, v112
    v_mul_f32 v137, v137, v113
    v_mul_f32 v138, v138, v114
    v_mul_f32 v139, v139, v115
    v_exp_f32 v136, v136
    v_exp_f32 v137, v137
    v_exp_f32 v138, v138
    v_exp_f32 v139, v139
    v_mul_f32 v112, v112, v116
    v_mul_f32 v113, v113, v117
    v_mul_f32 v114, v114, v118
    v_mul_f32 v115, v115, v119
    v_add_f32 v136, 1.0, v136
    v_add_f32 v137, 1.0, v137
    v_add_f32 v138, 1.0, v138
    v_add_f32 v139, 1.0, v139
    v_rcp_f32 v136, v136
    v_rcp_f32 v137, v137
    v_rcp_f32 v138, v138
    v_rcp_f32 v139, v139
    v_mul_f32 v112, v112, v136
    v_mul_f32 v113, v113, v137
    v_mul_f32 v114, v114, v138
    v_mul_f32 v115, v115, v139
    v_cvt_pk_bf16_f32 v146, v112, v113
    v_cvt_pk_bf16_f32 v147, v114, v115
    buffer_store_dwordx4 v[144:147], v28, s[40:43], s89 offen offset:0 sc1
    v_permlane32_swap_b32 v120, v124
    v_permlane32_swap_b32 v121, v125
    v_permlane32_swap_b32 v122, v126
    v_permlane32_swap_b32 v123, v127
    v_mul_f32 v136, v120, v120
    v_mul_f32 v137, v121, v121
    v_mul_f32 v138, v122, v122
    v_mul_f32 v139, v123, v123
    v_fma_f32 v136, v136, s78, v140
    v_fma_f32 v137, v137, s78, v140
    v_fma_f32 v138, v138, s78, v140
    v_fma_f32 v139, v139, s78, v140
    v_mul_f32 v136, v136, v120
    v_mul_f32 v137, v137, v121
    v_mul_f32 v138, v138, v122
    v_mul_f32 v139, v139, v123
    v_exp_f32 v136, v136
    v_exp_f32 v137, v137
    v_exp_f32 v138, v138
    v_exp_f32 v139, v139
    v_mul_f32 v120, v120, v124
    v_mul_f32 v121, v121, v125
    v_mul_f32 v122, v122, v126
    v_mul_f32 v123, v123, v127
    v_add_f32 v136, 1.0, v136
    v_add_f32 v137, 1.0, v137
    v_add_f32 v138, 1.0, v138
    v_add_f32 v139, 1.0, v139
    v_rcp_f32 v136, v136
    v_rcp_f32 v137, v137
    v_rcp_f32 v138, v138
    v_rcp_f32 v139, v139
    v_mul_f32 v120, v120, v136
    v_mul_f32 v121, v121, v137
    v_mul_f32 v122, v122, v138
    v_mul_f32 v123, v123, v139
    v_cvt_pk_bf16_f32 v148, v120, v121
    v_cvt_pk_bf16_f32 v149, v122, v123
    v_permlane32_swap_b32 v128, v132
    v_permlane32_swap_b32 v129, v133
    v_permlane32_swap_b32 v130, v134
    v_permlane32_swap_b32 v131, v135
    v_mul_f32 v136, v128, v128
    v_mul_f32 v137, v129, v129
    v_mul_f32 v138, v130, v130
    v_mul_f32 v139, v131, v131
    v_fma_f32 v136, v136, s78, v140
    v_fma_f32 v137, v137, s78, v140
    v_fma_f32 v138, v138, s78, v140
    v_fma_f32 v139, v139, s78, v140
    v_mul_f32 v136, v136, v128
    v_mul_f32 v137, v137, v129
    v_mul_f32 v138, v138, v130
    v_mul_f32 v139, v139, v131
    v_exp_f32 v136, v136
    v_exp_f32 v137, v137
    v_exp_f32 v138, v138
    v_exp_f32 v139, v139
    v_mul_f32 v128, v128, v132
    v_mul_f32 v129, v129, v133
    v_mul_f32 v130, v130, v134
    v_mul_f32 v131, v131, v135
    v_add_f32 v136, 1.0, v136
    v_add_f32 v137, 1.0, v137
    v_add_f32 v138, 1.0, v138
    v_add_f32 v139, 1.0, v139
    v_rcp_f32 v136, v136
    v_rcp_f32 v137, v137
    v_rcp_f32 v138, v138
    v_rcp_f32 v139, v139
    v_mul_f32 v128, v128, v136
    v_mul_f32 v129, v129, v137
    v_mul_f32 v130, v130, v138
    v_mul_f32 v131, v131, v139
    v_cvt_pk_bf16_f32 v150, v128, v129
    v_cvt_pk_bf16_f32 v151, v130, v131
    buffer_store_dwordx4 v[148:151], v28, s[40:43], s89 offen offset:512 sc1
    s_waitcnt vmcnt(0)
    s_barrier
    v_mov_b32 v6, s5
    buffer_store_dword v6, v5, s[40:43], s70 offen sc1
    s_endpgm
L_BU:
    s_getpc_b64 s[96:97]
L_pc_6:
    s_lshl_b32 s98, s3, 10
    v_lshl_add_u32 v250, v0, 4, s98
    v_mov_b32 v251, s97
    v_add_co_u32 v250, vcc, s96, v250
    s_nop 1
    v_addc_co_u32 v251, vcc, 0, v251, vcc
    global_load_dwordx4 v[252:255], v[250:251], off
    v_add_co_u32 v250, vcc, 0x1000, v250
    s_nop 1
    v_addc_co_u32 v251, vcc, 0, v251, vcc
    global_load_dwordx4 v[252:255], v[250:251], off
    v_add_co_u32 v250, vcc, 0x1000, v250
    s_nop 1
    v_addc_co_u32 v251, vcc, 0, v251, vcc
    s_mov_b32 s48, s18
    s_mov_b32 s49, s19
    s_mov_b32 s50, 0x780000
    s_mov_b32 s51, 0x20000
    s_add_u32 s70, s4, 72
    s_lshl_b32 s70, s70, 7
    v_and_b32 v1, 15, v0
    v_lshrrev_b32 v2, 4, v0
    v_lshrrev_b32 v3, 2, v1
    v_and_b32 v4, 3, v0
    v_mov_b32 v5, s3
    v_or_b32 v5, v5, v0
    v_cmp_eq_u32 vcc, 0, v5
    v_mov_b32 v5, 0x80000000
    s_nop 0
    v_cndmask_b32_e64 v5, v5, 0, vcc
    v_mov_b32 v6, 0
    buffer_store_dword v6, v5, s[40:43], s70 offen sc1
    s_waitcnt vmcnt(0)
    s_barrier
    v_mov_b32 v6, 1
    buffer_atomic_add v6, v5, s[60:63], 0 offen sc1
    s_mul_i32 s72, s3, 40960
    v_add_u32 v6, 0, v0
    v_mul_u32_u24 v7, 205, v6
    v_lshrrev_b32 v7, 12, v7
    v_mul_u32_u24 v8, 20, v7
    v_sub_u32 v8, v6, v8
    v_mul_u32_u24 v7, 1280, v7
    v_lshl_add_u32 v10, v8, 4, v7
    v_add_u32 v6, 64, v0
    v_mul_u32_u24 v7, 205, v6
    v_lshrrev_b32 v7, 12, v7
    v_mul_u32_u24 v8, 20, v7
    v_sub_u32 v8, v6, v8
    v_mul_u32_u24 v7, 1280, v7
    v_lshl_add_u32 v11, v8, 4, v7
    v_add_u32 v6, 128, v0
    v_mul_u32_u24 v7, 205, v6
    v_lshrrev_b32 v7, 12, v7
    v_mul_u32_u24 v8, 20, v7
    v_sub_u32 v8, v6, v8
    v_mul_u32_u24 v7, 1280, v7
    v_lshl_add_u32 v12, v8, 4, v7
    v_add_u32 v6, 192, v0
    v_mul_u32_u24 v7, 205, v6
    v_lshrrev_b32 v7, 12, v7
    v_mul_u32_u24 v8, 20, v7
    v_sub_u32 v8, v6, v8
    v_mul_u32_u24 v7, 1280, v7
    v_lshl_add_u32 v13, v8, 4, v7
    v_add_u32 v6, 256, v0
    v_mul_u32_u24 v7, 205, v6
    v_lshrrev_b32 v7, 12, v7
    v_mul_u32_u24 v8, 20, v7
    v_sub_u32 v8, v6, v8
    v_mul_u32_u24 v7, 1280, v7
    v_lshl_add_u32 v14, v8, 4, v7
    s_mul_i32 s73, s4, 245760
    s_mul_i32 s7, s3, 320
    s_add_u32 s73, s73, s7
    v_lshl_add_u32 v6, v2, 2, v3
    v_mul_u32_u24 v6, 320, v6
    v_lshl_add_u32 v15, v4, 3, v6
    v_add_u32 v15, s72, v15
    s_add_u32 m0, s72, 0
    s_nop 0
    buffer_load_dwordx4 v10, s[48:51], s73 offen lds
    s_add_u32 m0, s72, 1024
    s_nop 0
    buffer_load_dwordx4 v11, s[48:51], s73 offen lds
    s_add_u32 m0, s72, 2048
    s_nop 0
    buffer_load_dwordx4 v12, s[48:51], s73 offen lds
    s_add_u32 m0, s72, 3072
    s_nop 0
    buffer_load_dwordx4 v13, s[48:51], s73 offen lds
    s_add_u32 m0, s72, 4096
    s_nop 0
    buffer_load_dwordx4 v14, s[48:51], s73 offen lds
    s_add_u32 s73, s73, 20480
    s_add_u32 m0, s72, 5120
    s_nop 0
    buffer_load_dwordx4 v10, s[48:51], s73 offen lds
    s_add_u32 m0, s72, 6144
    s_nop 0
    buffer_load_dwordx4 v11, s[48:51], s73 offen lds
    s_add_u32 m0, s72, 7168
    s_nop 0
    buffer_load_dwordx4 v12, s[48:51], s73 offen lds
    s_add_u32 m0, s72, 8192
    s_nop 0
    buffer_load_dwordx4 v13, s[48:51], s73 offen lds
    s_add_u32 m0, s72, 9216
    s_nop 0
    buffer_load_dwordx4 v14, s[48:51], s73 offen lds
    s_add_u32 s73, s73, 20480
    s_add_u32 m0, s72, 10240
    s_nop 0
    buffer_load_dwordx4 v10, s[48:51], s73 offen lds
    s_add_u32 m0, s72, 11264
    s_nop 0
    buffer_load_dwordx4 v11, s[48:51], s73 offen lds
    s_add_u32 m0, s72, 12288
    s_nop 0
    buffer_load_dwordx4 v12, s[48:51], s73 offen lds
    s_add_u32 m0, s72, 13312
    s_nop 0
    buffer_load_dwordx4 v13, s[48:51], s73 offen lds
    s_add_u32 m0, s72, 14336
    s_nop 0
    buffer_load_dwordx4 v14, s[48:51], s73 offen lds
    s_add_u32 s73, s73, 20480
    s_add_u32 m0, s72, 15360
    s_nop 0
    buffer_load_dwordx4 v10, s[48:51], s73 offen lds
    s_add_u32 m0, s72, 16384
    s_nop 0
    buffer_load_dwordx4 v11, s[48:51], s73 offen lds
    s_add_u32 m0, s72, 17408
    s_nop 0
    buffer_load_dwordx4 v12, s[48:51], s73 offen lds
    s_add_u32 m0, s72, 18432
    s_nop 0
    buffer_load_dwordx4 v13, s[48:51], s73 offen lds
    s_add_u32 m0, s72, 19456
    s_nop 0
    buffer_load_dwordx4 v14, s[48:51], s73 offen lds
    s_add_u32 s73, s73, 20480
    s_add_u32 m0, s72, 20480
    s_nop 0
    buffer_load_dwordx4 v10, s[48:51], s73 offen lds
    s_add_u32 m0, s72, 21504
    s_nop 0
    buffer_load_dwordx4 v11, s[48:51], s73 offen lds
    s_add_u32 m0, s72, 22528
    s_nop 0
    buffer_load_dwordx4 v12, s[48:51], s73 offen lds
    s_add_u32 m0, s72, 23552
    s_nop 0
    buffer_load_dwordx4 v13, s[48:51], s73 offen lds
    s_add_u32 m0, s72, 24576
    s_nop 0
    buffer_load_dwordx4 v14, s[48:51], s73 offen lds
    s_add_u32 s73, s73, 20480
    s_add_u32 m0, s72, 25600
    s_nop 0
    buffer_load_dwordx4 v10, s[48:51], s73 offen lds
    s_add_u32 m0, s72, 26624
    s_nop 0
    buffer_load_dwordx4 v11, s[48:51], s73 offen lds
    s_add_u32 m0, s72, 27648
    s_nop 0
    buffer_load_dwordx4 v12, s[48:51], s73 offen lds
    s_add_u32 m0, s72, 28672
    s_nop 0
    buffer_load_dwordx4 v13, s[48:51], s73 offen lds
    s_add_u32 m0, s72, 29696
    s_nop 0
    buffer_load_dwordx4 v14, s[48:51], s73 offen lds
    s_add_u32 s73, s73, 20480
    s_add_u32 m0, s72, 30720
    s_nop 0
    buffer_load_dwordx4 v10, s[48:51], s73 offen lds
    s_add_u32 m0, s72, 31744
    s_nop 0
    buffer_load_dwordx4 v11, s[48:51], s73 offen lds
    s_add_u32 m0, s72, 32768
    s_nop 0
    buffer_load_dwordx4 v12, s[48:51], s73 offen lds
    s_add_u32 m0, s72, 33792
    s_nop 0
    buffer_load_dwordx4 v13, s[48:51], s73 offen lds
    s_add_u32 m0, s72, 34816
    s_nop 0
    buffer_load_dwordx4 v14, s[48:51], s73 offen lds
    s_add_u32 s73, s73, 20480
    s_add_u32 m0, s72, 35840
    s_nop 0
    buffer_load_dwordx4 v10, s[48:51], s73 offen lds
    s_add_u32 m0, s72, 36864
    s_nop 0
    buffer_load_dwordx4 v11, s[48:51], s73 offen lds
    s_add_u32 m0, s72, 37888
    s_nop 0
    buffer_load_dwordx4 v12, s[48:51], s73 offen lds
    s_add_u32 m0, s72, 38912
    s_nop 0
    buffer_load_dwordx4 v13, s[48:51], s73 offen lds
    s_add_u32 m0, s72, 39936
    s_nop 0
    buffer_load_dwordx4 v14, s[48:51], s73 offen lds
    s_add_u32 s73, s73, 20480
    s_waitcnt vmcnt(35)
    ds_read_b64_tr_b16 a[0:1], v15 offset:0
    ds_read_b64_tr_b16 a[24:25], v15 offset:32
    ds_read_b64_tr_b16 a[48:49], v15 offset:64
    ds_read_b64_tr_b16 a[72:73], v15 offset:96
    ds_read_b64_tr_b16 a[96:97], v15 offset:128
    ds_read_b64_tr_b16 a[120:121], v15 offset:160
    ds_read_b64_tr_b16 a[144:145], v15 offset:192
    ds_read_b64_tr_b16 a[168:169], v15 offset:224
    ds_read_b64_tr_b16 a[192:193], v15 offset:256
    ds_read_b64_tr_b16 a[216:217], v15 offset:288
    s_waitcnt lgkmcnt(0)
    s_add_u32 m0, s72, 0
    s_nop 0
    buffer_load_dwordx4 v10, s[48:51], s73 offen lds
    s_add_u32 m0, s72, 1024
    s_nop 0
    buffer_load_dwordx4 v11, s[48:51], s73 offen lds
    s_add_u32 m0, s72, 2048
    s_nop 0
    buffer_load_dwordx4 v12, s[48:51], s73 offen lds
    s_add_u32 m0, s72, 3072
    s_nop 0
    buffer_load_dwordx4 v13, s[48:51], s73 offen lds
    s_add_u32 m0, s72, 4096
    s_nop 0
    buffer_load_dwordx4 v14, s[48:51], s73 offen lds
    s_add_u32 s73, s73, 20480
    s_waitcnt vmcnt(35)
    ds_read_b64_tr_b16 a[2:3], v15 offset:5120
    ds_read_b64_tr_b16 a[26:27], v15 offset:5152
    ds_read_b64_tr_b16 a[50:51], v15 offset:5184
    ds_read_b64_tr_b16 a[74:75], v15 offset:5216
    ds_read_b64_tr_b16 a[98:99], v15 offset:5248
    ds_read_b64_tr_b16 a[122:123], v15 offset:5280
    ds_read_b64_tr_b16 a[146:147], v15 offset:5312
    ds_read_b64_tr_b16 a[170:171], v15 offset:5344
    ds_read_b64_tr_b16 a[194:195], v15 offset:5376
    ds_read_b64_tr_b16 a[218:219], v15 offset:5408
    s_waitcnt lgkmcnt(0)
    s_add_u32 m0, s72, 5120
    s_nop 0
    buffer_load_dwordx4 v10, s[48:51], s73 offen lds
    s_add_u32 m0, s72, 6144
    s_nop 0
    buffer_load_dwordx4 v11, s[48:51], s73 offen lds
    s_add_u32 m0, s72, 7168
    s_nop 0
    buffer_load_dwordx4 v12, s[48:51], s73 offen lds
    s_add_u32 m0, s72, 8192
    s_nop 0
    buffer_load_dwordx4 v13, s[48:51], s73 offen lds
    s_add_u32 m0, s72, 9216
    s_nop 0
    buffer_load_dwordx4 v14, s[48:51], s73 offen lds
    s_add_u32 s73, s73, 20480
    s_waitcnt vmcnt(35)
    ds_read_b64_tr_b16 a[4:5], v15 offset:10240
    ds_read_b64_tr_b16 a[28:29], v15 offset:10272
    ds_read_b64_tr_b16 a[52:53], v15 offset:10304
    ds_read_b64_tr_b16 a[76:77], v15 offset:10336
    ds_read_b64_tr_b16 a[100:101], v15 offset:10368
    ds_read_b64_tr_b16 a[124:125], v15 offset:10400
    ds_read_b64_tr_b16 a[148:149], v15 offset:10432
    ds_read_b64_tr_b16 a[172:173], v15 offset:10464
    ds_read_b64_tr_b16 a[196:197], v15 offset:10496
    ds_read_b64_tr_b16 a[220:221], v15 offset:10528
    s_waitcnt lgkmcnt(0)
    s_add_u32 m0, s72, 10240
    s_nop 0
    buffer_load_dwordx4 v10, s[48:51], s73 offen lds
    s_add_u32 m0, s72, 11264
    s_nop 0
    buffer_load_dwordx4 v11, s[48:51], s73 offen lds
    s_add_u32 m0, s72, 12288
    s_nop 0
    buffer_load_dwordx4 v12, s[48:51], s73 offen lds
    s_add_u32 m0, s72, 13312
    s_nop 0
    buffer_load_dwordx4 v13, s[48:51], s73 offen lds
    s_add_u32 m0, s72, 14336
    s_nop 0
    buffer_load_dwordx4 v14, s[48:51], s73 offen lds
    s_add_u32 s73, s73, 20480
    s_waitcnt vmcnt(35)
    ds_read_b64_tr_b16 a[6:7], v15 offset:15360
    ds_read_b64_tr_b16 a[30:31], v15 offset:15392
    ds_read_b64_tr_b16 a[54:55], v15 offset:15424
    ds_read_b64_tr_b16 a[78:79], v15 offset:15456
    ds_read_b64_tr_b16 a[102:103], v15 offset:15488
    ds_read_b64_tr_b16 a[126:127], v15 offset:15520
    ds_read_b64_tr_b16 a[150:151], v15 offset:15552
    ds_read_b64_tr_b16 a[174:175], v15 offset:15584
    ds_read_b64_tr_b16 a[198:199], v15 offset:15616
    ds_read_b64_tr_b16 a[222:223], v15 offset:15648
    s_waitcnt lgkmcnt(0)
    s_add_u32 m0, s72, 15360
    s_nop 0
    buffer_load_dwordx4 v10, s[48:51], s73 offen lds
    s_add_u32 m0, s72, 16384
    s_nop 0
    buffer_load_dwordx4 v11, s[48:51], s73 offen lds
    s_add_u32 m0, s72, 17408
    s_nop 0
    buffer_load_dwordx4 v12, s[48:51], s73 offen lds
    s_add_u32 m0, s72, 18432
    s_nop 0
    buffer_load_dwordx4 v13, s[48:51], s73 offen lds
    s_add_u32 m0, s72, 19456
    s_nop 0
    buffer_load_dwordx4 v14, s[48:51], s73 offen lds
    s_add_u32 s73, s73, 20480
    s_waitcnt vmcnt(35)
    ds_read_b64_tr_b16 a[8:9], v15 offset:20480
    ds_read_b64_tr_b16 a[32:33], v15 offset:20512
    ds_read_b64_tr_b16 a[56:57], v15 offset:20544
    ds_read_b64_tr_b16 a[80:81], v15 offset:20576
    ds_read_b64_tr_b16 a[104:105], v15 offset:20608
    ds_read_b64_tr_b16 a[128:129], v15 offset:20640
    ds_read_b64_tr_b16 a[152:153], v15 offset:20672
    ds_read_b64_tr_b16 a[176:177], v15 offset:20704
    ds_read_b64_tr_b16 a[200:201], v15 offset:20736
    ds_read_b64_tr_b16 a[224:225], v15 offset:20768
    s_waitcnt vmcnt(30)
    ds_read_b64_tr_b16 a[10:11], v15 offset:25600
    ds_read_b64_tr_b16 a[34:35], v15 offset:25632
    ds_read_b64_tr_b16 a[58:59], v15 offset:25664
    ds_read_b64_tr_b16 a[82:83], v15 offset:25696
    ds_read_b64_tr_b16 a[106:107], v15 offset:25728
    ds_read_b64_tr_b16 a[130:131], v15 offset:25760
    ds_read_b64_tr_b16 a[154:155], v15 offset:25792
    ds_read_b64_tr_b16 a[178:179], v15 offset:25824
    ds_read_b64_tr_b16 a[202:203], v15 offset:25856
    ds_read_b64_tr_b16 a[226:227], v15 offset:25888
    s_waitcnt vmcnt(25)
    ds_read_b64_tr_b16 a[12:13], v15 offset:30720
    ds_read_b64_tr_b16 a[36:37], v15 offset:30752
    ds_read_b64_tr_b16 a[60:61], v15 offset:30784
    ds_read_b64_tr_b16 a[84:85], v15 offset:30816
    ds_read_b64_tr_b16 a[108:109], v15 offset:30848
    ds_read_b64_tr_b16 a[132:133], v15 offset:30880
    ds_read_b64_tr_b16 a[156:157], v15 offset:30912
    ds_read_b64_tr_b16 a[180:181], v15 offset:30944
    ds_read_b64_tr_b16 a[204:205], v15 offset:30976
    ds_read_b64_tr_b16 a[228:229], v15 offset:31008
    s_waitcnt vmcnt(20)
    ds_read_b64_tr_b16 a[14:15], v15 offset:35840
    ds_read_b64_tr_b16 a[38:39], v15 offset:35872
    ds_read_b64_tr_b16 a[62:63], v15 offset:35904
    ds_read_b64_tr_b16 a[86:87], v15 offset:35936
    ds_read_b64_tr_b16 a[110:111], v15 offset:35968
    ds_read_b64_tr_b16 a[134:135], v15 offset:36000
    ds_read_b64_tr_b16 a[158:159], v15 offset:36032
    ds_read_b64_tr_b16 a[182:183], v15 offset:36064
    ds_read_b64_tr_b16 a[206:207], v15 offset:36096
    ds_read_b64_tr_b16 a[230:231], v15 offset:36128
    s_waitcnt vmcnt(15)
    ds_read_b64_tr_b16 a[16:17], v15 offset:0
    ds_read_b64_tr_b16 a[40:41], v15 offset:32
    ds_read_b64_tr_b16 a[64:65], v15 offset:64
    ds_read_b64_tr_b16 a[88:89], v15 offset:96
    ds_read_b64_tr_b16 a[112:113], v15 offset:128
    ds_read_b64_tr_b16 a[136:137], v15 offset:160
    ds_read_b64_tr_b16 a[160:161], v15 offset:192
    ds_read_b64_tr_b16 a[184:185], v15 offset:224
    ds_read_b64_tr_b16 a[208:209], v15 offset:256
    ds_read_b64_tr_b16 a[232:233], v15 offset:288
    s_waitcnt vmcnt(10)
    ds_read_b64_tr_b16 a[18:19], v15 offset:5120
    ds_read_b64_tr_b16 a[42:43], v15 offset:5152
    ds_read_b64_tr_b16 a[66:67], v15 offset:5184
    ds_read_b64_tr_b16 a[90:91], v15 offset:5216
    ds_read_b64_tr_b16 a[114:115], v15 offset:5248
    ds_read_b64_tr_b16 a[138:139], v15 offset:5280
    ds_read_b64_tr_b16 a[162:163], v15 offset:5312
    ds_read_b64_tr_b16 a[186:187], v15 offset:5344
    ds_read_b64_tr_b16 a[210:211], v15 offset:5376
    ds_read_b64_tr_b16 a[234:235], v15 offset:5408
    s_waitcnt vmcnt(5)
    ds_read_b64_tr_b16 a[20:21], v15 offset:10240
    ds_read_b64_tr_b16 a[44:45], v15 offset:10272
    ds_read_b64_tr_b16 a[68:69], v15 offset:10304
    ds_read_b64_tr_b16 a[92:93], v15 offset:10336
    ds_read_b64_tr_b16 a[116:117], v15 offset:10368
    ds_read_b64_tr_b16 a[140:141], v15 offset:10400
    ds_read_b64_tr_b16 a[164:165], v15 offset:10432
    ds_read_b64_tr_b16 a[188:189], v15 offset:10464
    ds_read_b64_tr_b16 a[212:213], v15 offset:10496
    ds_read_b64_tr_b16 a[236:237], v15 offset:10528
    s_waitcnt vmcnt(0)
    ds_read_b64_tr_b16 a[22:23], v15 offset:15360
    ds_read_b64_tr_b16 a[46:47], v15 offset:15392
    ds_read_b64_tr_b16 a[70:71], v15 offset:15424
    ds_read_b64_tr_b16 a[94:95], v15 offset:15456
    ds_read_b64_tr_b16 a[118:119], v15 offset:15488
    ds_read_b64_tr_b16 a[142:143], v15 offset:15520
    ds_read_b64_tr_b16 a[166:167], v15 offset:15552
    ds_read_b64_tr_b16 a[190:191], v15 offset:15584
    ds_read_b64_tr_b16 a[214:215], v15 offset:15616
    ds_read_b64_tr_b16 a[238:239], v15 offset:15648
    s_waitcnt lgkmcnt(0)
    v_lshlrev_b32 v16, 4, v0
    s_mul_i32 s7, s4, 3
    s_add_u32 s7, s7, 192
    v_and_b32 v6, 1, v0
    v_lshl_add_u32 v6, v6, 1, s7
    v_lshrrev_b32 v6, 2, v6
    v_lshlrev_b32 v20, 7, v6
    s_mov_b32 s77, 0
    s_mul_i32 s74, s4, 12288
    s_add_u32 s74, s74, 0x5000000
    s_lshl_b32 s71, s4, 10
    s_mul_i32 s7, s3, 327680
    s_add_u32 s71, s71, s7
    s_add_u32 s71, s71, 0x6800000
    s_cmp_lg_u32 s3, 0
    s_cbranch_scc1 L_wsd_8
L_ws_7:
    buffer_load_dword v6, off, s[60:63], 0 sc1
    s_waitcnt vmcnt(0)
    v_cmp_gt_u32 vcc, 256, v6
    s_cbranch_vccz L_wsd_8
L_ws_7_r:
    s_sleep 16
    s_add_u32 s6, s6, 1
    s_cmp_gt_u32 s6, 200000
    s_cbranch_scc1 L_timeout
    s_branch L_ws_7
L_wsd_8:
    s_barrier
    s_mov_b32 s75, 1
    s_cmp_ge_u32 s77, s75
    s_cbranch_scc1 L_wNd_9
L_wf_10:
    buffer_load_dword v6, v20, s[40:43], 0 offen sc1
    s_waitcnt vmcnt(0)
    v_cmp_gt_u32 vcc, s75, v6
    s_cbranch_vccz L_wfd_11
    s_sleep 1
    s_add_u32 s6, s6, 1
    s_cmp_gt_u32 s6, 200000
    s_cbranch_scc1 L_timeout
    s_branch L_wf_10
L_wfd_11:
    s_mov_b32 s77, s75
    s_add_u32 s76, s75, 1
    v_cmp_gt_u32 vcc, s76, v6
    s_cbranch_vccnz L_wNd_9
    s_mov_b32 s77, s76
    s_add_u32 s76, s75, 2
    v_cmp_gt_u32 vcc, s76, v6
    s_cbranch_vccnz L_wNd_9
    s_mov_b32 s77, s76
    s_add_u32 s76, s75, 4
    v_cmp_gt_u32 vcc, s76, v6
    s_cbranch_vccnz L_wNd_9
    s_mov_b32 s77, s76
    s_add_u32 s76, s75, 8
    v_cmp_gt_u32 vcc, s76, v6
    s_cbranch_vccnz L_wNd_9
    s_mov_b32 s77, s76
    s_add_u32 s76, s75, 16
    v_cmp_gt_u32 vcc, s76, v6
    s_cbranch_vccnz L_wNd_9
    s_mov_b32 s77, s76
L_wNd_9:
    s_add_u32 s78, s74, 0
    buffer_load_dwordx4 v[32:35], v16, s[40:43], s78 offen offset:0 sc1
    buffer_load_dwordx4 v[36:39], v16, s[40:43], s78 offen offset:1024 sc1
    buffer_load_dwordx4 v[40:43], v16, s[40:43], s78 offen offset:2048 sc1
    buffer_load_dwordx4 v[44:47], v16, s[40:43], s78 offen offset:3072 sc1
    s_add_u32 s78, s74, 4096
    buffer_load_dwordx4 v[48:51], v16, s[40:43], s78 offen offset:0 sc1
    buffer_load_dwordx4 v[52:55], v16, s[40:43], s78 offen offset:1024 sc1
    buffer_load_dwordx4 v[56:59], v16, s[40:43], s78 offen offset:2048 sc1
    buffer_load_dwordx4 v[60:63], v16, s[40:43], s78 offen offset:3072 sc1
    s_add_u32 s78, s74, 8192
    buffer_load_dwordx4 v[64:67], v16, s[40:43], s78 offen offset:0 sc1
    buffer_load_dwordx4 v[68:71], v16, s[40:43], s78 offen offset:1024 sc1
    buffer_load_dwordx4 v[72:75], v16, s[40:43], s78 offen offset:2048 sc1
    buffer_load_dwordx4 v[76:79], v16, s[40:43], s78 offen offset:3072 sc1
    v_mov_b32 v6, s5
    buffer_store_dword v6, v5, s[40:43], s70 offen sc1
.p2align 6
L_bu_loop_12:
    s_add_u32 s74, s74, 393216
    buffer_load_dword v22, v20, s[40:43], 0 offen sc1
    s_waitcnt vmcnt(12)
    v_mfma_f32_16x16x32_bf16 v[128:131], v[32:35], a[0:3], 0
    v_mfma_f32_16x16x32_bf16 v[132:135], v[36:39], a[0:3], 0
    s_waitcnt vmcnt(10)
    v_mfma_f32_16x16x32_bf16 v[128:131], v[40:43], a[4:7], v[128:131]
    v_mfma_f32_16x16x32_bf16 v[132:135], v[44:47], a[4:7], v[132:135]
    s_waitcnt vmcnt(8)
    v_mfma_f32_16x16x32_bf16 v[128:131], v[48:51], a[8:11], v[128:131]
    v_mfma_f32_16x16x32_bf16 v[132:135], v[52:55], a[8:11], v[132:135]
    s_waitcnt vmcnt(6)
    v_mfma_f32_16x16x32_bf16 v[128:131], v[56:59], a[12:15], v[128:131]
    v_mfma_f32_16x16x32_bf16 v[132:135], v[60:63], a[12:15], v[132:135]
    s_waitcnt vmcnt(4)
    v_mfma_f32_16x16x32_bf16 v[128:131], v[64:67], a[16:19], v[128:131]
    v_mfma_f32_16x16x32_bf16 v[132:135], v[68:71], a[16:19], v[132:135]
    s_waitcnt vmcnt(2)
    v_mfma_f32_16x16x32_bf16 v[128:131], v[72:75], a[20:23], v[128:131]
    v_mfma_f32_16x16x32_bf16 v[132:135], v[76:79], a[20:23], v[132:135]
    v_mfma_f32_16x16x32_bf16 v[136:139], v[32:35], a[24:27], 0
    v_mfma_f32_16x16x32_bf16 v[140:143], v[36:39], a[24:27], 0
    v_mfma_f32_16x16x32_bf16 v[136:139], v[40:43], a[28:31], v[136:139]
    v_mfma_f32_16x16x32_bf16 v[140:143], v[44:47], a[28:31], v[140:143]
    v_mfma_f32_16x16x32_bf16 v[136:139], v[48:51], a[32:35], v[136:139]
    v_cvt_pk_bf16_f32 v144, v128, v129
    v_mfma_f32_16x16x32_bf16 v[140:143], v[52:55], a[32:35], v[140:143]
    v_cvt_pk_bf16_f32 v145, v130, v131
    v_mfma_f32_16x16x32_bf16 v[136:139], v[56:59], a[36:39], v[136:139]
    v_cvt_pk_bf16_f32 v146, v132, v133
    v_mfma_f32_16x16x32_bf16 v[140:143], v[60:63], a[36:39], v[140:143]
    v_cvt_pk_bf16_f32 v147, v134, v135
    v_mfma_f32_16x16x32_bf16 v[136:139], v[64:67], a[40:43], v[136:139]
    s_add_u32 s76, s71, 0
    buffer_store_dwordx4 v[144:147], v16, s[40:43], s76 offen sc1
    v_mfma_f32_16x16x32_bf16 v[140:143], v[68:71], a[40:43], v[140:143]
    v_mfma_f32_16x16x32_bf16 v[136:139], v[72:75], a[44:47], v[136:139]
    v_mfma_f32_16x16x32_bf16 v[140:143], v[76:79], a[44:47], v[140:143]
    v_mfma_f32_16x16x32_bf16 v[128:131], v[32:35], a[48:51], 0
    v_mfma_f32_16x16x32_bf16 v[132:135], v[36:39], a[48:51], 0
    v_mfma_f32_16x16x32_bf16 v[128:131], v[40:43], a[52:55], v[128:131]
    v_mfma_f32_16x16x32_bf16 v[132:135], v[44:47], a[52:55], v[132:135]
    v_mfma_f32_16x16x32_bf16 v[128:131], v[48:51], a[56:59], v[128:131]
    v_cvt_pk_bf16_f32 v148, v136, v137
    v_mfma_f32_16x16x32_bf16 v[132:135], v[52:55], a[56:59], v[132:135]
    v_cvt_pk_bf16_f32 v149, v138, v139
    v_mfma_f32_16x16x32_bf16 v[128:131], v[56:59], a[60:63], v[128:131]
    v_cvt_pk_bf16_f32 v150, v140, v141
    v_mfma_f32_16x16x32_bf16 v[132:135], v[60:63], a[60:63], v[132:135]
    v_cvt_pk_bf16_f32 v151, v142, v143
    v_mfma_f32_16x16x32_bf16 v[128:131], v[64:67], a[64:67], v[128:131]
    s_add_u32 s76, s71, 32768
    buffer_store_dwordx4 v[148:151], v16, s[40:43], s76 offen sc1
    v_mfma_f32_16x16x32_bf16 v[132:135], v[68:71], a[64:67], v[132:135]
    v_mfma_f32_16x16x32_bf16 v[128:131], v[72:75], a[68:71], v[128:131]
    v_mfma_f32_16x16x32_bf16 v[132:135], v[76:79], a[68:71], v[132:135]
    v_mfma_f32_16x16x32_bf16 v[136:139], v[32:35], a[72:75], 0
    v_mfma_f32_16x16x32_bf16 v[140:143], v[36:39], a[72:75], 0
    v_mfma_f32_16x16x32_bf16 v[136:139], v[40:43], a[76:79], v[136:139]
    v_mfma_f32_16x16x32_bf16 v[140:143], v[44:47], a[76:79], v[140:143]
    v_mfma_f32_16x16x32_bf16 v[136:139], v[48:51], a[80:83], v[136:139]
    v_cvt_pk_bf16_f32 v144, v128, v129
    v_mfma_f32_16x16x32_bf16 v[140:143], v[52:55], a[80:83], v[140:143]
    v_cvt_pk_bf16_f32 v145, v130, v131
    v_mfma_f32_16x16x32_bf16 v[136:139], v[56:59], a[84:87], v[136:139]
    v_cvt_pk_bf16_f32 v146, v132, v133
    v_mfma_f32_16x16x32_bf16 v[140:143], v[60:63], a[84:87], v[140:143]
    v_cvt_pk_bf16_f32 v147, v134, v135
    v_mfma_f32_16x16x32_bf16 v[136:139], v[64:67], a[88:91], v[136:139]
    s_add_u32 s76, s71, 65536
    buffer_store_dwordx4 v[144:147], v16, s[40:43], s76 offen sc1
    v_mfma_f32_16x16x32_bf16 v[140:143], v[68:71], a[88:91], v[140:143]
    v_mfma_f32_16x16x32_bf16 v[136:139], v[72:75], a[92:95], v[136:139]
    v_mfma_f32_16x16x32_bf16 v[140:143], v[76:79], a[92:95], v[140:143]
    v_mfma_f32_16x16x32_bf16 v[128:131], v[32:35], a[96:99], 0
    v_mfma_f32_16x16x32_bf16 v[132:135], v[36:39], a[96:99], 0
    v_mfma_f32_16x16x32_bf16 v[128:131], v[40:43], a[100:103], v[128:131]
    v_mfma_f32_16x16x32_bf16 v[132:135], v[44:47], a[100:103], v[132:135]
    v_mfma_f32_16x16x32_bf16 v[128:131], v[48:51], a[104:107], v[128:131]
    v_cvt_pk_bf16_f32 v148, v136, v137
    v_mfma_f32_16x16x32_bf16 v[132:135], v[52:55], a[104:107], v[132:135]
    v_cvt_pk_bf16_f32 v149, v138, v139
    v_mfma_f32_16x16x32_bf16 v[128:131], v[56:59], a[108:111], v[128:131]
    v_cvt_pk_bf16_f32 v150, v140, v141
    v_mfma_f32_16x16x32_bf16 v[132:135], v[60:63], a[108:111], v[132:135]
    v_cvt_pk_bf16_f32 v151, v142, v143
    v_mfma_f32_16x16x32_bf16 v[128:131], v[64:67], a[112:115], v[128:131]
    s_add_u32 s76, s71, 98304
    buffer_store_dwordx4 v[148:151], v16, s[40:43], s76 offen sc1
    v_mfma_f32_16x16x32_bf16 v[132:135], v[68:71], a[112:115], v[132:135]
    v_mfma_f32_16x16x32_bf16 v[128:131], v[72:75], a[116:119], v[128:131]
    v_mfma_f32_16x16x32_bf16 v[132:135], v[76:79], a[116:119], v[132:135]
    v_mfma_f32_16x16x32_bf16 v[136:139], v[32:35], a[120:123], 0
    v_mfma_f32_16x16x32_bf16 v[140:143], v[36:39], a[120:123], 0
    v_mfma_f32_16x16x32_bf16 v[136:139], v[40:43], a[124:127], v[136:139]
    v_mfma_f32_16x16x32_bf16 v[140:143], v[44:47], a[124:127], v[140:143]
    v_mfma_f32_16x16x32_bf16 v[136:139], v[48:51], a[128:131], v[136:139]
    v_cvt_pk_bf16_f32 v144, v128, v129
    v_mfma_f32_16x16x32_bf16 v[140:143], v[52:55], a[128:131], v[140:143]
    v_cvt_pk_bf16_f32 v145, v130, v131
    v_mfma_f32_16x16x32_bf16 v[136:139], v[56:59], a[132:135], v[136:139]
    v_cvt_pk_bf16_f32 v146, v132, v133
    v_mfma_f32_16x16x32_bf16 v[140:143], v[60:63], a[132:135], v[140:143]
    v_cvt_pk_bf16_f32 v147, v134, v135
    v_mfma_f32_16x16x32_bf16 v[136:139], v[64:67], a[136:139], v[136:139]
    s_add_u32 s76, s71, 131072
    buffer_store_dwordx4 v[144:147], v16, s[40:43], s76 offen sc1
    v_mfma_f32_16x16x32_bf16 v[140:143], v[68:71], a[136:139], v[140:143]
    v_mfma_f32_16x16x32_bf16 v[136:139], v[72:75], a[140:143], v[136:139]
    v_mfma_f32_16x16x32_bf16 v[140:143], v[76:79], a[140:143], v[140:143]
    v_mfma_f32_16x16x32_bf16 v[128:131], v[32:35], a[144:147], 0
    v_mfma_f32_16x16x32_bf16 v[132:135], v[36:39], a[144:147], 0
    v_mfma_f32_16x16x32_bf16 v[128:131], v[40:43], a[148:151], v[128:131]
    v_mfma_f32_16x16x32_bf16 v[132:135], v[44:47], a[148:151], v[132:135]
    v_mfma_f32_16x16x32_bf16 v[128:131], v[48:51], a[152:155], v[128:131]
    v_cvt_pk_bf16_f32 v148, v136, v137
    v_mfma_f32_16x16x32_bf16 v[132:135], v[52:55], a[152:155], v[132:135]
    v_cvt_pk_bf16_f32 v149, v138, v139
    v_mfma_f32_16x16x32_bf16 v[128:131], v[56:59], a[156:159], v[128:131]
    v_cvt_pk_bf16_f32 v150, v140, v141
    v_mfma_f32_16x16x32_bf16 v[132:135], v[60:63], a[156:159], v[132:135]
    v_cvt_pk_bf16_f32 v151, v142, v143
    v_mfma_f32_16x16x32_bf16 v[128:131], v[64:67], a[160:163], v[128:131]
    s_add_u32 s76, s71, 163840
    buffer_store_dwordx4 v[148:151], v16, s[40:43], s76 offen sc1
    v_mfma_f32_16x16x32_bf16 v[132:135], v[68:71], a[160:163], v[132:135]
    v_mfma_f32_16x16x32_bf16 v[128:131], v[72:75], a[164:167], v[128:131]
    v_mfma_f32_16x16x32_bf16 v[132:135], v[76:79], a[164:167], v[132:135]
    v_mfma_f32_16x16x32_bf16 v[136:139], v[32:35], a[168:171], 0
    v_mfma_f32_16x16x32_bf16 v[140:143], v[36:39], a[168:171], 0
    v_mfma_f32_16x16x32_bf16 v[136:139], v[40:43], a[172:175], v[136:139]
    v_mfma_f32_16x16x32_bf16 v[140:143], v[44:47], a[172:175], v[140:143]
    v_mfma_f32_16x16x32_bf16 v[136:139], v[48:51], a[176:179], v[136:139]
    v_cvt_pk_bf16_f32 v144, v128, v129
    v_mfma_f32_16x16x32_bf16 v[140:143], v[52:55], a[176:179], v[140:143]
    v_cvt_pk_bf16_f32 v145, v130, v131
    v_mfma_f32_16x16x32_bf16 v[136:139], v[56:59], a[180:183], v[136:139]
    v_cvt_pk_bf16_f32 v146, v132, v133
    v_mfma_f32_16x16x32_bf16 v[140:143], v[60:63], a[180:183], v[140:143]
    v_cvt_pk_bf16_f32 v147, v134, v135
    v_mfma_f32_16x16x32_bf16 v[136:139], v[64:67], a[184:187], v[136:139]
    s_add_u32 s76, s71, 196608
    buffer_store_dwordx4 v[144:147], v16, s[40:43], s76 offen sc1
    v_mfma_f32_16x16x32_bf16 v[140:143], v[68:71], a[184:187], v[140:143]
    v_mfma_f32_16x16x32_bf16 v[136:139], v[72:75], a[188:191], v[136:139]
    v_mfma_f32_16x16x32_bf16 v[140:143], v[76:79], a[188:191], v[140:143]
    v_mfma_f32_16x16x32_bf16 v[128:131], v[32:35], a[192:195], 0
    v_mfma_f32_16x16x32_bf16 v[132:135], v[36:39], a[192:195], 0
    v_mfma_f32_16x16x32_bf16 v[128:131], v[40:43], a[196:199], v[128:131]
    v_mfma_f32_16x16x32_bf16 v[132:135], v[44:47], a[196:199], v[132:135]
    v_mfma_f32_16x16x32_bf16 v[128:131], v[48:51], a[200:203], v[128:131]
    v_cvt_pk_bf16_f32 v148, v136, v137
    v_mfma_f32_16x16x32_bf16 v[132:135], v[52:55], a[200:203], v[132:135]
    v_cvt_pk_bf16_f32 v149, v138, v139
    v_mfma_f32_16x16x32_bf16 v[128:131], v[56:59], a[204:207], v[128:131]
    v_cvt_pk_bf16_f32 v150, v140, v141
    v_mfma_f32_16x16x32_bf16 v[132:135], v[60:63], a[204:207], v[132:135]
    v_cvt_pk_bf16_f32 v151, v142, v143
    v_mfma_f32_16x16x32_bf16 v[128:131], v[64:67], a[208:211], v[128:131]
    s_add_u32 s76, s71, 229376
    buffer_store_dwordx4 v[148:151], v16, s[40:43], s76 offen sc1
    v_mfma_f32_16x16x32_bf16 v[132:135], v[68:71], a[208:211], v[132:135]
    v_mfma_f32_16x16x32_bf16 v[128:131], v[72:75], a[212:215], v[128:131]
    v_mfma_f32_16x16x32_bf16 v[132:135], v[76:79], a[212:215], v[132:135]
    v_mfma_f32_16x16x32_bf16 v[136:139], v[32:35], a[216:219], 0
    v_mfma_f32_16x16x32_bf16 v[140:143], v[36:39], a[216:219], 0
    v_mfma_f32_16x16x32_bf16 v[136:139], v[40:43], a[220:223], v[136:139]
    v_mfma_f32_16x16x32_bf16 v[140:143], v[44:47], a[220:223], v[140:143]
    v_mfma_f32_16x16x32_bf16 v[136:139], v[48:51], a[224:227], v[136:139]
    v_cvt_pk_bf16_f32 v144, v128, v129
    v_mfma_f32_16x16x32_bf16 v[140:143], v[52:55], a[224:227], v[140:143]
    v_cvt_pk_bf16_f32 v145, v130, v131
    v_mfma_f32_16x16x32_bf16 v[136:139], v[56:59], a[228:231], v[136:139]
    v_cvt_pk_bf16_f32 v146, v132, v133
    v_mfma_f32_16x16x32_bf16 v[140:143], v[60:63], a[228:231], v[140:143]
    v_cvt_pk_bf16_f32 v147, v134, v135
    v_mfma_f32_16x16x32_bf16 v[136:139], v[64:67], a[232:235], v[136:139]
    s_add_u32 s76, s71, 262144
    buffer_store_dwordx4 v[144:147], v16, s[40:43], s76 offen sc1
    v_mfma_f32_16x16x32_bf16 v[140:143], v[68:71], a[232:235], v[140:143]
    v_mfma_f32_16x16x32_bf16 v[136:139], v[72:75], a[236:239], v[136:139]
    v_mfma_f32_16x16x32_bf16 v[140:143], v[76:79], a[236:239], v[140:143]
    s_nop 3
    v_cvt_pk_bf16_f32 v148, v136, v137
    v_cvt_pk_bf16_f32 v149, v138, v139
    s_nop 1
    v_cvt_pk_bf16_f32 v150, v140, v141
    v_cvt_pk_bf16_f32 v151, v142, v143
    s_add_u32 s76, s71, 294912
    buffer_store_dwordx4 v[148:151], v16, s[40:43], s76 offen sc1
    s_add_u32 s71, s71, 1310720
    s_add_u32 s5, s5, 1
    s_cmp_ge_u32 s5, 64
    s_cbranch_scc1 L_bu_fin_14
    s_add_u32 s75, s5, 1
    s_waitcnt vmcnt(10)
    v_cmp_gt_u32 vcc, s75, v22
    s_cbranch_vccnz L_bu_slow_13
    s_add_u32 s78, s74, 0
    buffer_load_dwordx4 v[32:35], v16, s[40:43], s78 offen offset:0 sc1
    buffer_load_dwordx4 v[36:39], v16, s[40:43], s78 offen offset:1024 sc1
    buffer_load_dwordx4 v[40:43], v16, s[40:43], s78 offen offset:2048 sc1
    buffer_load_dwordx4 v[44:47], v16, s[40:43], s78 offen offset:3072 sc1
    s_add_u32 s78, s74, 4096
    buffer_load_dwordx4 v[48:51], v16, s[40:43], s78 offen offset:0 sc1
    buffer_load_dwordx4 v[52:55], v16, s[40:43], s78 offen offset:1024 sc1
    buffer_load_dwordx4 v[56:59], v16, s[40:43], s78 offen offset:2048 sc1
    buffer_load_dwordx4 v[60:63], v16, s[40:43], s78 offen offset:3072 sc1
    s_add_u32 s78, s74, 8192
    buffer_load_dwordx4 v[64:67], v16, s[40:43], s78 offen offset:0 sc1
    buffer_load_dwordx4 v[68:71], v16, s[40:43], s78 offen offset:1024 sc1
    buffer_load_dwordx4 v[72:75], v16, s[40:43], s78 offen offset:2048 sc1
    buffer_load_dwordx4 v[76:79], v16, s[40:43], s78 offen offset:3072 sc1
    s_waitcnt vmcnt(12)
    s_barrier
    v_mov_b32 v6, s5
    buffer_store_dword v6, v5, s[40:43], s70 offen sc1
    s_branch L_bu_loop_12
L_bu_slow_13:
    s_waitcnt vmcnt(0)
    s_barrier
    v_mov_b32 v6, s5
    buffer_store_dword v6, v5, s[40:43], s70 offen sc1
L_wf_15:
    buffer_load_dword v6, v20, s[40:43], 0 offen sc1
    s_waitcnt vmcnt(0)
    v_cmp_gt_u32 vcc, s75, v6
    s_cbranch_vccz L_wfd_16
    s_sleep 1
    s_add_u32 s6, s6, 1
    s_cmp_gt_u32 s6, 200000
    s_cbranch_scc1 L_timeout
    s_branch L_wf_15
L_wfd_16:
    s_add_u32 s78, s74, 0
    buffer_load_dwordx4 v[32:35], v16, s[40:43], s78 offen offset:0 sc1
    buffer_load_dwordx4 v[36:39], v16, s[40:43], s78 offen offset:1024 sc1
    buffer_load_dwordx4 v[40:43], v16, s[40:43], s78 offen offset:2048 sc1
    buffer_load_dwordx4 v[44:47], v16, s[40:43], s78 offen offset:3072 sc1
    s_add_u32 s78, s74, 4096
    buffer_load_dwordx4 v[48:51], v16, s[40:43], s78 offen offset:0 sc1
    buffer_load_dwordx4 v[52:55], v16, s[40:43], s78 offen offset:1024 sc1
    buffer_load_dwordx4 v[56:59], v16, s[40:43], s78 offen offset:2048 sc1
    buffer_load_dwordx4 v[60:63], v16, s[40:43], s78 offen offset:3072 sc1
    s_add_u32 s78, s74, 8192
    buffer_load_dwordx4 v[64:67], v16, s[40:43], s78 offen offset:0 sc1
    buffer_load_dwordx4 v[68:71], v16, s[40:43], s78 offen offset:1024 sc1
    buffer_load_dwordx4 v[72:75], v16, s[40:43], s78 offen offset:2048 sc1
    buffer_load_dwordx4 v[76:79], v16, s[40:43], s78 offen offset:3072 sc1
    v_mov_b32 v6, 0x80000000
    buffer_store_dword v6, v6, s[40:43], 0 offen sc1
    s_branch L_bu_loop_12
L_bu_fin_14:
    s_waitcnt vmcnt(0)
    s_barrier
    v_mov_b32 v6, s5
    buffer_store_dword v6, v5, s[40:43], s70 offen sc1
    s_endpgm
L_D:
    s_getpc_b64 s[96:97]
L_pc_17:
    s_lshl_b32 s98, s3, 10
    v_lshl_add_u32 v250, v0, 4, s98
    v_mov_b32 v251, s97
    v_add_co_u32 v250, vcc, s96, v250
    s_nop 1
    v_addc_co_u32 v251, vcc, 0, v251, vcc
    global_load_dwordx4 v[252:255], v[250:251], off
    v_add_co_u32 v250, vcc, 0x1000, v250
    s_nop 1
    v_addc_co_u32 v251, vcc, 0, v251, vcc
    s_mov_b32 s48, s28
    s_mov_b32 s49, s29
    s_mov_b32 s50, 0x1e0000
    s_mov_b32 s51, 0x20000
    s_add_u32 s70, s4, 116
    s_lshl_b32 s70, s70, 7
    v_and_b32 v1, 15, v0
    v_lshrrev_b32 v2, 4, v0
    v_lshrrev_b32 v3, 2, v1
    v_and_b32 v4, 3, v0
    v_mov_b32 v5, s3
    v_or_b32 v5, v5, v0
    v_cmp_eq_u32 vcc, 0, v5
    v_mov_b32 v5, 0x80000000
    s_nop 0
    v_cndmask_b32_e64 v5, v5, 0, vcc
    v_mov_b32 v6, 0
    buffer_store_dword v6, v5, s[40:43], s70 offen sc1
    s_waitcnt vmcnt(0)
    s_barrier
    v_mov_b32 v6, 1
    buffer_atomic_add v6, v5, s[60:63], 0 offen sc1
    s_mul_i32 s72, s3, 40960
    v_add_u32 v6, 0, v0
    v_mul_u32_u24 v7, 205, v6
    v_lshrrev_b32 v7, 11, v7
    v_mul_u32_u24 v8, 10, v7
    v_sub_u32 v8, v6, v8
    v_mul_u32_u24 v7, 1280, v7
    v_lshl_add_u32 v10, v8, 4, v7
    v_add_u32 v6, 64, v0
    v_mul_u32_u24 v7, 205, v6
    v_lshrrev_b32 v7, 11, v7
    v_mul_u32_u24 v8, 10, v7
    v_sub_u32 v8, v6, v8
    v_mul_u32_u24 v7, 1280, v7
    v_lshl_add_u32 v11, v8, 4, v7
    v_add_u32 v6, 128, v0
    v_mul_u32_u24 v7, 205, v6
    v_lshrrev_b32 v7, 11, v7
    v_mul_u32_u24 v8, 10, v7
    v_sub_u32 v8, v6, v8
    v_mul_u32_u24 v7, 1280, v7
    v_lshl_add_u32 v12, v8, 4, v7
    v_add_u32 v6, 192, v0
    v_mul_u32_u24 v7, 205, v6
    v_lshrrev_b32 v7, 11, v7
    v_mul_u32_u24 v8, 10, v7
    v_sub_u32 v8, v6, v8
    v_mul_u32_u24 v7, 1280, v7
    v_lshl_add_u32 v13, v8, 4, v7
    v_add_u32 v6, 256, v0
    v_mul_u32_u24 v7, 205, v6
    v_lshrrev_b32 v7, 11, v7
    v_mul_u32_u24 v8, 10, v7
    v_sub_u32 v8, v6, v8
    v_mul_u32_u24 v7, 1280, v7
    v_lshl_add_u32 v14, v8, 4, v7
    s_mul_i32 s73, s4, 160
    s_mul_i32 s7, s3, 491520
    s_add_u32 s73, s73, s7
    v_lshrrev_b32 v6, 1, v2
    v_lshlrev_b32 v6, 4, v6
    v_and_b32 v7, 1, v2
    v_lshl_add_u32 v6, v7, 2, v6
    v_add_u32 v6, v6, v3
    v_mul_u32_u24 v6, 160, v6
    v_lshl_add_u32 v15, v4, 3, v6
    v_add_u32 v15, s72, v15
    s_add_u32 m0, s72, 0
    s_nop 0
    buffer_load_dwordx4 v10, s[48:51], s73 offen lds
    s_add_u32 m0, s72, 1024
    s_nop 0
    buffer_load_dwordx4 v11, s[48:51], s73 offen lds
    s_add_u32 m0, s72, 2048
    s_nop 0
    buffer_load_dwordx4 v12, s[48:51], s73 offen lds
    s_add_u32 m0, s72, 3072
    s_nop 0
    buffer_load_dwordx4 v13, s[48:51], s73 offen lds
    s_add_u32 m0, s72, 4096
    s_nop 0
    buffer_load_dwordx4 v14, s[48:51], s73 offen lds
    s_add_u32 s73, s73, 40960
    s_add_u32 m0, s72, 5120
    s_nop 0
    buffer_load_dwordx4 v10, s[48:51], s73 offen lds
    s_add_u32 m0, s72, 6144
    s_nop 0
    buffer_load_dwordx4 v11, s[48:51], s73 offen lds
    s_add_u32 m0, s72, 7168
    s_nop 0
    buffer_load_dwordx4 v12, s[48:51], s73 offen lds
    s_add_u32 m0, s72, 8192
    s_nop 0
    buffer_load_dwordx4 v13, s[48:51], s73 offen lds
    s_add_u32 m0, s72, 9216
    s_nop 0
    buffer_load_dwordx4 v14, s[48:51], s73 offen lds
    s_add_u32 s73, s73, 40960
    s_add_u32 m0, s72, 10240
    s_nop 0
    buffer_load_dwordx4 v10, s[48:51], s73 offen lds
    s_add_u32 m0, s72, 11264
    s_nop 0
    buffer_load_dwordx4 v11, s[48:51], s73 offen lds
    s_add_u32 m0, s72, 12288
    s_nop 0
    buffer_load_dwordx4 v12, s[48:51], s73 offen lds
    s_add_u32 m0, s72, 13312
    s_nop 0
    buffer_load_dwordx4 v13, s[48:51], s73 offen lds
    s_add_u32 m0, s72, 14336
    s_nop 0
    buffer_load_dwordx4 v14, s[48:51], s73 offen lds
    s_add_u32 s73, s73, 40960
    s_add_u32 m0, s72, 15360
    s_nop 0
    buffer_load_dwordx4 v10, s[48:51], s73 offen lds
    s_add_u32 m0, s72, 16384
    s_nop 0
    buffer_load_dwordx4 v11, s[48:51], s73 offen lds
    s_add_u32 m0, s72, 17408
    s_nop 0
    buffer_load_dwordx4 v12, s[48:51], s73 offen lds
    s_add_u32 m0, s72, 18432
    s_nop 0
    buffer_load_dwordx4 v13, s[48:51], s73 offen lds
    s_add_u32 m0, s72, 19456
    s_nop 0
    buffer_load_dwordx4 v14, s[48:51], s73 offen lds
    s_add_u32 s73, s73, 40960
    s_add_u32 m0, s72, 20480
    s_nop 0
    buffer_load_dwordx4 v10, s[48:51], s73 offen lds
    s_add_u32 m0, s72, 21504
    s_nop 0
    buffer_load_dwordx4 v11, s[48:51], s73 offen lds
    s_add_u32 m0, s72, 22528
    s_nop 0
    buffer_load_dwordx4 v12, s[48:51], s73 offen lds
    s_add_u32 m0, s72, 23552
    s_nop 0
    buffer_load_dwordx4 v13, s[48:51], s73 offen lds
    s_add_u32 m0, s72, 24576
    s_nop 0
    buffer_load_dwordx4 v14, s[48:51], s73 offen lds
    s_add_u32 s73, s73, 40960
    s_add_u32 m0, s72, 25600
    s_nop 0
    buffer_load_dwordx4 v10, s[48:51], s73 offen lds
    s_add_u32 m0, s72, 26624
    s_nop 0
    buffer_load_dwordx4 v11, s[48:51], s73 offen lds
    s_add_u32 m0, s72, 27648
    s_nop 0
    buffer_load_dwordx4 v12, s[48:51], s73 offen lds
    s_add_u32 m0, s72, 28672
    s_nop 0
    buffer_load_dwordx4 v13, s[48:51], s73 offen lds
    s_add_u32 m0, s72, 29696
    s_nop 0
    buffer_load_dwordx4 v14, s[48:51], s73 offen lds
    s_add_u32 s73, s73, 40960
    s_add_u32 m0, s72, 30720
    s_nop 0
    buffer_load_dwordx4 v10, s[48:51], s73 offen lds
    s_add_u32 m0, s72, 31744
    s_nop 0
    buffer_load_dwordx4 v11, s[48:51], s73 offen lds
    s_add_u32 m0, s72, 32768
    s_nop 0
    buffer_load_dwordx4 v12, s[48:51], s73 offen lds
    s_add_u32 m0, s72, 33792
    s_nop 0
    buffer_load_dwordx4 v13, s[48:51], s73 offen lds
    s_add_u32 m0, s72, 34816
    s_nop 0
    buffer_load_dwordx4 v14, s[48:51], s73 offen lds
    s_add_u32 s73, s73, 40960
    s_add_u32 m0, s72, 35840
    s_nop 0
    buffer_load_dwordx4 v10, s[48:51], s73 offen lds
    s_add_u32 m0, s72, 36864
    s_nop 0
    buffer_load_dwordx4 v11, s[48:51], s73 offen lds
    s_add_u32 m0, s72, 37888
    s_nop 0
    buffer_load_dwordx4 v12, s[48:51], s73 offen lds
    s_add_u32 m0, s72, 38912
    s_nop 0
    buffer_load_dwordx4 v13, s[48:51], s73 offen lds
    s_add_u32 m0, s72, 39936
    s_nop 0
    buffer_load_dwordx4 v14, s[48:51], s73 offen lds
    s_add_u32 s73, s73, 40960
    s_waitcnt vmcnt(35)
    ds_read_b64_tr_b16 a[0:1], v15 offset:0
    ds_read_b64_tr_b16 a[2:3], v15 offset:1280
    ds_read_b64_tr_b16 a[4:5], v15 offset:32
    ds_read_b64_tr_b16 a[6:7], v15 offset:1312
    ds_read_b64_tr_b16 a[8:9], v15 offset:64
    ds_read_b64_tr_b16 a[10:11], v15 offset:1344
    ds_read_b64_tr_b16 a[12:13], v15 offset:96
    ds_read_b64_tr_b16 a[14:15], v15 offset:1376
    ds_read_b64_tr_b16 a[16:17], v15 offset:128
    ds_read_b64_tr_b16 a[18:19], v15 offset:1408
    s_waitcnt lgkmcnt(0)
    s_add_u32 m0, s72, 0
    s_nop 0
    buffer_load_dwordx4 v10, s[48:51], s73 offen lds
    s_add_u32 m0, s72, 1024
    s_nop 0
    buffer_load_dwordx4 v11, s[48:51], s73 offen lds
    s_add_u32 m0, s72, 2048
    s_nop 0
    buffer_load_dwordx4 v12, s[48:51], s73 offen lds
    s_add_u32 m0, s72, 3072
    s_nop 0
    buffer_load_dwordx4 v13, s[48:51], s73 offen lds
    s_add_u32 m0, s72, 4096
    s_nop 0
    buffer_load_dwordx4 v14, s[48:51], s73 offen lds
    s_add_u32 s73, s73, 40960
    s_waitcnt vmcnt(35)
    ds_read_b64_tr_b16 a[20:21], v15 offset:5120
    ds_read_b64_tr_b16 a[22:23], v15 offset:6400
    ds_read_b64_tr_b16 a[24:25], v15 offset:5152
    ds_read_b64_tr_b16 a[26:27], v15 offset:6432
    ds_read_b64_tr_b16 a[28:29], v15 offset:5184
    ds_read_b64_tr_b16 a[30:31], v15 offset:6464
    ds_read_b64_tr_b16 a[32:33], v15 offset:5216
    ds_read_b64_tr_b16 a[34:35], v15 offset:6496
    ds_read_b64_tr_b16 a[36:37], v15 offset:5248
    ds_read_b64_tr_b16 a[38:39], v15 offset:6528
    s_waitcnt lgkmcnt(0)
    s_add_u32 m0, s72, 5120
    s_nop 0
    buffer_load_dwordx4 v10, s[48:51], s73 offen lds
    s_add_u32 m0, s72, 6144
    s_nop 0
    buffer_load_dwordx4 v11, s[48:51], s73 offen lds
    s_add_u32 m0, s72, 7168
    s_nop 0
    buffer_load_dwordx4 v12, s[48:51], s73 offen lds
    s_add_u32 m0, s72, 8192
    s_nop 0
    buffer_load_dwordx4 v13, s[48:51], s73 offen lds
    s_add_u32 m0, s72, 9216
    s_nop 0
    buffer_load_dwordx4 v14, s[48:51], s73 offen lds
    s_add_u32 s73, s73, 40960
    s_waitcnt vmcnt(35)
    ds_read_b64_tr_b16 a[40:41], v15 offset:10240
    ds_read_b64_tr_b16 a[42:43], v15 offset:11520
    ds_read_b64_tr_b16 a[44:45], v15 offset:10272
    ds_read_b64_tr_b16 a[46:47], v15 offset:11552
    ds_read_b64_tr_b16 a[48:49], v15 offset:10304
    ds_read_b64_tr_b16 a[50:51], v15 offset:11584
    ds_read_b64_tr_b16 a[52:53], v15 offset:10336
    ds_read_b64_tr_b16 a[54:55], v15 offset:11616
    ds_read_b64_tr_b16 a[56:57], v15 offset:10368
    ds_read_b64_tr_b16 a[58:59], v15 offset:11648
    s_waitcnt lgkmcnt(0)
    s_add_u32 m0, s72, 10240
    s_nop 0
    buffer_load_dwordx4 v10, s[48:51], s73 offen lds
    s_add_u32 m0, s72, 11264
    s_nop 0
    buffer_load_dwordx4 v11, s[48:51], s73 offen lds
    s_add_u32 m0, s72, 12288
    s_nop 0
    buffer_load_dwordx4 v12, s[48:51], s73 offen lds
    s_add_u32 m0, s72, 13312
    s_nop 0
    buffer_load_dwordx4 v13, s[48:51], s73 offen lds
    s_add_u32 m0, s72, 14336
    s_nop 0
    buffer_load_dwordx4 v14, s[48:51], s73 offen lds
    s_add_u32 s73, s73, 40960
    s_waitcnt vmcnt(35)
    ds_read_b64_tr_b16 a[60:61], v15 offset:15360
    ds_read_b64_tr_b16 a[62:63], v15 offset:16640
    ds_read_b64_tr_b16 a[64:65], v15 offset:15392
    ds_read_b64_tr_b16 a[66:67], v15 offset:16672
    ds_read_b64_tr_b16 a[68:69], v15 offset:15424
    ds_read_b64_tr_b16 a[70:71], v15 offset:16704
    ds_read_b64_tr_b16 a[72:73], v15 offset:15456
    ds_read_b64_tr_b16 a[74:75], v15 offset:16736
    ds_read_b64_tr_b16 a[76:77], v15 offset:15488
    ds_read_b64_tr_b16 a[78:79], v15 offset:16768
    s_waitcnt lgkmcnt(0)
    s_add_u32 m0, s72, 15360
    s_nop 0
    buffer_load_dwordx4 v10, s[48:51], s73 offen lds
    s_add_u32 m0, s72, 16384
    s_nop 0
    buffer_load_dwordx4 v11, s[48:51], s73 offen lds
    s_add_u32 m0, s72, 17408
    s_nop 0
    buffer_load_dwordx4 v12, s[48:51], s73 offen lds
    s_add_u32 m0, s72, 18432
    s_nop 0
    buffer_load_dwordx4 v13, s[48:51], s73 offen lds
    s_add_u32 m0, s72, 19456
    s_nop 0
    buffer_load_dwordx4 v14, s[48:51], s73 offen lds
    s_add_u32 s73, s73, 40960
    s_waitcnt vmcnt(35)
    ds_read_b64_tr_b16 a[80:81], v15 offset:20480
    ds_read_b64_tr_b16 a[82:83], v15 offset:21760
    ds_read_b64_tr_b16 a[84:85], v15 offset:20512
    ds_read_b64_tr_b16 a[86:87], v15 offset:21792
    ds_read_b64_tr_b16 a[88:89], v15 offset:20544
    ds_read_b64_tr_b16 a[90:91], v15 offset:21824
    ds_read_b64_tr_b16 a[92:93], v15 offset:20576
    ds_read_b64_tr_b16 a[94:95], v15 offset:21856
    ds_read_b64_tr_b16 a[96:97], v15 offset:20608
    ds_read_b64_tr_b16 a[98:99], v15 offset:21888
    s_waitcnt vmcnt(30)
    ds_read_b64_tr_b16 a[100:101], v15 offset:25600
    ds_read_b64_tr_b16 a[102:103], v15 offset:26880
    ds_read_b64_tr_b16 a[104:105], v15 offset:25632
    ds_read_b64_tr_b16 a[106:107], v15 offset:26912
    ds_read_b64_tr_b16 a[108:109], v15 offset:25664
    ds_read_b64_tr_b16 a[110:111], v15 offset:26944
    ds_read_b64_tr_b16 a[112:113], v15 offset:25696
    ds_read_b64_tr_b16 a[114:115], v15 offset:26976
    ds_read_b64_tr_b16 a[116:117], v15 offset:25728
    ds_read_b64_tr_b16 a[118:119], v15 offset:27008
    s_waitcnt vmcnt(25)
    ds_read_b64_tr_b16 a[120:121], v15 offset:30720
    ds_read_b64_tr_b16 a[122:123], v15 offset:32000
    ds_read_b64_tr_b16 a[124:125], v15 offset:30752
    ds_read_b64_tr_b16 a[126:127], v15 offset:32032
    ds_read_b64_tr_b16 a[128:129], v15 offset:30784
    ds_read_b64_tr_b16 a[130:131], v15 offset:32064
    ds_read_b64_tr_b16 a[132:133], v15 offset:30816
    ds_read_b64_tr_b16 a[134:135], v15 offset:32096
    ds_read_b64_tr_b16 a[136:137], v15 offset:30848
    ds_read_b64_tr_b16 a[138:139], v15 offset:32128
    s_waitcnt vmcnt(20)
    ds_read_b64_tr_b16 a[140:141], v15 offset:35840
    ds_read_b64_tr_b16 a[142:143], v15 offset:37120
    ds_read_b64_tr_b16 a[144:145], v15 offset:35872
    ds_read_b64_tr_b16 a[146:147], v15 offset:37152
    ds_read_b64_tr_b16 a[148:149], v15 offset:35904
    ds_read_b64_tr_b16 a[150:151], v15 offset:37184
    ds_read_b64_tr_b16 a[152:153], v15 offset:35936
    ds_read_b64_tr_b16 a[154:155], v15 offset:37216
    ds_read_b64_tr_b16 a[156:157], v15 offset:35968
    ds_read_b64_tr_b16 a[158:159], v15 offset:37248
    s_waitcnt vmcnt(15)
    ds_read_b64_tr_b16 a[160:161], v15 offset:0
    ds_read_b64_tr_b16 a[162:163], v15 offset:1280
    ds_read_b64_tr_b16 a[164:165], v15 offset:32
    ds_read_b64_tr_b16 a[166:167], v15 offset:1312
    ds_read_b64_tr_b16 a[168:169], v15 offset:64
    ds_read_b64_tr_b16 a[170:171], v15 offset:1344
    ds_read_b64_tr_b16 a[172:173], v15 offset:96
    ds_read_b64_tr_b16 a[174:175], v15 offset:1376
    ds_read_b64_tr_b16 a[176:177], v15 offset:128
    ds_read_b64_tr_b16 a[178:179], v15 offset:1408
    s_waitcnt vmcnt(10)
    ds_read_b64_tr_b16 a[180:181], v15 offset:5120
    ds_read_b64_tr_b16 a[182:183], v15 offset:6400
    ds_read_b64_tr_b16 a[184:185], v15 offset:5152
    ds_read_b64_tr_b16 a[186:187], v15 offset:6432
    ds_read_b64_tr_b16 a[188:189], v15 offset:5184
    ds_read_b64_tr_b16 a[190:191], v15 offset:6464
    ds_read_b64_tr_b16 a[192:193], v15 offset:5216
    ds_read_b64_tr_b16 a[194:195], v15 offset:6496
    ds_read_b64_tr_b16 a[196:197], v15 offset:5248
    ds_read_b64_tr_b16 a[198:199], v15 offset:6528
    s_waitcnt vmcnt(5)
    ds_read_b64_tr_b16 a[200:201], v15 offset:10240
    ds_read_b64_tr_b16 a[202:203], v15 offset:11520
    ds_read_b64_tr_b16 a[204:205], v15 offset:10272
    ds_read_b64_tr_b16 a[206:207], v15 offset:11552
    ds_read_b64_tr_b16 a[208:209], v15 offset:10304
    ds_read_b64_tr_b16 a[210:211], v15 offset:11584
    ds_read_b64_tr_b16 a[212:213], v15 offset:10336
    ds_read_b64_tr_b16 a[214:215], v15 offset:11616
    ds_read_b64_tr_b16 a[216:217], v15 offset:10368
    ds_read_b64_tr_b16 a[218:219], v15 offset:11648
    s_waitcnt vmcnt(0)
    ds_read_b64_tr_b16 a[220:221], v15 offset:15360
    ds_read_b64_tr_b16 a[222:223], v15 offset:16640
    ds_read_b64_tr_b16 a[224:225], v15 offset:15392
    ds_read_b64_tr_b16 a[226:227], v15 offset:16672
    ds_read_b64_tr_b16 a[228:229], v15 offset:15424
    ds_read_b64_tr_b16 a[230:231], v15 offset:16704
    ds_read_b64_tr_b16 a[232:233], v15 offset:15456
    ds_read_b64_tr_b16 a[234:235], v15 offset:16736
    ds_read_b64_tr_b16 a[236:237], v15 offset:15488
    ds_read_b64_tr_b16 a[238:239], v15 offset:16768
    s_waitcnt lgkmcnt(0)
    v_lshlrev_b32 v17, 4, v0
    s_mul_i32 s7, s3, 3
    s_add_u32 s7, s7, 104
    v_min_u32 v18, 2, v4
    v_add_u32 v18, s7, v18
    v_lshlrev_b32 v18, 7, v18
    s_mov_b32 s78, 0
    s_mul_i32 s7, s3, 10240
    v_add_u32 v19, s7, v17
    s_lshl_b32 s7, s3, 10
    v_add_u32 v20, s7, v17
    v_add_u32 v21, 4096, v20
    v_add_u32 v22, 8192, v20
    s_cmp_lt_u32 s3, 2
    s_cselect_b32 s7, 0, 0x80000000
    v_or_b32 v22, s7, v22
    s_and_b32 s7, s3, 1
    s_lshl_b32 s7, s7, 6
    v_lshlrev_b32 v23, 2, v1
    v_add_u32 v23, s7, v23
    s_mov_b32 s76, 0x10000
    s_mul_i32 s74, s3, 12288
    s_add_u32 s74, s74, 0x1600000
    s_mul_i32 s71, s4, 10240
    s_add_u32 s71, s71, 0x1000000
    s_cmp_lg_u32 s3, 0
    s_cbranch_scc1 L_wsd_19
L_ws_18:
    buffer_load_dword v6, off, s[60:63], 0 sc1
    s_waitcnt vmcnt(0)
    v_cmp_gt_u32 vcc, 256, v6
    s_cbranch_vccz L_wsd_19
L_ws_18_r:
    s_sleep 16
    s_add_u32 s6, s6, 1
    s_cmp_gt_u32 s6, 200000
    s_cbranch_scc1 L_timeout
    s_branch L_ws_18
L_wsd_19:
    s_barrier
    s_mov_b32 s75, 1
    v_and_b32 v7, 7, v0
    v_add_u32 v7, 148, v7
    v_lshlrev_b32 v7, 7, v7
L_wf_20:
    buffer_load_dword v6, v7, s[40:43], 0 offen sc1
    s_waitcnt vmcnt(0)
    v_cmp_gt_u32 vcc, s75, v6
    s_cbranch_vccz L_wfd_21
    s_sleep 2
    s_add_u32 s6, s6, 1
    s_cmp_gt_u32 s6, 200000
    s_cbranch_scc1 L_timeout
    s_branch L_wf_20
L_wfd_21:
    s_cmp_ge_u32 s78, s75
    s_cbranch_scc1 L_wNd_22
L_wf_23:
    buffer_load_dword v6, v18, s[40:43], 0 offen sc1
    s_waitcnt vmcnt(0)
    v_cmp_gt_u32 vcc, s75, v6
    s_cbranch_vccz L_wfd_24
    s_sleep 2
    s_add_u32 s6, s6, 1
    s_cmp_gt_u32 s6, 200000
    s_cbranch_scc1 L_timeout
    s_branch L_wf_23
L_wfd_24:
    s_mov_b32 s78, s75
    s_add_u32 s77, s75, 1
    v_cmp_gt_u32 vcc, s77, v6
    s_cbranch_vccnz L_wNd_22
    s_mov_b32 s78, s77
    s_add_u32 s77, s75, 2
    v_cmp_gt_u32 vcc, s77, v6
    s_cbranch_vccnz L_wNd_22
    s_mov_b32 s78, s77
    s_add_u32 s77, s75, 4
    v_cmp_gt_u32 vcc, s77, v6
    s_cbranch_vccnz L_wNd_22
    s_mov_b32 s78, s77
    s_add_u32 s77, s75, 8
    v_cmp_gt_u32 vcc, s77, v6
    s_cbranch_vccnz L_wNd_22
    s_mov_b32 s78, s77
    s_add_u32 s77, s75, 16
    v_cmp_gt_u32 vcc, s77, v6
    s_cbranch_vccnz L_wNd_22
    s_mov_b32 s78, s77
L_wNd_22:
    s_add_u32 s77, s74, 0
    buffer_load_dwordx4 v[32:35], v17, s[40:43], s77 offen offset:0 sc1
    s_add_u32 s77, s74, 49152
    buffer_load_dwordx4 v[36:39], v17, s[40:43], s77 offen offset:0 sc1
    s_add_u32 s77, s74, 0
    buffer_load_dwordx4 v[40:43], v17, s[40:43], s77 offen offset:1024 sc1
    s_add_u32 s77, s74, 49152
    buffer_load_dwordx4 v[44:47], v17, s[40:43], s77 offen offset:1024 sc1
    s_add_u32 s77, s74, 0
    buffer_load_dwordx4 v[48:51], v17, s[40:43], s77 offen offset:2048 sc1
    s_add_u32 s77, s74, 49152
    buffer_load_dwordx4 v[52:55], v17, s[40:43], s77 offen offset:2048 sc1
    s_add_u32 s77, s74, 0
    buffer_load_dwordx4 v[56:59], v17, s[40:43], s77 offen offset:3072 sc1
    s_add_u32 s77, s74, 49152
    buffer_load_dwordx4 v[60:63], v17, s[40:43], s77 offen offset:3072 sc1
    s_add_u32 s77, s74, 4096
    buffer_load_dwordx4 v[64:67], v17, s[40:43], s77 offen offset:0 sc1
    s_add_u32 s77, s74, 53248
    buffer_load_dwordx4 v[68:71], v17, s[40:43], s77 offen offset:0 sc1
    s_add_u32 s77, s74, 4096
    buffer_load_dwordx4 v[72:75], v17, s[40:43], s77 offen offset:1024 sc1
    s_add_u32 s77, s74, 53248
    buffer_load_dwordx4 v[76:79], v17, s[40:43], s77 offen offset:1024 sc1
    s_add_u32 s77, s74, 4096
    buffer_load_dwordx4 v[80:83], v17, s[40:43], s77 offen offset:2048 sc1
    s_add_u32 s77, s74, 53248
    buffer_load_dwordx4 v[84:87], v17, s[40:43], s77 offen offset:2048 sc1
    s_add_u32 s77, s74, 4096
    buffer_load_dwordx4 v[88:91], v17, s[40:43], s77 offen offset:3072 sc1
    s_add_u32 s77, s74, 53248
    buffer_load_dwordx4 v[92:95], v17, s[40:43], s77 offen offset:3072 sc1
    s_add_u32 s77, s74, 8192
    buffer_load_dwordx4 v[96:99], v17, s[40:43], s77 offen offset:0 sc1
    s_add_u32 s77, s74, 57344
    buffer_load_dwordx4 v[100:103], v17, s[40:43], s77 offen offset:0 sc1
    s_add_u32 s77, s74, 8192
    buffer_load_dwordx4 v[104:107], v17, s[40:43], s77 offen offset:1024 sc1
    s_add_u32 s77, s74, 57344
    buffer_load_dwordx4 v[108:111], v17, s[40:43], s77 offen offset:1024 sc1
    s_add_u32 s77, s74, 8192
    buffer_load_dwordx4 v[112:115], v17, s[40:43], s77 offen offset:2048 sc1
    s_add_u32 s77, s74, 57344
    buffer_load_dwordx4 v[116:119], v17, s[40:43], s77 offen offset:2048 sc1
    s_add_u32 s77, s74, 8192
    buffer_load_dwordx4 v[120:123], v17, s[40:43], s77 offen offset:3072 sc1
    s_add_u32 s77, s74, 57344
    buffer_load_dwordx4 v[124:127], v17, s[40:43], s77 offen offset:3072 sc1
    s_waitcnt vmcnt(0)
    s_barrier
    s_mov_b32 s79, 0x40000000
    s_mov_b32 s80, s76
.p2align 6
L_d_loop_25:
    s_add_u32 s75, s5, 2
    s_min_u32 s75, s75, 64
    s_cmp_ge_u32 s78, s75
    s_cbranch_scc1 L_wNd_26
L_wf_27:
    buffer_load_dword v6, v18, s[40:43], 0 offen sc1
    s_waitcnt vmcnt(0)
    v_cmp_gt_u32 vcc, s75, v6
    s_cbranch_vccz L_wfd_28
    s_sleep 2
    s_add_u32 s6, s6, 1
    s_cmp_gt_u32 s6, 200000
    s_cbranch_scc1 L_timeout
    s_branch L_wf_27
L_wfd_28:
    s_mov_b32 s78, s75
    s_add_u32 s77, s75, 1
    v_cmp_gt_u32 vcc, s77, v6
    s_cbranch_vccnz L_wNd_26
    s_mov_b32 s78, s77
    s_add_u32 s77, s75, 2
    v_cmp_gt_u32 vcc, s77, v6
    s_cbranch_vccnz L_wNd_26
    s_mov_b32 s78, s77
    s_add_u32 s77, s75, 4
    v_cmp_gt_u32 vcc, s77, v6
    s_cbranch_vccnz L_wNd_26
    s_mov_b32 s78, s77
    s_add_u32 s77, s75, 8
    v_cmp_gt_u32 vcc, s77, v6
    s_cbranch_vccnz L_wNd_26
    s_mov_b32 s78, s77
    s_add_u32 s77, s75, 16
    v_cmp_gt_u32 vcc, s77, v6
    s_cbranch_vccnz L_wNd_26
    s_mov_b32 s78, s77
L_wNd_26:
    buffer_load_dword v24, v23, s[40:43], s80 offen sc1
    s_add_u32 s74, s74, 98304
    v_mfma_f32_16x16x32_bf16 v[128:131], a[0:3], v[32:35], 0
    v_mfma_f32_16x16x32_bf16 v[132:135], a[0:3], v[36:39], 0
    ds_write_b128 v19, v[216:219] offset:0
    v_mfma_f32_16x16x32_bf16 v[136:139], a[4:7], v[32:35], 0
    v_mfma_f32_16x16x32_bf16 v[140:143], a[4:7], v[36:39], 0
    ds_write_b128 v19, v[220:223] offset:1024
    v_mfma_f32_16x16x32_bf16 v[144:147], a[8:11], v[32:35], 0
    v_mfma_f32_16x16x32_bf16 v[148:151], a[8:11], v[36:39], 0
    ds_write_b128 v19, v[224:227] offset:2048
    v_mfma_f32_16x16x32_bf16 v[152:155], a[12:15], v[32:35], 0
    v_mfma_f32_16x16x32_bf16 v[156:159], a[12:15], v[36:39], 0
    ds_write_b128 v19, v[228:231] offset:3072
    v_mfma_f32_16x16x32_bf16 v[160:163], a[16:19], v[32:35], 0
    v_mfma_f32_16x16x32_bf16 v[164:167], a[16:19], v[36:39], 0
    ds_write_b128 v19, v[232:235] offset:4096
    s_add_u32 s77, s74, 0
    buffer_load_dwordx4 v[32:35], v17, s[40:43], s77 offen offset:0 sc1
    s_add_u32 s77, s74, 49152
    buffer_load_dwordx4 v[36:39], v17, s[40:43], s77 offen offset:0 sc1
    v_mfma_f32_16x16x32_bf16 v[128:131], a[20:23], v[40:43], v[128:131]
    v_mfma_f32_16x16x32_bf16 v[132:135], a[20:23], v[44:47], v[132:135]
    ds_write_b128 v19, v[236:239] offset:5120
    v_mfma_f32_16x16x32_bf16 v[136:139], a[24:27], v[40:43], v[136:139]
    v_mfma_f32_16x16x32_bf16 v[140:143], a[24:27], v[44:47], v[140:143]
    ds_write_b128 v19, v[240:243] offset:6144
    v_mfma_f32_16x16x32_bf16 v[144:147], a[28:31], v[40:43], v[144:147]
    v_mfma_f32_16x16x32_bf16 v[148:151], a[28:31], v[44:47], v[148:151]
    ds_write_b128 v19, v[244:247] offset:7168
    v_mfma_f32_16x16x32_bf16 v[152:155], a[32:35], v[40:43], v[152:155]
    v_mfma_f32_16x16x32_bf16 v[156:159], a[32:35], v[44:47], v[156:159]
    ds_write_b128 v19, v[248:251] offset:8192
    v_mfma_f32_16x16x32_bf16 v[160:163], a[36:39], v[40:43], v[160:163]
    v_mfma_f32_16x16x32_bf16 v[164:167], a[36:39], v[44:47], v[164:167]
    ds_write_b128 v19, v[252:255] offset:9216
    s_add_u32 s77, s74, 0
    buffer_load_dwordx4 v[40:43], v17, s[40:43], s77 offen offset:1024 sc1
    s_add_u32 s77, s74, 49152
    buffer_load_dwordx4 v[44:47], v17, s[40:43], s77 offen offset:1024 sc1
    v_mfma_f32_16x16x32_bf16 v[128:131], a[40:43], v[48:51], v[128:131]
    v_mfma_f32_16x16x32_bf16 v[132:135], a[40:43], v[52:55], v[132:135]
    v_mfma_f32_16x16x32_bf16 v[136:139], a[44:47], v[48:51], v[136:139]
    v_mfma_f32_16x16x32_bf16 v[140:143], a[44:47], v[52:55], v[140:143]
    v_mfma_f32_16x16x32_bf16 v[144:147], a[48:51], v[48:51], v[144:147]
    v_mfma_f32_16x16x32_bf16 v[148:151], a[48:51], v[52:55], v[148:151]
    v_mfma_f32_16x16x32_bf16 v[152:155], a[52:55], v[48:51], v[152:155]
    v_mfma_f32_16x16x32_bf16 v[156:159], a[52:55], v[52:55], v[156:159]
    v_mfma_f32_16x16x32_bf16 v[160:163], a[56:59], v[48:51], v[160:163]
    v_mfma_f32_16x16x32_bf16 v[164:167], a[56:59], v[52:55], v[164:167]
    s_add_u32 s77, s74, 0
    buffer_load_dwordx4 v[48:51], v17, s[40:43], s77 offen offset:2048 sc1
    s_add_u32 s77, s74, 49152
    buffer_load_dwordx4 v[52:55], v17, s[40:43], s77 offen offset:2048 sc1
    s_waitcnt vmcnt(11) lgkmcnt(0)
    s_barrier
    s_max_i32 s7, s5, 1
    s_sub_u32 s7, s7, 1
    v_mov_b32 v6, s7
    buffer_store_dword v6, v5, s[40:43], s70 offen sc1
    v_mfma_f32_16x16x32_bf16 v[128:131], a[60:63], v[56:59], v[128:131]
    ds_read_b128 v[168:171], v20 offset:0
    v_mfma_f32_16x16x32_bf16 v[132:135], a[60:63], v[60:63], v[132:135]
    ds_read_b128 v[172:175], v20 offset:10240
    v_mfma_f32_16x16x32_bf16 v[136:139], a[64:67], v[56:59], v[136:139]
    ds_read_b128 v[176:179], v20 offset:20480
    v_mfma_f32_16x16x32_bf16 v[140:143], a[64:67], v[60:63], v[140:143]
    ds_read_b128 v[180:183], v20 offset:30720
    v_mfma_f32_16x16x32_bf16 v[144:147], a[68:71], v[56:59], v[144:147]
    ds_read_b128 v[184:187], v20 offset:4096
    v_mfma_f32_16x16x32_bf16 v[148:151], a[68:71], v[60:63], v[148:151]
    ds_read_b128 v[188:191], v20 offset:14336
    v_mfma_f32_16x16x32_bf16 v[152:155], a[72:75], v[56:59], v[152:155]
    ds_read_b128 v[192:195], v20 offset:24576
    v_mfma_f32_16x16x32_bf16 v[156:159], a[72:75], v[60:63], v[156:159]
    ds_read_b128 v[196:199], v20 offset:34816
    v_mfma_f32_16x16x32_bf16 v[160:163], a[76:79], v[56:59], v[160:163]
    ds_read_b128 v[200:203], v20 offset:8192
    v_mfma_f32_16x16x32_bf16 v[164:167], a[76:79], v[60:63], v[164:167]
    ds_read_b128 v[204:207], v20 offset:18432
    s_add_u32 s77, s74, 0
    buffer_load_dwordx4 v[56:59], v17, s[40:43], s77 offen offset:3072 sc1
    s_add_u32 s77, s74, 49152
    buffer_load_dwordx4 v[60:63], v17, s[40:43], s77 offen offset:3072 sc1
    v_mfma_f32_16x16x32_bf16 v[128:131], a[80:83], v[64:67], v[128:131]
    ds_read_b128 v[208:211], v20 offset:28672
    v_mfma_f32_16x16x32_bf16 v[132:135], a[80:83], v[68:71], v[132:135]
    ds_read_b128 v[212:215], v20 offset:38912
    v_mfma_f32_16x16x32_bf16 v[136:139], a[84:87], v[64:67], v[136:139]
    v_mfma_f32_16x16x32_bf16 v[140:143], a[84:87], v[68:71], v[140:143]
    v_mfma_f32_16x16x32_bf16 v[144:147], a[88:91], v[64:67], v[144:147]
    v_mfma_f32_16x16x32_bf16 v[148:151], a[88:91], v[68:71], v[148:151]
    v_mfma_f32_16x16x32_bf16 v[152:155], a[92:95], v[64:67], v[152:155]
    v_mfma_f32_16x16x32_bf16 v[156:159], a[92:95], v[68:71], v[156:159]
    v_mfma_f32_16x16x32_bf16 v[160:163], a[96:99], v[64:67], v[160:163]
    v_mfma_f32_16x16x32_bf16 v[164:167], a[96:99], v[68:71], v[164:167]
    s_add_u32 s77, s74, 4096
    buffer_load_dwordx4 v[64:67], v17, s[40:43], s77 offen offset:0 sc1
    s_add_u32 s77, s74, 53248
    buffer_load_dwordx4 v[68:71], v17, s[40:43], s77 offen offset:0 sc1
    s_waitcnt vmcnt(11)
    s_waitcnt lgkmcnt(0)
    v_mfma_f32_16x16x32_bf16 v[128:131], a[100:103], v[72:75], v[128:131]
    v_sub_f32 v24, 1.0, v24
    v_mfma_f32_16x16x32_bf16 v[132:135], a[100:103], v[76:79], v[132:135]
    v_add_f32 v168, v168, v172
    v_mfma_f32_16x16x32_bf16 v[136:139], a[104:107], v[72:75], v[136:139]
    v_add_f32 v176, v176, v180
    v_mfma_f32_16x16x32_bf16 v[140:143], a[104:107], v[76:79], v[140:143]
    v_add_f32 v169, v169, v173
    v_mfma_f32_16x16x32_bf16 v[144:147], a[108:111], v[72:75], v[144:147]
    v_add_f32 v177, v177, v181
    v_mfma_f32_16x16x32_bf16 v[148:151], a[108:111], v[76:79], v[148:151]
    v_add_f32 v170, v170, v174
    v_mfma_f32_16x16x32_bf16 v[152:155], a[112:115], v[72:75], v[152:155]
    v_add_f32 v178, v178, v182
    v_mfma_f32_16x16x32_bf16 v[156:159], a[112:115], v[76:79], v[156:159]
    v_add_f32 v171, v171, v175
    v_mfma_f32_16x16x32_bf16 v[160:163], a[116:119], v[72:75], v[160:163]
    v_add_f32 v179, v179, v183
    v_mfma_f32_16x16x32_bf16 v[164:167], a[116:119], v[76:79], v[164:167]
    v_add_f32 v168, v168, v176
    s_add_u32 s77, s74, 4096
    buffer_load_dwordx4 v[72:75], v17, s[40:43], s77 offen offset:1024 sc1
    s_add_u32 s77, s74, 53248
    buffer_load_dwordx4 v[76:79], v17, s[40:43], s77 offen offset:1024 sc1
    v_mfma_f32_16x16x32_bf16 v[128:131], a[120:123], v[80:83], v[128:131]
    v_add_f32 v169, v169, v177
    v_mfma_f32_16x16x32_bf16 v[132:135], a[120:123], v[84:87], v[132:135]
    v_add_f32 v170, v170, v178
    v_mfma_f32_16x16x32_bf16 v[136:139], a[124:127], v[80:83], v[136:139]
    v_add_f32 v171, v171, v179
    v_mfma_f32_16x16x32_bf16 v[140:143], a[124:127], v[84:87], v[140:143]
    v_mul_f32 v168, v168, v24
    v_mfma_f32_16x16x32_bf16 v[144:147], a[128:131], v[80:83], v[144:147]
    v_mul_f32 v169, v169, v24
    v_mfma_f32_16x16x32_bf16 v[148:151], a[128:131], v[84:87], v[148:151]
    v_mul_f32 v170, v170, v24
    v_mfma_f32_16x16x32_bf16 v[152:155], a[132:135], v[80:83], v[152:155]
    v_mul_f32 v171, v171, v24
    v_mfma_f32_16x16x32_bf16 v[156:159], a[132:135], v[84:87], v[156:159]
    buffer_store_dwordx4 v[168:171], v20, s[40:43], s79 offen sc1
    v_mfma_f32_16x16x32_bf16 v[160:163], a[136:139], v[80:83], v[160:163]
    v_add_f32 v184, v184, v188
    v_mfma_f32_16x16x32_bf16 v[164:167], a[136:139], v[84:87], v[164:167]
    v_add_f32 v192, v192, v196
    s_add_u32 s77, s74, 4096
    buffer_load_dwordx4 v[80:83], v17, s[40:43], s77 offen offset:2048 sc1
    s_add_u32 s77, s74, 53248
    buffer_load_dwordx4 v[84:87], v17, s[40:43], s77 offen offset:2048 sc1
    v_mfma_f32_16x16x32_bf16 v[128:131], a[140:143], v[88:91], v[128:131]
    v_add_f32 v185, v185, v189
    v_mfma_f32_16x16x32_bf16 v[132:135], a[140:143], v[92:95], v[132:135]
    v_add_f32 v193, v193, v197
    v_mfma_f32_16x16x32_bf16 v[136:139], a[144:147], v[88:91], v[136:139]
    v_add_f32 v186, v186, v190
    v_mfma_f32_16x16x32_bf16 v[140:143], a[144:147], v[92:95], v[140:143]
    v_add_f32 v194, v194, v198
    v_mfma_f32_16x16x32_bf16 v[144:147], a[148:151], v[88:91], v[144:147]
    v_add_f32 v187, v187, v191
    v_mfma_f32_16x16x32_bf16 v[148:151], a[148:151], v[92:95], v[148:151]
    v_add_f32 v195, v195, v199
    v_mfma_f32_16x16x32_bf16 v[152:155], a[152:155], v[88:91], v[152:155]
    v_add_f32 v184, v184, v192
    v_mfma_f32_16x16x32_bf16 v[156:159], a[152:155], v[92:95], v[156:159]
    v_add_f32 v185, v185, v193
    v_mfma_f32_16x16x32_bf16 v[160:163], a[156:159], v[88:91], v[160:163]
    v_add_f32 v186, v186, v194
    v_mfma_f32_16x16x32_bf16 v[164:167], a[156:159], v[92:95], v[164:167]
    v_add_f32 v187, v187, v195
    s_add_u32 s77, s74, 4096
    buffer_load_dwordx4 v[88:91], v17, s[40:43], s77 offen offset:3072 sc1
    s_add_u32 s77, s74, 53248
    buffer_load_dwordx4 v[92:95], v17, s[40:43], s77 offen offset:3072 sc1
    v_mfma_f32_16x16x32_bf16 v[128:131], a[160:163], v[96:99], v[128:131]
    v_mul_f32 v184, v184, v24
    v_mfma_f32_16x16x32_bf16 v[132:135], a[160:163], v[100:103], v[132:135]
    v_mul_f32 v185, v185, v24
    v_mfma_f32_16x16x32_bf16 v[136:139], a[164:167], v[96:99], v[136:139]
    v_mul_f32 v186, v186, v24
    v_mfma_f32_16x16x32_bf16 v[140:143], a[164:167], v[100:103], v[140:143]
    v_mul_f32 v187, v187, v24
    v_mfma_f32_16x16x32_bf16 v[144:147], a[168:171], v[96:99], v[144:147]
    buffer_store_dwordx4 v[184:187], v21, s[40:43], s79 offen sc1
    v_mfma_f32_16x16x32_bf16 v[148:151], a[168:171], v[100:103], v[148:151]
    v_add_f32 v200, v200, v204
    v_mfma_f32_16x16x32_bf16 v[152:155], a[172:175], v[96:99], v[152:155]
    v_add_f32 v208, v208, v212
    v_mfma_f32_16x16x32_bf16 v[156:159], a[172:175], v[100:103], v[156:159]
    v_add_f32 v201, v201, v205
    v_mfma_f32_16x16x32_bf16 v[160:163], a[176:179], v[96:99], v[160:163]
    v_add_f32 v209, v209, v213
    v_mfma_f32_16x16x32_bf16 v[164:167], a[176:179], v[100:103], v[164:167]
    v_add_f32 v202, v202, v206
    s_add_u32 s77, s74, 8192
    buffer_load_dwordx4 v[96:99], v17, s[40:43], s77 offen offset:0 sc1
    s_add_u32 s77, s74, 57344
    buffer_load_dwordx4 v[100:103], v17, s[40:43], s77 offen offset:0 sc1
    v_mfma_f32_16x16x32_bf16 v[128:131], a[180:183], v[104:107], v[128:131]
    v_add_f32 v210, v210, v214
    v_mfma_f32_16x16x32_bf16 v[132:135], a[180:183], v[108:111], v[132:135]
    v_add_f32 v203, v203, v207
    v_mfma_f32_16x16x32_bf16 v[136:139], a[184:187], v[104:107], v[136:139]
    v_add_f32 v211, v211, v215
    v_mfma_f32_16x16x32_bf16 v[140:143], a[184:187], v[108:111], v[140:143]
    v_add_f32 v200, v200, v208
    v_mfma_f32_16x16x32_bf16 v[144:147], a[188:191], v[104:107], v[144:147]
    v_add_f32 v201, v201, v209
    v_mfma_f32_16x16x32_bf16 v[148:151], a[188:191], v[108:111], v[148:151]
    v_add_f32 v202, v202, v210
    v_mfma_f32_16x16x32_bf16 v[152:155], a[192:195], v[104:107], v[152:155]
    v_add_f32 v203, v203, v211
    v_mfma_f32_16x16x32_bf16 v[156:159], a[192:195], v[108:111], v[156:159]
    v_mul_f32 v200, v200, v24
    v_mfma_f32_16x16x32_bf16 v[160:163], a[196:199], v[104:107], v[160:163]
    v_mul_f32 v201, v201, v24
    v_mfma_f32_16x16x32_bf16 v[164:167], a[196:199], v[108:111], v[164:167]
    v_mul_f32 v202, v202, v24
    s_add_u32 s77, s74, 8192
    buffer_load_dwordx4 v[104:107], v17, s[40:43], s77 offen offset:1024 sc1
    s_add_u32 s77, s74, 57344
    buffer_load_dwordx4 v[108:111], v17, s[40:43], s77 offen offset:1024 sc1
    v_mfma_f32_16x16x32_bf16 v[128:131], a[200:203], v[112:115], v[128:131]
    v_mul_f32 v203, v203, v24
    v_mfma_f32_16x16x32_bf16 v[132:135], a[200:203], v[116:119], v[132:135]
    buffer_store_dwordx4 v[200:203], v22, s[40:43], s79 offen sc1
    v_mfma_f32_16x16x32_bf16 v[136:139], a[204:207], v[112:115], v[136:139]
    v_mfma_f32_16x16x32_bf16 v[140:143], a[204:207], v[116:119], v[140:143]
    v_mfma_f32_16x16x32_bf16 v[144:147], a[208:211], v[112:115], v[144:147]
    v_mfma_f32_16x16x32_bf16 v[148:151], a[208:211], v[116:119], v[148:151]
    v_mfma_f32_16x16x32_bf16 v[152:155], a[212:215], v[112:115], v[152:155]
    v_mfma_f32_16x16x32_bf16 v[156:159], a[212:215], v[116:119], v[156:159]
    v_mfma_f32_16x16x32_bf16 v[160:163], a[216:219], v[112:115], v[160:163]
    v_mfma_f32_16x16x32_bf16 v[164:167], a[216:219], v[116:119], v[164:167]
    s_add_u32 s77, s74, 8192
    buffer_load_dwordx4 v[112:115], v17, s[40:43], s77 offen offset:2048 sc1
    s_add_u32 s77, s74, 57344
    buffer_load_dwordx4 v[116:119], v17, s[40:43], s77 offen offset:2048 sc1
    v_mfma_f32_16x16x32_bf16 v[128:131], a[220:223], v[120:123], v[128:131]
    v_mfma_f32_16x16x32_bf16 v[132:135], a[220:223], v[124:127], v[132:135]
    v_mfma_f32_16x16x32_bf16 v[136:139], a[224:227], v[120:123], v[136:139]
    v_mfma_f32_16x16x32_bf16 v[140:143], a[224:227], v[124:127], v[140:143]
    v_mfma_f32_16x16x32_bf16 v[144:147], a[228:231], v[120:123], v[144:147]
    v_mfma_f32_16x16x32_bf16 v[148:151], a[228:231], v[124:127], v[148:151]
    v_mfma_f32_16x16x32_bf16 v[152:155], a[232:235], v[120:123], v[152:155]
    v_mfma_f32_16x16x32_bf16 v[156:159], a[232:235], v[124:127], v[156:159]
    v_mfma_f32_16x16x32_bf16 v[160:163], a[236:239], v[120:123], v[160:163]
    v_mfma_f32_16x16x32_bf16 v[164:167], a[236:239], v[124:127], v[164:167]
    s_add_u32 s77, s74, 8192
    buffer_load_dwordx4 v[120:123], v17, s[40:43], s77 offen offset:3072 sc1
    s_add_u32 s77, s74, 57344
    buffer_load_dwordx4 v[124:127], v17, s[40:43], s77 offen offset:3072 sc1
    s_mov_b32 s79, s71
    s_mov_b32 s80, s76
    s_add_u32 s71, s71, 81920
    s_add_u32 s76, s76, 128
    s_add_u32 s5, s5, 1
    s_waitcnt vmcnt(12)
    s_barrier
    s_add_u32 s75, s5, 2
    s_min_u32 s75, s75, 64
    s_cmp_ge_u32 s78, s75
    s_cbranch_scc1 L_wNd_29
L_wf_30:
    buffer_load_dword v6, v18, s[40:43], 0 offen sc1
    s_waitcnt vmcnt(0)
    v_cmp_gt_u32 vcc, s75, v6
    s_cbranch_vccz L_wfd_31
    s_sleep 2
    s_add_u32 s6, s6, 1
    s_cmp_gt_u32 s6, 200000
    s_cbranch_scc1 L_timeout
    s_branch L_wf_30
L_wfd_31:
    s_mov_b32 s78, s75
    s_add_u32 s77, s75, 1
    v_cmp_gt_u32 vcc, s77, v6
    s_cbranch_vccnz L_wNd_29
    s_mov_b32 s78, s77
    s_add_u32 s77, s75, 2
    v_cmp_gt_u32 vcc, s77, v6
    s_cbranch_vccnz L_wNd_29
    s_mov_b32 s78, s77
    s_add_u32 s77, s75, 4
    v_cmp_gt_u32 vcc, s77, v6
    s_cbranch_vccnz L_wNd_29
    s_mov_b32 s78, s77
    s_add_u32 s77, s75, 8
    v_cmp_gt_u32 vcc, s77, v6
    s_cbranch_vccnz L_wNd_29
    s_mov_b32 s78, s77
    s_add_u32 s77, s75, 16
    v_cmp_gt_u32 vcc, s77, v6
    s_cbranch_vccnz L_wNd_29
    s_mov_b32 s78, s77
L_wNd_29:
    buffer_load_dword v24, v23, s[40:43], s80 offen sc1
    s_add_u32 s74, s74, 98304
    v_mfma_f32_16x16x32_bf16 v[216:219], a[0:3], v[32:35], 0
    v_mfma_f32_16x16x32_bf16 v[220:223], a[0:3], v[36:39], 0
    ds_write_b128 v19, v[128:131] offset:0
    v_mfma_f32_16x16x32_bf16 v[224:227], a[4:7], v[32:35], 0
    v_mfma_f32_16x16x32_bf16 v[228:231], a[4:7], v[36:39], 0
    ds_write_b128 v19, v[132:135] offset:1024
    v_mfma_f32_16x16x32_bf16 v[232:235], a[8:11], v[32:35], 0
    v_mfma_f32_16x16x32_bf16 v[236:239], a[8:11], v[36:39], 0
    ds_write_b128 v19, v[136:139] offset:2048
    v_mfma_f32_16x16x32_bf16 v[240:243], a[12:15], v[32:35], 0
    v_mfma_f32_16x16x32_bf16 v[244:247], a[12:15], v[36:39], 0
    ds_write_b128 v19, v[140:143] offset:3072
    v_mfma_f32_16x16x32_bf16 v[248:251], a[16:19], v[32:35], 0
    v_mfma_f32_16x16x32_bf16 v[252:255], a[16:19], v[36:39], 0
    ds_write_b128 v19, v[144:147] offset:4096
    s_add_u32 s77, s74, 0
    buffer_load_dwordx4 v[32:35], v17, s[40:43], s77 offen offset:0 sc1
    s_add_u32 s77, s74, 49152
    buffer_load_dwordx4 v[36:39], v17, s[40:43], s77 offen offset:0 sc1
    v_mfma_f32_16x16x32_bf16 v[216:219], a[20:23], v[40:43], v[216:219]
    v_mfma_f32_16x16x32_bf16 v[220:223], a[20:23], v[44:47], v[220:223]
    ds_write_b128 v19, v[148:151] offset:5120
    v_mfma_f32_16x16x32_bf16 v[224:227], a[24:27], v[40:43], v[224:227]
    v_mfma_f32_16x16x32_bf16 v[228:231], a[24:27], v[44:47], v[228:231]
    ds_write_b128 v19, v[152:155] offset:6144
    v_mfma_f32_16x16x32_bf16 v[232:235], a[28:31], v[40:43], v[232:235]
    v_mfma_f32_16x16x32_bf16 v[236:239], a[28:31], v[44:47], v[236:239]
    ds_write_b128 v19, v[156:159] offset:7168
    v_mfma_f32_16x16x32_bf16 v[240:243], a[32:35], v[40:43], v[240:243]
    v_mfma_f32_16x16x32_bf16 v[244:247], a[32:35], v[44:47], v[244:247]
    ds_write_b128 v19, v[160:163] offset:8192
    v_mfma_f32_16x16x32_bf16 v[248:251], a[36:39], v[40:43], v[248:251]
    v_mfma_f32_16x16x32_bf16 v[252:255], a[36:39], v[44:47], v[252:255]
    ds_write_b128 v19, v[164:167] offset:9216
    s_add_u32 s77, s74, 0
    buffer_load_dwordx4 v[40:43], v17, s[40:43], s77 offen offset:1024 sc1
    s_add_u32 s77, s74, 49152
    buffer_load_dwordx4 v[44:47], v17, s[40:43], s77 offen offset:1024 sc1
    v_mfma_f32_16x16x32_bf16 v[216:219], a[40:43], v[48:51], v[216:219]
    v_mfma_f32_16x16x32_bf16 v[220:223], a[40:43], v[52:55], v[220:223]
    v_mfma_f32_16x16x32_bf16 v[224:227], a[44:47], v[48:51], v[224:227]
    v_mfma_f32_16x16x32_bf16 v[228:231], a[44:47], v[52:55], v[228:231]
    v_mfma_f32_16x16x32_bf16 v[232:235], a[48:51], v[48:51], v[232:235]
    v_mfma_f32_16x16x32_bf16 v[236:239], a[48:51], v[52:55], v[236:239]
    v_mfma_f32_16x16x32_bf16 v[240:243], a[52:55], v[48:51], v[240:243]
    v_mfma_f32_16x16x32_bf16 v[244:247], a[52:55], v[52:55], v[244:247]
    v_mfma_f32_16x16x32_bf16 v[248:251], a[56:59], v[48:51], v[248:251]
    v_mfma_f32_16x16x32_bf16 v[252:255], a[56:59], v[52:55], v[252:255]
    s_add_u32 s77, s74, 0
    buffer_load_dwordx4 v[48:51], v17, s[40:43], s77 offen offset:2048 sc1
    s_add_u32 s77, s74, 49152
    buffer_load_dwordx4 v[52:55], v17, s[40:43], s77 offen offset:2048 sc1
    s_waitcnt vmcnt(11) lgkmcnt(0)
    s_barrier
    s_max_i32 s7, s5, 1
    s_sub_u32 s7, s7, 1
    v_mov_b32 v6, s7
    buffer_store_dword v6, v5, s[40:43], s70 offen sc1
    v_mfma_f32_16x16x32_bf16 v[216:219], a[60:63], v[56:59], v[216:219]
    ds_read_b128 v[168:171], v20 offset:0
    v_mfma_f32_16x16x32_bf16 v[220:223], a[60:63], v[60:63], v[220:223]
    ds_read_b128 v[172:175], v20 offset:10240
    v_mfma_f32_16x16x32_bf16 v[224:227], a[64:67], v[56:59], v[224:227]
    ds_read_b128 v[176:179], v20 offset:20480
    v_mfma_f32_16x16x32_bf16 v[228:231], a[64:67], v[60:63], v[228:231]
    ds_read_b128 v[180:183], v20 offset:30720
    v_mfma_f32_16x16x32_bf16 v[232:235], a[68:71], v[56:59], v[232:235]
    ds_read_b128 v[184:187], v20 offset:4096
    v_mfma_f32_16x16x32_bf16 v[236:239], a[68:71], v[60:63], v[236:239]
    ds_read_b128 v[188:191], v20 offset:14336
    v_mfma_f32_16x16x32_bf16 v[240:243], a[72:75], v[56:59], v[240:243]
    ds_read_b128 v[192:195], v20 offset:24576
    v_mfma_f32_16x16x32_bf16 v[244:247], a[72:75], v[60:63], v[244:247]
    ds_read_b128 v[196:199], v20 offset:34816
    v_mfma_f32_16x16x32_bf16 v[248:251], a[76:79], v[56:59], v[248:251]
    ds_read_b128 v[200:203], v20 offset:8192
    v_mfma_f32_16x16x32_bf16 v[252:255], a[76:79], v[60:63], v[252:255]
    ds_read_b128 v[204:207], v20 offset:18432
    s_add_u32 s77, s74, 0
    buffer_load_dwordx4 v[56:59], v17, s[40:43], s77 offen offset:3072 sc1
    s_add_u32 s77, s74, 49152
    buffer_load_dwordx4 v[60:63], v17, s[40:43], s77 offen offset:3072 sc1
    v_mfma_f32_16x16x32_bf16 v[216:219], a[80:83], v[64:67], v[216:219]
    ds_read_b128 v[208:211], v20 offset:28672
    v_mfma_f32_16x16x32_bf16 v[220:223], a[80:83], v[68:71], v[220:223]
    ds_read_b128 v[212:215], v20 offset:38912
    v_mfma_f32_16x16x32_bf16 v[224:227], a[84:87], v[64:67], v[224:227]
    v_mfma_f32_16x16x32_bf16 v[228:231], a[84:87], v[68:71], v[228:231]
    v_mfma_f32_16x16x32_bf16 v[232:235], a[88:91], v[64:67], v[232:235]
    v_mfma_f32_16x16x32_bf16 v[236:239], a[88:91], v[68:71], v[236:239]
    v_mfma_f32_16x16x32_bf16 v[240:243], a[92:95], v[64:67], v[240:243]
    v_mfma_f32_16x16x32_bf16 v[244:247], a[92:95], v[68:71], v[244:247]
    v_mfma_f32_16x16x32_bf16 v[248:251], a[96:99], v[64:67], v[248:251]
    v_mfma_f32_16x16x32_bf16 v[252:255], a[96:99], v[68:71], v[252:255]
    s_add_u32 s77, s74, 4096
    buffer_load_dwordx4 v[64:67], v17, s[40:43], s77 offen offset:0 sc1
    s_add_u32 s77, s74, 53248
    buffer_load_dwordx4 v[68:71], v17, s[40:43], s77 offen offset:0 sc1
    s_waitcnt vmcnt(11)
    s_waitcnt lgkmcnt(0)
    v_mfma_f32_16x16x32_bf16 v[216:219], a[100:103], v[72:75], v[216:219]
    v_sub_f32 v24, 1.0, v24
    v_mfma_f32_16x16x32_bf16 v[220:223], a[100:103], v[76:79], v[220:223]
    v_add_f32 v168, v168, v172
    v_mfma_f32_16x16x32_bf16 v[224:227], a[104:107], v[72:75], v[224:227]
    v_add_f32 v176, v176, v180
    v_mfma_f32_16x16x32_bf16 v[228:231], a[104:107], v[76:79], v[228:231]
    v_add_f32 v169, v169, v173
    v_mfma_f32_16x16x32_bf16 v[232:235], a[108:111], v[72:75], v[232:235]
    v_add_f32 v177, v177, v181
    v_mfma_f32_16x16x32_bf16 v[236:239], a[108:111], v[76:79], v[236:239]
    v_add_f32 v170, v170, v174
    v_mfma_f32_16x16x32_bf16 v[240:243], a[112:115], v[72:75], v[240:243]
    v_add_f32 v178, v178, v182
    v_mfma_f32_16x16x32_bf16 v[244:247], a[112:115], v[76:79], v[244:247]
    v_add_f32 v171, v171, v175
    v_mfma_f32_16x16x32_bf16 v[248:251], a[116:119], v[72:75], v[248:251]
    v_add_f32 v179, v179, v183
    v_mfma_f32_16x16x32_bf16 v[252:255], a[116:119], v[76:79], v[252:255]
    v_add_f32 v168, v168, v176
    s_add_u32 s77, s74, 4096
    buffer_load_dwordx4 v[72:75], v17, s[40:43], s77 offen offset:1024 sc1
    s_add_u32 s77, s74, 53248
    buffer_load_dwordx4 v[76:79], v17, s[40:43], s77 offen offset:1024 sc1
    v_mfma_f32_16x16x32_bf16 v[216:219], a[120:123], v[80:83], v[216:219]
    v_add_f32 v169, v169, v177
    v_mfma_f32_16x16x32_bf16 v[220:223], a[120:123], v[84:87], v[220:223]
    v_add_f32 v170, v170, v178
    v_mfma_f32_16x16x32_bf16 v[224:227], a[124:127], v[80:83], v[224:227]
    v_add_f32 v171, v171, v179
    v_mfma_f32_16x16x32_bf16 v[228:231], a[124:127], v[84:87], v[228:231]
    v_mul_f32 v168, v168, v24
    v_mfma_f32_16x16x32_bf16 v[232:235], a[128:131], v[80:83], v[232:235]
    v_mul_f32 v169, v169, v24
    v_mfma_f32_16x16x32_bf16 v[236:239], a[128:131], v[84:87], v[236:239]
    v_mul_f32 v170, v170, v24
    v_mfma_f32_16x16x32_bf16 v[240:243], a[132:135], v[80:83], v[240:243]
    v_mul_f32 v171, v171, v24
    v_mfma_f32_16x16x32_bf16 v[244:247], a[132:135], v[84:87], v[244:247]
    buffer_store_dwordx4 v[168:171], v20, s[40:43], s79 offen sc1
    v_mfma_f32_16x16x32_bf16 v[248:251], a[136:139], v[80:83], v[248:251]
    v_add_f32 v184, v184, v188
    v_mfma_f32_16x16x32_bf16 v[252:255], a[136:139], v[84:87], v[252:255]
    v_add_f32 v192, v192, v196
    s_add_u32 s77, s74, 4096
    buffer_load_dwordx4 v[80:83], v17, s[40:43], s77 offen offset:2048 sc1
    s_add_u32 s77, s74, 53248
    buffer_load_dwordx4 v[84:87], v17, s[40:43], s77 offen offset:2048 sc1
    v_mfma_f32_16x16x32_bf16 v[216:219], a[140:143], v[88:91], v[216:219]
    v_add_f32 v185, v185, v189
    v_mfma_f32_16x16x32_bf16 v[220:223], a[140:143], v[92:95], v[220:223]
    v_add_f32 v193, v193, v197
    v_mfma_f32_16x16x32_bf16 v[224:227], a[144:147], v[88:91], v[224:227]
    v_add_f32 v186, v186, v190
    v_mfma_f32_16x16x32_bf16 v[228:231], a[144:147], v[92:95], v[228:231]
    v_add_f32 v194, v194, v198
    v_mfma_f32_16x16x32_bf16 v[232:235], a[148:151], v[88:91], v[232:235]
    v_add_f32 v187, v187, v191
    v_mfma_f32_16x16x32_bf16 v[236:239], a[148:151], v[92:95], v[236:239]
    v_add_f32 v195, v195, v199
    v_mfma_f32_16x16x32_bf16 v[240:243], a[152:155], v[88:91], v[240:243]
    v_add_f32 v184, v184, v192
    v_mfma_f32_16x16x32_bf16 v[244:247], a[152:155], v[92:95], v[244:247]
    v_add_f32 v185, v185, v193
    v_mfma_f32_16x16x32_bf16 v[248:251], a[156:159], v[88:91], v[248:251]
    v_add_f32 v186, v186, v194
    v_mfma_f32_16x16x32_bf16 v[252:255], a[156:159], v[92:95], v[252:255]
    v_add_f32 v187, v187, v195
    s_add_u32 s77, s74, 4096
    buffer_load_dwordx4 v[88:91], v17, s[40:43], s77 offen offset:3072 sc1
    s_add_u32 s77, s74, 53248
    buffer_load_dwordx4 v[92:95], v17, s[40:43], s77 offen offset:3072 sc1
    v_mfma_f32_16x16x32_bf16 v[216:219], a[160:163], v[96:99], v[216:219]
    v_mul_f32 v184, v184, v24
    v_mfma_f32_16x16x32_bf16 v[220:223], a[160:163], v[100:103], v[220:223]
    v_mul_f32 v185, v185, v24
    v_mfma_f32_16x16x32_bf16 v[224:227], a[164:167], v[96:99], v[224:227]
    v_mul_f32 v186, v186, v24
    v_mfma_f32_16x16x32_bf16 v[228:231], a[164:167], v[100:103], v[228:231]
    v_mul_f32 v187, v187, v24
    v_mfma_f32_16x16x32_bf16 v[232:235], a[168:171], v[96:99], v[232:235]
    buffer_store_dwordx4 v[184:187], v21, s[40:43], s79 offen sc1
    v_mfma_f32_16x16x32_bf16 v[236:239], a[168:171], v[100:103], v[236:239]
    v_add_f32 v200, v200, v204
    v_mfma_f32_16x16x32_bf16 v[240:243], a[172:175], v[96:99], v[240:243]
    v_add_f32 v208, v208, v212
    v_mfma_f32_16x16x32_bf16 v[244:247], a[172:175], v[100:103], v[244:247]
    v_add_f32 v201, v201, v205
    v_mfma_f32_16x16x32_bf16 v[248:251], a[176:179], v[96:99], v[248:251]
    v_add_f32 v209, v209, v213
    v_mfma_f32_16x16x32_bf16 v[252:255], a[176:179], v[100:103], v[252:255]
    v_add_f32 v202, v202, v206
    s_add_u32 s77, s74, 8192
    buffer_load_dwordx4 v[96:99], v17, s[40:43], s77 offen offset:0 sc1
    s_add_u32 s77, s74, 57344
    buffer_load_dwordx4 v[100:103], v17, s[40:43], s77 offen offset:0 sc1
    v_mfma_f32_16x16x32_bf16 v[216:219], a[180:183], v[104:107], v[216:219]
    v_add_f32 v210, v210, v214
    v_mfma_f32_16x16x32_bf16 v[220:223], a[180:183], v[108:111], v[220:223]
    v_add_f32 v203, v203, v207
    v_mfma_f32_16x16x32_bf16 v[224:227], a[184:187], v[104:107], v[224:227]
    v_add_f32 v211, v211, v215
    v_mfma_f32_16x16x32_bf16 v[228:231], a[184:187], v[108:111], v[228:231]
    v_add_f32 v200, v200, v208
    v_mfma_f32_16x16x32_bf16 v[232:235], a[188:191], v[104:107], v[232:235]
    v_add_f32 v201, v201, v209
    v_mfma_f32_16x16x32_bf16 v[236:239], a[188:191], v[108:111], v[236:239]
    v_add_f32 v202, v202, v210
    v_mfma_f32_16x16x32_bf16 v[240:243], a[192:195], v[104:107], v[240:243]
    v_add_f32 v203, v203, v211
    v_mfma_f32_16x16x32_bf16 v[244:247], a[192:195], v[108:111], v[244:247]
    v_mul_f32 v200, v200, v24
    v_mfma_f32_16x16x32_bf16 v[248:251], a[196:199], v[104:107], v[248:251]
    v_mul_f32 v201, v201, v24
    v_mfma_f32_16x16x32_bf16 v[252:255], a[196:199], v[108:111], v[252:255]
    v_mul_f32 v202, v202, v24
    s_add_u32 s77, s74, 8192
    buffer_load_dwordx4 v[104:107], v17, s[40:43], s77 offen offset:1024 sc1
    s_add_u32 s77, s74, 57344
    buffer_load_dwordx4 v[108:111], v17, s[40:43], s77 offen offset:1024 sc1
    v_mfma_f32_16x16x32_bf16 v[216:219], a[200:203], v[112:115], v[216:219]
    v_mul_f32 v203, v203, v24
    v_mfma_f32_16x16x32_bf16 v[220:223], a[200:203], v[116:119], v[220:223]
    buffer_store_dwordx4 v[200:203], v22, s[40:43], s79 offen sc1
    v_mfma_f32_16x16x32_bf16 v[224:227], a[204:207], v[112:115], v[224:227]
    v_mfma_f32_16x16x32_bf16 v[228:231], a[204:207], v[116:119], v[228:231]
    v_mfma_f32_16x16x32_bf16 v[232:235], a[208:211], v[112:115], v[232:235]
    v_mfma_f32_16x16x32_bf16 v[236:239], a[208:211], v[116:119], v[236:239]
    v_mfma_f32_16x16x32_bf16 v[240:243], a[212:215], v[112:115], v[240:243]
    v_mfma_f32_16x16x32_bf16 v[244:247], a[212:215], v[116:119], v[244:247]
    v_mfma_f32_16x16x32_bf16 v[248:251], a[216:219], v[112:115], v[248:251]
    v_mfma_f32_16x16x32_bf16 v[252:255], a[216:219], v[116:119], v[252:255]
    s_add_u32 s77, s74, 8192
    buffer_load_dwordx4 v[112:115], v17, s[40:43], s77 offen offset:2048 sc1
    s_add_u32 s77, s74, 57344
    buffer_load_dwordx4 v[116:119], v17, s[40:43], s77 offen offset:2048 sc1
    v_mfma_f32_16x16x32_bf16 v[216:219], a[220:223], v[120:123], v[216:219]
    v_mfma_f32_16x16x32_bf16 v[220:223], a[220:223], v[124:127], v[220:223]
    v_mfma_f32_16x16x32_bf16 v[224:227], a[224:227], v[120:123], v[224:227]
    v_mfma_f32_16x16x32_bf16 v[228:231], a[224:227], v[124:127], v[228:231]
    v_mfma_f32_16x16x32_bf16 v[232:235], a[228:231], v[120:123], v[232:235]
    v_mfma_f32_16x16x32_bf16 v[236:239], a[228:231], v[124:127], v[236:239]
    v_mfma_f32_16x16x32_bf16 v[240:243], a[232:235], v[120:123], v[240:243]
    v_mfma_f32_16x16x32_bf16 v[244:247], a[232:235], v[124:127], v[244:247]
    v_mfma_f32_16x16x32_bf16 v[248:251], a[236:239], v[120:123], v[248:251]
    v_mfma_f32_16x16x32_bf16 v[252:255], a[236:239], v[124:127], v[252:255]
    s_add_u32 s77, s74, 8192
    buffer_load_dwordx4 v[120:123], v17, s[40:43], s77 offen offset:3072 sc1
    s_add_u32 s77, s74, 57344
    buffer_load_dwordx4 v[124:127], v17, s[40:43], s77 offen offset:3072 sc1
    s_mov_b32 s79, s71
    s_mov_b32 s80, s76
    s_add_u32 s71, s71, 81920
    s_add_u32 s76, s76, 128
    s_add_u32 s5, s5, 1
    s_waitcnt vmcnt(12)
    s_barrier
    s_cmp_lt_u32 s5, 64
    s_cbranch_scc1 L_d_loop_25
    buffer_load_dword v24, v23, s[40:43], s80 offen sc1
    ds_write_b128 v19, v[216:219] offset:0
    ds_write_b128 v19, v[220:223] offset:1024
    ds_write_b128 v19, v[224:227] offset:2048
    ds_write_b128 v19, v[228:231] offset:3072
    ds_write_b128 v19, v[232:235] offset:4096
    ds_write_b128 v19, v[236:239] offset:5120
    ds_write_b128 v19, v[240:243] offset:6144
    ds_write_b128 v19, v[244:247] offset:7168
    ds_write_b128 v19, v[248:251] offset:8192
    ds_write_b128 v19, v[252:255] offset:9216
    s_waitcnt lgkmcnt(0)
    s_barrier
    ds_read_b128 v[168:171], v20 offset:0
    ds_read_b128 v[172:175], v20 offset:10240
    ds_read_b128 v[176:179], v20 offset:20480
    ds_read_b128 v[180:183], v20 offset:30720
    ds_read_b128 v[184:187], v20 offset:4096
    ds_read_b128 v[188:191], v20 offset:14336
    ds_read_b128 v[192:195], v20 offset:24576
    ds_read_b128 v[196:199], v20 offset:34816
    ds_read_b128 v[200:203], v20 offset:8192
    ds_read_b128 v[204:207], v20 offset:18432
    ds_read_b128 v[208:211], v20 offset:28672
    ds_read_b128 v[212:215], v20 offset:38912
    s_waitcnt vmcnt(0) lgkmcnt(0)
    v_sub_f32 v24, 1.0, v24
    v_add_f32 v168, v168, v172
    v_add_f32 v176, v176, v180
    v_add_f32 v169, v169, v173
    v_add_f32 v177, v177, v181
    v_add_f32 v170, v170, v174
    v_add_f32 v178, v178, v182
    v_add_f32 v171, v171, v175
    v_add_f32 v179, v179, v183
    v_add_f32 v168, v168, v176
    v_add_f32 v169, v169, v177
    v_add_f32 v170, v170, v178
    v_add_f32 v171, v171, v179
    v_mul_f32 v168, v168, v24
    v_mul_f32 v169, v169, v24
    v_mul_f32 v170, v170, v24
    v_mul_f32 v171, v171, v24
    buffer_store_dwordx4 v[168:171], v20, s[40:43], s79 offen sc1
    v_add_f32 v184, v184, v188
    v_add_f32 v192, v192, v196
    v_add_f32 v185, v185, v189
    v_add_f32 v193, v193, v197
    v_add_f32 v186, v186, v190
    v_add_f32 v194, v194, v198
    v_add_f32 v187, v187, v191
    v_add_f32 v195, v195, v199
    v_add_f32 v184, v184, v192
    v_add_f32 v185, v185, v193
    v_add_f32 v186, v186, v194
    v_add_f32 v187, v187, v195
    v_mul_f32 v184, v184, v24
    v_mul_f32 v185, v185, v24
    v_mul_f32 v186, v186, v24
    v_mul_f32 v187, v187, v24
    buffer_store_dwordx4 v[184:187], v21, s[40:43], s79 offen sc1
    v_add_f32 v200, v200, v204
    v_add_f32 v208, v208, v212
    v_add_f32 v201, v201, v205
    v_add_f32 v209, v209, v213
    v_add_f32 v202, v202, v206
    v_add_f32 v210, v210, v214
    v_add_f32 v203, v203, v207
    v_add_f32 v211, v211, v215
    v_add_f32 v200, v200, v208
    v_add_f32 v201, v201, v209
    v_add_f32 v202, v202, v210
    v_add_f32 v203, v203, v211
    v_mul_f32 v200, v200, v24
    v_mul_f32 v201, v201, v24
    v_mul_f32 v202, v202, v24
    v_mul_f32 v203, v203, v24
    buffer_store_dwordx4 v[200:203], v22, s[40:43], s79 offen sc1
    s_waitcnt vmcnt(0)
    s_barrier
    v_mov_b32 v6, s5
    buffer_store_dword v6, v5, s[40:43], s70 offen sc1
    s_endpgm
L_G:
    s_mov_b32 s48, s30
    s_mov_b32 s49, s31
    s_mov_b32 s50, 0x500
    s_mov_b32 s51, 0x20000
    v_and_b32 v1, 15, v0
    v_lshrrev_b32 v2, 4, v0
    v_lshrrev_b32 v3, 2, v1
    v_and_b32 v4, 3, v0
    v_mov_b32 v5, s3
    v_or_b32 v5, v5, v0
    v_cmp_eq_u32 vcc, 0, v5
    v_mov_b32 v5, 0x80000000
    s_nop 0
    v_cndmask_b32_e64 v5, v5, 0, vcc
    s_add_u32 s70, s4, 148
    s_lshl_b32 s70, s70, 7
    v_mov_b32 v6, 0
    buffer_store_dword v6, v5, s[40:43], s70 offen sc1
    s_waitcnt vmcnt(0)
    s_barrier
    v_mov_b32 v6, 1
    buffer_atomic_add v6, v5, s[60:63], 0 offen sc1
    v_lshlrev_b32 v6, 4, v2
    buffer_load_dwordx4 v[16:19], v6, s[48:51], 0 offen offset:0
    buffer_load_dwordx4 v[20:23], v6, s[48:51], 0 offen offset:64
    buffer_load_dwordx4 v[24:27], v6, s[48:51], 0 offen offset:128
    buffer_load_dwordx4 v[28:31], v6, s[48:51], 0 offen offset:192
    buffer_load_dwordx4 v[32:35], v6, s[48:51], 0 offen offset:256
    buffer_load_dwordx4 v[36:39], v6, s[48:51], 0 offen offset:320
    buffer_load_dwordx4 v[40:43], v6, s[48:51], 0 offen offset:384
    buffer_load_dwordx4 v[44:47], v6, s[48:51], 0 offen offset:448
    buffer_load_dwordx4 v[48:51], v6, s[48:51], 0 offen offset:512
    buffer_load_dwordx4 v[52:55], v6, s[48:51], 0 offen offset:576
    buffer_load_dwordx4 v[56:59], v6, s[48:51], 0 offen offset:640
    buffer_load_dwordx4 v[60:63], v6, s[48:51], 0 offen offset:704
    buffer_load_dwordx4 v[64:67], v6, s[48:51], 0 offen offset:768
    buffer_load_dwordx4 v[68:71], v6, s[48:51], 0 offen offset:832
    buffer_load_dwordx4 v[72:75], v6, s[48:51], 0 offen offset:896
    buffer_load_dwordx4 v[76:79], v6, s[48:51], 0 offen offset:960
    buffer_load_dwordx4 v[80:83], v6, s[48:51], 0 offen offset:1024
    buffer_load_dwordx4 v[84:87], v6, s[48:51], 0 offen offset:1088
    buffer_load_dwordx4 v[88:91], v6, s[48:51], 0 offen offset:1152
    buffer_load_dwordx4 v[92:95], v6, s[48:51], 0 offen offset:1216
    v_mul_u32_u24 v7, 1280, v1
    v_add_u32 v7, v7, v6
    v_cmp_eq_u32 vcc, 0, v2
    v_lshlrev_b32 v6, 2, v1
    v_mov_b32 v8, 0x80000000
    v_cndmask_b32 v8, v8, v6, vcc
    s_lshl_b32 s71, s4, 2
    s_add_u32 s71, s71, s3
    s_lshl_b32 s72, s71, 8
    s_add_u32 s72, s72, 0x10000
    s_mul_i32 s71, s71, 81920
.p2align 6
L_g_loop_32:
    buffer_load_dwordx4 v[96:99], v7, s[44:47], s71 offen offset:0
    buffer_load_dwordx4 v[100:103], v7, s[44:47], s71 offen offset:64
    buffer_load_dwordx4 v[104:107], v7, s[44:47], s71 offen offset:128
    buffer_load_dwordx4 v[108:111], v7, s[44:47], s71 offen offset:192
    buffer_load_dwordx4 v[112:115], v7, s[44:47], s71 offen offset:256
    buffer_load_dwordx4 v[116:119], v7, s[44:47], s71 offen offset:320
    buffer_load_dwordx4 v[120:123], v7, s[44:47], s71 offen offset:384
    buffer_load_dwordx4 v[124:127], v7, s[44:47], s71 offen offset:448
    buffer_load_dwordx4 v[128:131], v7, s[44:47], s71 offen offset:512
    buffer_load_dwordx4 v[132:135], v7, s[44:47], s71 offen offset:576
    buffer_load_dwordx4 v[136:139], v7, s[44:47], s71 offen offset:640
    buffer_load_dwordx4 v[140:143], v7, s[44:47], s71 offen offset:704
    buffer_load_dwordx4 v[144:147], v7, s[44:47], s71 offen offset:768
    buffer_load_dwordx4 v[148:151], v7, s[44:47], s71 offen offset:832
    buffer_load_dwordx4 v[152:155], v7, s[44:47], s71 offen offset:896
    buffer_load_dwordx4 v[156:159], v7, s[44:47], s71 offen offset:960
    buffer_load_dwordx4 v[160:163], v7, s[44:47], s71 offen offset:1024
    buffer_load_dwordx4 v[164:167], v7, s[44:47], s71 offen offset:1088
    buffer_load_dwordx4 v[168:171], v7, s[44:47], s71 offen offset:1152
    buffer_load_dwordx4 v[172:175], v7, s[44:47], s71 offen offset:1216
    s_waitcnt vmcnt(19)
    v_mfma_f32_16x16x32_bf16 v[12:15], v[16:19], v[96:99], 0
    s_waitcnt vmcnt(18)
    v_mfma_f32_16x16x32_bf16 v[12:15], v[20:23], v[100:103], v[12:15]
    s_waitcnt vmcnt(17)
    v_mfma_f32_16x16x32_bf16 v[12:15], v[24:27], v[104:107], v[12:15]
    s_waitcnt vmcnt(16)
    v_mfma_f32_16x16x32_bf16 v[12:15], v[28:31], v[108:111], v[12:15]
    s_waitcnt vmcnt(15)
    v_mfma_f32_16x16x32_bf16 v[12:15], v[32:35], v[112:115], v[12:15]
    s_waitcnt vmcnt(14)
    v_mfma_f32_16x16x32_bf16 v[12:15], v[36:39], v[116:119], v[12:15]
    s_waitcnt vmcnt(13)
    v_mfma_f32_16x16x32_bf16 v[12:15], v[40:43], v[120:123], v[12:15]
    s_waitcnt vmcnt(12)
    v_mfma_f32_16x16x32_bf16 v[12:15], v[44:47], v[124:127], v[12:15]
    s_waitcnt vmcnt(11)
    v_mfma_f32_16x16x32_bf16 v[12:15], v[48:51], v[128:131], v[12:15]
    s_waitcnt vmcnt(10)
    v_mfma_f32_16x16x32_bf16 v[12:15], v[52:55], v[132:135], v[12:15]
    s_waitcnt vmcnt(9)
    v_mfma_f32_16x16x32_bf16 v[12:15], v[56:59], v[136:139], v[12:15]
    s_waitcnt vmcnt(8)
    v_mfma_f32_16x16x32_bf16 v[12:15], v[60:63], v[140:143], v[12:15]
    s_waitcnt vmcnt(7)
    v_mfma_f32_16x16x32_bf16 v[12:15], v[64:67], v[144:147], v[12:15]
    s_waitcnt vmcnt(6)
    v_mfma_f32_16x16x32_bf16 v[12:15], v[68:71], v[148:151], v[12:15]
    s_waitcnt vmcnt(5)
    v_mfma_f32_16x16x32_bf16 v[12:15], v[72:75], v[152:155], v[12:15]
    s_waitcnt vmcnt(4)
    v_mfma_f32_16x16x32_bf16 v[12:15], v[76:79], v[156:159], v[12:15]
    s_waitcnt vmcnt(3)
    v_mfma_f32_16x16x32_bf16 v[12:15], v[80:83], v[160:163], v[12:15]
    s_waitcnt vmcnt(2)
    v_mfma_f32_16x16x32_bf16 v[12:15], v[84:87], v[164:167], v[12:15]
    s_waitcnt vmcnt(1)
    v_mfma_f32_16x16x32_bf16 v[12:15], v[88:91], v[168:171], v[12:15]
    s_waitcnt vmcnt(0)
    v_mfma_f32_16x16x32_bf16 v[12:15], v[92:95], v[172:175], v[12:15]
    s_nop 7
    v_mul_f32 v6, 0xbfb8aa3b, v12
    v_exp_f32 v6, v6
    s_nop 0
    v_add_f32 v6, 1.0, v6
    v_rcp_f32 v6, v6
    s_nop 0
    buffer_store_dword v6, v8, s[40:43], s72 offen sc1
    s_add_u32 s71, s71, 20480
    s_add_u32 s72, s72, 64
    s_add_u32 s5, s5, 1
    s_cmp_lt_u32 s5, 4
    s_cbranch_scc1 L_g_loop_32
    s_waitcnt vmcnt(0)
    s_barrier
    v_mov_b32 v6, s5
    buffer_store_dword v6, v5, s[40:43], s70 offen sc1
    s_endpgm
L_X:
    s_getpc_b64 s[96:97]
L_pc_33:
    s_lshl_b32 s98, s3, 10
    v_lshl_add_u32 v250, v0, 4, s98
    v_mov_b32 v251, s97
    v_add_co_u32 v250, vcc, s96, v250
    s_nop 1
    v_addc_co_u32 v251, vcc, 0, v251, vcc
    global_load_dwordx4 v[252:255], v[250:251], off
    v_add_co_u32 v250, vcc, 0x1000, v250
    s_nop 1
    v_addc_co_u32 v251, vcc, 0, v251, vcc
    v_and_b32 v1, 15, v0
    v_lshrrev_b32 v2, 4, v0
    v_lshrrev_b32 v3, 2, v1
    v_and_b32 v4, 3, v0
    v_mov_b32 v5, s3
    v_or_b32 v5, v5, v0
    v_cmp_eq_u32 vcc, 0, v5
    v_mov_b32 v5, 0x80000000
    s_nop 0
    v_cndmask_b32_e64 v5, v5, 0, vcc
    s_add_u32 s82, s4, 128
    s_lshl_b32 s82, s82, 7
    v_mov_b32 v6, 0
    buffer_store_dword v6, v5, s[40:43], s82 offen sc1
    s_waitcnt vmcnt(0)
    s_barrier
    v_mov_b32 v6, 1
    buffer_atomic_add v6, v5, s[60:63], 0 offen sc1
    v_lshlrev_b32 v8, 4, v0
    v_and_b32 v6, 7, v0
    s_lshl_b32 s7, s3, 3
    v_add_u32 v6, s7, v6
    v_bfe_u32 v7, v0, 3, 2
    v_add_u32 v9, 0, v6
    v_add_u32 v16, 32, v6
    v_cmp_eq_u32 vcc, 1, v7
    s_nop 1
    v_cndmask_b32 v9, v9, v16, vcc
    v_add_u32 v212, 72, v6
    v_lshlrev_b32 v212, 7, v212
    v_and_b32 v6, 1, v0
    s_lshl_b32 s7, s4, 1
    v_add_u32 v6, s7, v6
    v_mul_u32_u24 v6, 205, v6
    v_lshrrev_b32 v6, 10, v6
    v_add_u32 v16, 116, v6
    v_lshlrev_b32 v9, 7, v9
    v_lshlrev_b32 v36, 7, v16
    v_cmp_eq_u32 s[80:81], 3, v7
    v_mul_u32_u24 v10, 2560, v2
    v_lshl_add_u32 v10, v1, 4, v10
    v_add_u32 v10, 2048, v10
    s_lshl_b32 s7, s3, 12
    v_add_u32 v11, s7, v8
    s_lshl_b32 s7, s3, 10
    v_add_u32 v12, s7, v8
    s_and_b32 s77, s3, 1
    s_lshl_b32 s7, s77, 6
    v_lshlrev_b32 v13, 2, v1
    v_add_u32 v13, s7, v13
    s_mul_i32 s7, s77, 20480
    s_lshl_b32 s77, s4, 6
    s_add_u32 s7, s7, s77
    s_lshr_b32 s77, s3, 1
    s_lshl_b32 s77, s77, 5
    s_add_u32 s7, s7, s77
    v_mul_u32_u24 v14, 1280, v1
    v_lshl_add_u32 v14, v2, 3, v14
    v_add_u32 v14, s7, v14
    s_lshl_b32 s70, s4, 16
    s_lshl_b32 s7, s3, 13
    s_add_u32 s70, s70, s7
    s_add_u32 s70, s70, 0x6800000
    s_lshl_b32 s71, s4, 14
    s_lshl_b32 s7, s3, 11
    s_add_u32 s71, s71, s7
    s_add_u32 s71, s71, 0xc000000
    s_mul_i32 s72, s3, 20480
    s_add_u32 s72, s72, 0xa00000
    s_lshl_b32 s73, s4, 12
    s_add_u32 s73, s73, 0x1000000
    s_mov_b32 s74, 0x10000
    s_mov_b32 s75, 0
    s_mov_b32 s78, 0
    s_cmp_lg_u32 s3, 0
    s_cbranch_scc1 L_wsd_35
L_ws_34:
    buffer_load_dword v16, off, s[60:63], 0 sc1
    buffer_load_dword v17, off, s[60:63], 0 offset:128 sc1
    s_waitcnt vmcnt(0)
    v_cmp_gt_u32 vcc, 256, v16
    s_cbranch_vccnz L_ws_34_r
    v_cmp_gt_u32 vcc, 0x28000000, v17
    s_cbranch_vccz L_wsd_35
L_ws_34_r:
    s_sleep 16
    s_add_u32 s6, s6, 1
    s_cmp_gt_u32 s6, 200000
    s_cbranch_scc1 L_timeout
    s_branch L_ws_34
L_wsd_35:
    s_barrier
    buffer_load_dword v16, off, s[60:63], 0 offset:128 sc1
    s_waitcnt vmcnt(0)
    v_readfirstlane_b32 s68, v16
    s_nop 0
    s_bfe_u32 s7, s68, 0xc0000
    s_cmp_gt_u32 s7, 40
    s_cselect_b32 s7, 8192, 0
    s_add_u32 s38, s38, s7
    s_bfe_u32 s7, s68, 0xc000c
    s_cmp_gt_u32 s7, 40
    s_cselect_b32 s7, 8192, 0
    s_add_u32 s39, s39, s7
    s_add_u32 s68, s39, 1179648
    s_add_u32 s69, s39, 655360
    s_add_u32 s7, s39, 1835008
    v_add_u32 v9, s7, v9
    v_cndmask_b32_e64 v9, v9, v36, s[80:81]
    s_mov_b32 s79, 0
    s_mov_b32 s76, 1
    s_cmp_ge_u32 s79, s76
    s_cbranch_scc1 L_wNd_36
L_wf_37:
    buffer_load_dword v6, v212, s[40:43], 0 offen sc1
    s_waitcnt vmcnt(0)
    v_cmp_gt_u32 vcc, s76, v6
    s_cbranch_vccz L_wfd_38
    s_sleep 4
    s_add_u32 s6, s6, 1
    s_cmp_gt_u32 s6, 200000
    s_cbranch_scc1 L_timeout
    s_branch L_wf_37
L_wfd_38:
    s_mov_b32 s79, s76
    s_add_u32 s77, s76, 1
    v_cmp_gt_u32 vcc, s77, v6
    s_cbranch_vccnz L_wNd_36
    s_mov_b32 s79, s77
    s_add_u32 s77, s76, 2
    v_cmp_gt_u32 vcc, s77, v6
    s_cbranch_vccnz L_wNd_36
    s_mov_b32 s79, s77
    s_add_u32 s77, s76, 4
    v_cmp_gt_u32 vcc, s77, v6
    s_cbranch_vccnz L_wNd_36
    s_mov_b32 s79, s77
    s_add_u32 s77, s76, 8
    v_cmp_gt_u32 vcc, s77, v6
    s_cbranch_vccnz L_wNd_36
    s_mov_b32 s79, s77
    s_add_u32 s77, s76, 16
    v_cmp_gt_u32 vcc, s77, v6
    s_cbranch_vccnz L_wNd_36
    s_mov_b32 s79, s77
L_wNd_36:
    s_add_u32 s77, s70, 0
    buffer_load_dwordx4 v[52:55], v8, s[40:43], s77 offen sc1
    s_add_u32 s77, s70, 32768
    buffer_load_dwordx4 v[84:87], v8, s[40:43], s77 offen sc1
    s_add_u32 s77, s70, 1024
    buffer_load_dwordx4 v[56:59], v8, s[40:43], s77 offen sc1
    s_add_u32 s77, s70, 33792
    buffer_load_dwordx4 v[88:91], v8, s[40:43], s77 offen sc1
    s_add_u32 s77, s70, 2048
    buffer_load_dwordx4 v[60:63], v8, s[40:43], s77 offen sc1
    s_add_u32 s77, s70, 34816
    buffer_load_dwordx4 v[92:95], v8, s[40:43], s77 offen sc1
    s_add_u32 s77, s70, 3072
    buffer_load_dwordx4 v[64:67], v8, s[40:43], s77 offen sc1
    s_add_u32 s77, s70, 35840
    buffer_load_dwordx4 v[96:99], v8, s[40:43], s77 offen sc1
    s_add_u32 s77, s70, 4096
    buffer_load_dwordx4 v[68:71], v8, s[40:43], s77 offen sc1
    s_add_u32 s77, s70, 36864
    buffer_load_dwordx4 v[100:103], v8, s[40:43], s77 offen sc1
    s_add_u32 s77, s70, 5120
    buffer_load_dwordx4 v[72:75], v8, s[40:43], s77 offen sc1
    s_add_u32 s77, s70, 37888
    buffer_load_dwordx4 v[104:107], v8, s[40:43], s77 offen sc1
    s_add_u32 s77, s70, 6144
    buffer_load_dwordx4 v[76:79], v8, s[40:43], s77 offen sc1
    s_add_u32 s77, s70, 38912
    buffer_load_dwordx4 v[108:111], v8, s[40:43], s77 offen sc1
    s_add_u32 s77, s70, 7168
    buffer_load_dwordx4 v[80:83], v8, s[40:43], s77 offen sc1
    s_add_u32 s77, s70, 39936
    buffer_load_dwordx4 v[112:115], v8, s[40:43], s77 offen sc1
.p2align 6
L_x_loop_39:
    s_add_u32 s76, s5, 2
    s_min_u32 s76, s76, 64
    s_cmp_ge_u32 s79, s76
    s_cbranch_scc1 L_wNd_40
L_wf_41:
    buffer_load_dword v6, v212, s[40:43], 0 offen sc1
    s_waitcnt vmcnt(0)
    v_cmp_gt_u32 vcc, s76, v6
    s_cbranch_vccz L_wfd_42
    s_sleep 4
    s_add_u32 s6, s6, 1
    s_cmp_gt_u32 s6, 200000
    s_cbranch_scc1 L_timeout
    s_branch L_wf_41
L_wfd_42:
    s_mov_b32 s79, s76
    s_add_u32 s77, s76, 1
    v_cmp_gt_u32 vcc, s77, v6
    s_cbranch_vccnz L_wNd_40
    s_mov_b32 s79, s77
    s_add_u32 s77, s76, 2
    v_cmp_gt_u32 vcc, s77, v6
    s_cbranch_vccnz L_wNd_40
    s_mov_b32 s79, s77
    s_add_u32 s77, s76, 4
    v_cmp_gt_u32 vcc, s77, v6
    s_cbranch_vccnz L_wNd_40
    s_mov_b32 s79, s77
    s_add_u32 s77, s76, 8
    v_cmp_gt_u32 vcc, s77, v6
    s_cbranch_vccnz L_wNd_40
    s_mov_b32 s79, s77
    s_add_u32 s77, s76, 16
    v_cmp_gt_u32 vcc, s77, v6
    s_cbranch_vccnz L_wNd_40
    s_mov_b32 s79, s77
L_wNd_40:
    s_add_u32 s70, s70, 1310720
    s_add_u32 s76, s5, 1
    s_cmp_ge_u32 s78, s76
    s_cbranch_scc1 L_wNd_43
L_wf_44:
    buffer_load_dword v6, v9, s[40:43], 0 offen sc1
    s_waitcnt vmcnt(0)
    v_cmp_gt_u32 vcc, s76, v6
    s_cbranch_vccz L_wfd_45
    s_sleep 1
    s_add_u32 s6, s6, 1
    s_cmp_gt_u32 s6, 200000
    s_cbranch_scc1 L_timeout
    s_branch L_wf_44
L_wfd_45:
    s_mov_b32 s78, s76
    s_add_u32 s77, s76, 1
    v_cmp_gt_u32 vcc, s77, v6
    s_cbranch_vccnz L_wNd_43
    s_mov_b32 s78, s77
    s_add_u32 s77, s76, 2
    v_cmp_gt_u32 vcc, s77, v6
    s_cbranch_vccnz L_wNd_43
    s_mov_b32 s78, s77
    s_add_u32 s77, s76, 4
    v_cmp_gt_u32 vcc, s77, v6
    s_cbranch_vccnz L_wNd_43
    s_mov_b32 s78, s77
    s_add_u32 s77, s76, 8
    v_cmp_gt_u32 vcc, s77, v6
    s_cbranch_vccnz L_wNd_43
    s_mov_b32 s78, s77
    s_add_u32 s77, s76, 16
    v_cmp_gt_u32 vcc, s77, v6
    s_cbranch_vccnz L_wNd_43
    s_mov_b32 s78, s77
L_wNd_43:
    s_add_u32 s77, s72, 0
    buffer_load_dwordx4 v[132:135], v8, s[40:43], s77 offen offset:0 sc1
    buffer_load_dwordx4 v[136:139], v8, s[40:43], s77 offen offset:1024 sc1
    s_add_u32 s77, s72, 2560
    buffer_load_dwordx4 v[140:143], v8, s[40:43], s77 offen offset:0 sc1
    buffer_load_dwordx4 v[144:147], v8, s[40:43], s77 offen offset:1024 sc1
    s_add_u32 s77, s72, 5120
    buffer_load_dwordx4 v[148:151], v8, s[40:43], s77 offen offset:0 sc1
    buffer_load_dwordx4 v[152:155], v8, s[40:43], s77 offen offset:1024 sc1
    s_add_u32 s77, s72, 7680
    buffer_load_dwordx4 v[156:159], v8, s[40:43], s77 offen offset:0 sc1
    buffer_load_dwordx4 v[160:163], v8, s[40:43], s77 offen offset:1024 sc1
    s_add_u32 s77, s72, 10240
    buffer_load_dwordx4 v[164:167], v8, s[40:43], s77 offen offset:0 sc1
    buffer_load_dwordx4 v[168:171], v8, s[40:43], s77 offen offset:1024 sc1
    s_add_u32 s77, s72, 12800
    buffer_load_dwordx4 v[172:175], v8, s[40:43], s77 offen offset:0 sc1
    buffer_load_dwordx4 v[176:179], v8, s[40:43], s77 offen offset:1024 sc1
    s_add_u32 s77, s72, 15360
    buffer_load_dwordx4 v[180:183], v8, s[40:43], s77 offen offset:0 sc1
    buffer_load_dwordx4 v[184:187], v8, s[40:43], s77 offen offset:1024 sc1
    s_add_u32 s77, s72, 17920
    buffer_load_dwordx4 v[188:191], v8, s[40:43], s77 offen offset:0 sc1
    buffer_load_dwordx4 v[192:195], v8, s[40:43], s77 offen offset:1024 sc1
    s_add_u32 s77, s71, 0
    buffer_load_dwordx4 v[116:119], v8, s[40:43], s77 offen offset:0 sc1
    s_add_u32 s77, s71, 8192
    buffer_load_dwordx4 v[124:127], v8, s[40:43], s77 offen offset:0 sc1
    s_add_u32 s77, s72, 0
    buffer_load_dwordx4 v[196:199], v10, s[40:43], s77 offen offset:0 sc1
    buffer_load_dwordx4 v[200:203], v10, s[40:43], s77 offen offset:256 sc1
    s_add_u32 s77, s71, 0
    buffer_load_dwordx4 v[120:123], v8, s[40:43], s77 offen offset:1024 sc1
    s_add_u32 s77, s71, 8192
    buffer_load_dwordx4 v[128:131], v8, s[40:43], s77 offen offset:1024 sc1
    s_add_u32 s77, s72, 10240
    buffer_load_dwordx4 v[204:207], v10, s[40:43], s77 offen offset:0 sc1
    buffer_load_dwordx4 v[208:211], v10, s[40:43], s77 offen offset:256 sc1
    buffer_load_dwordx4 v[16:19], v12, s[40:43], s73 offen sc1
    buffer_load_dword v15, v13, s[40:43], s74 offen sc1
    s_waitcnt vmcnt(24)
    v_mfma_f32_16x16x32_bf16 v[20:23], v[52:55], v[132:135], 0
    v_mfma_f32_16x16x32_bf16 v[24:27], v[52:55], v[136:139], 0
    v_mfma_f32_16x16x32_bf16 v[28:31], v[84:87], v[132:135], 0
    v_mfma_f32_16x16x32_bf16 v[32:35], v[84:87], v[136:139], 0
    s_waitcnt vmcnt(22)
    v_mfma_f32_16x16x32_bf16 v[20:23], v[56:59], v[140:143], v[20:23]
    v_mfma_f32_16x16x32_bf16 v[24:27], v[56:59], v[144:147], v[24:27]
    v_mfma_f32_16x16x32_bf16 v[28:31], v[88:91], v[140:143], v[28:31]
    v_mfma_f32_16x16x32_bf16 v[32:35], v[88:91], v[144:147], v[32:35]
    s_waitcnt vmcnt(20)
    v_mfma_f32_16x16x32_bf16 v[20:23], v[60:63], v[148:151], v[20:23]
    v_mfma_f32_16x16x32_bf16 v[24:27], v[60:63], v[152:155], v[24:27]
    v_mfma_f32_16x16x32_bf16 v[28:31], v[92:95], v[148:151], v[28:31]
    v_mfma_f32_16x16x32_bf16 v[32:35], v[92:95], v[152:155], v[32:35]
    s_waitcnt vmcnt(18)
    v_mfma_f32_16x16x32_bf16 v[20:23], v[64:67], v[156:159], v[20:23]
    v_mfma_f32_16x16x32_bf16 v[24:27], v[64:67], v[160:163], v[24:27]
    v_mfma_f32_16x16x32_bf16 v[28:31], v[96:99], v[156:159], v[28:31]
    v_mfma_f32_16x16x32_bf16 v[32:35], v[96:99], v[160:163], v[32:35]
    s_waitcnt vmcnt(16)
    v_mfma_f32_16x16x32_bf16 v[20:23], v[68:71], v[164:167], v[20:23]
    v_mfma_f32_16x16x32_bf16 v[24:27], v[68:71], v[168:171], v[24:27]
    v_mfma_f32_16x16x32_bf16 v[28:31], v[100:103], v[164:167], v[28:31]
    v_mfma_f32_16x16x32_bf16 v[32:35], v[100:103], v[168:171], v[32:35]
    s_waitcnt vmcnt(14)
    v_mfma_f32_16x16x32_bf16 v[20:23], v[72:75], v[172:175], v[20:23]
    v_mfma_f32_16x16x32_bf16 v[24:27], v[72:75], v[176:179], v[24:27]
    v_mfma_f32_16x16x32_bf16 v[28:31], v[104:107], v[172:175], v[28:31]
    v_mfma_f32_16x16x32_bf16 v[32:35], v[104:107], v[176:179], v[32:35]
    s_waitcnt vmcnt(12)
    v_mfma_f32_16x16x32_bf16 v[20:23], v[76:79], v[180:183], v[20:23]
    v_mfma_f32_16x16x32_bf16 v[24:27], v[76:79], v[184:187], v[24:27]
    v_mfma_f32_16x16x32_bf16 v[28:31], v[108:111], v[180:183], v[28:31]
    v_mfma_f32_16x16x32_bf16 v[32:35], v[108:111], v[184:187], v[32:35]
    s_waitcnt vmcnt(10)
    v_mfma_f32_16x16x32_bf16 v[20:23], v[80:83], v[188:191], v[20:23]
    v_mfma_f32_16x16x32_bf16 v[24:27], v[80:83], v[192:195], v[24:27]
    v_mfma_f32_16x16x32_bf16 v[28:31], v[112:115], v[188:191], v[28:31]
    v_mfma_f32_16x16x32_bf16 v[32:35], v[112:115], v[192:195], v[32:35]
    s_waitcnt vmcnt(6)
    v_mfma_f32_16x16x32_bf16 v[20:23], v[116:119], v[196:199], v[20:23]
    v_mfma_f32_16x16x32_bf16 v[24:27], v[116:119], v[200:203], v[24:27]
    v_mfma_f32_16x16x32_bf16 v[28:31], v[124:127], v[196:199], v[28:31]
    v_mfma_f32_16x16x32_bf16 v[32:35], v[124:127], v[200:203], v[32:35]
    s_waitcnt vmcnt(2)
    v_mfma_f32_16x16x32_bf16 v[20:23], v[120:123], v[204:207], v[20:23]
    v_mfma_f32_16x16x32_bf16 v[24:27], v[120:123], v[208:211], v[24:27]
    v_mfma_f32_16x16x32_bf16 v[28:31], v[128:131], v[204:207], v[28:31]
    v_mfma_f32_16x16x32_bf16 v[32:35], v[128:131], v[208:211], v[32:35]
    s_add_u32 s77, s70, 0
    buffer_load_dwordx4 v[52:55], v8, s[40:43], s77 offen sc1
    s_add_u32 s77, s70, 32768
    buffer_load_dwordx4 v[84:87], v8, s[40:43], s77 offen sc1
    s_add_u32 s77, s70, 1024
    buffer_load_dwordx4 v[56:59], v8, s[40:43], s77 offen sc1
    s_add_u32 s77, s70, 33792
    buffer_load_dwordx4 v[88:91], v8, s[40:43], s77 offen sc1
    s_add_u32 s77, s70, 2048
    buffer_load_dwordx4 v[60:63], v8, s[40:43], s77 offen sc1
    s_add_u32 s77, s70, 34816
    buffer_load_dwordx4 v[92:95], v8, s[40:43], s77 offen sc1
    s_add_u32 s77, s70, 3072
    buffer_load_dwordx4 v[64:67], v8, s[40:43], s77 offen sc1
    s_add_u32 s77, s70, 35840
    buffer_load_dwordx4 v[96:99], v8, s[40:43], s77 offen sc1
    s_add_u32 s77, s70, 4096
    buffer_load_dwordx4 v[68:71], v8, s[40:43], s77 offen sc1
    s_add_u32 s77, s70, 36864
    buffer_load_dwordx4 v[100:103], v8, s[40:43], s77 offen sc1
    s_add_u32 s77, s70, 5120
    buffer_load_dwordx4 v[72:75], v8, s[40:43], s77 offen sc1
    s_add_u32 s77, s70, 37888
    buffer_load_dwordx4 v[104:107], v8, s[40:43], s77 offen sc1
    s_add_u32 s77, s70, 6144
    buffer_load_dwordx4 v[76:79], v8, s[40:43], s77 offen sc1
    s_add_u32 s77, s70, 38912
    buffer_load_dwordx4 v[108:111], v8, s[40:43], s77 offen sc1
    s_add_u32 s77, s70, 7168
    buffer_load_dwordx4 v[80:83], v8, s[40:43], s77 offen sc1
    s_add_u32 s77, s70, 39936
    buffer_load_dwordx4 v[112:115], v8, s[40:43], s77 offen sc1
    ds_write_b128 v11, v[20:23] offset:0
    ds_write_b128 v11, v[24:27] offset:1024
    ds_write_b128 v11, v[28:31] offset:2048
    ds_write_b128 v11, v[32:35] offset:3072
    s_waitcnt lgkmcnt(0)
    s_barrier
    ds_read_b128 v[36:39], v12 offset:0
    ds_read_b128 v[40:43], v12 offset:4096
    ds_read_b128 v[44:47], v12 offset:8192
    ds_read_b128 v[48:51], v12 offset:12288
    s_waitcnt lgkmcnt(0)
    s_barrier
    v_pk_add_f32 v[36:37], v[36:37], v[40:41]
    v_pk_add_f32 v[44:45], v[44:45], v[48:49]
    v_pk_add_f32 v[38:39], v[38:39], v[42:43]
    v_pk_add_f32 v[46:47], v[46:47], v[50:51]
    v_pk_add_f32 v[36:37], v[36:37], v[44:45]
    v_pk_add_f32 v[38:39], v[38:39], v[46:47]
    s_waitcnt vmcnt(16)
    v_fma_f32 v36, v36, v15, v16
    v_fma_f32 v37, v37, v15, v17
    v_fma_f32 v38, v38, v15, v18
    v_fma_f32 v39, v39, v15, v19
    v_cvt_pk_bf16_f32 v40, v36, v37
    v_cvt_pk_bf16_f32 v41, v38, v39
    buffer_store_dwordx2 v[40:41], v14, s[56:59], s75 offen
    s_add_u32 s75, s75, 40960
    s_add_u32 s72, s72, 81920
    s_add_u32 s73, s73, 81920
    s_add_u32 s74, s74, 128
    s_add_u32 s71, s71, 327680
    s_add_u32 s5, s5, 1
    s_cmp_lt_u32 s5, 64
    s_cbranch_scc1 L_x_loop_39
    s_endpgm
L_P:
    s_getpc_b64 s[96:97]
L_pc_46:
    s_lshl_b32 s98, s3, 10
    v_lshl_add_u32 v250, v0, 4, s98
    v_mov_b32 v251, s97
    v_add_co_u32 v250, vcc, s96, v250
    s_nop 1
    v_addc_co_u32 v251, vcc, 0, v251, vcc
    global_load_dwordx4 v[252:255], v[250:251], off
    v_add_co_u32 v250, vcc, 0x1000, v250
    s_nop 1
    v_addc_co_u32 v251, vcc, 0, v251, vcc
    global_load_dwordx4 v[252:255], v[250:251], off
    v_add_co_u32 v250, vcc, 0x1000, v250
    s_nop 1
    v_addc_co_u32 v251, vcc, 0, v251, vcc
    global_load_dwordx4 v[252:255], v[250:251], off
    v_add_co_u32 v250, vcc, 0x1000, v250
    s_nop 1
    v_addc_co_u32 v251, vcc, 0, v251, vcc
    global_load_dwordx4 v[252:255], v[250:251], off
    v_add_co_u32 v250, vcc, 0x1000, v250
    s_nop 1
    v_addc_co_u32 v251, vcc, 0, v251, vcc
    global_load_dwordx4 v[252:255], v[250:251], off
    v_add_co_u32 v250, vcc, 0x1000, v250
    s_nop 1
    v_addc_co_u32 v251, vcc, 0, v251, vcc
    global_load_dwordx4 v[252:255], v[250:251], off
    v_add_co_u32 v250, vcc, 0x1000, v250
    s_nop 1
    v_addc_co_u32 v251, vcc, 0, v251, vcc
    global_load_dwordx4 v[252:255], v[250:251], off
    v_add_co_u32 v250, vcc, 0x1000, v250
    s_nop 1
    v_addc_co_u32 v251, vcc, 0, v251, vcc
    s_mov_b32 s48, s12
    s_mov_b32 s49, s13
    s_mov_b32 s50, 0x780000
    s_mov_b32 s51, 0x20000
    s_mov_b32 s52, s14
    s_mov_b32 s53, s15
    s_mov_b32 s54, 0x780000
    s_mov_b32 s55, 0x20000
    v_and_b32 v7, 15, v0
    v_lshrrev_b32 v8, 4, v0
    v_lshrrev_b32 v9, 2, v7
    v_and_b32 v10, 3, v0
    v_and_b32 v16, 1, v0
    v_cmp_eq_u32 vcc, 0, v16
    v_mov_b32 v16, 0xeeee
    v_mov_b32 v17, 0x4444
    v_cndmask_b32 v1, v16, v17, vcc
    v_lshlrev_b32 v2, 4, v0
    s_mul_i32 s73, s3, 3
    s_sub_u32 s73, s73, 2
    s_cmp_lt_u32 s3, 2
    s_cselect_b32 s73, 0, s73
    s_add_u32 s7, s73, 0
    s_cmp_ge_u32 s7, 10
    s_cselect_b32 s90, 10, 0
    s_sub_u32 s7, s7, s90
    s_lshl_b32 s90, s7, 10
    s_add_u32 s7, s73, 1
    s_cmp_ge_u32 s7, 10
    s_cselect_b32 s91, 10, 0
    s_sub_u32 s7, s7, s91
    s_lshl_b32 s91, s7, 10
    s_add_u32 s7, s73, 2
    s_cmp_ge_u32 s7, 10
    s_cselect_b32 s92, 10, 0
    s_sub_u32 s7, s7, s92
    s_lshl_b32 s92, s7, 10
    s_add_u32 s7, s73, 3
    s_cmp_ge_u32 s7, 10
    s_cselect_b32 s93, 10, 0
    s_sub_u32 s7, s7, s93
    s_lshl_b32 s93, s7, 10
    s_add_u32 s7, s73, 4
    s_cmp_ge_u32 s7, 10
    s_cselect_b32 s94, 10, 0
    s_sub_u32 s7, s7, s94
    s_lshl_b32 s94, s7, 10
    s_add_u32 s7, s73, 5
    s_cmp_ge_u32 s7, 10
    s_cselect_b32 s95, 10, 0
    s_sub_u32 s7, s7, s95
    s_lshl_b32 s95, s7, 10
    s_add_u32 s7, s73, 6
    s_cmp_ge_u32 s7, 10
    s_cselect_b32 s96, 10, 0
    s_sub_u32 s7, s7, s96
    s_lshl_b32 s96, s7, 10
    s_add_u32 s7, s73, 7
    s_cmp_ge_u32 s7, 10
    s_cselect_b32 s97, 10, 0
    s_sub_u32 s7, s7, s97
    s_lshl_b32 s97, s7, 10
    s_add_u32 s7, s73, 8
    s_cmp_ge_u32 s7, 10
    s_cselect_b32 s98, 10, 0
    s_sub_u32 s7, s7, s98
    s_lshl_b32 s98, s7, 10
    s_add_u32 s7, s73, 9
    s_cmp_ge_u32 s7, 10
    s_cselect_b32 s99, 10, 0
    s_sub_u32 s7, s7, s99
    s_lshl_b32 s99, s7, 10
    s_add_u32 s7, s90, 150528
    v_add_u32 v20, s7, v2
    s_add_u32 s7, s93, 147456
    v_add_u32 v21, s7, v2
    s_add_u32 s7, s96, 144384
    v_add_u32 v22, s7, v2
    s_cmp_ge_u32 s90, 8192
    s_cselect_b32 s64, 24576, 0
    s_add_u32 s64, s64, s90
    s_cmp_ge_u32 s91, 8192
    s_cselect_b32 s65, 24576, 0
    s_add_u32 s65, s65, s91
    s_cmp_ge_u32 s92, 8192
    s_cselect_b32 s66, 24576, 0
    s_add_u32 s66, s66, s92
    s_cmp_ge_u32 s93, 8192
    s_cselect_b32 s67, 24576, 0
    s_add_u32 s67, s67, s93
    s_mov_b32 s67, 0x40000000
    s_mov_b32 s7, 160768
    s_cmp_eq_u32 s3, 1
    s_cselect_b32 s67, 3072, s67
    s_cselect_b32 s7, 153600, s7
    v_add_u32 v23, s7, v2
    v_lshlrev_b32 v4, 2, v8
    v_lshl_add_u32 v4, v7, 4, v4
    s_mul_i32 s7, s3, 768
    s_add_u32 s7, s7, 143360
    v_add_u32 v4, s7, v4
    s_cmp_eq_u32 s3, 0
    s_cbranch_scc1 L_PL
    s_sub_u32 s71, s3, 1
    s_lshl_b32 s70, s71, 7
    s_mul_i32 s71, s71, 50176
    v_add_u32 v16, 0, v0
    v_mul_u32_u24 v17, 171, v16
    v_lshrrev_b32 v17, 10, v17
    v_mul_u32_u24 v18, 6, v17
    v_sub_u32 v18, v16, v18
    v_mul_u32_u24 v17, 12288, v17
    v_lshl_add_u32 v12, v18, 4, v17
    v_add_u32 v16, 64, v0
    v_mul_u32_u24 v17, 171, v16
    v_lshrrev_b32 v17, 10, v17
    v_mul_u32_u24 v18, 6, v17
    v_sub_u32 v18, v16, v18
    v_mul_u32_u24 v17, 12288, v17
    v_lshl_add_u32 v13, v18, 4, v17
    v_add_u32 v16, 128, v0
    v_mul_u32_u24 v17, 171, v16
    v_lshrrev_b32 v17, 10, v17
    v_mul_u32_u24 v18, 6, v17
    v_sub_u32 v18, v16, v18
    v_mul_u32_u24 v17, 12288, v17
    v_lshl_add_u32 v14, v18, 4, v17
    s_mul_i32 s7, s4, 384
    s_mul_i32 s72, s3, 96
    s_add_u32 s7, s7, s72
    v_add_u32 v12, s7, v12
    v_add_u32 v13, s7, v13
    v_add_u32 v14, s7, v14
    v_lshrrev_b32 v16, 1, v8
    v_lshlrev_b32 v16, 4, v16
    v_lshrrev_b32 v17, 1, v9
    v_lshl_add_u32 v16, v17, 3, v16
    v_and_b32 v17, 1, v8
    v_lshl_add_u32 v16, v17, 2, v16
    v_and_b32 v17, 1, v9
    v_add_u32 v16, v16, v17
    v_mul_u32_u24 v18, 96, v16
    v_lshl_add_u32 v15, v10, 3, v18
    v_add_u32 v15, s71, v15
    v_lshlrev_b32 v18, 7, v16
    v_lshl_add_u32 v28, v10, 3, v18
    v_add_u32 v28, s71, v28
    v_lshrrev_b32 v16, 3, v0
    v_and_b32 v17, 7, v0
    v_mul_u32_u24 v16, 12288, v16
    v_lshl_add_u32 v24, v17, 4, v16
    s_mul_i32 s7, s4, 384
    s_add_u32 s7, s7, s70
    v_add_u32 v24, s7, v24
    v_add_u32 v25, 98304, v24
    v_add_u32 v26, 196608, v24
    v_add_u32 v27, 294912, v24
    v_add_u32 v3, s71, v2
    s_cmp_eq_u32 s3, 2
    s_cbranch_scc1 L_pwv_49
    s_cmp_eq_u32 s3, 3
    s_cbranch_scc1 L_pwv_50
L_pwv_48:
    s_mov_b32 s72, 0
    s_add_u32 m0, s71, 0
    s_nop 0
    buffer_load_dwordx4 v12, s[48:51], s72 offen lds
    s_add_u32 m0, s71, 1024
    s_nop 0
    buffer_load_dwordx4 v13, s[48:51], s72 offen lds
    s_add_u32 m0, s71, 2048
    s_nop 0
    buffer_load_dwordx4 v14, s[48:51], s72 offen lds
    s_mov_b32 s72, 0
    s_add_u32 m0, s71, 3072
    s_nop 0
    buffer_load_dwordx4 v24, s[52:55], s72 offen lds
    s_add_u32 m0, s71, 4096
    s_nop 0
    buffer_load_dwordx4 v25, s[52:55], s72 offen lds
    s_add_u32 m0, s71, 5120
    s_nop 0
    buffer_load_dwordx4 v26, s[52:55], s72 offen lds
    s_add_u32 m0, s71, 6144
    s_nop 0
    buffer_load_dwordx4 v27, s[52:55], s72 offen lds
    s_mov_b32 s72, 393216
    s_add_u32 m0, s71, 7168
    s_nop 0
    buffer_load_dwordx4 v12, s[48:51], s72 offen lds
    s_add_u32 m0, s71, 8192
    s_nop 0
    buffer_load_dwordx4 v13, s[48:51], s72 offen lds
    s_add_u32 m0, s71, 9216
    s_nop 0
    buffer_load_dwordx4 v14, s[48:51], s72 offen lds
    s_mov_b32 s72, 393216
    s_add_u32 m0, s71, 10240
    s_nop 0
    buffer_load_dwordx4 v24, s[52:55], s72 offen lds
    s_add_u32 m0, s71, 11264
    s_nop 0
    buffer_load_dwordx4 v25, s[52:55], s72 offen lds
    s_add_u32 m0, s71, 12288
    s_nop 0
    buffer_load_dwordx4 v26, s[52:55], s72 offen lds
    s_add_u32 m0, s71, 13312
    s_nop 0
    buffer_load_dwordx4 v27, s[52:55], s72 offen lds
    s_mov_b32 s72, 786432
    s_add_u32 m0, s71, 14336
    s_nop 0
    buffer_load_dwordx4 v12, s[48:51], s72 offen lds
    s_add_u32 m0, s71, 15360
    s_nop 0
    buffer_load_dwordx4 v13, s[48:51], s72 offen lds
    s_add_u32 m0, s71, 16384
    s_nop 0
    buffer_load_dwordx4 v14, s[48:51], s72 offen lds
    s_mov_b32 s72, 786432
    s_add_u32 m0, s71, 17408
    s_nop 0
    buffer_load_dwordx4 v24, s[52:55], s72 offen lds
    s_add_u32 m0, s71, 18432
    s_nop 0
    buffer_load_dwordx4 v25, s[52:55], s72 offen lds
    s_add_u32 m0, s71, 19456
    s_nop 0
    buffer_load_dwordx4 v26, s[52:55], s72 offen lds
    s_add_u32 m0, s71, 20480
    s_nop 0
    buffer_load_dwordx4 v27, s[52:55], s72 offen lds
    s_mov_b32 s72, 1179648
    s_add_u32 m0, s71, 21504
    s_nop 0
    buffer_load_dwordx4 v12, s[48:51], s72 offen lds
    s_add_u32 m0, s71, 22528
    s_nop 0
    buffer_load_dwordx4 v13, s[48:51], s72 offen lds
    s_add_u32 m0, s71, 23552
    s_nop 0
    buffer_load_dwordx4 v14, s[48:51], s72 offen lds
    s_mov_b32 s72, 1179648
    s_add_u32 m0, s71, 24576
    s_nop 0
    buffer_load_dwordx4 v24, s[52:55], s72 offen lds
    s_add_u32 m0, s71, 25600
    s_nop 0
    buffer_load_dwordx4 v25, s[52:55], s72 offen lds
    s_add_u32 m0, s71, 26624
    s_nop 0
    buffer_load_dwordx4 v26, s[52:55], s72 offen lds
    s_add_u32 m0, s71, 27648
    s_nop 0
    buffer_load_dwordx4 v27, s[52:55], s72 offen lds
    s_waitcnt vmcnt(25)
    s_barrier
    ds_read_b64_tr_b16 a[0:1], v15 offset:0
    ds_read_b64_tr_b16 a[2:3], v15 offset:192
    ds_read_b64_tr_b16 a[8:9], v15 offset:32
    ds_read_b64_tr_b16 a[10:11], v15 offset:224
    ds_read_b64_tr_b16 a[16:17], v15 offset:64
    ds_read_b64_tr_b16 a[18:19], v15 offset:256
    s_waitcnt lgkmcnt(0)
    s_mov_b32 s72, 1572864
    s_add_u32 m0, s71, 0
    s_nop 0
    buffer_load_dwordx4 v12, s[48:51], s72 offen lds
    s_add_u32 m0, s71, 1024
    s_nop 0
    buffer_load_dwordx4 v13, s[48:51], s72 offen lds
    s_add_u32 m0, s71, 2048
    s_nop 0
    buffer_load_dwordx4 v14, s[48:51], s72 offen lds
    s_waitcnt vmcnt(24)
    ds_read_b64_tr_b16 a[168:169], v28 offset:3072
    ds_read_b64_tr_b16 a[170:171], v28 offset:3328
    ds_read_b64_tr_b16 a[224:225], v28 offset:3104
    ds_read_b64_tr_b16 a[226:227], v28 offset:3360
    ds_read_b64_tr_b16 v[144:145], v28 offset:3136
    ds_read_b64_tr_b16 v[146:147], v28 offset:3392
    ds_read_b64_tr_b16 v[200:201], v28 offset:3168
    ds_read_b64_tr_b16 v[202:203], v28 offset:3424
    s_waitcnt lgkmcnt(0)
    s_mov_b32 s72, 1572864
    s_add_u32 m0, s71, 3072
    s_nop 0
    buffer_load_dwordx4 v24, s[52:55], s72 offen lds
    s_add_u32 m0, s71, 4096
    s_nop 0
    buffer_load_dwordx4 v25, s[52:55], s72 offen lds
    s_add_u32 m0, s71, 5120
    s_nop 0
    buffer_load_dwordx4 v26, s[52:55], s72 offen lds
    s_add_u32 m0, s71, 6144
    s_nop 0
    buffer_load_dwordx4 v27, s[52:55], s72 offen lds
    s_waitcnt vmcnt(25)
    ds_read_b64_tr_b16 a[4:5], v15 offset:7168
    ds_read_b64_tr_b16 a[6:7], v15 offset:7360
    ds_read_b64_tr_b16 a[12:13], v15 offset:7200
    ds_read_b64_tr_b16 a[14:15], v15 offset:7392
    ds_read_b64_tr_b16 a[20:21], v15 offset:7232
    ds_read_b64_tr_b16 a[22:23], v15 offset:7424
    s_waitcnt lgkmcnt(0)
    s_mov_b32 s72, 1966080
    s_add_u32 m0, s71, 7168
    s_nop 0
    buffer_load_dwordx4 v12, s[48:51], s72 offen lds
    s_add_u32 m0, s71, 8192
    s_nop 0
    buffer_load_dwordx4 v13, s[48:51], s72 offen lds
    s_add_u32 m0, s71, 9216
    s_nop 0
    buffer_load_dwordx4 v14, s[48:51], s72 offen lds
    s_waitcnt vmcnt(24)
    ds_read_b64_tr_b16 a[172:173], v28 offset:10240
    ds_read_b64_tr_b16 a[174:175], v28 offset:10496
    ds_read_b64_tr_b16 a[228:229], v28 offset:10272
    ds_read_b64_tr_b16 a[230:231], v28 offset:10528
    ds_read_b64_tr_b16 v[148:149], v28 offset:10304
    ds_read_b64_tr_b16 v[150:151], v28 offset:10560
    ds_read_b64_tr_b16 v[204:205], v28 offset:10336
    ds_read_b64_tr_b16 v[206:207], v28 offset:10592
    s_waitcnt lgkmcnt(0)
    s_mov_b32 s72, 1966080
    s_add_u32 m0, s71, 10240
    s_nop 0
    buffer_load_dwordx4 v24, s[52:55], s72 offen lds
    s_add_u32 m0, s71, 11264
    s_nop 0
    buffer_load_dwordx4 v25, s[52:55], s72 offen lds
    s_add_u32 m0, s71, 12288
    s_nop 0
    buffer_load_dwordx4 v26, s[52:55], s72 offen lds
    s_add_u32 m0, s71, 13312
    s_nop 0
    buffer_load_dwordx4 v27, s[52:55], s72 offen lds
    s_mov_b32 s72, 2359296
    s_add_u32 m0, s71, 28672
    s_nop 0
    buffer_load_dwordx4 v12, s[48:51], s72 offen lds
    s_add_u32 m0, s71, 29696
    s_nop 0
    buffer_load_dwordx4 v13, s[48:51], s72 offen lds
    s_add_u32 m0, s71, 30720
    s_nop 0
    buffer_load_dwordx4 v14, s[48:51], s72 offen lds
    s_mov_b32 s72, 2359296
    s_add_u32 m0, s71, 31744
    s_nop 0
    buffer_load_dwordx4 v24, s[52:55], s72 offen lds
    s_add_u32 m0, s71, 32768
    s_nop 0
    buffer_load_dwordx4 v25, s[52:55], s72 offen lds
    s_add_u32 m0, s71, 33792
    s_nop 0
    buffer_load_dwordx4 v26, s[52:55], s72 offen lds
    s_add_u32 m0, s71, 34816
    s_nop 0
    buffer_load_dwordx4 v27, s[52:55], s72 offen lds
    s_mov_b32 s72, 2752512
    s_add_u32 m0, s71, 35840
    s_nop 0
    buffer_load_dwordx4 v12, s[48:51], s72 offen lds
    s_add_u32 m0, s71, 36864
    s_nop 0
    buffer_load_dwordx4 v13, s[48:51], s72 offen lds
    s_add_u32 m0, s71, 37888
    s_nop 0
    buffer_load_dwordx4 v14, s[48:51], s72 offen lds
    s_mov_b32 s72, 2752512
    s_add_u32 m0, s71, 38912
    s_nop 0
    buffer_load_dwordx4 v24, s[52:55], s72 offen lds
    s_add_u32 m0, s71, 39936
    s_nop 0
    buffer_load_dwordx4 v25, s[52:55], s72 offen lds
    s_add_u32 m0, s71, 40960
    s_nop 0
    buffer_load_dwordx4 v26, s[52:55], s72 offen lds
    s_add_u32 m0, s71, 41984
    s_nop 0
    buffer_load_dwordx4 v27, s[52:55], s72 offen lds
    s_mov_b32 s72, 3145728
    s_add_u32 m0, s71, 43008
    s_nop 0
    buffer_load_dwordx4 v12, s[48:51], s72 offen lds
    s_add_u32 m0, s71, 44032
    s_nop 0
    buffer_load_dwordx4 v13, s[48:51], s72 offen lds
    s_add_u32 m0, s71, 45056
    s_nop 0
    buffer_load_dwordx4 v14, s[48:51], s72 offen lds
    s_mov_b32 s72, 3145728
    s_add_u32 m0, s71, 46080
    s_nop 0
    buffer_load_dwordx4 v24, s[52:55], s72 offen lds
    s_add_u32 m0, s71, 47104
    s_nop 0
    buffer_load_dwordx4 v25, s[52:55], s72 offen lds
    s_add_u32 m0, s71, 48128
    s_nop 0
    buffer_load_dwordx4 v26, s[52:55], s72 offen lds
    s_add_u32 m0, s71, 49152
    s_nop 0
    buffer_load_dwordx4 v27, s[52:55], s72 offen lds
    s_waitcnt vmcnt(46)
    ds_read_b64_tr_b16 a[24:25], v15 offset:14336
    ds_read_b64_tr_b16 a[26:27], v15 offset:14528
    ds_read_b64_tr_b16 a[32:33], v15 offset:14368
    ds_read_b64_tr_b16 a[34:35], v15 offset:14560
    ds_read_b64_tr_b16 a[40:41], v15 offset:14400
    ds_read_b64_tr_b16 a[42:43], v15 offset:14592
    s_waitcnt lgkmcnt(0)
    s_mov_b32 s72, 3538944
    s_add_u32 m0, s71, 14336
    s_nop 0
    buffer_load_dwordx4 v12, s[48:51], s72 offen lds
    s_add_u32 m0, s71, 15360
    s_nop 0
    buffer_load_dwordx4 v13, s[48:51], s72 offen lds
    s_add_u32 m0, s71, 16384
    s_nop 0
    buffer_load_dwordx4 v14, s[48:51], s72 offen lds
    s_waitcnt vmcnt(45)
    ds_read_b64_tr_b16 a[176:177], v28 offset:17408
    ds_read_b64_tr_b16 a[178:179], v28 offset:17664
    ds_read_b64_tr_b16 a[232:233], v28 offset:17440
    ds_read_b64_tr_b16 a[234:235], v28 offset:17696
    ds_read_b64_tr_b16 v[152:153], v28 offset:17472
    ds_read_b64_tr_b16 v[154:155], v28 offset:17728
    ds_read_b64_tr_b16 v[208:209], v28 offset:17504
    ds_read_b64_tr_b16 v[210:211], v28 offset:17760
    s_waitcnt lgkmcnt(0)
    s_mov_b32 s72, 3538944
    s_add_u32 m0, s71, 17408
    s_nop 0
    buffer_load_dwordx4 v24, s[52:55], s72 offen lds
    s_add_u32 m0, s71, 18432
    s_nop 0
    buffer_load_dwordx4 v25, s[52:55], s72 offen lds
    s_add_u32 m0, s71, 19456
    s_nop 0
    buffer_load_dwordx4 v26, s[52:55], s72 offen lds
    s_add_u32 m0, s71, 20480
    s_nop 0
    buffer_load_dwordx4 v27, s[52:55], s72 offen lds
    s_waitcnt vmcnt(46)
    ds_read_b64_tr_b16 a[28:29], v15 offset:21504
    ds_read_b64_tr_b16 a[30:31], v15 offset:21696
    ds_read_b64_tr_b16 a[36:37], v15 offset:21536
    ds_read_b64_tr_b16 a[38:39], v15 offset:21728
    ds_read_b64_tr_b16 a[44:45], v15 offset:21568
    ds_read_b64_tr_b16 a[46:47], v15 offset:21760
    s_waitcnt vmcnt(42)
    ds_read_b64_tr_b16 a[180:181], v28 offset:24576
    ds_read_b64_tr_b16 a[182:183], v28 offset:24832
    ds_read_b64_tr_b16 a[236:237], v28 offset:24608
    ds_read_b64_tr_b16 a[238:239], v28 offset:24864
    ds_read_b64_tr_b16 v[156:157], v28 offset:24640
    ds_read_b64_tr_b16 v[158:159], v28 offset:24896
    ds_read_b64_tr_b16 v[212:213], v28 offset:24672
    ds_read_b64_tr_b16 v[214:215], v28 offset:24928
    s_waitcnt vmcnt(39)
    ds_read_b64_tr_b16 v[52:53], v15 offset:0
    ds_read_b64_tr_b16 v[54:55], v15 offset:192
    ds_read_b64_tr_b16 v[56:57], v15 offset:32
    ds_read_b64_tr_b16 v[58:59], v15 offset:224
    ds_read_b64_tr_b16 v[60:61], v15 offset:64
    ds_read_b64_tr_b16 v[62:63], v15 offset:256
    s_waitcnt lgkmcnt(0)
    ds_write_b128 v3, v[52:55] offset:0
    ds_write_b128 v3, v[56:59] offset:1024
    ds_write_b128 v3, v[60:63] offset:2048
    s_waitcnt lgkmcnt(0)
    s_waitcnt vmcnt(35)
    ds_read_b64_tr_b16 v[52:53], v28 offset:3072
    ds_read_b64_tr_b16 v[54:55], v28 offset:3328
    ds_read_b64_tr_b16 v[56:57], v28 offset:3104
    ds_read_b64_tr_b16 v[58:59], v28 offset:3360
    ds_read_b64_tr_b16 v[60:61], v28 offset:3136
    ds_read_b64_tr_b16 v[62:63], v28 offset:3392
    ds_read_b64_tr_b16 v[64:65], v28 offset:3168
    ds_read_b64_tr_b16 v[66:67], v28 offset:3424
    s_waitcnt lgkmcnt(0)
    ds_write_b128 v3, v[52:55] offset:3072
    ds_write_b128 v3, v[56:59] offset:4096
    ds_write_b128 v3, v[60:63] offset:5120
    ds_write_b128 v3, v[64:67] offset:6144
    s_waitcnt lgkmcnt(0)
    s_waitcnt vmcnt(32)
    ds_read_b64_tr_b16 v[52:53], v15 offset:7168
    ds_read_b64_tr_b16 v[54:55], v15 offset:7360
    ds_read_b64_tr_b16 v[56:57], v15 offset:7200
    ds_read_b64_tr_b16 v[58:59], v15 offset:7392
    ds_read_b64_tr_b16 v[60:61], v15 offset:7232
    ds_read_b64_tr_b16 v[62:63], v15 offset:7424
    s_waitcnt lgkmcnt(0)
    ds_write_b128 v3, v[52:55] offset:7168
    ds_write_b128 v3, v[56:59] offset:8192
    ds_write_b128 v3, v[60:63] offset:9216
    s_waitcnt lgkmcnt(0)
    s_waitcnt vmcnt(28)
    ds_read_b64_tr_b16 v[52:53], v28 offset:10240
    ds_read_b64_tr_b16 v[54:55], v28 offset:10496
    ds_read_b64_tr_b16 v[56:57], v28 offset:10272
    ds_read_b64_tr_b16 v[58:59], v28 offset:10528
    ds_read_b64_tr_b16 v[60:61], v28 offset:10304
    ds_read_b64_tr_b16 v[62:63], v28 offset:10560
    ds_read_b64_tr_b16 v[64:65], v28 offset:10336
    ds_read_b64_tr_b16 v[66:67], v28 offset:10592
    s_waitcnt lgkmcnt(0)
    ds_write_b128 v3, v[52:55] offset:10240
    ds_write_b128 v3, v[56:59] offset:11264
    ds_write_b128 v3, v[60:63] offset:12288
    ds_write_b128 v3, v[64:67] offset:13312
    s_waitcnt lgkmcnt(0)
    s_waitcnt vmcnt(25)
    ds_read_b64_tr_b16 a[48:49], v15 offset:28672
    ds_read_b64_tr_b16 a[50:51], v15 offset:28864
    ds_read_b64_tr_b16 a[88:89], v15 offset:28704
    ds_read_b64_tr_b16 a[90:91], v15 offset:28896
    ds_read_b64_tr_b16 a[128:129], v15 offset:28736
    ds_read_b64_tr_b16 a[130:131], v15 offset:28928
    s_waitcnt vmcnt(21)
    ds_read_b64_tr_b16 a[184:185], v28 offset:31744
    ds_read_b64_tr_b16 a[186:187], v28 offset:32000
    ds_read_b64_tr_b16 a[240:241], v28 offset:31776
    ds_read_b64_tr_b16 a[242:243], v28 offset:32032
    ds_read_b64_tr_b16 v[160:161], v28 offset:31808
    ds_read_b64_tr_b16 v[162:163], v28 offset:32064
    ds_read_b64_tr_b16 v[216:217], v28 offset:31840
    ds_read_b64_tr_b16 v[218:219], v28 offset:32096
    s_waitcnt vmcnt(18)
    ds_read_b64_tr_b16 a[52:53], v15 offset:35840
    ds_read_b64_tr_b16 a[54:55], v15 offset:36032
    ds_read_b64_tr_b16 a[92:93], v15 offset:35872
    ds_read_b64_tr_b16 a[94:95], v15 offset:36064
    ds_read_b64_tr_b16 a[132:133], v15 offset:35904
    ds_read_b64_tr_b16 a[134:135], v15 offset:36096
    s_waitcnt vmcnt(14)
    ds_read_b64_tr_b16 a[188:189], v28 offset:38912
    ds_read_b64_tr_b16 a[190:191], v28 offset:39168
    ds_read_b64_tr_b16 a[244:245], v28 offset:38944
    ds_read_b64_tr_b16 a[246:247], v28 offset:39200
    ds_read_b64_tr_b16 v[164:165], v28 offset:38976
    ds_read_b64_tr_b16 v[166:167], v28 offset:39232
    ds_read_b64_tr_b16 v[220:221], v28 offset:39008
    ds_read_b64_tr_b16 v[222:223], v28 offset:39264
    s_waitcnt vmcnt(11)
    ds_read_b64_tr_b16 a[56:57], v15 offset:43008
    ds_read_b64_tr_b16 a[58:59], v15 offset:43200
    ds_read_b64_tr_b16 a[96:97], v15 offset:43040
    ds_read_b64_tr_b16 a[98:99], v15 offset:43232
    ds_read_b64_tr_b16 a[136:137], v15 offset:43072
    ds_read_b64_tr_b16 a[138:139], v15 offset:43264
    s_waitcnt vmcnt(7)
    ds_read_b64_tr_b16 a[192:193], v28 offset:46080
    ds_read_b64_tr_b16 a[194:195], v28 offset:46336
    ds_read_b64_tr_b16 a[248:249], v28 offset:46112
    ds_read_b64_tr_b16 a[250:251], v28 offset:46368
    ds_read_b64_tr_b16 v[168:169], v28 offset:46144
    ds_read_b64_tr_b16 v[170:171], v28 offset:46400
    ds_read_b64_tr_b16 v[224:225], v28 offset:46176
    ds_read_b64_tr_b16 v[226:227], v28 offset:46432
    s_waitcnt vmcnt(4)
    ds_read_b64_tr_b16 a[60:61], v15 offset:14336
    ds_read_b64_tr_b16 a[62:63], v15 offset:14528
    ds_read_b64_tr_b16 a[100:101], v15 offset:14368
    ds_read_b64_tr_b16 a[102:103], v15 offset:14560
    ds_read_b64_tr_b16 a[140:141], v15 offset:14400
    ds_read_b64_tr_b16 a[142:143], v15 offset:14592
    s_waitcnt lgkmcnt(0)
    s_mov_b32 s72, 3932160
    s_add_u32 m0, s71, 14336
    s_nop 0
    buffer_load_dwordx4 v12, s[48:51], s72 offen lds
    s_add_u32 m0, s71, 15360
    s_nop 0
    buffer_load_dwordx4 v13, s[48:51], s72 offen lds
    s_add_u32 m0, s71, 16384
    s_nop 0
    buffer_load_dwordx4 v14, s[48:51], s72 offen lds
    s_waitcnt vmcnt(3)
    ds_read_b64_tr_b16 a[196:197], v28 offset:17408
    ds_read_b64_tr_b16 a[198:199], v28 offset:17664
    ds_read_b64_tr_b16 a[252:253], v28 offset:17440
    ds_read_b64_tr_b16 a[254:255], v28 offset:17696
    ds_read_b64_tr_b16 v[172:173], v28 offset:17472
    ds_read_b64_tr_b16 v[174:175], v28 offset:17728
    ds_read_b64_tr_b16 v[228:229], v28 offset:17504
    ds_read_b64_tr_b16 v[230:231], v28 offset:17760
    s_waitcnt lgkmcnt(0)
    s_mov_b32 s72, 3932160
    s_add_u32 m0, s71, 17408
    s_nop 0
    buffer_load_dwordx4 v24, s[52:55], s72 offen lds
    s_add_u32 m0, s71, 18432
    s_nop 0
    buffer_load_dwordx4 v25, s[52:55], s72 offen lds
    s_add_u32 m0, s71, 19456
    s_nop 0
    buffer_load_dwordx4 v26, s[52:55], s72 offen lds
    s_add_u32 m0, s71, 20480
    s_nop 0
    buffer_load_dwordx4 v27, s[52:55], s72 offen lds
    s_mov_b32 s72, 4325376
    s_add_u32 m0, s71, 21504
    s_nop 0
    buffer_load_dwordx4 v12, s[48:51], s72 offen lds
    s_add_u32 m0, s71, 22528
    s_nop 0
    buffer_load_dwordx4 v13, s[48:51], s72 offen lds
    s_add_u32 m0, s71, 23552
    s_nop 0
    buffer_load_dwordx4 v14, s[48:51], s72 offen lds
    s_mov_b32 s72, 4325376
    s_add_u32 m0, s71, 24576
    s_nop 0
    buffer_load_dwordx4 v24, s[52:55], s72 offen lds
    s_add_u32 m0, s71, 25600
    s_nop 0
    buffer_load_dwordx4 v25, s[52:55], s72 offen lds
    s_add_u32 m0, s71, 26624
    s_nop 0
    buffer_load_dwordx4 v26, s[52:55], s72 offen lds
    s_add_u32 m0, s71, 27648
    s_nop 0
    buffer_load_dwordx4 v27, s[52:55], s72 offen lds
    s_mov_b32 s72, 4718592
    s_add_u32 m0, s71, 28672
    s_nop 0
    buffer_load_dwordx4 v12, s[48:51], s72 offen lds
    s_add_u32 m0, s71, 29696
    s_nop 0
    buffer_load_dwordx4 v13, s[48:51], s72 offen lds
    s_add_u32 m0, s71, 30720
    s_nop 0
    buffer_load_dwordx4 v14, s[48:51], s72 offen lds
    s_mov_b32 s72, 4718592
    s_add_u32 m0, s71, 31744
    s_nop 0
    buffer_load_dwordx4 v24, s[52:55], s72 offen lds
    s_add_u32 m0, s71, 32768
    s_nop 0
    buffer_load_dwordx4 v25, s[52:55], s72 offen lds
    s_add_u32 m0, s71, 33792
    s_nop 0
    buffer_load_dwordx4 v26, s[52:55], s72 offen lds
    s_add_u32 m0, s71, 34816
    s_nop 0
    buffer_load_dwordx4 v27, s[52:55], s72 offen lds
    s_mov_b32 s72, 5111808
    s_add_u32 m0, s71, 35840
    s_nop 0
    buffer_load_dwordx4 v12, s[48:51], s72 offen lds
    s_add_u32 m0, s71, 36864
    s_nop 0
    buffer_load_dwordx4 v13, s[48:51], s72 offen lds
    s_add_u32 m0, s71, 37888
    s_nop 0
    buffer_load_dwordx4 v14, s[48:51], s72 offen lds
    s_mov_b32 s72, 5111808
    s_add_u32 m0, s71, 38912
    s_nop 0
    buffer_load_dwordx4 v24, s[52:55], s72 offen lds
    s_add_u32 m0, s71, 39936
    s_nop 0
    buffer_load_dwordx4 v25, s[52:55], s72 offen lds
    s_add_u32 m0, s71, 40960
    s_nop 0
    buffer_load_dwordx4 v26, s[52:55], s72 offen lds
    s_add_u32 m0, s71, 41984
    s_nop 0
    buffer_load_dwordx4 v27, s[52:55], s72 offen lds
    s_mov_b32 s72, 5505024
    s_add_u32 m0, s71, 43008
    s_nop 0
    buffer_load_dwordx4 v12, s[48:51], s72 offen lds
    s_add_u32 m0, s71, 44032
    s_nop 0
    buffer_load_dwordx4 v13, s[48:51], s72 offen lds
    s_add_u32 m0, s71, 45056
    s_nop 0
    buffer_load_dwordx4 v14, s[48:51], s72 offen lds
    s_mov_b32 s72, 5505024
    s_add_u32 m0, s71, 46080
    s_nop 0
    buffer_load_dwordx4 v24, s[52:55], s72 offen lds
    s_add_u32 m0, s71, 47104
    s_nop 0
    buffer_load_dwordx4 v25, s[52:55], s72 offen lds
    s_add_u32 m0, s71, 48128
    s_nop 0
    buffer_load_dwordx4 v26, s[52:55], s72 offen lds
    s_add_u32 m0, s71, 49152
    s_nop 0
    buffer_load_dwordx4 v27, s[52:55], s72 offen lds
    s_waitcnt vmcnt(32)
    ds_read_b64_tr_b16 v[52:53], v15 offset:14336
    ds_read_b64_tr_b16 v[54:55], v15 offset:14528
    ds_read_b64_tr_b16 v[56:57], v15 offset:14368
    ds_read_b64_tr_b16 v[58:59], v15 offset:14560
    ds_read_b64_tr_b16 v[60:61], v15 offset:14400
    ds_read_b64_tr_b16 v[62:63], v15 offset:14592
    s_waitcnt lgkmcnt(0)
    ds_write_b128 v3, v[52:55] offset:14336
    ds_write_b128 v3, v[56:59] offset:15360
    ds_write_b128 v3, v[60:63] offset:16384
    s_waitcnt lgkmcnt(0)
    s_waitcnt vmcnt(28)
    ds_read_b64_tr_b16 v[52:53], v28 offset:17408
    ds_read_b64_tr_b16 v[54:55], v28 offset:17664
    ds_read_b64_tr_b16 v[56:57], v28 offset:17440
    ds_read_b64_tr_b16 v[58:59], v28 offset:17696
    ds_read_b64_tr_b16 v[60:61], v28 offset:17472
    ds_read_b64_tr_b16 v[62:63], v28 offset:17728
    ds_read_b64_tr_b16 v[64:65], v28 offset:17504
    ds_read_b64_tr_b16 v[66:67], v28 offset:17760
    s_waitcnt lgkmcnt(0)
    ds_write_b128 v3, v[52:55] offset:17408
    ds_write_b128 v3, v[56:59] offset:18432
    ds_write_b128 v3, v[60:63] offset:19456
    ds_write_b128 v3, v[64:67] offset:20480
    s_waitcnt lgkmcnt(0)
    s_waitcnt vmcnt(25)
    ds_read_b64_tr_b16 v[52:53], v15 offset:21504
    ds_read_b64_tr_b16 v[54:55], v15 offset:21696
    ds_read_b64_tr_b16 v[56:57], v15 offset:21536
    ds_read_b64_tr_b16 v[58:59], v15 offset:21728
    ds_read_b64_tr_b16 v[60:61], v15 offset:21568
    ds_read_b64_tr_b16 v[62:63], v15 offset:21760
    s_waitcnt lgkmcnt(0)
    ds_write_b128 v3, v[52:55] offset:21504
    ds_write_b128 v3, v[56:59] offset:22528
    ds_write_b128 v3, v[60:63] offset:23552
    s_waitcnt lgkmcnt(0)
    s_waitcnt vmcnt(21)
    ds_read_b64_tr_b16 v[52:53], v28 offset:24576
    ds_read_b64_tr_b16 v[54:55], v28 offset:24832
    ds_read_b64_tr_b16 v[56:57], v28 offset:24608
    ds_read_b64_tr_b16 v[58:59], v28 offset:24864
    ds_read_b64_tr_b16 v[60:61], v28 offset:24640
    ds_read_b64_tr_b16 v[62:63], v28 offset:24896
    ds_read_b64_tr_b16 v[64:65], v28 offset:24672
    ds_read_b64_tr_b16 v[66:67], v28 offset:24928
    s_waitcnt lgkmcnt(0)
    ds_write_b128 v3, v[52:55] offset:24576
    ds_write_b128 v3, v[56:59] offset:25600
    ds_write_b128 v3, v[60:63] offset:26624
    ds_write_b128 v3, v[64:67] offset:27648
    s_waitcnt lgkmcnt(0)
    s_waitcnt vmcnt(18)
    ds_read_b64_tr_b16 a[64:65], v15 offset:28672
    ds_read_b64_tr_b16 a[66:67], v15 offset:28864
    ds_read_b64_tr_b16 a[104:105], v15 offset:28704
    ds_read_b64_tr_b16 a[106:107], v15 offset:28896
    ds_read_b64_tr_b16 a[144:145], v15 offset:28736
    ds_read_b64_tr_b16 a[146:147], v15 offset:28928
    s_waitcnt lgkmcnt(0)
    s_mov_b32 s72, 5898240
    s_add_u32 m0, s71, 28672
    s_nop 0
    buffer_load_dwordx4 v12, s[48:51], s72 offen lds
    s_add_u32 m0, s71, 29696
    s_nop 0
    buffer_load_dwordx4 v13, s[48:51], s72 offen lds
    s_add_u32 m0, s71, 30720
    s_nop 0
    buffer_load_dwordx4 v14, s[48:51], s72 offen lds
    s_waitcnt vmcnt(17)
    ds_read_b64_tr_b16 a[200:201], v28 offset:31744
    ds_read_b64_tr_b16 a[202:203], v28 offset:32000
    ds_read_b64_tr_b16 v[120:121], v28 offset:31776
    ds_read_b64_tr_b16 v[122:123], v28 offset:32032
    ds_read_b64_tr_b16 v[176:177], v28 offset:31808
    ds_read_b64_tr_b16 v[178:179], v28 offset:32064
    ds_read_b64_tr_b16 v[232:233], v28 offset:31840
    ds_read_b64_tr_b16 v[234:235], v28 offset:32096
    s_waitcnt lgkmcnt(0)
    s_mov_b32 s72, 5898240
    s_add_u32 m0, s71, 31744
    s_nop 0
    buffer_load_dwordx4 v24, s[52:55], s72 offen lds
    s_add_u32 m0, s71, 32768
    s_nop 0
    buffer_load_dwordx4 v25, s[52:55], s72 offen lds
    s_add_u32 m0, s71, 33792
    s_nop 0
    buffer_load_dwordx4 v26, s[52:55], s72 offen lds
    s_add_u32 m0, s71, 34816
    s_nop 0
    buffer_load_dwordx4 v27, s[52:55], s72 offen lds
    s_waitcnt vmcnt(18)
    ds_read_b64_tr_b16 a[68:69], v15 offset:35840
    ds_read_b64_tr_b16 a[70:71], v15 offset:36032
    ds_read_b64_tr_b16 a[108:109], v15 offset:35872
    ds_read_b64_tr_b16 a[110:111], v15 offset:36064
    ds_read_b64_tr_b16 a[148:149], v15 offset:35904
    ds_read_b64_tr_b16 a[150:151], v15 offset:36096
    s_waitcnt lgkmcnt(0)
    s_mov_b32 s72, 7077888
    s_add_u32 m0, s71, 35840
    s_nop 0
    buffer_load_dwordx4 v12, s[48:51], s72 offen lds
    s_add_u32 m0, s71, 36864
    s_nop 0
    buffer_load_dwordx4 v13, s[48:51], s72 offen lds
    s_add_u32 m0, s71, 37888
    s_nop 0
    buffer_load_dwordx4 v14, s[48:51], s72 offen lds
    s_waitcnt vmcnt(17)
    ds_read_b64_tr_b16 a[204:205], v28 offset:38912
    ds_read_b64_tr_b16 a[206:207], v28 offset:39168
    ds_read_b64_tr_b16 v[124:125], v28 offset:38944
    ds_read_b64_tr_b16 v[126:127], v28 offset:39200
    ds_read_b64_tr_b16 v[180:181], v28 offset:38976
    ds_read_b64_tr_b16 v[182:183], v28 offset:39232
    ds_read_b64_tr_b16 v[236:237], v28 offset:39008
    ds_read_b64_tr_b16 v[238:239], v28 offset:39264
    s_waitcnt lgkmcnt(0)
    s_mov_b32 s72, 7077888
    s_add_u32 m0, s71, 38912
    s_nop 0
    buffer_load_dwordx4 v24, s[52:55], s72 offen lds
    s_add_u32 m0, s71, 39936
    s_nop 0
    buffer_load_dwordx4 v25, s[52:55], s72 offen lds
    s_add_u32 m0, s71, 40960
    s_nop 0
    buffer_load_dwordx4 v26, s[52:55], s72 offen lds
    s_add_u32 m0, s71, 41984
    s_nop 0
    buffer_load_dwordx4 v27, s[52:55], s72 offen lds
    s_waitcnt vmcnt(18)
    ds_read_b64_tr_b16 a[72:73], v15 offset:43008
    ds_read_b64_tr_b16 a[74:75], v15 offset:43200
    ds_read_b64_tr_b16 a[112:113], v15 offset:43040
    ds_read_b64_tr_b16 a[114:115], v15 offset:43232
    ds_read_b64_tr_b16 a[152:153], v15 offset:43072
    ds_read_b64_tr_b16 a[154:155], v15 offset:43264
    s_waitcnt lgkmcnt(0)
    s_mov_b32 s72, 7471104
    s_add_u32 m0, s71, 43008
    s_nop 0
    buffer_load_dwordx4 v12, s[48:51], s72 offen lds
    s_add_u32 m0, s71, 44032
    s_nop 0
    buffer_load_dwordx4 v13, s[48:51], s72 offen lds
    s_add_u32 m0, s71, 45056
    s_nop 0
    buffer_load_dwordx4 v14, s[48:51], s72 offen lds
    s_waitcnt vmcnt(17)
    ds_read_b64_tr_b16 a[208:209], v28 offset:46080
    ds_read_b64_tr_b16 a[210:211], v28 offset:46336
    ds_read_b64_tr_b16 v[128:129], v28 offset:46112
    ds_read_b64_tr_b16 v[130:131], v28 offset:46368
    ds_read_b64_tr_b16 v[184:185], v28 offset:46144
    ds_read_b64_tr_b16 v[186:187], v28 offset:46400
    ds_read_b64_tr_b16 v[240:241], v28 offset:46176
    ds_read_b64_tr_b16 v[242:243], v28 offset:46432
    s_waitcnt lgkmcnt(0)
    s_mov_b32 s72, 7471104
    s_add_u32 m0, s71, 46080
    s_nop 0
    buffer_load_dwordx4 v24, s[52:55], s72 offen lds
    s_add_u32 m0, s71, 47104
    s_nop 0
    buffer_load_dwordx4 v25, s[52:55], s72 offen lds
    s_add_u32 m0, s71, 48128
    s_nop 0
    buffer_load_dwordx4 v26, s[52:55], s72 offen lds
    s_add_u32 m0, s71, 49152
    s_nop 0
    buffer_load_dwordx4 v27, s[52:55], s72 offen lds
    s_waitcnt vmcnt(18)
    ds_read_b64_tr_b16 a[76:77], v15 offset:28672
    ds_read_b64_tr_b16 a[78:79], v15 offset:28864
    ds_read_b64_tr_b16 a[116:117], v15 offset:28704
    ds_read_b64_tr_b16 a[118:119], v15 offset:28896
    ds_read_b64_tr_b16 a[156:157], v15 offset:28736
    ds_read_b64_tr_b16 a[158:159], v15 offset:28928
    s_waitcnt lgkmcnt(0)
    s_mov_b32 s72, 6291456
    s_add_u32 m0, s71, 28672
    s_nop 0
    buffer_load_dwordx4 v12, s[48:51], s72 offen lds
    s_add_u32 m0, s71, 29696
    s_nop 0
    buffer_load_dwordx4 v13, s[48:51], s72 offen lds
    s_add_u32 m0, s71, 30720
    s_nop 0
    buffer_load_dwordx4 v14, s[48:51], s72 offen lds
    s_waitcnt vmcnt(17)
    ds_read_b64_tr_b16 a[212:213], v28 offset:31744
    ds_read_b64_tr_b16 a[214:215], v28 offset:32000
    ds_read_b64_tr_b16 v[132:133], v28 offset:31776
    ds_read_b64_tr_b16 v[134:135], v28 offset:32032
    ds_read_b64_tr_b16 v[188:189], v28 offset:31808
    ds_read_b64_tr_b16 v[190:191], v28 offset:32064
    ds_read_b64_tr_b16 v[244:245], v28 offset:31840
    ds_read_b64_tr_b16 v[246:247], v28 offset:32096
    s_waitcnt lgkmcnt(0)
    s_mov_b32 s72, 6291456
    s_add_u32 m0, s71, 31744
    s_nop 0
    buffer_load_dwordx4 v24, s[52:55], s72 offen lds
    s_add_u32 m0, s71, 32768
    s_nop 0
    buffer_load_dwordx4 v25, s[52:55], s72 offen lds
    s_add_u32 m0, s71, 33792
    s_nop 0
    buffer_load_dwordx4 v26, s[52:55], s72 offen lds
    s_add_u32 m0, s71, 34816
    s_nop 0
    buffer_load_dwordx4 v27, s[52:55], s72 offen lds
    s_waitcnt vmcnt(18)
    ds_read_b64_tr_b16 a[80:81], v15 offset:35840
    ds_read_b64_tr_b16 a[82:83], v15 offset:36032
    ds_read_b64_tr_b16 a[120:121], v15 offset:35872
    ds_read_b64_tr_b16 a[122:123], v15 offset:36064
    ds_read_b64_tr_b16 a[160:161], v15 offset:35904
    ds_read_b64_tr_b16 a[162:163], v15 offset:36096
    s_waitcnt lgkmcnt(0)
    s_mov_b32 s72, 6684672
    s_add_u32 m0, s71, 35840
    s_nop 0
    buffer_load_dwordx4 v12, s[48:51], s72 offen lds
    s_add_u32 m0, s71, 36864
    s_nop 0
    buffer_load_dwordx4 v13, s[48:51], s72 offen lds
    s_add_u32 m0, s71, 37888
    s_nop 0
    buffer_load_dwordx4 v14, s[48:51], s72 offen lds
    s_waitcnt vmcnt(17)
    ds_read_b64_tr_b16 a[216:217], v28 offset:38912
    ds_read_b64_tr_b16 a[218:219], v28 offset:39168
    ds_read_b64_tr_b16 v[136:137], v28 offset:38944
    ds_read_b64_tr_b16 v[138:139], v28 offset:39200
    ds_read_b64_tr_b16 v[192:193], v28 offset:38976
    ds_read_b64_tr_b16 v[194:195], v28 offset:39232
    ds_read_b64_tr_b16 v[248:249], v28 offset:39008
    ds_read_b64_tr_b16 v[250:251], v28 offset:39264
    s_waitcnt lgkmcnt(0)
    s_mov_b32 s72, 6684672
    s_add_u32 m0, s71, 38912
    s_nop 0
    buffer_load_dwordx4 v24, s[52:55], s72 offen lds
    s_add_u32 m0, s71, 39936
    s_nop 0
    buffer_load_dwordx4 v25, s[52:55], s72 offen lds
    s_add_u32 m0, s71, 40960
    s_nop 0
    buffer_load_dwordx4 v26, s[52:55], s72 offen lds
    s_add_u32 m0, s71, 41984
    s_nop 0
    buffer_load_dwordx4 v27, s[52:55], s72 offen lds
    s_waitcnt vmcnt(18)
    ds_read_b64_tr_b16 a[84:85], v15 offset:43008
    ds_read_b64_tr_b16 a[86:87], v15 offset:43200
    ds_read_b64_tr_b16 a[124:125], v15 offset:43040
    ds_read_b64_tr_b16 a[126:127], v15 offset:43232
    ds_read_b64_tr_b16 a[164:165], v15 offset:43072
    ds_read_b64_tr_b16 a[166:167], v15 offset:43264
    s_waitcnt vmcnt(14)
    ds_read_b64_tr_b16 a[220:221], v28 offset:46080
    ds_read_b64_tr_b16 a[222:223], v28 offset:46336
    ds_read_b64_tr_b16 v[140:141], v28 offset:46112
    ds_read_b64_tr_b16 v[142:143], v28 offset:46368
    ds_read_b64_tr_b16 v[196:197], v28 offset:46144
    ds_read_b64_tr_b16 v[198:199], v28 offset:46400
    ds_read_b64_tr_b16 v[252:253], v28 offset:46176
    ds_read_b64_tr_b16 v[254:255], v28 offset:46432
    s_waitcnt vmcnt(11)
    ds_read_b64_tr_b16 v[52:53], v15 offset:28672
    ds_read_b64_tr_b16 v[54:55], v15 offset:28864
    ds_read_b64_tr_b16 v[56:57], v15 offset:28704
    ds_read_b64_tr_b16 v[58:59], v15 offset:28896
    ds_read_b64_tr_b16 v[60:61], v15 offset:28736
    ds_read_b64_tr_b16 v[62:63], v15 offset:28928
    s_waitcnt lgkmcnt(0)
    ds_write_b128 v3, v[52:55] offset:28672
    ds_write_b128 v3, v[56:59] offset:29696
    ds_write_b128 v3, v[60:63] offset:30720
    s_waitcnt lgkmcnt(0)
    s_waitcnt vmcnt(7)
    ds_read_b64_tr_b16 v[52:53], v28 offset:31744
    ds_read_b64_tr_b16 v[54:55], v28 offset:32000
    ds_read_b64_tr_b16 v[56:57], v28 offset:31776
    ds_read_b64_tr_b16 v[58:59], v28 offset:32032
    ds_read_b64_tr_b16 v[60:61], v28 offset:31808
    ds_read_b64_tr_b16 v[62:63], v28 offset:32064
    ds_read_b64_tr_b16 v[64:65], v28 offset:31840
    ds_read_b64_tr_b16 v[66:67], v28 offset:32096
    s_waitcnt lgkmcnt(0)
    ds_write_b128 v3, v[52:55] offset:31744
    ds_write_b128 v3, v[56:59] offset:32768
    ds_write_b128 v3, v[60:63] offset:33792
    ds_write_b128 v3, v[64:67] offset:34816
    s_waitcnt lgkmcnt(0)
    s_waitcnt vmcnt(4)
    ds_read_b64_tr_b16 v[52:53], v15 offset:35840
    ds_read_b64_tr_b16 v[54:55], v15 offset:36032
    ds_read_b64_tr_b16 v[56:57], v15 offset:35872
    ds_read_b64_tr_b16 v[58:59], v15 offset:36064
    ds_read_b64_tr_b16 v[60:61], v15 offset:35904
    ds_read_b64_tr_b16 v[62:63], v15 offset:36096
    s_waitcnt lgkmcnt(0)
    ds_write_b128 v3, v[52:55] offset:35840
    ds_write_b128 v3, v[56:59] offset:36864
    ds_write_b128 v3, v[60:63] offset:37888
    s_waitcnt lgkmcnt(0)
    s_waitcnt vmcnt(0)
    ds_read_b64_tr_b16 v[52:53], v28 offset:38912
    ds_read_b64_tr_b16 v[54:55], v28 offset:39168
    ds_read_b64_tr_b16 v[56:57], v28 offset:38944
    ds_read_b64_tr_b16 v[58:59], v28 offset:39200
    ds_read_b64_tr_b16 v[60:61], v28 offset:38976
    ds_read_b64_tr_b16 v[62:63], v28 offset:39232
    ds_read_b64_tr_b16 v[64:65], v28 offset:39008
    ds_read_b64_tr_b16 v[66:67], v28 offset:39264
    s_waitcnt lgkmcnt(0)
    ds_write_b128 v3, v[52:55] offset:38912
    ds_write_b128 v3, v[56:59] offset:39936
    ds_write_b128 v3, v[60:63] offset:40960
    ds_write_b128 v3, v[64:67] offset:41984
    s_waitcnt lgkmcnt(0)
    s_waitcnt lgkmcnt(0)
    s_branch L_pwj_47
L_pwv_49:
    s_mov_b32 s72, 0
    s_add_u32 m0, s71, 0
    s_nop 0
    buffer_load_dwordx4 v12, s[48:51], s72 offen lds
    s_add_u32 m0, s71, 1024
    s_nop 0
    buffer_load_dwordx4 v13, s[48:51], s72 offen lds
    s_add_u32 m0, s71, 2048
    s_nop 0
    buffer_load_dwordx4 v14, s[48:51], s72 offen lds
    s_mov_b32 s72, 0
    s_add_u32 m0, s71, 3072
    s_nop 0
    buffer_load_dwordx4 v24, s[52:55], s72 offen lds
    s_add_u32 m0, s71, 4096
    s_nop 0
    buffer_load_dwordx4 v25, s[52:55], s72 offen lds
    s_add_u32 m0, s71, 5120
    s_nop 0
    buffer_load_dwordx4 v26, s[52:55], s72 offen lds
    s_add_u32 m0, s71, 6144
    s_nop 0
    buffer_load_dwordx4 v27, s[52:55], s72 offen lds
    s_mov_b32 s72, 393216
    s_add_u32 m0, s71, 7168
    s_nop 0
    buffer_load_dwordx4 v12, s[48:51], s72 offen lds
    s_add_u32 m0, s71, 8192
    s_nop 0
    buffer_load_dwordx4 v13, s[48:51], s72 offen lds
    s_add_u32 m0, s71, 9216
    s_nop 0
    buffer_load_dwordx4 v14, s[48:51], s72 offen lds
    s_mov_b32 s72, 393216
    s_add_u32 m0, s71, 10240
    s_nop 0
    buffer_load_dwordx4 v24, s[52:55], s72 offen lds
    s_add_u32 m0, s71, 11264
    s_nop 0
    buffer_load_dwordx4 v25, s[52:55], s72 offen lds
    s_add_u32 m0, s71, 12288
    s_nop 0
    buffer_load_dwordx4 v26, s[52:55], s72 offen lds
    s_add_u32 m0, s71, 13312
    s_nop 0
    buffer_load_dwordx4 v27, s[52:55], s72 offen lds
    s_mov_b32 s72, 786432
    s_add_u32 m0, s71, 14336
    s_nop 0
    buffer_load_dwordx4 v12, s[48:51], s72 offen lds
    s_add_u32 m0, s71, 15360
    s_nop 0
    buffer_load_dwordx4 v13, s[48:51], s72 offen lds
    s_add_u32 m0, s71, 16384
    s_nop 0
    buffer_load_dwordx4 v14, s[48:51], s72 offen lds
    s_mov_b32 s72, 786432
    s_add_u32 m0, s71, 17408
    s_nop 0
    buffer_load_dwordx4 v24, s[52:55], s72 offen lds
    s_add_u32 m0, s71, 18432
    s_nop 0
    buffer_load_dwordx4 v25, s[52:55], s72 offen lds
    s_add_u32 m0, s71, 19456
    s_nop 0
    buffer_load_dwordx4 v26, s[52:55], s72 offen lds
    s_add_u32 m0, s71, 20480
    s_nop 0
    buffer_load_dwordx4 v27, s[52:55], s72 offen lds
    s_mov_b32 s72, 1179648
    s_add_u32 m0, s71, 21504
    s_nop 0
    buffer_load_dwordx4 v12, s[48:51], s72 offen lds
    s_add_u32 m0, s71, 22528
    s_nop 0
    buffer_load_dwordx4 v13, s[48:51], s72 offen lds
    s_add_u32 m0, s71, 23552
    s_nop 0
    buffer_load_dwordx4 v14, s[48:51], s72 offen lds
    s_mov_b32 s72, 1179648
    s_add_u32 m0, s71, 24576
    s_nop 0
    buffer_load_dwordx4 v24, s[52:55], s72 offen lds
    s_add_u32 m0, s71, 25600
    s_nop 0
    buffer_load_dwordx4 v25, s[52:55], s72 offen lds
    s_add_u32 m0, s71, 26624
    s_nop 0
    buffer_load_dwordx4 v26, s[52:55], s72 offen lds
    s_add_u32 m0, s71, 27648
    s_nop 0
    buffer_load_dwordx4 v27, s[52:55], s72 offen lds
    s_mov_b32 s72, 1572864
    s_add_u32 m0, s71, 28672
    s_nop 0
    buffer_load_dwordx4 v12, s[48:51], s72 offen lds
    s_add_u32 m0, s71, 29696
    s_nop 0
    buffer_load_dwordx4 v13, s[48:51], s72 offen lds
    s_add_u32 m0, s71, 30720
    s_nop 0
    buffer_load_dwordx4 v14, s[48:51], s72 offen lds
    s_mov_b32 s72, 1572864
    s_add_u32 m0, s71, 31744
    s_nop 0
    buffer_load_dwordx4 v24, s[52:55], s72 offen lds
    s_add_u32 m0, s71, 32768
    s_nop 0
    buffer_load_dwordx4 v25, s[52:55], s72 offen lds
    s_add_u32 m0, s71, 33792
    s_nop 0
    buffer_load_dwordx4 v26, s[52:55], s72 offen lds
    s_add_u32 m0, s71, 34816
    s_nop 0
    buffer_load_dwordx4 v27, s[52:55], s72 offen lds
    s_mov_b32 s72, 1966080
    s_add_u32 m0, s71, 35840
    s_nop 0
    buffer_load_dwordx4 v12, s[48:51], s72 offen lds
    s_add_u32 m0, s71, 36864
    s_nop 0
    buffer_load_dwordx4 v13, s[48:51], s72 offen lds
    s_add_u32 m0, s71, 37888
    s_nop 0
    buffer_load_dwordx4 v14, s[48:51], s72 offen lds
    s_mov_b32 s72, 1966080
    s_add_u32 m0, s71, 38912
    s_nop 0
    buffer_load_dwordx4 v24, s[52:55], s72 offen lds
    s_add_u32 m0, s71, 39936
    s_nop 0
    buffer_load_dwordx4 v25, s[52:55], s72 offen lds
    s_add_u32 m0, s71, 40960
    s_nop 0
    buffer_load_dwordx4 v26, s[52:55], s72 offen lds
    s_add_u32 m0, s71, 41984
    s_nop 0
    buffer_load_dwordx4 v27, s[52:55], s72 offen lds
    s_mov_b32 s72, 2359296
    s_add_u32 m0, s71, 43008
    s_nop 0
    buffer_load_dwordx4 v12, s[48:51], s72 offen lds
    s_add_u32 m0, s71, 44032
    s_nop 0
    buffer_load_dwordx4 v13, s[48:51], s72 offen lds
    s_add_u32 m0, s71, 45056
    s_nop 0
    buffer_load_dwordx4 v14, s[48:51], s72 offen lds
    s_mov_b32 s72, 2359296
    s_add_u32 m0, s71, 46080
    s_nop 0
    buffer_load_dwordx4 v24, s[52:55], s72 offen lds
    s_add_u32 m0, s71, 47104
    s_nop 0
    buffer_load_dwordx4 v25, s[52:55], s72 offen lds
    s_add_u32 m0, s71, 48128
    s_nop 0
    buffer_load_dwordx4 v26, s[52:55], s72 offen lds
    s_add_u32 m0, s71, 49152
    s_nop 0
    buffer_load_dwordx4 v27, s[52:55], s72 offen lds
    s_waitcnt vmcnt(46)
    s_barrier
    ds_read_b64_tr_b16 a[64:65], v15 offset:0
    ds_read_b64_tr_b16 a[66:67], v15 offset:192
    ds_read_b64_tr_b16 a[104:105], v15 offset:32
    ds_read_b64_tr_b16 a[106:107], v15 offset:224
    ds_read_b64_tr_b16 a[144:145], v15 offset:64
    ds_read_b64_tr_b16 a[146:147], v15 offset:256
    s_waitcnt lgkmcnt(0)
    s_mov_b32 s72, 2752512
    s_add_u32 m0, s71, 0
    s_nop 0
    buffer_load_dwordx4 v12, s[48:51], s72 offen lds
    s_add_u32 m0, s71, 1024
    s_nop 0
    buffer_load_dwordx4 v13, s[48:51], s72 offen lds
    s_add_u32 m0, s71, 2048
    s_nop 0
    buffer_load_dwordx4 v14, s[48:51], s72 offen lds
    s_waitcnt vmcnt(45)
    ds_read_b64_tr_b16 a[200:201], v28 offset:3072
    ds_read_b64_tr_b16 a[202:203], v28 offset:3328
    ds_read_b64_tr_b16 v[120:121], v28 offset:3104
    ds_read_b64_tr_b16 v[122:123], v28 offset:3360
    ds_read_b64_tr_b16 v[176:177], v28 offset:3136
    ds_read_b64_tr_b16 v[178:179], v28 offset:3392
    ds_read_b64_tr_b16 v[232:233], v28 offset:3168
    ds_read_b64_tr_b16 v[234:235], v28 offset:3424
    s_waitcnt lgkmcnt(0)
    s_mov_b32 s72, 2752512
    s_add_u32 m0, s71, 3072
    s_nop 0
    buffer_load_dwordx4 v24, s[52:55], s72 offen lds
    s_add_u32 m0, s71, 4096
    s_nop 0
    buffer_load_dwordx4 v25, s[52:55], s72 offen lds
    s_add_u32 m0, s71, 5120
    s_nop 0
    buffer_load_dwordx4 v26, s[52:55], s72 offen lds
    s_add_u32 m0, s71, 6144
    s_nop 0
    buffer_load_dwordx4 v27, s[52:55], s72 offen lds
    s_waitcnt vmcnt(46)
    ds_read_b64_tr_b16 a[68:69], v15 offset:7168
    ds_read_b64_tr_b16 a[70:71], v15 offset:7360
    ds_read_b64_tr_b16 a[108:109], v15 offset:7200
    ds_read_b64_tr_b16 a[110:111], v15 offset:7392
    ds_read_b64_tr_b16 a[148:149], v15 offset:7232
    ds_read_b64_tr_b16 a[150:151], v15 offset:7424
    s_waitcnt lgkmcnt(0)
    s_mov_b32 s72, 3145728
    s_add_u32 m0, s71, 7168
    s_nop 0
    buffer_load_dwordx4 v12, s[48:51], s72 offen lds
    s_add_u32 m0, s71, 8192
    s_nop 0
    buffer_load_dwordx4 v13, s[48:51], s72 offen lds
    s_add_u32 m0, s71, 9216
    s_nop 0
    buffer_load_dwordx4 v14, s[48:51], s72 offen lds
    s_waitcnt vmcnt(45)
    ds_read_b64_tr_b16 a[204:205], v28 offset:10240
    ds_read_b64_tr_b16 a[206:207], v28 offset:10496
    ds_read_b64_tr_b16 v[124:125], v28 offset:10272
    ds_read_b64_tr_b16 v[126:127], v28 offset:10528
    ds_read_b64_tr_b16 v[180:181], v28 offset:10304
    ds_read_b64_tr_b16 v[182:183], v28 offset:10560
    ds_read_b64_tr_b16 v[236:237], v28 offset:10336
    ds_read_b64_tr_b16 v[238:239], v28 offset:10592
    s_waitcnt lgkmcnt(0)
    s_mov_b32 s72, 3145728
    s_add_u32 m0, s71, 10240
    s_nop 0
    buffer_load_dwordx4 v24, s[52:55], s72 offen lds
    s_add_u32 m0, s71, 11264
    s_nop 0
    buffer_load_dwordx4 v25, s[52:55], s72 offen lds
    s_add_u32 m0, s71, 12288
    s_nop 0
    buffer_load_dwordx4 v26, s[52:55], s72 offen lds
    s_add_u32 m0, s71, 13312
    s_nop 0
    buffer_load_dwordx4 v27, s[52:55], s72 offen lds
    s_waitcnt vmcnt(46)
    ds_read_b64_tr_b16 a[72:73], v15 offset:14336
    ds_read_b64_tr_b16 a[74:75], v15 offset:14528
    ds_read_b64_tr_b16 a[112:113], v15 offset:14368
    ds_read_b64_tr_b16 a[114:115], v15 offset:14560
    ds_read_b64_tr_b16 a[152:153], v15 offset:14400
    ds_read_b64_tr_b16 a[154:155], v15 offset:14592
    s_waitcnt lgkmcnt(0)
    s_mov_b32 s72, 3538944
    s_add_u32 m0, s71, 14336
    s_nop 0
    buffer_load_dwordx4 v12, s[48:51], s72 offen lds
    s_add_u32 m0, s71, 15360
    s_nop 0
    buffer_load_dwordx4 v13, s[48:51], s72 offen lds
    s_add_u32 m0, s71, 16384
    s_nop 0
    buffer_load_dwordx4 v14, s[48:51], s72 offen lds
    s_waitcnt vmcnt(45)
    ds_read_b64_tr_b16 a[208:209], v28 offset:17408
    ds_read_b64_tr_b16 a[210:211], v28 offset:17664
    ds_read_b64_tr_b16 v[128:129], v28 offset:17440
    ds_read_b64_tr_b16 v[130:131], v28 offset:17696
    ds_read_b64_tr_b16 v[184:185], v28 offset:17472
    ds_read_b64_tr_b16 v[186:187], v28 offset:17728
    ds_read_b64_tr_b16 v[240:241], v28 offset:17504
    ds_read_b64_tr_b16 v[242:243], v28 offset:17760
    s_waitcnt lgkmcnt(0)
    s_mov_b32 s72, 3538944
    s_add_u32 m0, s71, 17408
    s_nop 0
    buffer_load_dwordx4 v24, s[52:55], s72 offen lds
    s_add_u32 m0, s71, 18432
    s_nop 0
    buffer_load_dwordx4 v25, s[52:55], s72 offen lds
    s_add_u32 m0, s71, 19456
    s_nop 0
    buffer_load_dwordx4 v26, s[52:55], s72 offen lds
    s_add_u32 m0, s71, 20480
    s_nop 0
    buffer_load_dwordx4 v27, s[52:55], s72 offen lds
    s_waitcnt vmcnt(46)
    ds_read_b64_tr_b16 a[76:77], v15 offset:21504
    ds_read_b64_tr_b16 a[78:79], v15 offset:21696
    ds_read_b64_tr_b16 a[116:117], v15 offset:21536
    ds_read_b64_tr_b16 a[118:119], v15 offset:21728
    ds_read_b64_tr_b16 a[156:157], v15 offset:21568
    ds_read_b64_tr_b16 a[158:159], v15 offset:21760
    s_waitcnt lgkmcnt(0)
    s_mov_b32 s72, 3932160
    s_add_u32 m0, s71, 21504
    s_nop 0
    buffer_load_dwordx4 v12, s[48:51], s72 offen lds
    s_add_u32 m0, s71, 22528
    s_nop 0
    buffer_load_dwordx4 v13, s[48:51], s72 offen lds
    s_add_u32 m0, s71, 23552
    s_nop 0
    buffer_load_dwordx4 v14, s[48:51], s72 offen lds
    s_waitcnt vmcnt(45)
    ds_read_b64_tr_b16 a[212:213], v28 offset:24576
    ds_read_b64_tr_b16 a[214:215], v28 offset:24832
    ds_read_b64_tr_b16 v[132:133], v28 offset:24608
    ds_read_b64_tr_b16 v[134:135], v28 offset:24864
    ds_read_b64_tr_b16 v[188:189], v28 offset:24640
    ds_read_b64_tr_b16 v[190:191], v28 offset:24896
    ds_read_b64_tr_b16 v[244:245], v28 offset:24672
    ds_read_b64_tr_b16 v[246:247], v28 offset:24928
    s_waitcnt lgkmcnt(0)
    s_mov_b32 s72, 3932160
    s_add_u32 m0, s71, 24576
    s_nop 0
    buffer_load_dwordx4 v24, s[52:55], s72 offen lds
    s_add_u32 m0, s71, 25600
    s_nop 0
    buffer_load_dwordx4 v25, s[52:55], s72 offen lds
    s_add_u32 m0, s71, 26624
    s_nop 0
    buffer_load_dwordx4 v26, s[52:55], s72 offen lds
    s_add_u32 m0, s71, 27648
    s_nop 0
    buffer_load_dwordx4 v27, s[52:55], s72 offen lds
    s_waitcnt vmcnt(46)
    ds_read_b64_tr_b16 v[52:53], v15 offset:28672
    ds_read_b64_tr_b16 v[54:55], v15 offset:28864
    ds_read_b64_tr_b16 v[56:57], v15 offset:28704
    ds_read_b64_tr_b16 v[58:59], v15 offset:28896
    ds_read_b64_tr_b16 v[60:61], v15 offset:28736
    ds_read_b64_tr_b16 v[62:63], v15 offset:28928
    s_waitcnt lgkmcnt(0)
    ds_write_b128 v3, v[52:55] offset:28672
    ds_write_b128 v3, v[56:59] offset:29696
    ds_write_b128 v3, v[60:63] offset:30720
    s_waitcnt lgkmcnt(0)
    s_waitcnt vmcnt(42)
    ds_read_b64_tr_b16 v[52:53], v28 offset:31744
    ds_read_b64_tr_b16 v[54:55], v28 offset:32000
    ds_read_b64_tr_b16 v[56:57], v28 offset:31776
    ds_read_b64_tr_b16 v[58:59], v28 offset:32032
    ds_read_b64_tr_b16 v[60:61], v28 offset:31808
    ds_read_b64_tr_b16 v[62:63], v28 offset:32064
    ds_read_b64_tr_b16 v[64:65], v28 offset:31840
    ds_read_b64_tr_b16 v[66:67], v28 offset:32096
    s_waitcnt lgkmcnt(0)
    ds_write_b128 v3, v[52:55] offset:31744
    ds_write_b128 v3, v[56:59] offset:32768
    ds_write_b128 v3, v[60:63] offset:33792
    ds_write_b128 v3, v[64:67] offset:34816
    s_waitcnt lgkmcnt(0)
    s_waitcnt vmcnt(39)
    ds_read_b64_tr_b16 v[52:53], v15 offset:35840
    ds_read_b64_tr_b16 v[54:55], v15 offset:36032
    ds_read_b64_tr_b16 v[56:57], v15 offset:35872
    ds_read_b64_tr_b16 v[58:59], v15 offset:36064
    ds_read_b64_tr_b16 v[60:61], v15 offset:35904
    ds_read_b64_tr_b16 v[62:63], v15 offset:36096
    s_waitcnt lgkmcnt(0)
    ds_write_b128 v3, v[52:55] offset:35840
    ds_write_b128 v3, v[56:59] offset:36864
    ds_write_b128 v3, v[60:63] offset:37888
    s_waitcnt lgkmcnt(0)
    s_waitcnt vmcnt(35)
    ds_read_b64_tr_b16 v[52:53], v28 offset:38912
    ds_read_b64_tr_b16 v[54:55], v28 offset:39168
    ds_read_b64_tr_b16 v[56:57], v28 offset:38944
    ds_read_b64_tr_b16 v[58:59], v28 offset:39200
    ds_read_b64_tr_b16 v[60:61], v28 offset:38976
    ds_read_b64_tr_b16 v[62:63], v28 offset:39232
    ds_read_b64_tr_b16 v[64:65], v28 offset:39008
    ds_read_b64_tr_b16 v[66:67], v28 offset:39264
    s_waitcnt lgkmcnt(0)
    ds_write_b128 v3, v[52:55] offset:38912
    ds_write_b128 v3, v[56:59] offset:39936
    ds_write_b128 v3, v[60:63] offset:40960
    ds_write_b128 v3, v[64:67] offset:41984
    s_waitcnt lgkmcnt(0)
    s_waitcnt vmcnt(32)
    ds_read_b64_tr_b16 a[80:81], v15 offset:43008
    ds_read_b64_tr_b16 a[82:83], v15 offset:43200
    ds_read_b64_tr_b16 a[120:121], v15 offset:43040
    ds_read_b64_tr_b16 a[122:123], v15 offset:43232
    ds_read_b64_tr_b16 a[160:161], v15 offset:43072
    ds_read_b64_tr_b16 a[162:163], v15 offset:43264
    s_waitcnt lgkmcnt(0)
    s_mov_b32 s72, 4325376
    s_add_u32 m0, s71, 43008
    s_nop 0
    buffer_load_dwordx4 v12, s[48:51], s72 offen lds
    s_add_u32 m0, s71, 44032
    s_nop 0
    buffer_load_dwordx4 v13, s[48:51], s72 offen lds
    s_add_u32 m0, s71, 45056
    s_nop 0
    buffer_load_dwordx4 v14, s[48:51], s72 offen lds
    s_waitcnt vmcnt(31)
    ds_read_b64_tr_b16 a[216:217], v28 offset:46080
    ds_read_b64_tr_b16 a[218:219], v28 offset:46336
    ds_read_b64_tr_b16 v[136:137], v28 offset:46112
    ds_read_b64_tr_b16 v[138:139], v28 offset:46368
    ds_read_b64_tr_b16 v[192:193], v28 offset:46144
    ds_read_b64_tr_b16 v[194:195], v28 offset:46400
    ds_read_b64_tr_b16 v[248:249], v28 offset:46176
    ds_read_b64_tr_b16 v[250:251], v28 offset:46432
    s_waitcnt lgkmcnt(0)
    s_mov_b32 s72, 4325376
    s_add_u32 m0, s71, 46080
    s_nop 0
    buffer_load_dwordx4 v24, s[52:55], s72 offen lds
    s_add_u32 m0, s71, 47104
    s_nop 0
    buffer_load_dwordx4 v25, s[52:55], s72 offen lds
    s_add_u32 m0, s71, 48128
    s_nop 0
    buffer_load_dwordx4 v26, s[52:55], s72 offen lds
    s_add_u32 m0, s71, 49152
    s_nop 0
    buffer_load_dwordx4 v27, s[52:55], s72 offen lds
    s_waitcnt vmcnt(32)
    ds_read_b64_tr_b16 a[84:85], v15 offset:0
    ds_read_b64_tr_b16 a[86:87], v15 offset:192
    ds_read_b64_tr_b16 a[124:125], v15 offset:32
    ds_read_b64_tr_b16 a[126:127], v15 offset:224
    ds_read_b64_tr_b16 a[164:165], v15 offset:64
    ds_read_b64_tr_b16 a[166:167], v15 offset:256
    s_waitcnt lgkmcnt(0)
    s_mov_b32 s72, 4718592
    s_add_u32 m0, s71, 0
    s_nop 0
    buffer_load_dwordx4 v12, s[48:51], s72 offen lds
    s_add_u32 m0, s71, 1024
    s_nop 0
    buffer_load_dwordx4 v13, s[48:51], s72 offen lds
    s_add_u32 m0, s71, 2048
    s_nop 0
    buffer_load_dwordx4 v14, s[48:51], s72 offen lds
    s_waitcnt vmcnt(31)
    ds_read_b64_tr_b16 a[220:221], v28 offset:3072
    ds_read_b64_tr_b16 a[222:223], v28 offset:3328
    ds_read_b64_tr_b16 v[140:141], v28 offset:3104
    ds_read_b64_tr_b16 v[142:143], v28 offset:3360
    ds_read_b64_tr_b16 v[196:197], v28 offset:3136
    ds_read_b64_tr_b16 v[198:199], v28 offset:3392
    ds_read_b64_tr_b16 v[252:253], v28 offset:3168
    ds_read_b64_tr_b16 v[254:255], v28 offset:3424
    s_waitcnt lgkmcnt(0)
    s_mov_b32 s72, 4718592
    s_add_u32 m0, s71, 3072
    s_nop 0
    buffer_load_dwordx4 v24, s[52:55], s72 offen lds
    s_add_u32 m0, s71, 4096
    s_nop 0
    buffer_load_dwordx4 v25, s[52:55], s72 offen lds
    s_add_u32 m0, s71, 5120
    s_nop 0
    buffer_load_dwordx4 v26, s[52:55], s72 offen lds
    s_add_u32 m0, s71, 6144
    s_nop 0
    buffer_load_dwordx4 v27, s[52:55], s72 offen lds
    s_waitcnt vmcnt(32)
    ds_read_b64_tr_b16 a[0:1], v15 offset:7168
    ds_read_b64_tr_b16 a[2:3], v15 offset:7360
    ds_read_b64_tr_b16 a[8:9], v15 offset:7200
    ds_read_b64_tr_b16 a[10:11], v15 offset:7392
    ds_read_b64_tr_b16 a[16:17], v15 offset:7232
    ds_read_b64_tr_b16 a[18:19], v15 offset:7424
    s_waitcnt lgkmcnt(0)
    s_mov_b32 s72, 5111808
    s_add_u32 m0, s71, 7168
    s_nop 0
    buffer_load_dwordx4 v12, s[48:51], s72 offen lds
    s_add_u32 m0, s71, 8192
    s_nop 0
    buffer_load_dwordx4 v13, s[48:51], s72 offen lds
    s_add_u32 m0, s71, 9216
    s_nop 0
    buffer_load_dwordx4 v14, s[48:51], s72 offen lds
    s_waitcnt vmcnt(31)
    ds_read_b64_tr_b16 a[168:169], v28 offset:10240
    ds_read_b64_tr_b16 a[170:171], v28 offset:10496
    ds_read_b64_tr_b16 a[224:225], v28 offset:10272
    ds_read_b64_tr_b16 a[226:227], v28 offset:10528
    ds_read_b64_tr_b16 v[144:145], v28 offset:10304
    ds_read_b64_tr_b16 v[146:147], v28 offset:10560
    ds_read_b64_tr_b16 v[200:201], v28 offset:10336
    ds_read_b64_tr_b16 v[202:203], v28 offset:10592
    s_waitcnt lgkmcnt(0)
    s_mov_b32 s72, 5111808
    s_add_u32 m0, s71, 10240
    s_nop 0
    buffer_load_dwordx4 v24, s[52:55], s72 offen lds
    s_add_u32 m0, s71, 11264
    s_nop 0
    buffer_load_dwordx4 v25, s[52:55], s72 offen lds
    s_add_u32 m0, s71, 12288
    s_nop 0
    buffer_load_dwordx4 v26, s[52:55], s72 offen lds
    s_add_u32 m0, s71, 13312
    s_nop 0
    buffer_load_dwordx4 v27, s[52:55], s72 offen lds
    s_waitcnt vmcnt(32)
    ds_read_b64_tr_b16 a[4:5], v15 offset:14336
    ds_read_b64_tr_b16 a[6:7], v15 offset:14528
    ds_read_b64_tr_b16 a[12:13], v15 offset:14368
    ds_read_b64_tr_b16 a[14:15], v15 offset:14560
    ds_read_b64_tr_b16 a[20:21], v15 offset:14400
    ds_read_b64_tr_b16 a[22:23], v15 offset:14592
    s_waitcnt lgkmcnt(0)
    s_mov_b32 s72, 5505024
    s_add_u32 m0, s71, 14336
    s_nop 0
    buffer_load_dwordx4 v12, s[48:51], s72 offen lds
    s_add_u32 m0, s71, 15360
    s_nop 0
    buffer_load_dwordx4 v13, s[48:51], s72 offen lds
    s_add_u32 m0, s71, 16384
    s_nop 0
    buffer_load_dwordx4 v14, s[48:51], s72 offen lds
    s_waitcnt vmcnt(31)
    ds_read_b64_tr_b16 a[172:173], v28 offset:17408
    ds_read_b64_tr_b16 a[174:175], v28 offset:17664
    ds_read_b64_tr_b16 a[228:229], v28 offset:17440
    ds_read_b64_tr_b16 a[230:231], v28 offset:17696
    ds_read_b64_tr_b16 v[148:149], v28 offset:17472
    ds_read_b64_tr_b16 v[150:151], v28 offset:17728
    ds_read_b64_tr_b16 v[204:205], v28 offset:17504
    ds_read_b64_tr_b16 v[206:207], v28 offset:17760
    s_waitcnt lgkmcnt(0)
    s_mov_b32 s72, 5505024
    s_add_u32 m0, s71, 17408
    s_nop 0
    buffer_load_dwordx4 v24, s[52:55], s72 offen lds
    s_add_u32 m0, s71, 18432
    s_nop 0
    buffer_load_dwordx4 v25, s[52:55], s72 offen lds
    s_add_u32 m0, s71, 19456
    s_nop 0
    buffer_load_dwordx4 v26, s[52:55], s72 offen lds
    s_add_u32 m0, s71, 20480
    s_nop 0
    buffer_load_dwordx4 v27, s[52:55], s72 offen lds
    s_waitcnt vmcnt(32)
    ds_read_b64_tr_b16 a[24:25], v15 offset:21504
    ds_read_b64_tr_b16 a[26:27], v15 offset:21696
    ds_read_b64_tr_b16 a[32:33], v15 offset:21536
    ds_read_b64_tr_b16 a[34:35], v15 offset:21728
    ds_read_b64_tr_b16 a[40:41], v15 offset:21568
    ds_read_b64_tr_b16 a[42:43], v15 offset:21760
    s_waitcnt lgkmcnt(0)
    s_mov_b32 s72, 5898240
    s_add_u32 m0, s71, 21504
    s_nop 0
    buffer_load_dwordx4 v12, s[48:51], s72 offen lds
    s_add_u32 m0, s71, 22528
    s_nop 0
    buffer_load_dwordx4 v13, s[48:51], s72 offen lds
    s_add_u32 m0, s71, 23552
    s_nop 0
    buffer_load_dwordx4 v14, s[48:51], s72 offen lds
    s_waitcnt vmcnt(31)
    ds_read_b64_tr_b16 a[176:177], v28 offset:24576
    ds_read_b64_tr_b16 a[178:179], v28 offset:24832
    ds_read_b64_tr_b16 a[232:233], v28 offset:24608
    ds_read_b64_tr_b16 a[234:235], v28 offset:24864
    ds_read_b64_tr_b16 v[152:153], v28 offset:24640
    ds_read_b64_tr_b16 v[154:155], v28 offset:24896
    ds_read_b64_tr_b16 v[208:209], v28 offset:24672
    ds_read_b64_tr_b16 v[210:211], v28 offset:24928
    s_waitcnt lgkmcnt(0)
    s_mov_b32 s72, 5898240
    s_add_u32 m0, s71, 24576
    s_nop 0
    buffer_load_dwordx4 v24, s[52:55], s72 offen lds
    s_add_u32 m0, s71, 25600
    s_nop 0
    buffer_load_dwordx4 v25, s[52:55], s72 offen lds
    s_add_u32 m0, s71, 26624
    s_nop 0
    buffer_load_dwordx4 v26, s[52:55], s72 offen lds
    s_add_u32 m0, s71, 27648
    s_nop 0
    buffer_load_dwordx4 v27, s[52:55], s72 offen lds
    s_waitcnt vmcnt(32)
    ds_read_b64_tr_b16 a[28:29], v15 offset:43008
    ds_read_b64_tr_b16 a[30:31], v15 offset:43200
    ds_read_b64_tr_b16 a[36:37], v15 offset:43040
    ds_read_b64_tr_b16 a[38:39], v15 offset:43232
    ds_read_b64_tr_b16 a[44:45], v15 offset:43072
    ds_read_b64_tr_b16 a[46:47], v15 offset:43264
    s_waitcnt lgkmcnt(0)
    s_mov_b32 s72, 6291456
    s_add_u32 m0, s71, 43008
    s_nop 0
    buffer_load_dwordx4 v12, s[48:51], s72 offen lds
    s_add_u32 m0, s71, 44032
    s_nop 0
    buffer_load_dwordx4 v13, s[48:51], s72 offen lds
    s_add_u32 m0, s71, 45056
    s_nop 0
    buffer_load_dwordx4 v14, s[48:51], s72 offen lds
    s_waitcnt vmcnt(31)
    ds_read_b64_tr_b16 a[180:181], v28 offset:46080
    ds_read_b64_tr_b16 a[182:183], v28 offset:46336
    ds_read_b64_tr_b16 a[236:237], v28 offset:46112
    ds_read_b64_tr_b16 a[238:239], v28 offset:46368
    ds_read_b64_tr_b16 v[156:157], v28 offset:46144
    ds_read_b64_tr_b16 v[158:159], v28 offset:46400
    ds_read_b64_tr_b16 v[212:213], v28 offset:46176
    ds_read_b64_tr_b16 v[214:215], v28 offset:46432
    s_waitcnt lgkmcnt(0)
    s_mov_b32 s72, 6291456
    s_add_u32 m0, s71, 46080
    s_nop 0
    buffer_load_dwordx4 v24, s[52:55], s72 offen lds
    s_add_u32 m0, s71, 47104
    s_nop 0
    buffer_load_dwordx4 v25, s[52:55], s72 offen lds
    s_add_u32 m0, s71, 48128
    s_nop 0
    buffer_load_dwordx4 v26, s[52:55], s72 offen lds
    s_add_u32 m0, s71, 49152
    s_nop 0
    buffer_load_dwordx4 v27, s[52:55], s72 offen lds
    s_waitcnt vmcnt(32)
    ds_read_b64_tr_b16 v[52:53], v15 offset:0
    ds_read_b64_tr_b16 v[54:55], v15 offset:192
    ds_read_b64_tr_b16 v[56:57], v15 offset:32
    ds_read_b64_tr_b16 v[58:59], v15 offset:224
    ds_read_b64_tr_b16 v[60:61], v15 offset:64
    ds_read_b64_tr_b16 v[62:63], v15 offset:256
    s_waitcnt lgkmcnt(0)
    ds_write_b128 v3, v[52:55] offset:0
    ds_write_b128 v3, v[56:59] offset:1024
    ds_write_b128 v3, v[60:63] offset:2048
    s_waitcnt lgkmcnt(0)
    s_waitcnt vmcnt(28)
    ds_read_b64_tr_b16 v[52:53], v28 offset:3072
    ds_read_b64_tr_b16 v[54:55], v28 offset:3328
    ds_read_b64_tr_b16 v[56:57], v28 offset:3104
    ds_read_b64_tr_b16 v[58:59], v28 offset:3360
    ds_read_b64_tr_b16 v[60:61], v28 offset:3136
    ds_read_b64_tr_b16 v[62:63], v28 offset:3392
    ds_read_b64_tr_b16 v[64:65], v28 offset:3168
    ds_read_b64_tr_b16 v[66:67], v28 offset:3424
    s_waitcnt lgkmcnt(0)
    ds_write_b128 v3, v[52:55] offset:3072
    ds_write_b128 v3, v[56:59] offset:4096
    ds_write_b128 v3, v[60:63] offset:5120
    ds_write_b128 v3, v[64:67] offset:6144
    s_waitcnt lgkmcnt(0)
    s_waitcnt vmcnt(25)
    ds_read_b64_tr_b16 v[52:53], v15 offset:7168
    ds_read_b64_tr_b16 v[54:55], v15 offset:7360
    ds_read_b64_tr_b16 v[56:57], v15 offset:7200
    ds_read_b64_tr_b16 v[58:59], v15 offset:7392
    ds_read_b64_tr_b16 v[60:61], v15 offset:7232
    ds_read_b64_tr_b16 v[62:63], v15 offset:7424
    s_waitcnt lgkmcnt(0)
    ds_write_b128 v3, v[52:55] offset:7168
    ds_write_b128 v3, v[56:59] offset:8192
    ds_write_b128 v3, v[60:63] offset:9216
    s_waitcnt lgkmcnt(0)
    s_waitcnt vmcnt(21)
    ds_read_b64_tr_b16 v[52:53], v28 offset:10240
    ds_read_b64_tr_b16 v[54:55], v28 offset:10496
    ds_read_b64_tr_b16 v[56:57], v28 offset:10272
    ds_read_b64_tr_b16 v[58:59], v28 offset:10528
    ds_read_b64_tr_b16 v[60:61], v28 offset:10304
    ds_read_b64_tr_b16 v[62:63], v28 offset:10560
    ds_read_b64_tr_b16 v[64:65], v28 offset:10336
    ds_read_b64_tr_b16 v[66:67], v28 offset:10592
    s_waitcnt lgkmcnt(0)
    ds_write_b128 v3, v[52:55] offset:10240
    ds_write_b128 v3, v[56:59] offset:11264
    ds_write_b128 v3, v[60:63] offset:12288
    ds_write_b128 v3, v[64:67] offset:13312
    s_waitcnt lgkmcnt(0)
    s_waitcnt vmcnt(18)
    ds_read_b64_tr_b16 a[48:49], v15 offset:14336
    ds_read_b64_tr_b16 a[50:51], v15 offset:14528
    ds_read_b64_tr_b16 a[88:89], v15 offset:14368
    ds_read_b64_tr_b16 a[90:91], v15 offset:14560
    ds_read_b64_tr_b16 a[128:129], v15 offset:14400
    ds_read_b64_tr_b16 a[130:131], v15 offset:14592
    s_waitcnt lgkmcnt(0)
    s_mov_b32 s72, 6684672
    s_add_u32 m0, s71, 14336
    s_nop 0
    buffer_load_dwordx4 v12, s[48:51], s72 offen lds
    s_add_u32 m0, s71, 15360
    s_nop 0
    buffer_load_dwordx4 v13, s[48:51], s72 offen lds
    s_add_u32 m0, s71, 16384
    s_nop 0
    buffer_load_dwordx4 v14, s[48:51], s72 offen lds
    s_waitcnt vmcnt(17)
    ds_read_b64_tr_b16 a[184:185], v28 offset:17408
    ds_read_b64_tr_b16 a[186:187], v28 offset:17664
    ds_read_b64_tr_b16 a[240:241], v28 offset:17440
    ds_read_b64_tr_b16 a[242:243], v28 offset:17696
    ds_read_b64_tr_b16 v[160:161], v28 offset:17472
    ds_read_b64_tr_b16 v[162:163], v28 offset:17728
    ds_read_b64_tr_b16 v[216:217], v28 offset:17504
    ds_read_b64_tr_b16 v[218:219], v28 offset:17760
    s_waitcnt lgkmcnt(0)
    s_mov_b32 s72, 6684672
    s_add_u32 m0, s71, 17408
    s_nop 0
    buffer_load_dwordx4 v24, s[52:55], s72 offen lds
    s_add_u32 m0, s71, 18432
    s_nop 0
    buffer_load_dwordx4 v25, s[52:55], s72 offen lds
    s_add_u32 m0, s71, 19456
    s_nop 0
    buffer_load_dwordx4 v26, s[52:55], s72 offen lds
    s_add_u32 m0, s71, 20480
    s_nop 0
    buffer_load_dwordx4 v27, s[52:55], s72 offen lds
    s_waitcnt vmcnt(18)
    ds_read_b64_tr_b16 a[52:53], v15 offset:21504
    ds_read_b64_tr_b16 a[54:55], v15 offset:21696
    ds_read_b64_tr_b16 a[92:93], v15 offset:21536
    ds_read_b64_tr_b16 a[94:95], v15 offset:21728
    ds_read_b64_tr_b16 a[132:133], v15 offset:21568
    ds_read_b64_tr_b16 a[134:135], v15 offset:21760
    s_waitcnt vmcnt(14)
    ds_read_b64_tr_b16 a[188:189], v28 offset:24576
    ds_read_b64_tr_b16 a[190:191], v28 offset:24832
    ds_read_b64_tr_b16 a[244:245], v28 offset:24608
    ds_read_b64_tr_b16 a[246:247], v28 offset:24864
    ds_read_b64_tr_b16 v[164:165], v28 offset:24640
    ds_read_b64_tr_b16 v[166:167], v28 offset:24896
    ds_read_b64_tr_b16 v[220:221], v28 offset:24672
    ds_read_b64_tr_b16 v[222:223], v28 offset:24928
    s_waitcnt vmcnt(11)
    ds_read_b64_tr_b16 a[56:57], v15 offset:43008
    ds_read_b64_tr_b16 a[58:59], v15 offset:43200
    ds_read_b64_tr_b16 a[96:97], v15 offset:43040
    ds_read_b64_tr_b16 a[98:99], v15 offset:43232
    ds_read_b64_tr_b16 a[136:137], v15 offset:43072
    ds_read_b64_tr_b16 a[138:139], v15 offset:43264
    s_waitcnt vmcnt(7)
    ds_read_b64_tr_b16 a[192:193], v28 offset:46080
    ds_read_b64_tr_b16 a[194:195], v28 offset:46336
    ds_read_b64_tr_b16 a[248:249], v28 offset:46112
    ds_read_b64_tr_b16 a[250:251], v28 offset:46368
    ds_read_b64_tr_b16 v[168:169], v28 offset:46144
    ds_read_b64_tr_b16 v[170:171], v28 offset:46400
    ds_read_b64_tr_b16 v[224:225], v28 offset:46176
    ds_read_b64_tr_b16 v[226:227], v28 offset:46432
    s_waitcnt vmcnt(4)
    ds_read_b64_tr_b16 a[60:61], v15 offset:14336
    ds_read_b64_tr_b16 a[62:63], v15 offset:14528
    ds_read_b64_tr_b16 a[100:101], v15 offset:14368
    ds_read_b64_tr_b16 a[102:103], v15 offset:14560
    ds_read_b64_tr_b16 a[140:141], v15 offset:14400
    ds_read_b64_tr_b16 a[142:143], v15 offset:14592
    s_waitcnt lgkmcnt(0)
    s_mov_b32 s72, 7077888
    s_add_u32 m0, s71, 14336
    s_nop 0
    buffer_load_dwordx4 v12, s[48:51], s72 offen lds
    s_add_u32 m0, s71, 15360
    s_nop 0
    buffer_load_dwordx4 v13, s[48:51], s72 offen lds
    s_add_u32 m0, s71, 16384
    s_nop 0
    buffer_load_dwordx4 v14, s[48:51], s72 offen lds
    s_waitcnt vmcnt(3)
    ds_read_b64_tr_b16 a[196:197], v28 offset:17408
    ds_read_b64_tr_b16 a[198:199], v28 offset:17664
    ds_read_b64_tr_b16 a[252:253], v28 offset:17440
    ds_read_b64_tr_b16 a[254:255], v28 offset:17696
    ds_read_b64_tr_b16 v[172:173], v28 offset:17472
    ds_read_b64_tr_b16 v[174:175], v28 offset:17728
    ds_read_b64_tr_b16 v[228:229], v28 offset:17504
    ds_read_b64_tr_b16 v[230:231], v28 offset:17760
    s_waitcnt lgkmcnt(0)
    s_mov_b32 s72, 7077888
    s_add_u32 m0, s71, 17408
    s_nop 0
    buffer_load_dwordx4 v24, s[52:55], s72 offen lds
    s_add_u32 m0, s71, 18432
    s_nop 0
    buffer_load_dwordx4 v25, s[52:55], s72 offen lds
    s_add_u32 m0, s71, 19456
    s_nop 0
    buffer_load_dwordx4 v26, s[52:55], s72 offen lds
    s_add_u32 m0, s71, 20480
    s_nop 0
    buffer_load_dwordx4 v27, s[52:55], s72 offen lds
    s_mov_b32 s72, 7471104
    s_add_u32 m0, s71, 21504
    s_nop 0
    buffer_load_dwordx4 v12, s[48:51], s72 offen lds
    s_add_u32 m0, s71, 22528
    s_nop 0
    buffer_load_dwordx4 v13, s[48:51], s72 offen lds
    s_add_u32 m0, s71, 23552
    s_nop 0
    buffer_load_dwordx4 v14, s[48:51], s72 offen lds
    s_mov_b32 s72, 7471104
    s_add_u32 m0, s71, 24576
    s_nop 0
    buffer_load_dwordx4 v24, s[52:55], s72 offen lds
    s_add_u32 m0, s71, 25600
    s_nop 0
    buffer_load_dwordx4 v25, s[52:55], s72 offen lds
    s_add_u32 m0, s71, 26624
    s_nop 0
    buffer_load_dwordx4 v26, s[52:55], s72 offen lds
    s_add_u32 m0, s71, 27648
    s_nop 0
    buffer_load_dwordx4 v27, s[52:55], s72 offen lds
    s_waitcnt vmcnt(11)
    ds_read_b64_tr_b16 v[52:53], v15 offset:14336
    ds_read_b64_tr_b16 v[54:55], v15 offset:14528
    ds_read_b64_tr_b16 v[56:57], v15 offset:14368
    ds_read_b64_tr_b16 v[58:59], v15 offset:14560
    ds_read_b64_tr_b16 v[60:61], v15 offset:14400
    ds_read_b64_tr_b16 v[62:63], v15 offset:14592
    s_waitcnt lgkmcnt(0)
    ds_write_b128 v3, v[52:55] offset:14336
    ds_write_b128 v3, v[56:59] offset:15360
    ds_write_b128 v3, v[60:63] offset:16384
    s_waitcnt lgkmcnt(0)
    s_waitcnt vmcnt(7)
    ds_read_b64_tr_b16 v[52:53], v28 offset:17408
    ds_read_b64_tr_b16 v[54:55], v28 offset:17664
    ds_read_b64_tr_b16 v[56:57], v28 offset:17440
    ds_read_b64_tr_b16 v[58:59], v28 offset:17696
    ds_read_b64_tr_b16 v[60:61], v28 offset:17472
    ds_read_b64_tr_b16 v[62:63], v28 offset:17728
    ds_read_b64_tr_b16 v[64:65], v28 offset:17504
    ds_read_b64_tr_b16 v[66:67], v28 offset:17760
    s_waitcnt lgkmcnt(0)
    ds_write_b128 v3, v[52:55] offset:17408
    ds_write_b128 v3, v[56:59] offset:18432
    ds_write_b128 v3, v[60:63] offset:19456
    ds_write_b128 v3, v[64:67] offset:20480
    s_waitcnt lgkmcnt(0)
    s_waitcnt vmcnt(4)
    ds_read_b64_tr_b16 v[52:53], v15 offset:21504
    ds_read_b64_tr_b16 v[54:55], v15 offset:21696
    ds_read_b64_tr_b16 v[56:57], v15 offset:21536
    ds_read_b64_tr_b16 v[58:59], v15 offset:21728
    ds_read_b64_tr_b16 v[60:61], v15 offset:21568
    ds_read_b64_tr_b16 v[62:63], v15 offset:21760
    s_waitcnt lgkmcnt(0)
    ds_write_b128 v3, v[52:55] offset:21504
    ds_write_b128 v3, v[56:59] offset:22528
    ds_write_b128 v3, v[60:63] offset:23552
    s_waitcnt lgkmcnt(0)
    s_waitcnt vmcnt(0)
    ds_read_b64_tr_b16 v[52:53], v28 offset:24576
    ds_read_b64_tr_b16 v[54:55], v28 offset:24832
    ds_read_b64_tr_b16 v[56:57], v28 offset:24608
    ds_read_b64_tr_b16 v[58:59], v28 offset:24864
    ds_read_b64_tr_b16 v[60:61], v28 offset:24640
    ds_read_b64_tr_b16 v[62:63], v28 offset:24896
    ds_read_b64_tr_b16 v[64:65], v28 offset:24672
    ds_read_b64_tr_b16 v[66:67], v28 offset:24928
    s_waitcnt lgkmcnt(0)
    ds_write_b128 v3, v[52:55] offset:24576
    ds_write_b128 v3, v[56:59] offset:25600
    ds_write_b128 v3, v[60:63] offset:26624
    ds_write_b128 v3, v[64:67] offset:27648
    s_waitcnt lgkmcnt(0)
    s_waitcnt lgkmcnt(0)
    s_branch L_pwj_47
L_pwv_50:
    s_mov_b32 s72, 0
    s_add_u32 m0, s71, 0
    s_nop 0
    buffer_load_dwordx4 v12, s[48:51], s72 offen lds
    s_add_u32 m0, s71, 1024
    s_nop 0
    buffer_load_dwordx4 v13, s[48:51], s72 offen lds
    s_add_u32 m0, s71, 2048
    s_nop 0
    buffer_load_dwordx4 v14, s[48:51], s72 offen lds
    s_mov_b32 s72, 0
    s_add_u32 m0, s71, 3072
    s_nop 0
    buffer_load_dwordx4 v24, s[52:55], s72 offen lds
    s_add_u32 m0, s71, 4096
    s_nop 0
    buffer_load_dwordx4 v25, s[52:55], s72 offen lds
    s_add_u32 m0, s71, 5120
    s_nop 0
    buffer_load_dwordx4 v26, s[52:55], s72 offen lds
    s_add_u32 m0, s71, 6144
    s_nop 0
    buffer_load_dwordx4 v27, s[52:55], s72 offen lds
    s_mov_b32 s72, 393216
    s_add_u32 m0, s71, 7168
    s_nop 0
    buffer_load_dwordx4 v12, s[48:51], s72 offen lds
    s_add_u32 m0, s71, 8192
    s_nop 0
    buffer_load_dwordx4 v13, s[48:51], s72 offen lds
    s_add_u32 m0, s71, 9216
    s_nop 0
    buffer_load_dwordx4 v14, s[48:51], s72 offen lds
    s_mov_b32 s72, 393216
    s_add_u32 m0, s71, 10240
    s_nop 0
    buffer_load_dwordx4 v24, s[52:55], s72 offen lds
    s_add_u32 m0, s71, 11264
    s_nop 0
    buffer_load_dwordx4 v25, s[52:55], s72 offen lds
    s_add_u32 m0, s71, 12288
    s_nop 0
    buffer_load_dwordx4 v26, s[52:55], s72 offen lds
    s_add_u32 m0, s71, 13312
    s_nop 0
    buffer_load_dwordx4 v27, s[52:55], s72 offen lds
    s_mov_b32 s72, 786432
    s_add_u32 m0, s71, 14336
    s_nop 0
    buffer_load_dwordx4 v12, s[48:51], s72 offen lds
    s_add_u32 m0, s71, 15360
    s_nop 0
    buffer_load_dwordx4 v13, s[48:51], s72 offen lds
    s_add_u32 m0, s71, 16384
    s_nop 0
    buffer_load_dwordx4 v14, s[48:51], s72 offen lds
    s_mov_b32 s72, 786432
    s_add_u32 m0, s71, 17408
    s_nop 0
    buffer_load_dwordx4 v24, s[52:55], s72 offen lds
    s_add_u32 m0, s71, 18432
    s_nop 0
    buffer_load_dwordx4 v25, s[52:55], s72 offen lds
    s_add_u32 m0, s71, 19456
    s_nop 0
    buffer_load_dwordx4 v26, s[52:55], s72 offen lds
    s_add_u32 m0, s71, 20480
    s_nop 0
    buffer_load_dwordx4 v27, s[52:55], s72 offen lds
    s_mov_b32 s72, 1179648
    s_add_u32 m0, s71, 21504
    s_nop 0
    buffer_load_dwordx4 v12, s[48:51], s72 offen lds
    s_add_u32 m0, s71, 22528
    s_nop 0
    buffer_load_dwordx4 v13, s[48:51], s72 offen lds
    s_add_u32 m0, s71, 23552
    s_nop 0
    buffer_load_dwordx4 v14, s[48:51], s72 offen lds
    s_mov_b32 s72, 1179648
    s_add_u32 m0, s71, 24576
    s_nop 0
    buffer_load_dwordx4 v24, s[52:55], s72 offen lds
    s_add_u32 m0, s71, 25600
    s_nop 0
    buffer_load_dwordx4 v25, s[52:55], s72 offen lds
    s_add_u32 m0, s71, 26624
    s_nop 0
    buffer_load_dwordx4 v26, s[52:55], s72 offen lds
    s_add_u32 m0, s71, 27648
    s_nop 0
    buffer_load_dwordx4 v27, s[52:55], s72 offen lds
    s_waitcnt vmcnt(25)
    s_barrier
    ds_read_b64_tr_b16 a[48:49], v15 offset:0
    ds_read_b64_tr_b16 a[50:51], v15 offset:192
    ds_read_b64_tr_b16 a[88:89], v15 offset:32
    ds_read_b64_tr_b16 a[90:91], v15 offset:224
    ds_read_b64_tr_b16 a[128:129], v15 offset:64
    ds_read_b64_tr_b16 a[130:131], v15 offset:256
    s_waitcnt vmcnt(21)
    ds_read_b64_tr_b16 a[184:185], v28 offset:3072
    ds_read_b64_tr_b16 a[186:187], v28 offset:3328
    ds_read_b64_tr_b16 a[240:241], v28 offset:3104
    ds_read_b64_tr_b16 a[242:243], v28 offset:3360
    ds_read_b64_tr_b16 v[160:161], v28 offset:3136
    ds_read_b64_tr_b16 v[162:163], v28 offset:3392
    ds_read_b64_tr_b16 v[216:217], v28 offset:3168
    ds_read_b64_tr_b16 v[218:219], v28 offset:3424
    s_waitcnt vmcnt(18)
    ds_read_b64_tr_b16 a[52:53], v15 offset:7168
    ds_read_b64_tr_b16 a[54:55], v15 offset:7360
    ds_read_b64_tr_b16 a[92:93], v15 offset:7200
    ds_read_b64_tr_b16 a[94:95], v15 offset:7392
    ds_read_b64_tr_b16 a[132:133], v15 offset:7232
    ds_read_b64_tr_b16 a[134:135], v15 offset:7424
    s_waitcnt vmcnt(14)
    ds_read_b64_tr_b16 a[188:189], v28 offset:10240
    ds_read_b64_tr_b16 a[190:191], v28 offset:10496
    ds_read_b64_tr_b16 a[244:245], v28 offset:10272
    ds_read_b64_tr_b16 a[246:247], v28 offset:10528
    ds_read_b64_tr_b16 v[164:165], v28 offset:10304
    ds_read_b64_tr_b16 v[166:167], v28 offset:10560
    ds_read_b64_tr_b16 v[220:221], v28 offset:10336
    ds_read_b64_tr_b16 v[222:223], v28 offset:10592
    s_waitcnt vmcnt(11)
    ds_read_b64_tr_b16 a[56:57], v15 offset:14336
    ds_read_b64_tr_b16 a[58:59], v15 offset:14528
    ds_read_b64_tr_b16 a[96:97], v15 offset:14368
    ds_read_b64_tr_b16 a[98:99], v15 offset:14560
    ds_read_b64_tr_b16 a[136:137], v15 offset:14400
    ds_read_b64_tr_b16 a[138:139], v15 offset:14592
    s_waitcnt lgkmcnt(0)
    s_mov_b32 s72, 1572864
    s_add_u32 m0, s71, 14336
    s_nop 0
    buffer_load_dwordx4 v12, s[48:51], s72 offen lds
    s_add_u32 m0, s71, 15360
    s_nop 0
    buffer_load_dwordx4 v13, s[48:51], s72 offen lds
    s_add_u32 m0, s71, 16384
    s_nop 0
    buffer_load_dwordx4 v14, s[48:51], s72 offen lds
    s_waitcnt vmcnt(10)
    ds_read_b64_tr_b16 a[192:193], v28 offset:17408
    ds_read_b64_tr_b16 a[194:195], v28 offset:17664
    ds_read_b64_tr_b16 a[248:249], v28 offset:17440
    ds_read_b64_tr_b16 a[250:251], v28 offset:17696
    ds_read_b64_tr_b16 v[168:169], v28 offset:17472
    ds_read_b64_tr_b16 v[170:171], v28 offset:17728
    ds_read_b64_tr_b16 v[224:225], v28 offset:17504
    ds_read_b64_tr_b16 v[226:227], v28 offset:17760
    s_waitcnt lgkmcnt(0)
    s_mov_b32 s72, 1572864
    s_add_u32 m0, s71, 17408
    s_nop 0
    buffer_load_dwordx4 v24, s[52:55], s72 offen lds
    s_add_u32 m0, s71, 18432
    s_nop 0
    buffer_load_dwordx4 v25, s[52:55], s72 offen lds
    s_add_u32 m0, s71, 19456
    s_nop 0
    buffer_load_dwordx4 v26, s[52:55], s72 offen lds
    s_add_u32 m0, s71, 20480
    s_nop 0
    buffer_load_dwordx4 v27, s[52:55], s72 offen lds
    s_waitcnt vmcnt(11)
    ds_read_b64_tr_b16 a[60:61], v15 offset:21504
    ds_read_b64_tr_b16 a[62:63], v15 offset:21696
    ds_read_b64_tr_b16 a[100:101], v15 offset:21536
    ds_read_b64_tr_b16 a[102:103], v15 offset:21728
    ds_read_b64_tr_b16 a[140:141], v15 offset:21568
    ds_read_b64_tr_b16 a[142:143], v15 offset:21760
    s_waitcnt lgkmcnt(0)
    s_mov_b32 s72, 1966080
    s_add_u32 m0, s71, 21504
    s_nop 0
    buffer_load_dwordx4 v12, s[48:51], s72 offen lds
    s_add_u32 m0, s71, 22528
    s_nop 0
    buffer_load_dwordx4 v13, s[48:51], s72 offen lds
    s_add_u32 m0, s71, 23552
    s_nop 0
    buffer_load_dwordx4 v14, s[48:51], s72 offen lds
    s_waitcnt vmcnt(10)
    ds_read_b64_tr_b16 a[196:197], v28 offset:24576
    ds_read_b64_tr_b16 a[198:199], v28 offset:24832
    ds_read_b64_tr_b16 a[252:253], v28 offset:24608
    ds_read_b64_tr_b16 a[254:255], v28 offset:24864
    ds_read_b64_tr_b16 v[172:173], v28 offset:24640
    ds_read_b64_tr_b16 v[174:175], v28 offset:24896
    ds_read_b64_tr_b16 v[228:229], v28 offset:24672
    ds_read_b64_tr_b16 v[230:231], v28 offset:24928
    s_waitcnt lgkmcnt(0)
    s_mov_b32 s72, 1966080
    s_add_u32 m0, s71, 24576
    s_nop 0
    buffer_load_dwordx4 v24, s[52:55], s72 offen lds
    s_add_u32 m0, s71, 25600
    s_nop 0
    buffer_load_dwordx4 v25, s[52:55], s72 offen lds
    s_add_u32 m0, s71, 26624
    s_nop 0
    buffer_load_dwordx4 v26, s[52:55], s72 offen lds
    s_add_u32 m0, s71, 27648
    s_nop 0
    buffer_load_dwordx4 v27, s[52:55], s72 offen lds
    s_mov_b32 s72, 2359296
    s_add_u32 m0, s71, 28672
    s_nop 0
    buffer_load_dwordx4 v12, s[48:51], s72 offen lds
    s_add_u32 m0, s71, 29696
    s_nop 0
    buffer_load_dwordx4 v13, s[48:51], s72 offen lds
    s_add_u32 m0, s71, 30720
    s_nop 0
    buffer_load_dwordx4 v14, s[48:51], s72 offen lds
    s_mov_b32 s72, 2359296
    s_add_u32 m0, s71, 31744
    s_nop 0
    buffer_load_dwordx4 v24, s[52:55], s72 offen lds
    s_add_u32 m0, s71, 32768
    s_nop 0
    buffer_load_dwordx4 v25, s[52:55], s72 offen lds
    s_add_u32 m0, s71, 33792
    s_nop 0
    buffer_load_dwordx4 v26, s[52:55], s72 offen lds
    s_add_u32 m0, s71, 34816
    s_nop 0
    buffer_load_dwordx4 v27, s[52:55], s72 offen lds
    s_mov_b32 s72, 2752512
    s_add_u32 m0, s71, 35840
    s_nop 0
    buffer_load_dwordx4 v12, s[48:51], s72 offen lds
    s_add_u32 m0, s71, 36864
    s_nop 0
    buffer_load_dwordx4 v13, s[48:51], s72 offen lds
    s_add_u32 m0, s71, 37888
    s_nop 0
    buffer_load_dwordx4 v14, s[48:51], s72 offen lds
    s_mov_b32 s72, 2752512
    s_add_u32 m0, s71, 38912
    s_nop 0
    buffer_load_dwordx4 v24, s[52:55], s72 offen lds
    s_add_u32 m0, s71, 39936
    s_nop 0
    buffer_load_dwordx4 v25, s[52:55], s72 offen lds
    s_add_u32 m0, s71, 40960
    s_nop 0
    buffer_load_dwordx4 v26, s[52:55], s72 offen lds
    s_add_u32 m0, s71, 41984
    s_nop 0
    buffer_load_dwordx4 v27, s[52:55], s72 offen lds
    s_mov_b32 s72, 3145728
    s_add_u32 m0, s71, 43008
    s_nop 0
    buffer_load_dwordx4 v12, s[48:51], s72 offen lds
    s_add_u32 m0, s71, 44032
    s_nop 0
    buffer_load_dwordx4 v13, s[48:51], s72 offen lds
    s_add_u32 m0, s71, 45056
    s_nop 0
    buffer_load_dwordx4 v14, s[48:51], s72 offen lds
    s_mov_b32 s72, 3145728
    s_add_u32 m0, s71, 46080
    s_nop 0
    buffer_load_dwordx4 v24, s[52:55], s72 offen lds
    s_add_u32 m0, s71, 47104
    s_nop 0
    buffer_load_dwordx4 v25, s[52:55], s72 offen lds
    s_add_u32 m0, s71, 48128
    s_nop 0
    buffer_load_dwordx4 v26, s[52:55], s72 offen lds
    s_add_u32 m0, s71, 49152
    s_nop 0
    buffer_load_dwordx4 v27, s[52:55], s72 offen lds
    s_mov_b32 s72, 3538944
    s_add_u32 m0, s71, 0
    s_nop 0
    buffer_load_dwordx4 v12, s[48:51], s72 offen lds
    s_add_u32 m0, s71, 1024
    s_nop 0
    buffer_load_dwordx4 v13, s[48:51], s72 offen lds
    s_add_u32 m0, s71, 2048
    s_nop 0
    buffer_load_dwordx4 v14, s[48:51], s72 offen lds
    s_mov_b32 s72, 3538944
    s_add_u32 m0, s71, 3072
    s_nop 0
    buffer_load_dwordx4 v24, s[52:55], s72 offen lds
    s_add_u32 m0, s71, 4096
    s_nop 0
    buffer_load_dwordx4 v25, s[52:55], s72 offen lds
    s_add_u32 m0, s71, 5120
    s_nop 0
    buffer_load_dwordx4 v26, s[52:55], s72 offen lds
    s_add_u32 m0, s71, 6144
    s_nop 0
    buffer_load_dwordx4 v27, s[52:55], s72 offen lds
    s_waitcnt vmcnt(39)
    ds_read_b64_tr_b16 v[52:53], v15 offset:14336
    ds_read_b64_tr_b16 v[54:55], v15 offset:14528
    ds_read_b64_tr_b16 v[56:57], v15 offset:14368
    ds_read_b64_tr_b16 v[58:59], v15 offset:14560
    ds_read_b64_tr_b16 v[60:61], v15 offset:14400
    ds_read_b64_tr_b16 v[62:63], v15 offset:14592
    s_waitcnt lgkmcnt(0)
    ds_write_b128 v3, v[52:55] offset:14336
    ds_write_b128 v3, v[56:59] offset:15360
    ds_write_b128 v3, v[60:63] offset:16384
    s_waitcnt lgkmcnt(0)
    s_waitcnt vmcnt(35)
    ds_read_b64_tr_b16 v[52:53], v28 offset:17408
    ds_read_b64_tr_b16 v[54:55], v28 offset:17664
    ds_read_b64_tr_b16 v[56:57], v28 offset:17440
    ds_read_b64_tr_b16 v[58:59], v28 offset:17696
    ds_read_b64_tr_b16 v[60:61], v28 offset:17472
    ds_read_b64_tr_b16 v[62:63], v28 offset:17728
    ds_read_b64_tr_b16 v[64:65], v28 offset:17504
    ds_read_b64_tr_b16 v[66:67], v28 offset:17760
    s_waitcnt lgkmcnt(0)
    ds_write_b128 v3, v[52:55] offset:17408
    ds_write_b128 v3, v[56:59] offset:18432
    ds_write_b128 v3, v[60:63] offset:19456
    ds_write_b128 v3, v[64:67] offset:20480
    s_waitcnt lgkmcnt(0)
    s_waitcnt vmcnt(32)
    ds_read_b64_tr_b16 v[52:53], v15 offset:21504
    ds_read_b64_tr_b16 v[54:55], v15 offset:21696
    ds_read_b64_tr_b16 v[56:57], v15 offset:21536
    ds_read_b64_tr_b16 v[58:59], v15 offset:21728
    ds_read_b64_tr_b16 v[60:61], v15 offset:21568
    ds_read_b64_tr_b16 v[62:63], v15 offset:21760
    s_waitcnt lgkmcnt(0)
    ds_write_b128 v3, v[52:55] offset:21504
    ds_write_b128 v3, v[56:59] offset:22528
    ds_write_b128 v3, v[60:63] offset:23552
    s_waitcnt lgkmcnt(0)
    s_waitcnt vmcnt(28)
    ds_read_b64_tr_b16 v[52:53], v28 offset:24576
    ds_read_b64_tr_b16 v[54:55], v28 offset:24832
    ds_read_b64_tr_b16 v[56:57], v28 offset:24608
    ds_read_b64_tr_b16 v[58:59], v28 offset:24864
    ds_read_b64_tr_b16 v[60:61], v28 offset:24640
    ds_read_b64_tr_b16 v[62:63], v28 offset:24896
    ds_read_b64_tr_b16 v[64:65], v28 offset:24672
    ds_read_b64_tr_b16 v[66:67], v28 offset:24928
    s_waitcnt lgkmcnt(0)
    ds_write_b128 v3, v[52:55] offset:24576
    ds_write_b128 v3, v[56:59] offset:25600
    ds_write_b128 v3, v[60:63] offset:26624
    ds_write_b128 v3, v[64:67] offset:27648
    s_waitcnt lgkmcnt(0)
    s_waitcnt vmcnt(25)
    ds_read_b64_tr_b16 a[64:65], v15 offset:28672
    ds_read_b64_tr_b16 a[66:67], v15 offset:28864
    ds_read_b64_tr_b16 a[104:105], v15 offset:28704
    ds_read_b64_tr_b16 a[106:107], v15 offset:28896
    ds_read_b64_tr_b16 a[144:145], v15 offset:28736
    ds_read_b64_tr_b16 a[146:147], v15 offset:28928
    s_waitcnt lgkmcnt(0)
    s_mov_b32 s72, 3932160
    s_add_u32 m0, s71, 28672
    s_nop 0
    buffer_load_dwordx4 v12, s[48:51], s72 offen lds
    s_add_u32 m0, s71, 29696
    s_nop 0
    buffer_load_dwordx4 v13, s[48:51], s72 offen lds
    s_add_u32 m0, s71, 30720
    s_nop 0
    buffer_load_dwordx4 v14, s[48:51], s72 offen lds
    s_waitcnt vmcnt(24)
    ds_read_b64_tr_b16 a[200:201], v28 offset:31744
    ds_read_b64_tr_b16 a[202:203], v28 offset:32000
    ds_read_b64_tr_b16 v[120:121], v28 offset:31776
    ds_read_b64_tr_b16 v[122:123], v28 offset:32032
    ds_read_b64_tr_b16 v[176:177], v28 offset:31808
    ds_read_b64_tr_b16 v[178:179], v28 offset:32064
    ds_read_b64_tr_b16 v[232:233], v28 offset:31840
    ds_read_b64_tr_b16 v[234:235], v28 offset:32096
    s_waitcnt lgkmcnt(0)
    s_mov_b32 s72, 3932160
    s_add_u32 m0, s71, 31744
    s_nop 0
    buffer_load_dwordx4 v24, s[52:55], s72 offen lds
    s_add_u32 m0, s71, 32768
    s_nop 0
    buffer_load_dwordx4 v25, s[52:55], s72 offen lds
    s_add_u32 m0, s71, 33792
    s_nop 0
    buffer_load_dwordx4 v26, s[52:55], s72 offen lds
    s_add_u32 m0, s71, 34816
    s_nop 0
    buffer_load_dwordx4 v27, s[52:55], s72 offen lds
    s_waitcnt vmcnt(25)
    ds_read_b64_tr_b16 a[68:69], v15 offset:35840
    ds_read_b64_tr_b16 a[70:71], v15 offset:36032
    ds_read_b64_tr_b16 a[108:109], v15 offset:35872
    ds_read_b64_tr_b16 a[110:111], v15 offset:36064
    ds_read_b64_tr_b16 a[148:149], v15 offset:35904
    ds_read_b64_tr_b16 a[150:151], v15 offset:36096
    s_waitcnt lgkmcnt(0)
    s_mov_b32 s72, 4325376
    s_add_u32 m0, s71, 35840
    s_nop 0
    buffer_load_dwordx4 v12, s[48:51], s72 offen lds
    s_add_u32 m0, s71, 36864
    s_nop 0
    buffer_load_dwordx4 v13, s[48:51], s72 offen lds
    s_add_u32 m0, s71, 37888
    s_nop 0
    buffer_load_dwordx4 v14, s[48:51], s72 offen lds
    s_waitcnt vmcnt(24)
    ds_read_b64_tr_b16 a[204:205], v28 offset:38912
    ds_read_b64_tr_b16 a[206:207], v28 offset:39168
    ds_read_b64_tr_b16 v[124:125], v28 offset:38944
    ds_read_b64_tr_b16 v[126:127], v28 offset:39200
    ds_read_b64_tr_b16 v[180:181], v28 offset:38976
    ds_read_b64_tr_b16 v[182:183], v28 offset:39232
    ds_read_b64_tr_b16 v[236:237], v28 offset:39008
    ds_read_b64_tr_b16 v[238:239], v28 offset:39264
    s_waitcnt lgkmcnt(0)
    s_mov_b32 s72, 4325376
    s_add_u32 m0, s71, 38912
    s_nop 0
    buffer_load_dwordx4 v24, s[52:55], s72 offen lds
    s_add_u32 m0, s71, 39936
    s_nop 0
    buffer_load_dwordx4 v25, s[52:55], s72 offen lds
    s_add_u32 m0, s71, 40960
    s_nop 0
    buffer_load_dwordx4 v26, s[52:55], s72 offen lds
    s_add_u32 m0, s71, 41984
    s_nop 0
    buffer_load_dwordx4 v27, s[52:55], s72 offen lds
    s_mov_b32 s72, 4718592
    s_add_u32 m0, s71, 7168
    s_nop 0
    buffer_load_dwordx4 v12, s[48:51], s72 offen lds
    s_add_u32 m0, s71, 8192
    s_nop 0
    buffer_load_dwordx4 v13, s[48:51], s72 offen lds
    s_add_u32 m0, s71, 9216
    s_nop 0
    buffer_load_dwordx4 v14, s[48:51], s72 offen lds
    s_mov_b32 s72, 4718592
    s_add_u32 m0, s71, 10240
    s_nop 0
    buffer_load_dwordx4 v24, s[52:55], s72 offen lds
    s_add_u32 m0, s71, 11264
    s_nop 0
    buffer_load_dwordx4 v25, s[52:55], s72 offen lds
    s_add_u32 m0, s71, 12288
    s_nop 0
    buffer_load_dwordx4 v26, s[52:55], s72 offen lds
    s_add_u32 m0, s71, 13312
    s_nop 0
    buffer_load_dwordx4 v27, s[52:55], s72 offen lds
    s_waitcnt vmcnt(32)
    ds_read_b64_tr_b16 a[72:73], v15 offset:43008
    ds_read_b64_tr_b16 a[74:75], v15 offset:43200
    ds_read_b64_tr_b16 a[112:113], v15 offset:43040
    ds_read_b64_tr_b16 a[114:115], v15 offset:43232
    ds_read_b64_tr_b16 a[152:153], v15 offset:43072
    ds_read_b64_tr_b16 a[154:155], v15 offset:43264
    s_waitcnt lgkmcnt(0)
    s_mov_b32 s72, 5111808
    s_add_u32 m0, s71, 43008
    s_nop 0
    buffer_load_dwordx4 v12, s[48:51], s72 offen lds
    s_add_u32 m0, s71, 44032
    s_nop 0
    buffer_load_dwordx4 v13, s[48:51], s72 offen lds
    s_add_u32 m0, s71, 45056
    s_nop 0
    buffer_load_dwordx4 v14, s[48:51], s72 offen lds
    s_waitcnt vmcnt(31)
    ds_read_b64_tr_b16 a[208:209], v28 offset:46080
    ds_read_b64_tr_b16 a[210:211], v28 offset:46336
    ds_read_b64_tr_b16 v[128:129], v28 offset:46112
    ds_read_b64_tr_b16 v[130:131], v28 offset:46368
    ds_read_b64_tr_b16 v[184:185], v28 offset:46144
    ds_read_b64_tr_b16 v[186:187], v28 offset:46400
    ds_read_b64_tr_b16 v[240:241], v28 offset:46176
    ds_read_b64_tr_b16 v[242:243], v28 offset:46432
    s_waitcnt lgkmcnt(0)
    s_mov_b32 s72, 5111808
    s_add_u32 m0, s71, 46080
    s_nop 0
    buffer_load_dwordx4 v24, s[52:55], s72 offen lds
    s_add_u32 m0, s71, 47104
    s_nop 0
    buffer_load_dwordx4 v25, s[52:55], s72 offen lds
    s_add_u32 m0, s71, 48128
    s_nop 0
    buffer_load_dwordx4 v26, s[52:55], s72 offen lds
    s_add_u32 m0, s71, 49152
    s_nop 0
    buffer_load_dwordx4 v27, s[52:55], s72 offen lds
    s_waitcnt vmcnt(32)
    ds_read_b64_tr_b16 a[76:77], v15 offset:0
    ds_read_b64_tr_b16 a[78:79], v15 offset:192
    ds_read_b64_tr_b16 a[116:117], v15 offset:32
    ds_read_b64_tr_b16 a[118:119], v15 offset:224
    ds_read_b64_tr_b16 a[156:157], v15 offset:64
    ds_read_b64_tr_b16 a[158:159], v15 offset:256
    s_waitcnt lgkmcnt(0)
    s_mov_b32 s72, 5505024
    s_add_u32 m0, s71, 0
    s_nop 0
    buffer_load_dwordx4 v12, s[48:51], s72 offen lds
    s_add_u32 m0, s71, 1024
    s_nop 0
    buffer_load_dwordx4 v13, s[48:51], s72 offen lds
    s_add_u32 m0, s71, 2048
    s_nop 0
    buffer_load_dwordx4 v14, s[48:51], s72 offen lds
    s_waitcnt vmcnt(31)
    ds_read_b64_tr_b16 a[212:213], v28 offset:3072
    ds_read_b64_tr_b16 a[214:215], v28 offset:3328
    ds_read_b64_tr_b16 v[132:133], v28 offset:3104
    ds_read_b64_tr_b16 v[134:135], v28 offset:3360
    ds_read_b64_tr_b16 v[188:189], v28 offset:3136
    ds_read_b64_tr_b16 v[190:191], v28 offset:3392
    ds_read_b64_tr_b16 v[244:245], v28 offset:3168
    ds_read_b64_tr_b16 v[246:247], v28 offset:3424
    s_waitcnt lgkmcnt(0)
    s_mov_b32 s72, 5505024
    s_add_u32 m0, s71, 3072
    s_nop 0
    buffer_load_dwordx4 v24, s[52:55], s72 offen lds
    s_add_u32 m0, s71, 4096
    s_nop 0
    buffer_load_dwordx4 v25, s[52:55], s72 offen lds
    s_add_u32 m0, s71, 5120
    s_nop 0
    buffer_load_dwordx4 v26, s[52:55], s72 offen lds
    s_add_u32 m0, s71, 6144
    s_nop 0
    buffer_load_dwordx4 v27, s[52:55], s72 offen lds
    s_waitcnt vmcnt(32)
    ds_read_b64_tr_b16 v[52:53], v15 offset:28672
    ds_read_b64_tr_b16 v[54:55], v15 offset:28864
    ds_read_b64_tr_b16 v[56:57], v15 offset:28704
    ds_read_b64_tr_b16 v[58:59], v15 offset:28896
    ds_read_b64_tr_b16 v[60:61], v15 offset:28736
    ds_read_b64_tr_b16 v[62:63], v15 offset:28928
    s_waitcnt lgkmcnt(0)
    ds_write_b128 v3, v[52:55] offset:28672
    ds_write_b128 v3, v[56:59] offset:29696
    ds_write_b128 v3, v[60:63] offset:30720
    s_waitcnt lgkmcnt(0)
    s_waitcnt vmcnt(28)
    ds_read_b64_tr_b16 v[52:53], v28 offset:31744
    ds_read_b64_tr_b16 v[54:55], v28 offset:32000
    ds_read_b64_tr_b16 v[56:57], v28 offset:31776
    ds_read_b64_tr_b16 v[58:59], v28 offset:32032
    ds_read_b64_tr_b16 v[60:61], v28 offset:31808
    ds_read_b64_tr_b16 v[62:63], v28 offset:32064
    ds_read_b64_tr_b16 v[64:65], v28 offset:31840
    ds_read_b64_tr_b16 v[66:67], v28 offset:32096
    s_waitcnt lgkmcnt(0)
    ds_write_b128 v3, v[52:55] offset:31744
    ds_write_b128 v3, v[56:59] offset:32768
    ds_write_b128 v3, v[60:63] offset:33792
    ds_write_b128 v3, v[64:67] offset:34816
    s_waitcnt lgkmcnt(0)
    s_waitcnt vmcnt(25)
    ds_read_b64_tr_b16 v[52:53], v15 offset:35840
    ds_read_b64_tr_b16 v[54:55], v15 offset:36032
    ds_read_b64_tr_b16 v[56:57], v15 offset:35872
    ds_read_b64_tr_b16 v[58:59], v15 offset:36064
    ds_read_b64_tr_b16 v[60:61], v15 offset:35904
    ds_read_b64_tr_b16 v[62:63], v15 offset:36096
    s_waitcnt lgkmcnt(0)
    ds_write_b128 v3, v[52:55] offset:35840
    ds_write_b128 v3, v[56:59] offset:36864
    ds_write_b128 v3, v[60:63] offset:37888
    s_waitcnt lgkmcnt(0)
    s_waitcnt vmcnt(21)
    ds_read_b64_tr_b16 v[52:53], v28 offset:38912
    ds_read_b64_tr_b16 v[54:55], v28 offset:39168
    ds_read_b64_tr_b16 v[56:57], v28 offset:38944
    ds_read_b64_tr_b16 v[58:59], v28 offset:39200
    ds_read_b64_tr_b16 v[60:61], v28 offset:38976
    ds_read_b64_tr_b16 v[62:63], v28 offset:39232
    ds_read_b64_tr_b16 v[64:65], v28 offset:39008
    ds_read_b64_tr_b16 v[66:67], v28 offset:39264
    s_waitcnt lgkmcnt(0)
    ds_write_b128 v3, v[52:55] offset:38912
    ds_write_b128 v3, v[56:59] offset:39936
    ds_write_b128 v3, v[60:63] offset:40960
    ds_write_b128 v3, v[64:67] offset:41984
    s_waitcnt lgkmcnt(0)
    s_waitcnt vmcnt(18)
    ds_read_b64_tr_b16 a[80:81], v15 offset:7168
    ds_read_b64_tr_b16 a[82:83], v15 offset:7360
    ds_read_b64_tr_b16 a[120:121], v15 offset:7200
    ds_read_b64_tr_b16 a[122:123], v15 offset:7392
    ds_read_b64_tr_b16 a[160:161], v15 offset:7232
    ds_read_b64_tr_b16 a[162:163], v15 offset:7424
    s_waitcnt lgkmcnt(0)
    s_mov_b32 s72, 5898240
    s_add_u32 m0, s71, 7168
    s_nop 0
    buffer_load_dwordx4 v12, s[48:51], s72 offen lds
    s_add_u32 m0, s71, 8192
    s_nop 0
    buffer_load_dwordx4 v13, s[48:51], s72 offen lds
    s_add_u32 m0, s71, 9216
    s_nop 0
    buffer_load_dwordx4 v14, s[48:51], s72 offen lds
    s_waitcnt vmcnt(17)
    ds_read_b64_tr_b16 a[216:217], v28 offset:10240
    ds_read_b64_tr_b16 a[218:219], v28 offset:10496
    ds_read_b64_tr_b16 v[136:137], v28 offset:10272
    ds_read_b64_tr_b16 v[138:139], v28 offset:10528
    ds_read_b64_tr_b16 v[192:193], v28 offset:10304
    ds_read_b64_tr_b16 v[194:195], v28 offset:10560
    ds_read_b64_tr_b16 v[248:249], v28 offset:10336
    ds_read_b64_tr_b16 v[250:251], v28 offset:10592
    s_waitcnt lgkmcnt(0)
    s_mov_b32 s72, 5898240
    s_add_u32 m0, s71, 10240
    s_nop 0
    buffer_load_dwordx4 v24, s[52:55], s72 offen lds
    s_add_u32 m0, s71, 11264
    s_nop 0
    buffer_load_dwordx4 v25, s[52:55], s72 offen lds
    s_add_u32 m0, s71, 12288
    s_nop 0
    buffer_load_dwordx4 v26, s[52:55], s72 offen lds
    s_add_u32 m0, s71, 13312
    s_nop 0
    buffer_load_dwordx4 v27, s[52:55], s72 offen lds
    s_waitcnt vmcnt(18)
    ds_read_b64_tr_b16 a[84:85], v15 offset:43008
    ds_read_b64_tr_b16 a[86:87], v15 offset:43200
    ds_read_b64_tr_b16 a[124:125], v15 offset:43040
    ds_read_b64_tr_b16 a[126:127], v15 offset:43232
    ds_read_b64_tr_b16 a[164:165], v15 offset:43072
    ds_read_b64_tr_b16 a[166:167], v15 offset:43264
    s_waitcnt lgkmcnt(0)
    s_mov_b32 s72, 6291456
    s_add_u32 m0, s71, 43008
    s_nop 0
    buffer_load_dwordx4 v12, s[48:51], s72 offen lds
    s_add_u32 m0, s71, 44032
    s_nop 0
    buffer_load_dwordx4 v13, s[48:51], s72 offen lds
    s_add_u32 m0, s71, 45056
    s_nop 0
    buffer_load_dwordx4 v14, s[48:51], s72 offen lds
    s_waitcnt vmcnt(17)
    ds_read_b64_tr_b16 a[220:221], v28 offset:46080
    ds_read_b64_tr_b16 a[222:223], v28 offset:46336
    ds_read_b64_tr_b16 v[140:141], v28 offset:46112
    ds_read_b64_tr_b16 v[142:143], v28 offset:46368
    ds_read_b64_tr_b16 v[196:197], v28 offset:46144
    ds_read_b64_tr_b16 v[198:199], v28 offset:46400
    ds_read_b64_tr_b16 v[252:253], v28 offset:46176
    ds_read_b64_tr_b16 v[254:255], v28 offset:46432
    s_waitcnt lgkmcnt(0)
    s_mov_b32 s72, 6291456
    s_add_u32 m0, s71, 46080
    s_nop 0
    buffer_load_dwordx4 v24, s[52:55], s72 offen lds
    s_add_u32 m0, s71, 47104
    s_nop 0
    buffer_load_dwordx4 v25, s[52:55], s72 offen lds
    s_add_u32 m0, s71, 48128
    s_nop 0
    buffer_load_dwordx4 v26, s[52:55], s72 offen lds
    s_add_u32 m0, s71, 49152
    s_nop 0
    buffer_load_dwordx4 v27, s[52:55], s72 offen lds
    s_waitcnt vmcnt(18)
    ds_read_b64_tr_b16 a[0:1], v15 offset:0
    ds_read_b64_tr_b16 a[2:3], v15 offset:192
    ds_read_b64_tr_b16 a[8:9], v15 offset:32
    ds_read_b64_tr_b16 a[10:11], v15 offset:224
    ds_read_b64_tr_b16 a[16:17], v15 offset:64
    ds_read_b64_tr_b16 a[18:19], v15 offset:256
    s_waitcnt lgkmcnt(0)
    s_mov_b32 s72, 6684672
    s_add_u32 m0, s71, 0
    s_nop 0
    buffer_load_dwordx4 v12, s[48:51], s72 offen lds
    s_add_u32 m0, s71, 1024
    s_nop 0
    buffer_load_dwordx4 v13, s[48:51], s72 offen lds
    s_add_u32 m0, s71, 2048
    s_nop 0
    buffer_load_dwordx4 v14, s[48:51], s72 offen lds
    s_waitcnt vmcnt(17)
    ds_read_b64_tr_b16 a[168:169], v28 offset:3072
    ds_read_b64_tr_b16 a[170:171], v28 offset:3328
    ds_read_b64_tr_b16 a[224:225], v28 offset:3104
    ds_read_b64_tr_b16 a[226:227], v28 offset:3360
    ds_read_b64_tr_b16 v[144:145], v28 offset:3136
    ds_read_b64_tr_b16 v[146:147], v28 offset:3392
    ds_read_b64_tr_b16 v[200:201], v28 offset:3168
    ds_read_b64_tr_b16 v[202:203], v28 offset:3424
    s_waitcnt lgkmcnt(0)
    s_mov_b32 s72, 6684672
    s_add_u32 m0, s71, 3072
    s_nop 0
    buffer_load_dwordx4 v24, s[52:55], s72 offen lds
    s_add_u32 m0, s71, 4096
    s_nop 0
    buffer_load_dwordx4 v25, s[52:55], s72 offen lds
    s_add_u32 m0, s71, 5120
    s_nop 0
    buffer_load_dwordx4 v26, s[52:55], s72 offen lds
    s_add_u32 m0, s71, 6144
    s_nop 0
    buffer_load_dwordx4 v27, s[52:55], s72 offen lds
    s_waitcnt vmcnt(18)
    ds_read_b64_tr_b16 a[4:5], v15 offset:7168
    ds_read_b64_tr_b16 a[6:7], v15 offset:7360
    ds_read_b64_tr_b16 a[12:13], v15 offset:7200
    ds_read_b64_tr_b16 a[14:15], v15 offset:7392
    ds_read_b64_tr_b16 a[20:21], v15 offset:7232
    ds_read_b64_tr_b16 a[22:23], v15 offset:7424
    s_waitcnt vmcnt(14)
    ds_read_b64_tr_b16 a[172:173], v28 offset:10240
    ds_read_b64_tr_b16 a[174:175], v28 offset:10496
    ds_read_b64_tr_b16 a[228:229], v28 offset:10272
    ds_read_b64_tr_b16 a[230:231], v28 offset:10528
    ds_read_b64_tr_b16 v[148:149], v28 offset:10304
    ds_read_b64_tr_b16 v[150:151], v28 offset:10560
    ds_read_b64_tr_b16 v[204:205], v28 offset:10336
    ds_read_b64_tr_b16 v[206:207], v28 offset:10592
    s_waitcnt vmcnt(11)
    ds_read_b64_tr_b16 a[24:25], v15 offset:43008
    ds_read_b64_tr_b16 a[26:27], v15 offset:43200
    ds_read_b64_tr_b16 a[32:33], v15 offset:43040
    ds_read_b64_tr_b16 a[34:35], v15 offset:43232
    ds_read_b64_tr_b16 a[40:41], v15 offset:43072
    ds_read_b64_tr_b16 a[42:43], v15 offset:43264
    s_waitcnt vmcnt(7)
    ds_read_b64_tr_b16 a[176:177], v28 offset:46080
    ds_read_b64_tr_b16 a[178:179], v28 offset:46336
    ds_read_b64_tr_b16 a[232:233], v28 offset:46112
    ds_read_b64_tr_b16 a[234:235], v28 offset:46368
    ds_read_b64_tr_b16 v[152:153], v28 offset:46144
    ds_read_b64_tr_b16 v[154:155], v28 offset:46400
    ds_read_b64_tr_b16 v[208:209], v28 offset:46176
    ds_read_b64_tr_b16 v[210:211], v28 offset:46432
    s_waitcnt vmcnt(4)
    ds_read_b64_tr_b16 a[28:29], v15 offset:0
    ds_read_b64_tr_b16 a[30:31], v15 offset:192
    ds_read_b64_tr_b16 a[36:37], v15 offset:32
    ds_read_b64_tr_b16 a[38:39], v15 offset:224
    ds_read_b64_tr_b16 a[44:45], v15 offset:64
    ds_read_b64_tr_b16 a[46:47], v15 offset:256
    s_waitcnt lgkmcnt(0)
    s_mov_b32 s72, 7077888
    s_add_u32 m0, s71, 0
    s_nop 0
    buffer_load_dwordx4 v12, s[48:51], s72 offen lds
    s_add_u32 m0, s71, 1024
    s_nop 0
    buffer_load_dwordx4 v13, s[48:51], s72 offen lds
    s_add_u32 m0, s71, 2048
    s_nop 0
    buffer_load_dwordx4 v14, s[48:51], s72 offen lds
    s_waitcnt vmcnt(3)
    ds_read_b64_tr_b16 a[180:181], v28 offset:3072
    ds_read_b64_tr_b16 a[182:183], v28 offset:3328
    ds_read_b64_tr_b16 a[236:237], v28 offset:3104
    ds_read_b64_tr_b16 a[238:239], v28 offset:3360
    ds_read_b64_tr_b16 v[156:157], v28 offset:3136
    ds_read_b64_tr_b16 v[158:159], v28 offset:3392
    ds_read_b64_tr_b16 v[212:213], v28 offset:3168
    ds_read_b64_tr_b16 v[214:215], v28 offset:3424
    s_waitcnt lgkmcnt(0)
    s_mov_b32 s72, 7077888
    s_add_u32 m0, s71, 3072
    s_nop 0
    buffer_load_dwordx4 v24, s[52:55], s72 offen lds
    s_add_u32 m0, s71, 4096
    s_nop 0
    buffer_load_dwordx4 v25, s[52:55], s72 offen lds
    s_add_u32 m0, s71, 5120
    s_nop 0
    buffer_load_dwordx4 v26, s[52:55], s72 offen lds
    s_add_u32 m0, s71, 6144
    s_nop 0
    buffer_load_dwordx4 v27, s[52:55], s72 offen lds
    s_mov_b32 s72, 7471104
    s_add_u32 m0, s71, 7168
    s_nop 0
    buffer_load_dwordx4 v12, s[48:51], s72 offen lds
    s_add_u32 m0, s71, 8192
    s_nop 0
    buffer_load_dwordx4 v13, s[48:51], s72 offen lds
    s_add_u32 m0, s71, 9216
    s_nop 0
    buffer_load_dwordx4 v14, s[48:51], s72 offen lds
    s_mov_b32 s72, 7471104
    s_add_u32 m0, s71, 10240
    s_nop 0
    buffer_load_dwordx4 v24, s[52:55], s72 offen lds
    s_add_u32 m0, s71, 11264
    s_nop 0
    buffer_load_dwordx4 v25, s[52:55], s72 offen lds
    s_add_u32 m0, s71, 12288
    s_nop 0
    buffer_load_dwordx4 v26, s[52:55], s72 offen lds
    s_add_u32 m0, s71, 13312
    s_nop 0
    buffer_load_dwordx4 v27, s[52:55], s72 offen lds
    s_waitcnt vmcnt(11)
    ds_read_b64_tr_b16 v[52:53], v15 offset:0
    ds_read_b64_tr_b16 v[54:55], v15 offset:192
    ds_read_b64_tr_b16 v[56:57], v15 offset:32
    ds_read_b64_tr_b16 v[58:59], v15 offset:224
    ds_read_b64_tr_b16 v[60:61], v15 offset:64
    ds_read_b64_tr_b16 v[62:63], v15 offset:256
    s_waitcnt lgkmcnt(0)
    ds_write_b128 v3, v[52:55] offset:0
    ds_write_b128 v3, v[56:59] offset:1024
    ds_write_b128 v3, v[60:63] offset:2048
    s_waitcnt lgkmcnt(0)
    s_waitcnt vmcnt(7)
    ds_read_b64_tr_b16 v[52:53], v28 offset:3072
    ds_read_b64_tr_b16 v[54:55], v28 offset:3328
    ds_read_b64_tr_b16 v[56:57], v28 offset:3104
    ds_read_b64_tr_b16 v[58:59], v28 offset:3360
    ds_read_b64_tr_b16 v[60:61], v28 offset:3136
    ds_read_b64_tr_b16 v[62:63], v28 offset:3392
    ds_read_b64_tr_b16 v[64:65], v28 offset:3168
    ds_read_b64_tr_b16 v[66:67], v28 offset:3424
    s_waitcnt lgkmcnt(0)
    ds_write_b128 v3, v[52:55] offset:3072
    ds_write_b128 v3, v[56:59] offset:4096
    ds_write_b128 v3, v[60:63] offset:5120
    ds_write_b128 v3, v[64:67] offset:6144
    s_waitcnt lgkmcnt(0)
    s_waitcnt vmcnt(4)
    ds_read_b64_tr_b16 v[52:53], v15 offset:7168
    ds_read_b64_tr_b16 v[54:55], v15 offset:7360
    ds_read_b64_tr_b16 v[56:57], v15 offset:7200
    ds_read_b64_tr_b16 v[58:59], v15 offset:7392
    ds_read_b64_tr_b16 v[60:61], v15 offset:7232
    ds_read_b64_tr_b16 v[62:63], v15 offset:7424
    s_waitcnt lgkmcnt(0)
    ds_write_b128 v3, v[52:55] offset:7168
    ds_write_b128 v3, v[56:59] offset:8192
    ds_write_b128 v3, v[60:63] offset:9216
    s_waitcnt lgkmcnt(0)
    s_waitcnt vmcnt(0)
    ds_read_b64_tr_b16 v[52:53], v28 offset:10240
    ds_read_b64_tr_b16 v[54:55], v28 offset:10496
    ds_read_b64_tr_b16 v[56:57], v28 offset:10272
    ds_read_b64_tr_b16 v[58:59], v28 offset:10528
    ds_read_b64_tr_b16 v[60:61], v28 offset:10304
    ds_read_b64_tr_b16 v[62:63], v28 offset:10560
    ds_read_b64_tr_b16 v[64:65], v28 offset:10336
    ds_read_b64_tr_b16 v[66:67], v28 offset:10592
    s_waitcnt lgkmcnt(0)
    ds_write_b128 v3, v[52:55] offset:10240
    ds_write_b128 v3, v[56:59] offset:11264
    ds_write_b128 v3, v[60:63] offset:12288
    ds_write_b128 v3, v[64:67] offset:13312
    s_waitcnt lgkmcnt(0)
    s_waitcnt lgkmcnt(0)
L_pwj_47:
    s_lshl_b32 s7, s3, 8
    s_add_u32 s7, s7, 2048
    v_add_u32 v5, s7, v4
    s_barrier
    s_cmp_lg_u32 s3, 0
    s_cbranch_scc1 L_wsd_52
L_ws_51:
    buffer_load_dword v16, off, s[60:63], 0 sc1
    buffer_load_dword v17, off, s[60:63], 0 offset:128 sc1
    s_waitcnt vmcnt(0)
    v_cmp_gt_u32 vcc, 256, v16
    s_cbranch_vccnz L_ws_51_r
    v_cmp_gt_u32 vcc, 0x28000000, v17
    s_cbranch_vccz L_wsd_52
L_ws_51_r:
    s_sleep 16
    s_add_u32 s6, s6, 1
    s_cmp_gt_u32 s6, 200000
    s_cbranch_scc1 L_timeout
    s_branch L_ws_51
L_wsd_52:
    s_barrier
    buffer_load_dword v16, off, s[60:63], 0 offset:128 sc1
    s_waitcnt vmcnt(0)
    v_readfirstlane_b32 s68, v16
    s_nop 0
    s_bfe_u32 s7, s68, 0xc0000
    s_cmp_gt_u32 s7, 40
    s_cselect_b32 s7, 8192, 0
    s_add_u32 s38, s38, s7
    s_bfe_u32 s7, s68, 0xc000c
    s_cmp_gt_u32 s7, 40
    s_cselect_b32 s7, 8192, 0
    s_add_u32 s39, s39, s7
    s_add_u32 s68, s39, 1179648
    s_add_u32 s69, s39, 655360
    v_mov_b64 v[24:25], 0
    v_mov_b64 v[26:27], 0
    v_mov_b64 v[28:29], 0
    v_mov_b64 v[30:31], 0
    v_mov_b64 v[32:33], 0
    v_mov_b64 v[34:35], 0
    v_mov_b64 v[36:37], 0
    v_mov_b64 v[38:39], 0
    v_mov_b64 v[40:41], 0
    v_mov_b64 v[42:43], 0
    v_mov_b64 v[44:45], 0
    v_mov_b64 v[46:47], 0
    v_mov_b64 v[48:49], 0
    v_mov_b64 v[50:51], 0
    ds_read_b128 v[92:95], v3 offset:0
    ds_read_b128 v[96:99], v3 offset:7168
    ds_read_b128 v[100:103], v3 offset:1024
    ds_read_b128 v[104:107], v3 offset:8192
    ds_read_b128 v[108:111], v3 offset:2048
    ds_read_b128 v[112:115], v3 offset:9216
    s_and_b32 s70, s5, 3
    s_lshl_b32 s70, s70, 16
    s_add_u32 s70, s70, s68
    s_add_u32 s86, s70, s64
    s_add_u32 s87, s70, s65
    s_add_u32 s88, s70, s66
    s_add_u32 s89, s70, s67
    s_waitcnt lgkmcnt(0)
.p2align 6
L_pw_loop_53:
L_pm_54:
    buffer_load_dwordx4 v[52:55], v2, s[40:43], s86 offen sc1
    buffer_load_dwordx4 v[56:59], v2, s[40:43], s87 offen sc1
    buffer_load_dwordx4 v[60:63], v2, s[40:43], s88 offen sc1
    buffer_load_dwordx4 v[116:119], v2, s[40:43], s89 offen sc1
    s_waitcnt vmcnt(3)
    ds_write_b128 v20, v[52:55] offset:0
    v_max3_u32 v16, v52, v53, v54
    v_max_u32 v16, v16, v55
    s_waitcnt vmcnt(2)
    ds_write_b128 v20, v[56:59] offset:1024
    v_max3_u32 v16, v16, v56, v57
    v_max3_u32 v16, v16, v58, v59
    s_waitcnt vmcnt(1)
    ds_write_b128 v20, v[60:63] offset:2048
    v_max3_u32 v16, v16, v60, v61
    v_max3_u32 v16, v16, v62, v63
    s_waitcnt vmcnt(0)
    ds_write_b128 v23, v[116:119] offset:0
    v_max3_u32 v16, v16, v116, v117
    v_max3_u32 v16, v16, v118, v119
    v_cmp_eq_u32 vcc, -1, v16
    s_cbranch_vccnz L_rt_55
    v_smfmac_f32_16x16x64_bf16 v[24:27], v[52:55], a[0:7], v1
    s_waitcnt lgkmcnt(0)
    s_barrier
    ds_read_b128 v[64:67], v21 offset:3072
    ds_read_b128 v[68:71], v21 offset:4096
    v_smfmac_f32_16x16x64_bf16 v[28:31], v[52:55], a[8:15], v1
    ds_read_b128 v[72:75], v21 offset:5120
    ds_read_b128 v[76:79], v22 offset:6144
    v_smfmac_f32_16x16x64_bf16 v[32:35], v[52:55], a[16:23], v1
    ds_read_b128 v[80:83], v22 offset:7168
    ds_read_b128 v[84:87], v22 offset:8192
    v_smfmac_f32_16x16x64_bf16 v[24:27], v[56:59], a[24:31], v1
    ds_read_b128 v[88:91], v22 offset:9216
    v_smfmac_f32_16x16x64_bf16 v[28:31], v[56:59], a[32:39], v1
    v_smfmac_f32_16x16x64_bf16 v[32:35], v[56:59], a[40:47], v1
    v_smfmac_f32_16x16x64_bf16 v[24:27], v[60:63], v[92:99], v1
    ds_read_b128 v[92:95], v3 offset:14336
    ds_read_b128 v[96:99], v3 offset:21504
    v_smfmac_f32_16x16x64_bf16 v[28:31], v[60:63], v[100:107], v1
    ds_read_b128 v[100:103], v3 offset:28672
    v_smfmac_f32_16x16x64_bf16 v[32:35], v[60:63], v[108:115], v1
    ds_read_b128 v[104:107], v3 offset:35840
    s_waitcnt lgkmcnt(7)
    v_smfmac_f32_16x16x64_bf16 v[24:27], v[64:67], a[48:55], v1
    ds_read_b128 v[108:111], v3 offset:15360
    v_smfmac_f32_16x16x64_bf16 v[24:27], v[68:71], a[56:63], v1
    ds_read_b128 v[112:115], v3 offset:22528
    s_waitcnt lgkmcnt(2)
    v_smfmac_f32_16x16x64_bf16 v[24:27], v[72:75], v[92:99], v1
    ds_read_b128 v[92:95], v3 offset:29696
    v_smfmac_f32_16x16x64_bf16 v[24:27], v[76:79], a[64:71], v1
    ds_read_b128 v[96:99], v3 offset:36864
    v_smfmac_f32_16x16x64_bf16 v[24:27], v[80:83], a[72:79], v1
    v_smfmac_f32_16x16x64_bf16 v[24:27], v[84:87], v[100:107], v1
    ds_read_b128 v[100:103], v3 offset:16384
    v_smfmac_f32_16x16x64_bf16 v[24:27], v[88:91], a[80:87], v1
    ds_read_b128 v[104:107], v3 offset:23552
    v_smfmac_f32_16x16x64_bf16 v[28:31], v[64:67], a[88:95], v1
    v_smfmac_f32_16x16x64_bf16 v[28:31], v[68:71], a[96:103], v1
    v_add_f32 v24, v24, v25
    v_add_f32 v26, v26, v27
    s_waitcnt lgkmcnt(2)
    v_smfmac_f32_16x16x64_bf16 v[28:31], v[72:75], v[108:115], v1
    v_cvt_pk_bf16_f32 v24, v24, v26
    ds_write_b32 v4, v24 offset:0
    v_smfmac_f32_16x16x64_bf16 v[28:31], v[76:79], a[104:111], v1
    ds_read_b128 v[108:111], v3 offset:30720
    v_smfmac_f32_16x16x64_bf16 v[28:31], v[80:83], a[112:119], v1
    ds_read_b128 v[112:115], v3 offset:37888
    v_smfmac_f32_16x16x64_bf16 v[28:31], v[84:87], v[92:99], v1
    ds_read_b128 v[92:95], v3 offset:3072
    v_smfmac_f32_16x16x64_bf16 v[28:31], v[88:91], a[120:127], v1
    ds_read_b128 v[96:99], v3 offset:10240
    v_smfmac_f32_16x16x64_bf16 v[32:35], v[64:67], a[128:135], v1
    v_smfmac_f32_16x16x64_bf16 v[32:35], v[68:71], a[136:143], v1
    v_add_f32 v28, v28, v29
    v_add_f32 v30, v30, v31
    s_waitcnt lgkmcnt(2)
    v_smfmac_f32_16x16x64_bf16 v[32:35], v[72:75], v[100:107], v1
    v_cvt_pk_bf16_f32 v28, v28, v30
    ds_write_b32 v4, v28 offset:256
    v_smfmac_f32_16x16x64_bf16 v[32:35], v[76:79], a[144:151], v1
    ds_read_b128 v[100:103], v3 offset:17408
    v_smfmac_f32_16x16x64_bf16 v[32:35], v[80:83], a[152:159], v1
    ds_read_b128 v[104:107], v3 offset:24576
    v_smfmac_f32_16x16x64_bf16 v[32:35], v[84:87], v[108:115], v1
    ds_read_b128 v[108:111], v3 offset:31744
    v_smfmac_f32_16x16x64_bf16 v[32:35], v[88:91], a[160:167], v1
    ds_read_b128 v[112:115], v3 offset:38912
    v_smfmac_f32_16x16x64_bf16 v[36:39], v[52:55], a[168:175], v1
    v_smfmac_f32_16x16x64_bf16 v[36:39], v[56:59], a[176:183], v1
    v_add_f32 v32, v32, v33
    v_add_f32 v34, v34, v35
    s_waitcnt lgkmcnt(2)
    v_smfmac_f32_16x16x64_bf16 v[36:39], v[60:63], v[92:99], v1
    v_cvt_pk_bf16_f32 v32, v32, v34
    ds_write_b32 v4, v32 offset:512
    v_smfmac_f32_16x16x64_bf16 v[36:39], v[64:67], a[184:191], v1
    ds_read_b128 v[92:95], v3 offset:4096
    v_smfmac_f32_16x16x64_bf16 v[36:39], v[68:71], a[192:199], v1
    ds_read_b128 v[96:99], v3 offset:11264
    v_smfmac_f32_16x16x64_bf16 v[36:39], v[72:75], v[100:107], v1
    ds_read_b128 v[100:103], v3 offset:18432
    v_smfmac_f32_16x16x64_bf16 v[36:39], v[76:79], a[200:207], v1
    ds_read_b128 v[104:107], v3 offset:25600
    v_smfmac_f32_16x16x64_bf16 v[36:39], v[80:83], a[208:215], v1
    s_waitcnt lgkmcnt(2)
    v_smfmac_f32_16x16x64_bf16 v[36:39], v[84:87], v[108:115], v1
    ds_read_b128 v[108:111], v3 offset:32768
    v_smfmac_f32_16x16x64_bf16 v[36:39], v[88:91], a[216:223], v1
    ds_read_b128 v[112:115], v3 offset:39936
    v_smfmac_f32_16x16x64_bf16 v[40:43], v[52:55], a[224:231], v1
    s_barrier
    v_smfmac_f32_16x16x64_bf16 v[40:43], v[56:59], a[232:239], v1
    v_add_f32 v36, v36, v37
    v_add_f32 v38, v38, v39
    v_smfmac_f32_16x16x64_bf16 v[40:43], v[60:63], v[92:99], v1
    v_cvt_pk_bf16_f32 v36, v36, v38
    ds_write_b32 v5, v36 offset:0
    v_smfmac_f32_16x16x64_bf16 v[40:43], v[64:67], a[240:247], v1
    ds_read_b128 v[92:95], v3 offset:5120
    v_smfmac_f32_16x16x64_bf16 v[40:43], v[68:71], a[248:255], v1
    ds_read_b128 v[96:99], v3 offset:12288
    s_waitcnt lgkmcnt(3)
    v_smfmac_f32_16x16x64_bf16 v[40:43], v[72:75], v[100:107], v1
    ds_read_b128 v[100:103], v3 offset:19456
    v_smfmac_f32_16x16x64_bf16 v[40:43], v[76:79], v[120:127], v1
    ds_read_b128 v[104:107], v3 offset:26624
    v_smfmac_f32_16x16x64_bf16 v[40:43], v[80:83], v[128:135], v1
    v_smfmac_f32_16x16x64_bf16 v[40:43], v[84:87], v[108:115], v1
    ds_read_b128 v[108:111], v3 offset:33792
    v_smfmac_f32_16x16x64_bf16 v[40:43], v[88:91], v[136:143], v1
    ds_read_b128 v[112:115], v3 offset:40960
    v_smfmac_f32_16x16x64_bf16 v[44:47], v[52:55], v[144:151], v1
    v_smfmac_f32_16x16x64_bf16 v[44:47], v[56:59], v[152:159], v1
    v_add_f32 v40, v40, v41
    v_add_f32 v42, v42, v43
    s_waitcnt lgkmcnt(2)
    v_smfmac_f32_16x16x64_bf16 v[44:47], v[60:63], v[92:99], v1
    v_cvt_pk_bf16_f32 v40, v40, v42
    ds_write_b32 v5, v40 offset:256
    v_smfmac_f32_16x16x64_bf16 v[44:47], v[64:67], v[160:167], v1
    ds_read_b128 v[92:95], v3 offset:6144
    v_smfmac_f32_16x16x64_bf16 v[44:47], v[68:71], v[168:175], v1
    ds_read_b128 v[96:99], v3 offset:13312
    v_smfmac_f32_16x16x64_bf16 v[44:47], v[72:75], v[100:107], v1
    ds_read_b128 v[100:103], v3 offset:20480
    v_smfmac_f32_16x16x64_bf16 v[44:47], v[76:79], v[176:183], v1
    ds_read_b128 v[104:107], v3 offset:27648
    v_smfmac_f32_16x16x64_bf16 v[44:47], v[80:83], v[184:191], v1
    s_waitcnt lgkmcnt(2)
    v_smfmac_f32_16x16x64_bf16 v[44:47], v[84:87], v[108:115], v1
    ds_read_b128 v[108:111], v3 offset:34816
    s_barrier
    v_smfmac_f32_16x16x64_bf16 v[44:47], v[88:91], v[192:199], v1
    ds_read_b128 v[112:115], v3 offset:41984
    v_smfmac_f32_16x16x64_bf16 v[48:51], v[52:55], v[200:207], v1
    v_smfmac_f32_16x16x64_bf16 v[48:51], v[56:59], v[208:215], v1
    v_add_f32 v44, v44, v45
    v_add_f32 v46, v46, v47
    v_smfmac_f32_16x16x64_bf16 v[48:51], v[60:63], v[92:99], v1
    v_cvt_pk_bf16_f32 v44, v44, v46
    v_smfmac_f32_16x16x64_bf16 v[48:51], v[64:67], v[216:223], v1
    ds_write_b32 v5, v44 offset:512
    v_smfmac_f32_16x16x64_bf16 v[48:51], v[68:71], v[224:231], v1
    s_waitcnt lgkmcnt(3)
    v_smfmac_f32_16x16x64_bf16 v[48:51], v[72:75], v[100:107], v1
    v_smfmac_f32_16x16x64_bf16 v[48:51], v[76:79], v[232:239], v1
    v_smfmac_f32_16x16x64_bf16 v[48:51], v[80:83], v[240:247], v1
    s_waitcnt lgkmcnt(1)
    v_smfmac_f32_16x16x64_bf16 v[48:51], v[84:87], v[108:115], v1
    v_smfmac_f32_16x16x64_bf16 v[48:51], v[88:91], v[248:255], v1
    s_nop 7
    v_add_f32 v48, v48, v49
    v_add_f32 v50, v50, v51
    v_cvt_pk_bf16_f32 v48, v48, v50
    ds_write_b32 v5, v48 offset:768
    s_waitcnt lgkmcnt(0)
    s_barrier
    s_add_u32 s5, s5, 1
    s_cmp_ge_u32 s5, 64
    s_cbranch_scc1 L_end2
    v_mov_b64 v[24:25], 0
    v_mov_b64 v[26:27], 0
    v_mov_b64 v[28:29], 0
    v_mov_b64 v[30:31], 0
    v_mov_b64 v[32:33], 0
    v_mov_b64 v[34:35], 0
    v_mov_b64 v[36:37], 0
    v_mov_b64 v[38:39], 0
    v_mov_b64 v[40:41], 0
    v_mov_b64 v[42:43], 0
    v_mov_b64 v[44:45], 0
    v_mov_b64 v[46:47], 0
    v_mov_b64 v[48:49], 0
    v_mov_b64 v[50:51], 0
    ds_read_b128 v[92:95], v3 offset:0
    ds_read_b128 v[96:99], v3 offset:7168
    ds_read_b128 v[100:103], v3 offset:1024
    ds_read_b128 v[104:107], v3 offset:8192
    ds_read_b128 v[108:111], v3 offset:2048
    ds_read_b128 v[112:115], v3 offset:9216
    s_and_b32 s70, s5, 3
    s_lshl_b32 s70, s70, 16
    s_add_u32 s70, s70, s68
    s_add_u32 s86, s70, s64
    s_add_u32 s87, s70, s65
    s_add_u32 s88, s70, s66
    s_add_u32 s89, s70, s67
    s_waitcnt lgkmcnt(0)
    s_branch L_pw_loop_53
L_rt_55:
    s_add_u32 s6, s6, 1
    s_cmp_gt_u32 s6, 200000
    s_cbranch_scc1 L_timeout
    s_nop 3
    s_branch L_pm_54
L_PL:
    v_mov_b32 v24, -1
    v_mov_b32 v25, -1
    v_mov_b32 v26, -1
    v_mov_b32 v27, -1
    v_cmp_gt_u32 vcc, 40, v0
    v_mov_b32 v16, 0x80000000
    s_nop 0
    v_cndmask_b32 v16, v16, v2, vcc
    s_mul_i32 s76, s4, 640
    s_lshr_b32 s7, s4, 3
    s_mul_i32 s7, s7, 27648
    s_add_u32 s76, s76, s7
    s_add_u32 s80, s76, s39
    s_add_u32 s7, s80, 655360
    buffer_store_dwordx4 v[24:27], v16, s[40:43], s7 offen sc1
    s_add_u32 s7, s80, 663552
    buffer_store_dwordx4 v[24:27], v16, s[40:43], s7 offen sc1
    s_add_u32 s7, s80, 671744
    buffer_store_dwordx4 v[24:27], v16, s[40:43], s7 offen sc1
    s_add_u32 s7, s80, 679936
    buffer_store_dwordx4 v[24:27], v16, s[40:43], s7 offen sc1
    s_add_u32 s7, s80, 786432
    buffer_store_dwordx4 v[24:27], v16, s[40:43], s7 offen sc1
    s_add_u32 s7, s80, 794624
    buffer_store_dwordx4 v[24:27], v16, s[40:43], s7 offen sc1
    s_add_u32 s7, s80, 802816
    buffer_store_dwordx4 v[24:27], v16, s[40:43], s7 offen sc1
    s_add_u32 s7, s80, 811008
    buffer_store_dwordx4 v[24:27], v16, s[40:43], s7 offen sc1
    s_add_u32 s7, s80, 917504
    buffer_store_dwordx4 v[24:27], v16, s[40:43], s7 offen sc1
    s_add_u32 s7, s80, 925696
    buffer_store_dwordx4 v[24:27], v16, s[40:43], s7 offen sc1
    s_add_u32 s7, s80, 933888
    buffer_store_dwordx4 v[24:27], v16, s[40:43], s7 offen sc1
    s_add_u32 s7, s80, 942080
    buffer_store_dwordx4 v[24:27], v16, s[40:43], s7 offen sc1
    v_mov_b32 v11, s3
    v_or_b32 v11, v11, v0
    v_cmp_eq_u32 vcc, 0, v11
    v_mov_b32 v11, 0x80000000
    s_nop 0
    v_cndmask_b32_e64 v11, v11, 0, vcc
    s_add_u32 s85, s4, 0
    s_lshl_b32 s85, s85, 7
    s_add_u32 s85, s85, 1835008
    v_mov_b32 v16, 0
    s_add_u32 s7, s85, s39
    buffer_store_dword v16, v11, s[40:43], s7 offen sc1
    s_add_u32 s7, s85, s39
    s_add_u32 s7, s7, 8192
    buffer_store_dword v16, v11, s[40:43], s7 offen sc1
    s_nop 1
    s_mov_b32 s71, 150528
    v_add_u32 v16, 0, v0
    v_mul_u32_u24 v17, 171, v16
    v_lshrrev_b32 v17, 10, v17
    v_mul_u32_u24 v18, 6, v17
    v_sub_u32 v18, v16, v18
    v_mul_u32_u24 v17, 12288, v17
    v_lshl_add_u32 v12, v18, 4, v17
    v_add_u32 v16, 64, v0
    v_mul_u32_u24 v17, 171, v16
    v_lshrrev_b32 v17, 10, v17
    v_mul_u32_u24 v18, 6, v17
    v_sub_u32 v18, v16, v18
    v_mul_u32_u24 v17, 12288, v17
    v_lshl_add_u32 v13, v18, 4, v17
    v_add_u32 v16, 128, v0
    v_mul_u32_u24 v17, 171, v16
    v_lshrrev_b32 v17, 10, v17
    v_mul_u32_u24 v18, 6, v17
    v_sub_u32 v18, v16, v18
    v_mul_u32_u24 v17, 12288, v17
    v_lshl_add_u32 v14, v18, 4, v17
    s_mul_i32 s7, s4, 384
    s_mul_i32 s72, s3, 96
    s_add_u32 s7, s7, s72
    v_add_u32 v12, s7, v12
    v_add_u32 v13, s7, v13
    v_add_u32 v14, s7, v14
    v_lshrrev_b32 v16, 1, v8
    v_lshlrev_b32 v16, 4, v16
    v_lshrrev_b32 v17, 1, v9
    v_lshl_add_u32 v16, v17, 3, v16
    v_and_b32 v17, 1, v8
    v_lshl_add_u32 v16, v17, 2, v16
    v_and_b32 v17, 1, v9
    v_add_u32 v16, v16, v17
    v_mul_u32_u24 v18, 96, v16
    v_lshl_add_u32 v15, v10, 3, v18
    v_add_u32 v15, s71, v15
    s_mov_b32 s72, 0
    s_add_u32 m0, s71, 0
    s_nop 0
    buffer_load_dwordx4 v12, s[48:51], s72 offen lds
    s_add_u32 m0, s71, 1024
    s_nop 0
    buffer_load_dwordx4 v13, s[48:51], s72 offen lds
    s_add_u32 m0, s71, 2048
    s_nop 0
    buffer_load_dwordx4 v14, s[48:51], s72 offen lds
    s_mov_b32 s72, 393216
    s_add_u32 m0, s71, 3072
    s_nop 0
    buffer_load_dwordx4 v12, s[48:51], s72 offen lds
    s_add_u32 m0, s71, 4096
    s_nop 0
    buffer_load_dwordx4 v13, s[48:51], s72 offen lds
    s_add_u32 m0, s71, 5120
    s_nop 0
    buffer_load_dwordx4 v14, s[48:51], s72 offen lds
    s_mov_b32 s72, 786432
    s_add_u32 m0, s71, 6144
    s_nop 0
    buffer_load_dwordx4 v12, s[48:51], s72 offen lds
    s_add_u32 m0, s71, 7168
    s_nop 0
    buffer_load_dwordx4 v13, s[48:51], s72 offen lds
    s_add_u32 m0, s71, 8192
    s_nop 0
    buffer_load_dwordx4 v14, s[48:51], s72 offen lds
    s_mov_b32 s72, 1179648
    s_add_u32 m0, s71, 9216
    s_nop 0
    buffer_load_dwordx4 v12, s[48:51], s72 offen lds
    s_add_u32 m0, s71, 10240
    s_nop 0
    buffer_load_dwordx4 v13, s[48:51], s72 offen lds
    s_add_u32 m0, s71, 11264
    s_nop 0
    buffer_load_dwordx4 v14, s[48:51], s72 offen lds
    s_waitcnt vmcnt(9)
    s_barrier
    v_mov_b32 v16, 1
    buffer_atomic_add v16, v11, s[60:63], 0 offen sc1
    ds_read_b64_tr_b16 a[0:1], v15 offset:0
    ds_read_b64_tr_b16 a[2:3], v15 offset:192
    ds_read_b64_tr_b16 a[8:9], v15 offset:32
    ds_read_b64_tr_b16 a[10:11], v15 offset:224
    ds_read_b64_tr_b16 a[16:17], v15 offset:64
    ds_read_b64_tr_b16 a[18:19], v15 offset:256
    s_waitcnt lgkmcnt(0)
    s_mov_b32 s72, 1572864
    s_add_u32 m0, s71, 0
    s_nop 0
    buffer_load_dwordx4 v12, s[48:51], s72 offen lds
    s_add_u32 m0, s71, 1024
    s_nop 0
    buffer_load_dwordx4 v13, s[48:51], s72 offen lds
    s_add_u32 m0, s71, 2048
    s_nop 0
    buffer_load_dwordx4 v14, s[48:51], s72 offen lds
    s_waitcnt vmcnt(9)
    ds_read_b64_tr_b16 a[4:5], v15 offset:3072
    ds_read_b64_tr_b16 a[6:7], v15 offset:3264
    ds_read_b64_tr_b16 a[12:13], v15 offset:3104
    ds_read_b64_tr_b16 a[14:15], v15 offset:3296
    ds_read_b64_tr_b16 a[20:21], v15 offset:3136
    ds_read_b64_tr_b16 a[22:23], v15 offset:3328
    s_waitcnt lgkmcnt(0)
    s_mov_b32 s72, 1966080
    s_add_u32 m0, s71, 3072
    s_nop 0
    buffer_load_dwordx4 v12, s[48:51], s72 offen lds
    s_add_u32 m0, s71, 4096
    s_nop 0
    buffer_load_dwordx4 v13, s[48:51], s72 offen lds
    s_add_u32 m0, s71, 5120
    s_nop 0
    buffer_load_dwordx4 v14, s[48:51], s72 offen lds
    s_waitcnt vmcnt(9)
    ds_read_b64_tr_b16 a[24:25], v15 offset:6144
    ds_read_b64_tr_b16 a[26:27], v15 offset:6336
    ds_read_b64_tr_b16 a[32:33], v15 offset:6176
    ds_read_b64_tr_b16 a[34:35], v15 offset:6368
    ds_read_b64_tr_b16 a[40:41], v15 offset:6208
    ds_read_b64_tr_b16 a[42:43], v15 offset:6400
    s_waitcnt lgkmcnt(0)
    s_mov_b32 s72, 2359296
    s_add_u32 m0, s71, 6144
    s_nop 0
    buffer_load_dwordx4 v12, s[48:51], s72 offen lds
    s_add_u32 m0, s71, 7168
    s_nop 0
    buffer_load_dwordx4 v13, s[48:51], s72 offen lds
    s_add_u32 m0, s71, 8192
    s_nop 0
    buffer_load_dwordx4 v14, s[48:51], s72 offen lds
    s_waitcnt vmcnt(9)
    ds_read_b64_tr_b16 a[28:29], v15 offset:9216
    ds_read_b64_tr_b16 a[30:31], v15 offset:9408
    ds_read_b64_tr_b16 a[36:37], v15 offset:9248
    ds_read_b64_tr_b16 a[38:39], v15 offset:9440
    ds_read_b64_tr_b16 a[44:45], v15 offset:9280
    ds_read_b64_tr_b16 a[46:47], v15 offset:9472
    s_waitcnt lgkmcnt(0)
    s_mov_b32 s72, 2752512
    s_add_u32 m0, s71, 9216
    s_nop 0
    buffer_load_dwordx4 v12, s[48:51], s72 offen lds
    s_add_u32 m0, s71, 10240
    s_nop 0
    buffer_load_dwordx4 v13, s[48:51], s72 offen lds
    s_add_u32 m0, s71, 11264
    s_nop 0
    buffer_load_dwordx4 v14, s[48:51], s72 offen lds
    s_waitcnt vmcnt(9)
    ds_read_b64_tr_b16 a[48:49], v15 offset:0
    ds_read_b64_tr_b16 a[50:51], v15 offset:192
    ds_read_b64_tr_b16 a[56:57], v15 offset:32
    ds_read_b64_tr_b16 a[58:59], v15 offset:224
    ds_read_b64_tr_b16 a[64:65], v15 offset:64
    ds_read_b64_tr_b16 a[66:67], v15 offset:256
    s_waitcnt lgkmcnt(0)
    s_mov_b32 s72, 3145728
    s_add_u32 m0, s71, 0
    s_nop 0
    buffer_load_dwordx4 v12, s[48:51], s72 offen lds
    s_add_u32 m0, s71, 1024
    s_nop 0
    buffer_load_dwordx4 v13, s[48:51], s72 offen lds
    s_add_u32 m0, s71, 2048
    s_nop 0
    buffer_load_dwordx4 v14, s[48:51], s72 offen lds
    s_waitcnt vmcnt(9)
    ds_read_b64_tr_b16 a[52:53], v15 offset:3072
    ds_read_b64_tr_b16 a[54:55], v15 offset:3264
    ds_read_b64_tr_b16 a[60:61], v15 offset:3104
    ds_read_b64_tr_b16 a[62:63], v15 offset:3296
    ds_read_b64_tr_b16 a[68:69], v15 offset:3136
    ds_read_b64_tr_b16 a[70:71], v15 offset:3328
    s_waitcnt lgkmcnt(0)
    s_mov_b32 s72, 3538944
    s_add_u32 m0, s71, 3072
    s_nop 0
    buffer_load_dwordx4 v12, s[48:51], s72 offen lds
    s_add_u32 m0, s71, 4096
    s_nop 0
    buffer_load_dwordx4 v13, s[48:51], s72 offen lds
    s_add_u32 m0, s71, 5120
    s_nop 0
    buffer_load_dwordx4 v14, s[48:51], s72 offen lds
    s_waitcnt vmcnt(9)
    ds_read_b64_tr_b16 a[72:73], v15 offset:6144
    ds_read_b64_tr_b16 a[74:75], v15 offset:6336
    ds_read_b64_tr_b16 a[128:129], v15 offset:6176
    ds_read_b64_tr_b16 a[130:131], v15 offset:6368
    ds_read_b64_tr_b16 a[184:185], v15 offset:6208
    ds_read_b64_tr_b16 a[186:187], v15 offset:6400
    s_waitcnt lgkmcnt(0)
    s_mov_b32 s72, 3932160
    s_add_u32 m0, s71, 6144
    s_nop 0
    buffer_load_dwordx4 v12, s[48:51], s72 offen lds
    s_add_u32 m0, s71, 7168
    s_nop 0
    buffer_load_dwordx4 v13, s[48:51], s72 offen lds
    s_add_u32 m0, s71, 8192
    s_nop 0
    buffer_load_dwordx4 v14, s[48:51], s72 offen lds
    s_waitcnt vmcnt(9)
    ds_read_b64_tr_b16 a[76:77], v15 offset:9216
    ds_read_b64_tr_b16 a[78:79], v15 offset:9408
    ds_read_b64_tr_b16 a[132:133], v15 offset:9248
    ds_read_b64_tr_b16 a[134:135], v15 offset:9440
    ds_read_b64_tr_b16 a[188:189], v15 offset:9280
    ds_read_b64_tr_b16 a[190:191], v15 offset:9472
    s_waitcnt lgkmcnt(0)
    s_mov_b32 s72, 4325376
    s_add_u32 m0, s71, 9216
    s_nop 0
    buffer_load_dwordx4 v12, s[48:51], s72 offen lds
    s_add_u32 m0, s71, 10240
    s_nop 0
    buffer_load_dwordx4 v13, s[48:51], s72 offen lds
    s_add_u32 m0, s71, 11264
    s_nop 0
    buffer_load_dwordx4 v14, s[48:51], s72 offen lds
    s_waitcnt vmcnt(9)
    ds_read_b64_tr_b16 a[80:81], v15 offset:0
    ds_read_b64_tr_b16 a[82:83], v15 offset:192
    ds_read_b64_tr_b16 a[136:137], v15 offset:32
    ds_read_b64_tr_b16 a[138:139], v15 offset:224
    ds_read_b64_tr_b16 a[192:193], v15 offset:64
    ds_read_b64_tr_b16 a[194:195], v15 offset:256
    s_waitcnt lgkmcnt(0)
    s_mov_b32 s72, 4718592
    s_add_u32 m0, s71, 0
    s_nop 0
    buffer_load_dwordx4 v12, s[48:51], s72 offen lds
    s_add_u32 m0, s71, 1024
    s_nop 0
    buffer_load_dwordx4 v13, s[48:51], s72 offen lds
    s_add_u32 m0, s71, 2048
    s_nop 0
    buffer_load_dwordx4 v14, s[48:51], s72 offen lds
    s_waitcnt vmcnt(9)
    ds_read_b64_tr_b16 a[84:85], v15 offset:3072
    ds_read_b64_tr_b16 a[86:87], v15 offset:3264
    ds_read_b64_tr_b16 a[140:141], v15 offset:3104
    ds_read_b64_tr_b16 a[142:143], v15 offset:3296
    ds_read_b64_tr_b16 a[196:197], v15 offset:3136
    ds_read_b64_tr_b16 a[198:199], v15 offset:3328
    s_waitcnt lgkmcnt(0)
    s_mov_b32 s72, 5111808
    s_add_u32 m0, s71, 3072
    s_nop 0
    buffer_load_dwordx4 v12, s[48:51], s72 offen lds
    s_add_u32 m0, s71, 4096
    s_nop 0
    buffer_load_dwordx4 v13, s[48:51], s72 offen lds
    s_add_u32 m0, s71, 5120
    s_nop 0
    buffer_load_dwordx4 v14, s[48:51], s72 offen lds
    s_waitcnt vmcnt(9)
    ds_read_b64_tr_b16 a[88:89], v15 offset:6144
    ds_read_b64_tr_b16 a[90:91], v15 offset:6336
    ds_read_b64_tr_b16 a[144:145], v15 offset:6176
    ds_read_b64_tr_b16 a[146:147], v15 offset:6368
    ds_read_b64_tr_b16 a[200:201], v15 offset:6208
    ds_read_b64_tr_b16 a[202:203], v15 offset:6400
    s_waitcnt lgkmcnt(0)
    s_mov_b32 s72, 5505024
    s_add_u32 m0, s71, 6144
    s_nop 0
    buffer_load_dwordx4 v12, s[48:51], s72 offen lds
    s_add_u32 m0, s71, 7168
    s_nop 0
    buffer_load_dwordx4 v13, s[48:51], s72 offen lds
    s_add_u32 m0, s71, 8192
    s_nop 0
    buffer_load_dwordx4 v14, s[48:51], s72 offen lds
    s_waitcnt vmcnt(9)
    ds_read_b64_tr_b16 a[92:93], v15 offset:9216
    ds_read_b64_tr_b16 a[94:95], v15 offset:9408
    ds_read_b64_tr_b16 a[148:149], v15 offset:9248
    ds_read_b64_tr_b16 a[150:151], v15 offset:9440
    ds_read_b64_tr_b16 a[204:205], v15 offset:9280
    ds_read_b64_tr_b16 a[206:207], v15 offset:9472
    s_waitcnt lgkmcnt(0)
    s_mov_b32 s72, 5898240
    s_add_u32 m0, s71, 9216
    s_nop 0
    buffer_load_dwordx4 v12, s[48:51], s72 offen lds
    s_add_u32 m0, s71, 10240
    s_nop 0
    buffer_load_dwordx4 v13, s[48:51], s72 offen lds
    s_add_u32 m0, s71, 11264
    s_nop 0
    buffer_load_dwordx4 v14, s[48:51], s72 offen lds
    s_waitcnt vmcnt(9)
    ds_read_b64_tr_b16 a[96:97], v15 offset:0
    ds_read_b64_tr_b16 a[98:99], v15 offset:192
    ds_read_b64_tr_b16 a[152:153], v15 offset:32
    ds_read_b64_tr_b16 a[154:155], v15 offset:224
    ds_read_b64_tr_b16 a[208:209], v15 offset:64
    ds_read_b64_tr_b16 a[210:211], v15 offset:256
    s_waitcnt lgkmcnt(0)
    s_mov_b32 s72, 6291456
    s_add_u32 m0, s71, 0
    s_nop 0
    buffer_load_dwordx4 v12, s[48:51], s72 offen lds
    s_add_u32 m0, s71, 1024
    s_nop 0
    buffer_load_dwordx4 v13, s[48:51], s72 offen lds
    s_add_u32 m0, s71, 2048
    s_nop 0
    buffer_load_dwordx4 v14, s[48:51], s72 offen lds
    s_waitcnt vmcnt(9)
    ds_read_b64_tr_b16 a[100:101], v15 offset:3072
    ds_read_b64_tr_b16 a[102:103], v15 offset:3264
    ds_read_b64_tr_b16 a[156:157], v15 offset:3104
    ds_read_b64_tr_b16 a[158:159], v15 offset:3296
    ds_read_b64_tr_b16 a[212:213], v15 offset:3136
    ds_read_b64_tr_b16 a[214:215], v15 offset:3328
    s_waitcnt lgkmcnt(0)
    s_mov_b32 s72, 6684672
    s_add_u32 m0, s71, 3072
    s_nop 0
    buffer_load_dwordx4 v12, s[48:51], s72 offen lds
    s_add_u32 m0, s71, 4096
    s_nop 0
    buffer_load_dwordx4 v13, s[48:51], s72 offen lds
    s_add_u32 m0, s71, 5120
    s_nop 0
    buffer_load_dwordx4 v14, s[48:51], s72 offen lds
    s_waitcnt vmcnt(9)
    ds_read_b64_tr_b16 a[104:105], v15 offset:6144
    ds_read_b64_tr_b16 a[106:107], v15 offset:6336
    ds_read_b64_tr_b16 a[160:161], v15 offset:6176
    ds_read_b64_tr_b16 a[162:163], v15 offset:6368
    ds_read_b64_tr_b16 a[216:217], v15 offset:6208
    ds_read_b64_tr_b16 a[218:219], v15 offset:6400
    s_waitcnt lgkmcnt(0)
    s_mov_b32 s72, 7077888
    s_add_u32 m0, s71, 6144
    s_nop 0
    buffer_load_dwordx4 v12, s[48:51], s72 offen lds
    s_add_u32 m0, s71, 7168
    s_nop 0
    buffer_load_dwordx4 v13, s[48:51], s72 offen lds
    s_add_u32 m0, s71, 8192
    s_nop 0
    buffer_load_dwordx4 v14, s[48:51], s72 offen lds
    s_waitcnt vmcnt(9)
    ds_read_b64_tr_b16 a[108:109], v15 offset:9216
    ds_read_b64_tr_b16 a[110:111], v15 offset:9408
    ds_read_b64_tr_b16 a[164:165], v15 offset:9248
    ds_read_b64_tr_b16 a[166:167], v15 offset:9440
    ds_read_b64_tr_b16 a[220:221], v15 offset:9280
    ds_read_b64_tr_b16 a[222:223], v15 offset:9472
    s_waitcnt lgkmcnt(0)
    s_mov_b32 s72, 7471104
    s_add_u32 m0, s71, 9216
    s_nop 0
    buffer_load_dwordx4 v12, s[48:51], s72 offen lds
    s_add_u32 m0, s71, 10240
    s_nop 0
    buffer_load_dwordx4 v13, s[48:51], s72 offen lds
    s_add_u32 m0, s71, 11264
    s_nop 0
    buffer_load_dwordx4 v14, s[48:51], s72 offen lds
    s_waitcnt vmcnt(9)
    ds_read_b64_tr_b16 a[112:113], v15 offset:0
    ds_read_b64_tr_b16 a[114:115], v15 offset:192
    ds_read_b64_tr_b16 a[168:169], v15 offset:32
    ds_read_b64_tr_b16 a[170:171], v15 offset:224
    ds_read_b64_tr_b16 a[224:225], v15 offset:64
    ds_read_b64_tr_b16 a[226:227], v15 offset:256
    s_waitcnt vmcnt(6)
    ds_read_b64_tr_b16 a[116:117], v15 offset:3072
    ds_read_b64_tr_b16 a[118:119], v15 offset:3264
    ds_read_b64_tr_b16 a[172:173], v15 offset:3104
    ds_read_b64_tr_b16 a[174:175], v15 offset:3296
    ds_read_b64_tr_b16 a[228:229], v15 offset:3136
    ds_read_b64_tr_b16 a[230:231], v15 offset:3328
    s_waitcnt vmcnt(3)
    ds_read_b64_tr_b16 a[120:121], v15 offset:6144
    ds_read_b64_tr_b16 a[122:123], v15 offset:6336
    ds_read_b64_tr_b16 a[176:177], v15 offset:6176
    ds_read_b64_tr_b16 a[178:179], v15 offset:6368
    ds_read_b64_tr_b16 a[232:233], v15 offset:6208
    ds_read_b64_tr_b16 a[234:235], v15 offset:6400
    s_waitcnt vmcnt(0)
    ds_read_b64_tr_b16 a[124:125], v15 offset:9216
    ds_read_b64_tr_b16 a[126:127], v15 offset:9408
    ds_read_b64_tr_b16 a[180:181], v15 offset:9248
    ds_read_b64_tr_b16 a[182:183], v15 offset:9440
    ds_read_b64_tr_b16 a[236:237], v15 offset:9280
    ds_read_b64_tr_b16 a[238:239], v15 offset:9472
    s_waitcnt lgkmcnt(0)
    s_barrier
    v_lshl_add_u32 v16, v8, 2, v9
    v_and_b32 v17, 1, v10
    v_lshlrev_b32 v17, 3, v17
    v_lshl_add_u32 v16, v16, 4, v17
    v_add_u32 v5, 143360, v16
    v_lshlrev_b32 v16, 2, v8
    v_sub_u32 v16, v7, v16
    v_cmp_le_i32 s[44:45], 0, v16
    v_cmp_le_i32 s[46:47], 1, v16
    v_cmp_le_i32 s[48:49], 2, v16
    v_cmp_le_i32 s[50:51], 3, v16
    v_mov_b32 v15, 0x80000000
    v_lshrrev_b32 v16, 1, v8
    v_lshlrev_b32 v17, 8, v16
    v_lshl_add_u32 v17, v7, 5, v17
    v_and_b32 v18, 1, v8
    v_lshl_add_u32 v17, v18, 4, v17
    v_cmp_gt_u32 vcc, 8, v7
    v_add_u32 v17, s76, v17
    s_nop 0
    v_cndmask_b32 v6, v15, v17, vcc
    v_lshl_add_u32 v16, v16, 4, v7
    v_cmp_gt_u32 vcc, 8, v16
    v_lshlrev_b32 v17, 4, v7
    v_lshl_add_u32 v17, v8, 3, v17
    v_add_u32 v18, 512, v17
    v_add_u32 v18, s76, v18
    v_cndmask_b32 v12, v15, v18, vcc
    v_add_u32 v17, 2048, v17
    v_cmp_gt_u32 vcc, 2, v8
    s_nop 1
    v_cndmask_b32 v13, v15, v17, vcc
    s_mul_i32 s7, s4, 3
    s_add_u32 s7, s7, 96
    v_and_b32 v16, 1, v0
    v_lshl_add_u32 v16, v16, 1, s7
    v_lshrrev_b32 v16, 2, v16
    v_lshlrev_b32 v14, 7, v16
    s_mul_i32 s7, s4, 3
    s_add_u32 s7, s7, 0
    v_and_b32 v16, 1, v0
    v_lshl_add_u32 v16, v16, 1, s7
    v_lshrrev_b32 v16, 2, v16
    v_lshlrev_b32 v18, 7, v16
    v_and_b32 v16, 2, v0
    v_cmp_eq_u32 vcc, 0, v16
    s_nop 1
    v_cndmask_b32 v14, v18, v14, vcc
    s_mov_b32 s84, 0
    v_mov_b32 v15, 0xff61b1e6
    s_mov_b32 s74, 0x3dd53b95
    s_mov_b32 s75, s74
    s_mul_i32 s77, s4, 12288
    s_add_u32 s77, s77, 0x2000000
    s_mul_i32 s79, s4, 2560
    s_add_u32 s79, s79, 0xa00000
    s_cmp_lg_u32 s3, 0
    s_cbranch_scc1 L_wsd_57
L_ws_56:
    buffer_load_dword v16, off, s[60:63], 0 sc1
    buffer_load_dword v17, off, s[60:63], 0 offset:128 sc1
    s_waitcnt vmcnt(0)
    v_cmp_gt_u32 vcc, 256, v16
    s_cbranch_vccnz L_ws_56_r
    v_cmp_gt_u32 vcc, 0x28000000, v17
    s_cbranch_vccz L_wsd_57
L_ws_56_r:
    s_sleep 16
    s_add_u32 s6, s6, 1
    s_cmp_gt_u32 s6, 200000
    s_cbranch_scc1 L_timeout
    s_branch L_ws_56
L_wsd_57:
    s_barrier
    buffer_load_dword v16, off, s[60:63], 0 offset:128 sc1
    s_waitcnt vmcnt(0)
    v_readfirstlane_b32 s68, v16
    s_nop 0
    s_bfe_u32 s7, s68, 0xc0000
    s_cmp_gt_u32 s7, 40
    s_cselect_b32 s7, 8192, 0
    s_add_u32 s38, s38, s7
    s_bfe_u32 s7, s68, 0xc000c
    s_cmp_gt_u32 s7, 40
    s_cselect_b32 s7, 8192, 0
    s_add_u32 s39, s39, s7
    s_add_u32 s68, s39, 1179648
    s_add_u32 s69, s39, 655360
    s_add_u32 s85, s85, s39
    s_add_u32 s83, s5, 1
    s_min_u32 s83, s83, 64
    s_cmp_ge_u32 s84, s83
    s_cbranch_scc1 L_wNd_58
L_wf_59:
    buffer_load_dword v36, v14, s[40:43], 0 offen sc1
    s_waitcnt vmcnt(0)
    v_cmp_gt_u32 vcc, s83, v36
    s_cbranch_vccz L_wfd_60
    s_sleep 2
    s_add_u32 s6, s6, 1
    s_cmp_gt_u32 s6, 200000
    s_cbranch_scc1 L_timeout
    s_branch L_wf_59
L_wfd_60:
    s_mov_b32 s84, s83
    s_add_u32 s80, s83, 1
    v_cmp_gt_u32 vcc, s80, v36
    s_cbranch_vccnz L_wNd_58
    s_mov_b32 s84, s80
    s_add_u32 s80, s83, 2
    v_cmp_gt_u32 vcc, s80, v36
    s_cbranch_vccnz L_wNd_58
    s_mov_b32 s84, s80
    s_add_u32 s80, s83, 4
    v_cmp_gt_u32 vcc, s80, v36
    s_cbranch_vccnz L_wNd_58
    s_mov_b32 s84, s80
    s_add_u32 s80, s83, 8
    v_cmp_gt_u32 vcc, s80, v36
    s_cbranch_vccnz L_wNd_58
    s_mov_b32 s84, s80
    s_add_u32 s80, s83, 16
    v_cmp_gt_u32 vcc, s80, v36
    s_cbranch_vccnz L_wNd_58
    s_mov_b32 s84, s80
L_wNd_58:
    s_add_u32 s80, s77, 25165824
    buffer_load_dwordx4 v[92:95], v2, s[40:43], s80 offen offset:0 sc1
    buffer_load_dwordx4 v[96:99], v2, s[40:43], s80 offen offset:1024 sc1
    buffer_load_dwordx4 v[100:103], v2, s[40:43], s80 offen offset:2048 sc1
    buffer_load_dwordx4 v[104:107], v2, s[40:43], s80 offen offset:3072 sc1
    s_add_u32 s80, s77, 25169920
    buffer_load_dwordx4 v[108:111], v2, s[40:43], s80 offen offset:0 sc1
    buffer_load_dwordx4 v[112:115], v2, s[40:43], s80 offen offset:1024 sc1
    buffer_load_dwordx4 v[116:119], v2, s[40:43], s80 offen offset:2048 sc1
    buffer_load_dwordx4 v[120:123], v2, s[40:43], s80 offen offset:3072 sc1
    s_add_u32 s80, s77, 25174016
    buffer_load_dwordx4 v[124:127], v2, s[40:43], s80 offen offset:0 sc1
    buffer_load_dwordx4 v[128:131], v2, s[40:43], s80 offen offset:1024 sc1
    buffer_load_dwordx4 v[132:135], v2, s[40:43], s80 offen offset:2048 sc1
    buffer_load_dwordx4 v[136:139], v2, s[40:43], s80 offen offset:3072 sc1
    s_add_u32 s80, s77, 0
    buffer_load_dwordx4 v[140:143], v2, s[40:43], s80 offen offset:0 sc1
    buffer_load_dwordx4 v[144:147], v2, s[40:43], s80 offen offset:1024 sc1
    buffer_load_dwordx4 v[148:151], v2, s[40:43], s80 offen offset:2048 sc1
    buffer_load_dwordx4 v[152:155], v2, s[40:43], s80 offen offset:3072 sc1
    s_add_u32 s80, s77, 4096
    buffer_load_dwordx4 v[156:159], v2, s[40:43], s80 offen offset:0 sc1
    buffer_load_dwordx4 v[160:163], v2, s[40:43], s80 offen offset:1024 sc1
    buffer_load_dwordx4 v[164:167], v2, s[40:43], s80 offen offset:2048 sc1
    buffer_load_dwordx4 v[168:171], v2, s[40:43], s80 offen offset:3072 sc1
    s_add_u32 s80, s77, 8192
    buffer_load_dwordx4 v[172:175], v2, s[40:43], s80 offen offset:0 sc1
    buffer_load_dwordx4 v[176:179], v2, s[40:43], s80 offen offset:1024 sc1
    buffer_load_dwordx4 v[180:183], v2, s[40:43], s80 offen offset:2048 sc1
    buffer_load_dwordx4 v[184:187], v2, s[40:43], s80 offen offset:3072 sc1
    s_add_u32 s77, s77, 393216
    v_mov_b64 v[24:25], 0
    v_mov_b64 v[26:27], 0
    v_mov_b64 v[28:29], 0
    v_mov_b64 v[30:31], 0
    v_mov_b64 v[32:33], 0
    v_mov_b64 v[34:35], 0
    s_and_b32 s76, s5, 3
    s_lshl_b32 s76, s76, 17
    s_add_u32 s76, s76, s69
.p2align 6
L_pl_loop_61:
    s_barrier
    ds_read_b128 v[52:55], v20 offset:0
    ds_read_b128 v[56:59], v20 offset:1024
    ds_read_b128 v[60:63], v20 offset:2048
    s_waitcnt lgkmcnt(2)
    v_smfmac_f32_16x16x64_bf16 v[24:27], v[52:55], a[0:7], v1
    ds_read_b128 v[64:67], v20 offset:3072
    v_smfmac_f32_16x16x64_bf16 v[28:31], v[52:55], a[8:15], v1
    ds_read_b128 v[68:71], v20 offset:4096
    v_smfmac_f32_16x16x64_bf16 v[32:35], v[52:55], a[16:23], v1
    ds_read_b128 v[72:75], v20 offset:5120
    s_waitcnt lgkmcnt(4)
    v_smfmac_f32_16x16x64_bf16 v[24:27], v[56:59], a[24:31], v1
    ds_read_b128 v[76:79], v20 offset:6144
    v_smfmac_f32_16x16x64_bf16 v[28:31], v[56:59], a[32:39], v1
    ds_read_b128 v[80:83], v20 offset:7168
    v_smfmac_f32_16x16x64_bf16 v[32:35], v[56:59], a[40:47], v1
    ds_read_b128 v[84:87], v20 offset:8192
    s_waitcnt lgkmcnt(6)
    v_smfmac_f32_16x16x64_bf16 v[24:27], v[60:63], a[48:55], v1
    ds_read_b128 v[88:91], v20 offset:9216
    v_smfmac_f32_16x16x64_bf16 v[28:31], v[60:63], a[56:63], v1
    v_smfmac_f32_16x16x64_bf16 v[32:35], v[60:63], a[64:71], v1
    s_waitcnt lgkmcnt(6)
    v_smfmac_f32_16x16x64_bf16 v[24:27], v[64:67], a[72:79], v1
    s_waitcnt lgkmcnt(5)
    v_smfmac_f32_16x16x64_bf16 v[24:27], v[68:71], a[80:87], v1
    s_waitcnt lgkmcnt(4)
    v_smfmac_f32_16x16x64_bf16 v[24:27], v[72:75], a[88:95], v1
    s_waitcnt lgkmcnt(3)
    v_smfmac_f32_16x16x64_bf16 v[24:27], v[76:79], a[96:103], v1
    s_waitcnt lgkmcnt(2)
    v_smfmac_f32_16x16x64_bf16 v[24:27], v[80:83], a[104:111], v1
    s_waitcnt lgkmcnt(1)
    v_smfmac_f32_16x16x64_bf16 v[24:27], v[84:87], a[112:119], v1
    s_waitcnt lgkmcnt(0)
    v_smfmac_f32_16x16x64_bf16 v[24:27], v[88:91], a[120:127], v1
    v_smfmac_f32_16x16x64_bf16 v[28:31], v[64:67], a[128:135], v1
    v_smfmac_f32_16x16x64_bf16 v[28:31], v[68:71], a[136:143], v1
    v_add_f32 v24, v24, v25
    v_smfmac_f32_16x16x64_bf16 v[28:31], v[72:75], a[144:151], v1
    v_add_f32 v26, v26, v27
    v_smfmac_f32_16x16x64_bf16 v[28:31], v[76:79], a[152:159], v1
    v_cvt_pk_bf16_f32 v24, v24, v26
    v_smfmac_f32_16x16x64_bf16 v[28:31], v[80:83], a[160:167], v1
    ds_write_b32 v4, v24 offset:0
    v_smfmac_f32_16x16x64_bf16 v[28:31], v[84:87], a[168:175], v1
    v_smfmac_f32_16x16x64_bf16 v[28:31], v[88:91], a[176:183], v1
    v_smfmac_f32_16x16x64_bf16 v[32:35], v[64:67], a[184:191], v1
    v_smfmac_f32_16x16x64_bf16 v[32:35], v[68:71], a[192:199], v1
    v_add_f32 v28, v28, v29
    v_smfmac_f32_16x16x64_bf16 v[32:35], v[72:75], a[200:207], v1
    v_add_f32 v30, v30, v31
    v_smfmac_f32_16x16x64_bf16 v[32:35], v[76:79], a[208:215], v1
    v_cvt_pk_bf16_f32 v28, v28, v30
    v_smfmac_f32_16x16x64_bf16 v[32:35], v[80:83], a[216:223], v1
    s_waitcnt vmcnt(0)
    v_mov_b32 v16, s5
    buffer_store_dword v16, v11, s[40:43], s85 offen sc1
    ds_write_b32 v4, v28 offset:256
    v_smfmac_f32_16x16x64_bf16 v[32:35], v[84:87], a[224:231], v1
    v_smfmac_f32_16x16x64_bf16 v[32:35], v[88:91], a[232:239], v1
    s_nop 7
    v_add_f32 v32, v32, v33
    v_add_f32 v34, v34, v35
    v_cvt_pk_bf16_f32 v32, v32, v34
    ds_write_b32 v4, v32 offset:512
    s_waitcnt lgkmcnt(0)
    s_barrier
    ds_read_b64_tr_b16 v[188:189], v5 offset:0
    ds_read_b64_tr_b16 v[190:191], v5 offset:256
    ds_read_b64_tr_b16 v[192:193], v5 offset:512
    ds_read_b64_tr_b16 v[194:195], v5 offset:768
    ds_read_b64_tr_b16 v[196:197], v5 offset:1024
    ds_read_b64_tr_b16 v[198:199], v5 offset:1280
    ds_read_b64_tr_b16 v[200:201], v5 offset:1536
    ds_read_b64_tr_b16 v[202:203], v5 offset:1792
    ds_read_b64_tr_b16 v[204:205], v5 offset:2048
    ds_read_b64_tr_b16 v[206:207], v5 offset:2304
    ds_read_b64_tr_b16 v[208:209], v5 offset:2560
    ds_read_b64_tr_b16 v[210:211], v5 offset:2816
    s_waitcnt lgkmcnt(10)
    v_mfma_f32_16x16x32_bf16 v[236:239], v[92:95], v[188:191], 0
    v_mfma_f32_16x16x32_bf16 v[240:243], v[96:99], v[188:191], 0
    s_waitcnt lgkmcnt(8)
    v_mfma_f32_16x16x32_bf16 v[236:239], v[100:103], v[192:195], v[236:239]
    v_mfma_f32_16x16x32_bf16 v[240:243], v[104:107], v[192:195], v[240:243]
    s_waitcnt lgkmcnt(6)
    v_mfma_f32_16x16x32_bf16 v[236:239], v[108:111], v[196:199], v[236:239]
    v_mfma_f32_16x16x32_bf16 v[240:243], v[112:115], v[196:199], v[240:243]
    s_waitcnt lgkmcnt(4)
    v_mfma_f32_16x16x32_bf16 v[236:239], v[116:119], v[200:203], v[236:239]
    v_mfma_f32_16x16x32_bf16 v[240:243], v[120:123], v[200:203], v[240:243]
    s_waitcnt lgkmcnt(2)
    v_mfma_f32_16x16x32_bf16 v[236:239], v[124:127], v[204:207], v[236:239]
    v_mfma_f32_16x16x32_bf16 v[240:243], v[128:131], v[204:207], v[240:243]
    s_waitcnt lgkmcnt(0)
    v_mfma_f32_16x16x32_bf16 v[236:239], v[132:135], v[208:211], v[236:239]
    v_mfma_f32_16x16x32_bf16 v[240:243], v[136:139], v[208:211], v[240:243]
    s_barrier
    ds_read_b64_tr_b16 v[212:213], v5 offset:3072
    ds_read_b64_tr_b16 v[214:215], v5 offset:3328
    ds_read_b64_tr_b16 v[220:221], v5 offset:4096
    ds_read_b64_tr_b16 v[222:223], v5 offset:4352
    ds_read_b64_tr_b16 v[228:229], v5 offset:5120
    ds_read_b64_tr_b16 v[230:231], v5 offset:5376
    v_max3_f32 v37, v236, v237, v238
    v_max3_f32 v37, v37, v239, v240
    v_max3_f32 v37, v37, v241, v242
    v_max_f32 v37, v37, v243
    v_mov_b32 v17, v37
    s_nop 1
    v_permlane32_swap_b32 v37, v17
    v_max_f32 v37, v37, v17
    v_mov_b32 v17, v37
    s_nop 1
    v_permlane16_swap_b32 v37, v17
    v_max_f32 v37, v37, v17
    v_mul_f32 v38, s74, v37
    v_pk_fma_f32 v[236:237], v[236:237], s[74:75], v[38:39] op_sel_hi:[1,1,0] neg_lo:[0,0,1] neg_hi:[0,0,1]
    v_pk_fma_f32 v[238:239], v[238:239], s[74:75], v[38:39] op_sel_hi:[1,1,0] neg_lo:[0,0,1] neg_hi:[0,0,1]
    v_pk_fma_f32 v[240:241], v[240:241], s[74:75], v[38:39] op_sel_hi:[1,1,0] neg_lo:[0,0,1] neg_hi:[0,0,1]
    v_pk_fma_f32 v[242:243], v[242:243], s[74:75], v[38:39] op_sel_hi:[1,1,0] neg_lo:[0,0,1] neg_hi:[0,0,1]
    s_waitcnt lgkmcnt(4)
    v_mfma_f32_16x16x32_bf16 v[244:247], v[212:215], v[188:191], 0
    v_exp_f32 v236, v236
    s_waitcnt lgkmcnt(2)
    v_mfma_f32_16x16x32_bf16 v[244:247], v[220:223], v[196:199], v[244:247]
    v_exp_f32 v237, v237
    s_waitcnt lgkmcnt(0)
    v_mfma_f32_16x16x32_bf16 v[244:247], v[228:231], v[204:207], v[244:247]
    v_exp_f32 v238, v238
    v_exp_f32 v239, v239
    v_exp_f32 v240, v240
    v_exp_f32 v241, v241
    v_exp_f32 v242, v242
    v_exp_f32 v243, v243
    v_pk_add_f32 v[40:41], v[236:237], v[238:239]
    v_pk_add_f32 v[42:43], v[240:241], v[242:243]
    v_pk_add_f32 v[40:41], v[40:41], v[42:43]
    v_add_f32 v39, v40, v41
    v_mov_b32 v17, v39
    v_permlane16_swap_b32 v236, v238
    v_permlane16_swap_b32 v237, v239
    v_permlane32_swap_b32 v39, v17
    v_permlane16_swap_b32 v240, v242
    v_permlane16_swap_b32 v241, v243
    v_add_f32 v39, v39, v17
    s_barrier
    ds_read_b64_tr_b16 v[216:217], v5 offset:3584
    ds_read_b64_tr_b16 v[218:219], v5 offset:3840
    ds_read_b64_tr_b16 v[224:225], v5 offset:4608
    ds_read_b64_tr_b16 v[226:227], v5 offset:4864
    ds_read_b64_tr_b16 v[232:233], v5 offset:5632
    ds_read_b64_tr_b16 v[234:235], v5 offset:5888
    s_waitcnt lgkmcnt(4)
    v_mfma_f32_16x16x32_bf16 v[244:247], v[216:219], v[192:195], v[244:247]
    s_waitcnt lgkmcnt(2)
    v_mfma_f32_16x16x32_bf16 v[244:247], v[224:227], v[200:203], v[244:247]
    s_waitcnt lgkmcnt(0)
    v_mfma_f32_16x16x32_bf16 v[244:247], v[232:235], v[208:211], v[244:247]
    s_nop 7
    v_max3_f32 v18, v244, v245, v246
    v_max3_f32 v18, v18, v247, v37
    v_mov_b32 v17, v18
    s_nop 1
    v_permlane16_swap_b32 v18, v17
    v_max_f32 v18, v18, v17
    v_mul_f32 v18, s74, v18
    v_sub_f32 v19, v38, v18
    v_pk_fma_f32 v[244:245], v[244:245], s[74:75], v[18:19] op_sel_hi:[1,1,0] neg_lo:[0,0,1] neg_hi:[0,0,1]
    v_pk_fma_f32 v[246:247], v[246:247], s[74:75], v[18:19] op_sel_hi:[1,1,0] neg_lo:[0,0,1] neg_hi:[0,0,1]
    v_exp_f32 v19, v19
    v_exp_f32 v244, v244
    v_exp_f32 v245, v245
    v_exp_f32 v246, v246
    v_exp_f32 v247, v247
    s_nop 0
    v_pk_add_f32 v[40:41], v[244:245], v[246:247]
    v_add_f32 v40, v40, v41
    v_fma_f32 v39, v39, v19, v40
    v_mov_b32 v17, v39
    s_nop 1
    v_permlane16_swap_b32 v39, v17
    v_add_f32 v39, v39, v17
    v_rcp_f32 v16, v39
    s_nop 0
    v_mul_f32 v38, v19, v16
    v_pk_mul_f32 v[244:245], v[244:245], v[16:17] op_sel_hi:[1,0]
    v_pk_mul_f32 v[246:247], v[246:247], v[16:17] op_sel_hi:[1,0]
    v_cvt_pk_bf16_f32 v252, v244, v245
    v_cvt_pk_bf16_f32 v253, v246, v247
    v_pk_mul_f32 v[236:237], v[236:237], v[38:39] op_sel_hi:[1,0]
    v_pk_mul_f32 v[240:241], v[240:241], v[38:39] op_sel_hi:[1,0]
    v_permlane16_swap_b32 v252, v253
    v_pk_mul_f32 v[238:239], v[238:239], v[38:39] op_sel_hi:[1,0]
    v_pk_mul_f32 v[242:243], v[242:243], v[38:39] op_sel_hi:[1,0]
    buffer_store_dwordx2 v[252:253], v12, s[40:43], s76 offen sc1
    v_cvt_pk_bf16_f32 v248, v236, v237
    v_cvt_pk_bf16_f32 v249, v240, v241
    v_cvt_pk_bf16_f32 v250, v238, v239
    v_cvt_pk_bf16_f32 v251, v242, v243
    buffer_store_dwordx4 v[248:251], v6, s[40:43], s76 offen sc1
    buffer_load_dword v36, v14, s[40:43], 0 offen sc1
    s_add_u32 s7, s5, 3
    s_and_b32 s7, s7, 3
    s_lshl_b32 s7, s7, 17
    s_add_u32 s7, s7, s69
    v_mov_b32 v24, -1
    v_mov_b32 v25, -1
    v_mov_b32 v26, -1
    v_mov_b32 v27, -1
    buffer_store_dwordx4 v[24:27], v6, s[40:43], s7 offen sc1
    buffer_store_dwordx2 v[24:25], v12, s[40:43], s7 offen sc1
    v_mfma_f32_16x16x32_bf16 v[52:55], v[212:215], v[140:143], 0
    v_mfma_f32_16x16x32_bf16 v[56:59], v[92:95], v[140:143], 0
    v_mfma_f32_16x16x32_bf16 v[60:63], v[212:215], v[144:147], 0
    v_mfma_f32_16x16x32_bf16 v[64:67], v[92:95], v[144:147], 0
    v_mfma_f32_16x16x32_bf16 v[68:71], v[96:99], v[144:147], 0
    v_mfma_f32_16x16x32_bf16 v[52:55], v[216:219], v[148:151], v[52:55]
    v_mfma_f32_16x16x32_bf16 v[56:59], v[100:103], v[148:151], v[56:59]
    v_mfma_f32_16x16x32_bf16 v[60:63], v[216:219], v[152:155], v[60:63]
    v_mfma_f32_16x16x32_bf16 v[64:67], v[100:103], v[152:155], v[64:67]
    v_mfma_f32_16x16x32_bf16 v[68:71], v[104:107], v[152:155], v[68:71]
    v_mfma_f32_16x16x32_bf16 v[52:55], v[220:223], v[156:159], v[52:55]
    v_mfma_f32_16x16x32_bf16 v[56:59], v[108:111], v[156:159], v[56:59]
    v_mfma_f32_16x16x32_bf16 v[60:63], v[220:223], v[160:163], v[60:63]
    v_mfma_f32_16x16x32_bf16 v[64:67], v[108:111], v[160:163], v[64:67]
    v_mfma_f32_16x16x32_bf16 v[68:71], v[112:115], v[160:163], v[68:71]
    v_mfma_f32_16x16x32_bf16 v[52:55], v[224:227], v[164:167], v[52:55]
    v_mfma_f32_16x16x32_bf16 v[56:59], v[116:119], v[164:167], v[56:59]
    v_mfma_f32_16x16x32_bf16 v[60:63], v[224:227], v[168:171], v[60:63]
    v_mfma_f32_16x16x32_bf16 v[64:67], v[116:119], v[168:171], v[64:67]
    v_mfma_f32_16x16x32_bf16 v[68:71], v[120:123], v[168:171], v[68:71]
    v_mfma_f32_16x16x32_bf16 v[52:55], v[228:231], v[172:175], v[52:55]
    v_mfma_f32_16x16x32_bf16 v[56:59], v[124:127], v[172:175], v[56:59]
    v_mfma_f32_16x16x32_bf16 v[60:63], v[228:231], v[176:179], v[60:63]
    v_mfma_f32_16x16x32_bf16 v[64:67], v[124:127], v[176:179], v[64:67]
    v_mfma_f32_16x16x32_bf16 v[68:71], v[128:131], v[176:179], v[68:71]
    v_mfma_f32_16x16x32_bf16 v[52:55], v[232:235], v[180:183], v[52:55]
    v_mfma_f32_16x16x32_bf16 v[56:59], v[132:135], v[180:183], v[56:59]
    v_mfma_f32_16x16x32_bf16 v[60:63], v[232:235], v[184:187], v[60:63]
    v_mfma_f32_16x16x32_bf16 v[64:67], v[132:135], v[184:187], v[64:67]
    v_mfma_f32_16x16x32_bf16 v[68:71], v[136:139], v[184:187], v[68:71]
    s_add_u32 s5, s5, 1
    s_add_u32 s83, s5, 1
    s_min_u32 s83, s83, 64
    s_cmp_ge_u32 s84, s83
    s_cbranch_scc1 L_wNd_62
    s_waitcnt vmcnt(2)
    v_cmp_gt_u32 vcc, s83, v36
    s_cbranch_vccz L_wNo_63
L_wf_64:
    buffer_load_dword v36, v14, s[40:43], 0 offen sc1
    s_waitcnt vmcnt(0)
    v_cmp_gt_u32 vcc, s83, v36
    s_cbranch_vccz L_wfd_65
    s_sleep 2
    s_add_u32 s6, s6, 1
    s_cmp_gt_u32 s6, 200000
    s_cbranch_scc1 L_timeout
    s_branch L_wf_64
L_wfd_65:
L_wNo_63:
    s_mov_b32 s84, s83
    s_add_u32 s80, s83, 1
    v_cmp_gt_u32 vcc, s80, v36
    s_cbranch_vccnz L_wNd_62
    s_mov_b32 s84, s80
    s_add_u32 s80, s83, 2
    v_cmp_gt_u32 vcc, s80, v36
    s_cbranch_vccnz L_wNd_62
    s_mov_b32 s84, s80
    s_add_u32 s80, s83, 4
    v_cmp_gt_u32 vcc, s80, v36
    s_cbranch_vccnz L_wNd_62
    s_mov_b32 s84, s80
    s_add_u32 s80, s83, 8
    v_cmp_gt_u32 vcc, s80, v36
    s_cbranch_vccnz L_wNd_62
    s_mov_b32 s84, s80
    s_add_u32 s80, s83, 16
    v_cmp_gt_u32 vcc, s80, v36
    s_cbranch_vccnz L_wNd_62
    s_mov_b32 s84, s80
L_wNd_62:
    v_cndmask_b32_e64 v56, v15, v56, s[44:45]
    s_add_u32 s80, s77, 25165824
    buffer_load_dwordx4 v[92:95], v2, s[40:43], s80 offen offset:0 sc1
    v_cndmask_b32_e64 v57, v15, v57, s[46:47]
    v_cndmask_b32_e64 v58, v15, v58, s[48:49]
    v_cndmask_b32_e64 v59, v15, v59, s[50:51]
    v_max3_f32 v37, v52, v53, v54
    buffer_load_dwordx4 v[96:99], v2, s[40:43], s80 offen offset:1024 sc1
    v_max3_f32 v37, v37, v55, v56
    v_max3_f32 v37, v37, v57, v58
    v_max_f32 v37, v37, v59
    v_mov_b32 v17, v37
    buffer_load_dwordx4 v[100:103], v2, s[40:43], s80 offen offset:2048 sc1
    s_nop 0
    v_permlane32_swap_b32 v37, v17
    v_max_f32 v37, v37, v17
    v_mov_b32 v17, v37
    s_nop 1
    v_permlane16_swap_b32 v37, v17
    buffer_load_dwordx4 v[104:107], v2, s[40:43], s80 offen offset:3072 sc1
    v_max_f32 v37, v37, v17
    v_mul_f32 v38, s74, v37
    v_pk_fma_f32 v[52:53], v[52:53], s[74:75], v[38:39] op_sel_hi:[1,1,0] neg_lo:[0,0,1] neg_hi:[0,0,1]
    v_pk_fma_f32 v[54:55], v[54:55], s[74:75], v[38:39] op_sel_hi:[1,1,0] neg_lo:[0,0,1] neg_hi:[0,0,1]
    s_add_u32 s80, s77, 25169920
    buffer_load_dwordx4 v[108:111], v2, s[40:43], s80 offen offset:0 sc1
    v_pk_fma_f32 v[56:57], v[56:57], s[74:75], v[38:39] op_sel_hi:[1,1,0] neg_lo:[0,0,1] neg_hi:[0,0,1]
    v_pk_fma_f32 v[58:59], v[58:59], s[74:75], v[38:39] op_sel_hi:[1,1,0] neg_lo:[0,0,1] neg_hi:[0,0,1]
    v_exp_f32 v52, v52
    v_exp_f32 v53, v53
    buffer_load_dwordx4 v[112:115], v2, s[40:43], s80 offen offset:1024 sc1
    v_exp_f32 v54, v54
    v_exp_f32 v55, v55
    v_exp_f32 v56, v56
    v_exp_f32 v57, v57
    buffer_load_dwordx4 v[116:119], v2, s[40:43], s80 offen offset:2048 sc1
    v_exp_f32 v58, v58
    v_exp_f32 v59, v59
    v_pk_add_f32 v[40:41], v[52:53], v[54:55]
    v_pk_add_f32 v[42:43], v[56:57], v[58:59]
    buffer_load_dwordx4 v[120:123], v2, s[40:43], s80 offen offset:3072 sc1
    v_add_f32 v40, v40, v41
    v_add_f32 v39, v42, v43
    v_fma_f32 v39, v40, 0.5, v39
    v_mov_b32 v17, v39
    s_add_u32 s80, s77, 25174016
    buffer_load_dwordx4 v[124:127], v2, s[40:43], s80 offen offset:0 sc1
    v_permlane32_swap_b32 v39, v17
    v_add_f32 v39, v39, v17
    v_mov_b32 v17, v39
    s_nop 1
    v_permlane16_swap_b32 v39, v17
    buffer_load_dwordx4 v[128:131], v2, s[40:43], s80 offen offset:1024 sc1
    v_add_f32 v39, v39, v17
    v_rcp_f32 v16, v39
    s_nop 0
    v_pk_mul_f32 v[52:53], v[52:53], v[16:17] op_sel_hi:[1,0]
    v_pk_mul_f32 v[54:55], v[54:55], v[16:17] op_sel_hi:[1,0]
    buffer_load_dwordx4 v[132:135], v2, s[40:43], s80 offen offset:2048 sc1
    v_pk_mul_f32 v[56:57], v[56:57], v[16:17] op_sel_hi:[1,0]
    v_pk_mul_f32 v[58:59], v[58:59], v[16:17] op_sel_hi:[1,0]
    v_cvt_pk_bf16_f32 v72, v56, v57
    v_cvt_pk_bf16_f32 v76, v52, v53
    buffer_load_dwordx4 v[136:139], v2, s[40:43], s80 offen offset:3072 sc1
    v_cvt_pk_bf16_f32 v73, v58, v59
    v_cvt_pk_bf16_f32 v77, v54, v55
    v_mov_b64 v[74:75], 0
    buffer_store_dwordx4 v[72:75], v2, s[40:43], s79 offen offset:0 sc1
    s_add_u32 s80, s77, 0
    buffer_load_dwordx4 v[140:143], v2, s[40:43], s80 offen offset:0 sc1
    buffer_store_dwordx2 v[76:77], v13, s[40:43], s79 offen offset:0 sc1
    v_cndmask_b32_e64 v68, v15, v68, s[44:45]
    v_cndmask_b32_e64 v69, v15, v69, s[46:47]
    v_cndmask_b32_e64 v70, v15, v70, s[48:49]
    buffer_load_dwordx4 v[144:147], v2, s[40:43], s80 offen offset:1024 sc1
    v_cndmask_b32_e64 v71, v15, v71, s[50:51]
    v_max3_f32 v37, v60, v61, v62
    v_max3_f32 v37, v37, v63, v64
    v_max3_f32 v37, v37, v65, v66
    buffer_load_dwordx4 v[148:151], v2, s[40:43], s80 offen offset:2048 sc1
    v_max3_f32 v37, v37, v67, v68
    v_max3_f32 v37, v37, v69, v70
    v_max_f32 v37, v37, v71
    v_mov_b32 v17, v37
    buffer_load_dwordx4 v[152:155], v2, s[40:43], s80 offen offset:3072 sc1
    s_nop 0
    v_permlane32_swap_b32 v37, v17
    v_max_f32 v37, v37, v17
    v_mov_b32 v17, v37
    s_nop 1
    v_permlane16_swap_b32 v37, v17
    s_add_u32 s80, s77, 4096
    buffer_load_dwordx4 v[156:159], v2, s[40:43], s80 offen offset:0 sc1
    v_max_f32 v37, v37, v17
    v_mul_f32 v38, s74, v37
    v_pk_fma_f32 v[60:61], v[60:61], s[74:75], v[38:39] op_sel_hi:[1,1,0] neg_lo:[0,0,1] neg_hi:[0,0,1]
    v_pk_fma_f32 v[62:63], v[62:63], s[74:75], v[38:39] op_sel_hi:[1,1,0] neg_lo:[0,0,1] neg_hi:[0,0,1]
    buffer_load_dwordx4 v[160:163], v2, s[40:43], s80 offen offset:1024 sc1
    v_pk_fma_f32 v[64:65], v[64:65], s[74:75], v[38:39] op_sel_hi:[1,1,0] neg_lo:[0,0,1] neg_hi:[0,0,1]
    v_pk_fma_f32 v[66:67], v[66:67], s[74:75], v[38:39] op_sel_hi:[1,1,0] neg_lo:[0,0,1] neg_hi:[0,0,1]
    v_pk_fma_f32 v[68:69], v[68:69], s[74:75], v[38:39] op_sel_hi:[1,1,0] neg_lo:[0,0,1] neg_hi:[0,0,1]
    v_pk_fma_f32 v[70:71], v[70:71], s[74:75], v[38:39] op_sel_hi:[1,1,0] neg_lo:[0,0,1] neg_hi:[0,0,1]
    buffer_load_dwordx4 v[164:167], v2, s[40:43], s80 offen offset:2048 sc1
    v_exp_f32 v60, v60
    v_exp_f32 v61, v61
    v_exp_f32 v62, v62
    v_exp_f32 v63, v63
    buffer_load_dwordx4 v[168:171], v2, s[40:43], s80 offen offset:3072 sc1
    v_exp_f32 v64, v64
    v_exp_f32 v65, v65
    v_exp_f32 v66, v66
    v_exp_f32 v67, v67
    s_add_u32 s80, s77, 8192
    buffer_load_dwordx4 v[172:175], v2, s[40:43], s80 offen offset:0 sc1
    v_exp_f32 v68, v68
    v_exp_f32 v69, v69
    v_exp_f32 v70, v70
    v_exp_f32 v71, v71
    buffer_load_dwordx4 v[176:179], v2, s[40:43], s80 offen offset:1024 sc1
    v_pk_add_f32 v[40:41], v[60:61], v[62:63]
    v_pk_add_f32 v[42:43], v[64:65], v[66:67]
    v_pk_add_f32 v[44:45], v[68:69], v[70:71]
    v_pk_add_f32 v[42:43], v[42:43], v[44:45]
    buffer_load_dwordx4 v[180:183], v2, s[40:43], s80 offen offset:2048 sc1
    v_add_f32 v40, v40, v41
    v_add_f32 v39, v42, v43
    v_fma_f32 v39, v40, 0.5, v39
    v_mov_b32 v17, v39
    buffer_load_dwordx4 v[184:187], v2, s[40:43], s80 offen offset:3072 sc1
    s_nop 0
    v_permlane32_swap_b32 v39, v17
    v_add_f32 v39, v39, v17
    v_mov_b32 v17, v39
    s_nop 1
    v_permlane16_swap_b32 v39, v17
    v_add_f32 v39, v39, v17
    v_rcp_f32 v16, v39
    s_nop 0
    v_pk_mul_f32 v[60:61], v[60:61], v[16:17] op_sel_hi:[1,0]
    v_pk_mul_f32 v[62:63], v[62:63], v[16:17] op_sel_hi:[1,0]
    v_pk_mul_f32 v[64:65], v[64:65], v[16:17] op_sel_hi:[1,0]
    v_pk_mul_f32 v[66:67], v[66:67], v[16:17] op_sel_hi:[1,0]
    v_pk_mul_f32 v[68:69], v[68:69], v[16:17] op_sel_hi:[1,0]
    v_pk_mul_f32 v[70:71], v[70:71], v[16:17] op_sel_hi:[1,0]
    v_cvt_pk_bf16_f32 v80, v64, v65
    v_cvt_pk_bf16_f32 v82, v68, v69
    v_cvt_pk_bf16_f32 v84, v60, v61
    v_cvt_pk_bf16_f32 v81, v66, v67
    v_cvt_pk_bf16_f32 v83, v70, v71
    v_cvt_pk_bf16_f32 v85, v62, v63
    buffer_store_dwordx4 v[80:83], v2, s[40:43], s79 offen offset:1024 sc1
    buffer_store_dwordx2 v[84:85], v13, s[40:43], s79 offen offset:256 sc1
    s_add_u32 s77, s77, 393216
    s_add_u32 s79, s79, 81920
    s_cmp_ge_u32 s5, 64
    s_cbranch_scc1 L_p_fin_66
    v_mov_b64 v[24:25], 0
    v_mov_b64 v[26:27], 0
    v_mov_b64 v[28:29], 0
    v_mov_b64 v[30:31], 0
    v_mov_b64 v[32:33], 0
    v_mov_b64 v[34:35], 0
    s_and_b32 s76, s5, 3
    s_lshl_b32 s76, s76, 17
    s_add_u32 s76, s76, s69
    s_branch L_pl_loop_61
L_p_fin_66:
    s_waitcnt vmcnt(0)
    v_mov_b32 v16, s5
    buffer_store_dword v16, v11, s[40:43], s85 offen sc1
    s_endpgm
L_V:
    s_getpc_b64 s[96:97]
L_pc_67:
    s_lshl_b32 s98, s3, 10
    v_lshl_add_u32 v250, v0, 4, s98
    v_mov_b32 v251, s97
    v_add_co_u32 v250, vcc, s96, v250
    s_nop 1
    v_addc_co_u32 v251, vcc, 0, v251, vcc
    global_load_dwordx4 v[252:255], v[250:251], off
    v_add_co_u32 v250, vcc, 0x1000, v250
    s_nop 1
    v_addc_co_u32 v251, vcc, 0, v251, vcc
    global_load_dwordx4 v[252:255], v[250:251], off
    v_add_co_u32 v250, vcc, 0x1000, v250
    s_nop 1
    v_addc_co_u32 v251, vcc, 0, v251, vcc
    global_load_dwordx4 v[252:255], v[250:251], off
    v_add_co_u32 v250, vcc, 0x1000, v250
    s_nop 1
    v_addc_co_u32 v251, vcc, 0, v251, vcc
    global_load_dwordx4 v[252:255], v[250:251], off
    v_add_co_u32 v250, vcc, 0x1000, v250
    s_nop 1
    v_addc_co_u32 v251, vcc, 0, v251, vcc
    global_load_dwordx4 v[252:255], v[250:251], off
    v_add_co_u32 v250, vcc, 0x1000, v250
    s_nop 1
    v_addc_co_u32 v251, vcc, 0, v251, vcc
    global_load_dwordx4 v[252:255], v[250:251], off
    v_add_co_u32 v250, vcc, 0x1000, v250
    s_nop 1
    v_addc_co_u32 v251, vcc, 0, v251, vcc
    s_mov_b32 s48, s16
    s_mov_b32 s49, s17
    s_mov_b32 s50, 0x780000
    s_mov_b32 s51, 0x20000
    s_mov_b32 s52, s18
    s_mov_b32 s53, s19
    s_mov_b32 s54, 0x780000
    s_mov_b32 s55, 0x20000
    v_and_b32 v24, 15, v0
    v_lshrrev_b32 v25, 4, v0
    v_lshrrev_b32 v26, 2, v24
    v_and_b32 v27, 3, v0
    v_and_b32 v16, 1, v0
    v_cmp_eq_u32 vcc, 0, v16
    v_mov_b32 v16, 0xeeee
    v_mov_b32 v17, 0x4444
    v_cndmask_b32 v1, v16, v17, vcc
    v_lshlrev_b32 v2, 4, v0
    s_mul_i32 s73, s3, 3
    s_add_u32 s7, s73, 0
    s_cmp_ge_u32 s7, 10
    s_cselect_b32 s90, 10, 0
    s_sub_u32 s7, s7, s90
    s_lshl_b32 s90, s7, 10
    s_add_u32 s7, s73, 1
    s_cmp_ge_u32 s7, 10
    s_cselect_b32 s91, 10, 0
    s_sub_u32 s7, s7, s91
    s_lshl_b32 s91, s7, 10
    s_add_u32 s7, s73, 2
    s_cmp_ge_u32 s7, 10
    s_cselect_b32 s92, 10, 0
    s_sub_u32 s7, s7, s92
    s_lshl_b32 s92, s7, 10
    s_add_u32 s7, s73, 3
    s_cmp_ge_u32 s7, 10
    s_cselect_b32 s93, 10, 0
    s_sub_u32 s7, s7, s93
    s_lshl_b32 s93, s7, 10
    s_add_u32 s7, s73, 4
    s_cmp_ge_u32 s7, 10
    s_cselect_b32 s94, 10, 0
    s_sub_u32 s7, s7, s94
    s_lshl_b32 s94, s7, 10
    s_add_u32 s7, s73, 5
    s_cmp_ge_u32 s7, 10
    s_cselect_b32 s95, 10, 0
    s_sub_u32 s7, s7, s95
    s_lshl_b32 s95, s7, 10
    s_add_u32 s7, s73, 6
    s_cmp_ge_u32 s7, 10
    s_cselect_b32 s96, 10, 0
    s_sub_u32 s7, s7, s96
    s_lshl_b32 s96, s7, 10
    s_add_u32 s7, s73, 7
    s_cmp_ge_u32 s7, 10
    s_cselect_b32 s97, 10, 0
    s_sub_u32 s7, s7, s97
    s_lshl_b32 s97, s7, 10
    s_add_u32 s7, s73, 8
    s_cmp_ge_u32 s7, 10
    s_cselect_b32 s98, 10, 0
    s_sub_u32 s7, s7, s98
    s_lshl_b32 s98, s7, 10
    s_add_u32 s7, s73, 9
    s_cmp_ge_u32 s7, 10
    s_cselect_b32 s99, 10, 0
    s_sub_u32 s7, s7, s99
    s_lshl_b32 s99, s7, 10
    s_add_u32 s7, s90, 98304
    v_add_u32 v20, s7, v2
    s_add_u32 s7, s91, 97280
    v_add_u32 v21, s7, v2
    s_add_u32 s7, s94, 94208
    v_add_u32 v22, s7, v2
    s_add_u32 s7, s97, 91136
    v_add_u32 v23, s7, v2
    s_cmp_ge_u32 s90, 8192
    s_cselect_b32 s64, 24576, 0
    s_add_u32 s64, s64, s90
    s_cmp_ge_u32 s91, 8192
    s_cselect_b32 s65, 24576, 0
    s_add_u32 s65, s65, s91
    s_cmp_ge_u32 s92, 8192
    s_cselect_b32 s66, 24576, 0
    s_add_u32 s66, s66, s92
    s_cmp_ge_u32 s93, 8192
    s_cselect_b32 s67, 24576, 0
    s_add_u32 s67, s67, s93
    s_mul_i32 s7, s3, 24576
    v_add_u32 v3, s7, v2
    v_lshlrev_b32 v16, 3, v25
    v_lshl_add_u32 v16, v24, 5, v16
    s_lshl_b32 s7, s3, 9
    s_add_u32 s7, s7, 108544
    v_add_u32 v4, s7, v16
    s_lshr_b32 s7, s3, 1
    s_lshl_b32 s7, s7, 9
    s_and_b32 s76, s3, 1
    s_lshl_b32 s76, s76, 1
    s_add_u32 s7, s7, s76
    s_add_u32 s7, s7, 110592
    v_add_u32 v5, s7, v16
    s_mul_i32 s7, s3, 163840
    s_lshl_b32 s76, s4, 8
    s_add_u32 s7, s7, s76
    v_lshlrev_b32 v16, 4, v24
    v_add_u32 v16, s7, v16
    v_and_b32 v17, 1, v25
    v_lshl_add_u32 v6, v17, 14, v16
    v_lshrrev_b32 v17, 1, v25
    v_lshl_add_u32 v6, v17, 3, v6
    v_lshl_add_u32 v8, v25, 14, v16
    v_lshrrev_b32 v17, 5, v0
    v_lshl_add_u32 v9, v17, 14, v16
    v_and_b32 v17, 1, v25
    v_lshl_add_u32 v9, v17, 3, v9
    v_add_u32 v9, 131072, v9
    v_mov_b32 v11, s3
    v_or_b32 v11, v11, v0
    v_cmp_eq_u32 vcc, 0, v11
    v_mov_b32 v11, 0x80000000
    s_nop 0
    v_cndmask_b32_e64 v11, v11, 0, vcc
    s_add_u32 s77, s4, 32
    s_lshl_b32 s77, s77, 7
    s_add_u32 s77, s77, 1835008
    v_mov_b32 v16, 0
    s_add_u32 s7, s77, s39
    buffer_store_dword v16, v11, s[40:43], s7 offen sc1
    s_add_u32 s7, s77, s39
    s_add_u32 s7, s7, 8192
    buffer_store_dword v16, v11, s[40:43], s7 offen sc1
    s_nop 1
    s_mul_i32 s71, s3, 40960
    v_add_u32 v16, 0, v0
    v_mul_u32_u24 v17, 171, v16
    v_lshrrev_b32 v17, 10, v17
    v_mul_u32_u24 v18, 6, v17
    v_sub_u32 v18, v16, v18
    v_mul_u32_u24 v17, 12288, v17
    v_lshl_add_u32 v12, v18, 4, v17
    v_add_u32 v16, 64, v0
    v_mul_u32_u24 v17, 171, v16
    v_lshrrev_b32 v17, 10, v17
    v_mul_u32_u24 v18, 6, v17
    v_sub_u32 v18, v16, v18
    v_mul_u32_u24 v17, 12288, v17
    v_lshl_add_u32 v13, v18, 4, v17
    v_add_u32 v16, 128, v0
    v_mul_u32_u24 v17, 171, v16
    v_lshrrev_b32 v17, 10, v17
    v_mul_u32_u24 v18, 6, v17
    v_sub_u32 v18, v16, v18
    v_mul_u32_u24 v17, 12288, v17
    v_lshl_add_u32 v14, v18, 4, v17
    s_mul_i32 s7, s4, 384
    s_mul_i32 s72, s3, 96
    s_add_u32 s7, s7, s72
    v_add_u32 v12, s7, v12
    v_add_u32 v13, s7, v13
    v_add_u32 v14, s7, v14
    v_lshrrev_b32 v16, 1, v25
    v_lshlrev_b32 v16, 4, v16
    v_lshrrev_b32 v17, 1, v26
    v_lshl_add_u32 v16, v17, 3, v16
    v_and_b32 v17, 1, v25
    v_lshl_add_u32 v16, v17, 2, v16
    v_and_b32 v17, 1, v26
    v_add_u32 v16, v16, v17
    v_mul_u32_u24 v18, 96, v16
    v_lshl_add_u32 v15, v27, 3, v18
    v_add_u32 v15, s71, v15
    v_add_u32 v16, 0, v0
    v_mul_u32_u24 v17, 205, v16
    v_lshrrev_b32 v17, 12, v17
    v_mul_u32_u24 v18, 20, v17
    v_sub_u32 v18, v16, v18
    v_mul_u32_u24 v17, 1280, v17
    v_lshl_add_u32 v28, v18, 4, v17
    v_add_u32 v16, 64, v0
    v_mul_u32_u24 v17, 205, v16
    v_lshrrev_b32 v17, 12, v17
    v_mul_u32_u24 v18, 20, v17
    v_sub_u32 v18, v16, v18
    v_mul_u32_u24 v17, 1280, v17
    v_lshl_add_u32 v29, v18, 4, v17
    v_add_u32 v16, 128, v0
    v_mul_u32_u24 v17, 205, v16
    v_lshrrev_b32 v17, 12, v17
    v_mul_u32_u24 v18, 20, v17
    v_sub_u32 v18, v16, v18
    v_mul_u32_u24 v17, 1280, v17
    v_lshl_add_u32 v30, v18, 4, v17
    v_add_u32 v16, 192, v0
    v_mul_u32_u24 v17, 205, v16
    v_lshrrev_b32 v17, 12, v17
    v_mul_u32_u24 v18, 20, v17
    v_sub_u32 v18, v16, v18
    v_mul_u32_u24 v17, 1280, v17
    v_lshl_add_u32 v31, v18, 4, v17
    v_add_u32 v16, 256, v0
    v_mul_u32_u24 v17, 205, v16
    v_lshrrev_b32 v17, 12, v17
    v_mul_u32_u24 v18, 20, v17
    v_sub_u32 v18, v16, v18
    v_mul_u32_u24 v17, 1280, v17
    v_lshl_add_u32 v19, v18, 4, v17
    s_mul_i32 s7, s4, 245760
    s_mul_i32 s72, s3, 320
    s_add_u32 s7, s7, s72
    v_add_u32 v28, s7, v28
    v_add_u32 v29, s7, v29
    v_add_u32 v30, s7, v30
    v_add_u32 v31, s7, v31
    v_add_u32 v19, s7, v19
    v_lshrrev_b32 v16, 1, v26
    v_lshlrev_b32 v16, 4, v16
    v_lshl_add_u32 v16, v25, 2, v16
    v_and_b32 v17, 1, v26
    v_add_u32 v16, v16, v17
    v_mul_u32_u24 v16, 320, v16
    v_lshl_add_u32 v10, v27, 3, v16
    v_add_u32 v10, s71, v10
    v_and_b32 v16, 1, v25
    v_lshl_add_u32 v16, v16, 3, v26
    v_lshlrev_b32 v16, 5, v16
    v_lshl_add_u32 v16, v27, 3, v16
    v_lshrrev_b32 v17, 1, v25
    v_lshl_add_u32 v16, v17, 9, v16
    v_add_u32 v7, 108544, v16
    s_cmp_eq_u32 s3, 1
    s_cbranch_scc1 L_pwv_70
    s_cmp_eq_u32 s3, 2
    s_cbranch_scc1 L_pwv_71
    s_cmp_eq_u32 s3, 3
    s_cbranch_scc1 L_pwv_72
L_pwv_69:
    s_mov_b32 s72, 0
    s_add_u32 m0, s71, 0
    s_nop 0
    buffer_load_dwordx4 v28, s[52:55], s72 offen lds
    s_add_u32 m0, s71, 1024
    s_nop 0
    buffer_load_dwordx4 v29, s[52:55], s72 offen lds
    s_add_u32 m0, s71, 2048
    s_nop 0
    buffer_load_dwordx4 v30, s[52:55], s72 offen lds
    s_add_u32 m0, s71, 3072
    s_nop 0
    buffer_load_dwordx4 v31, s[52:55], s72 offen lds
    s_add_u32 m0, s71, 4096
    s_nop 0
    buffer_load_dwordx4 v19, s[52:55], s72 offen lds
    s_mov_b32 s72, 20480
    s_add_u32 m0, s71, 5120
    s_nop 0
    buffer_load_dwordx4 v28, s[52:55], s72 offen lds
    s_add_u32 m0, s71, 6144
    s_nop 0
    buffer_load_dwordx4 v29, s[52:55], s72 offen lds
    s_add_u32 m0, s71, 7168
    s_nop 0
    buffer_load_dwordx4 v30, s[52:55], s72 offen lds
    s_add_u32 m0, s71, 8192
    s_nop 0
    buffer_load_dwordx4 v31, s[52:55], s72 offen lds
    s_add_u32 m0, s71, 9216
    s_nop 0
    buffer_load_dwordx4 v19, s[52:55], s72 offen lds
    s_mov_b32 s72, 0
    s_add_u32 m0, s71, 20480
    s_nop 0
    buffer_load_dwordx4 v12, s[48:51], s72 offen lds
    s_add_u32 m0, s71, 21504
    s_nop 0
    buffer_load_dwordx4 v13, s[48:51], s72 offen lds
    s_add_u32 m0, s71, 22528
    s_nop 0
    buffer_load_dwordx4 v14, s[48:51], s72 offen lds
    s_mov_b32 s72, 393216
    s_add_u32 m0, s71, 23552
    s_nop 0
    buffer_load_dwordx4 v12, s[48:51], s72 offen lds
    s_add_u32 m0, s71, 24576
    s_nop 0
    buffer_load_dwordx4 v13, s[48:51], s72 offen lds
    s_add_u32 m0, s71, 25600
    s_nop 0
    buffer_load_dwordx4 v14, s[48:51], s72 offen lds
    s_mov_b32 s72, 786432
    s_add_u32 m0, s71, 26624
    s_nop 0
    buffer_load_dwordx4 v12, s[48:51], s72 offen lds
    s_add_u32 m0, s71, 27648
    s_nop 0
    buffer_load_dwordx4 v13, s[48:51], s72 offen lds
    s_add_u32 m0, s71, 28672
    s_nop 0
    buffer_load_dwordx4 v14, s[48:51], s72 offen lds
    s_mov_b32 s72, 61440
    s_add_u32 m0, s71, 10240
    s_nop 0
    buffer_load_dwordx4 v28, s[52:55], s72 offen lds
    s_add_u32 m0, s71, 11264
    s_nop 0
    buffer_load_dwordx4 v29, s[52:55], s72 offen lds
    s_add_u32 m0, s71, 12288
    s_nop 0
    buffer_load_dwordx4 v30, s[52:55], s72 offen lds
    s_add_u32 m0, s71, 13312
    s_nop 0
    buffer_load_dwordx4 v31, s[52:55], s72 offen lds
    s_add_u32 m0, s71, 14336
    s_nop 0
    buffer_load_dwordx4 v19, s[52:55], s72 offen lds
    s_mov_b32 s72, 81920
    s_add_u32 m0, s71, 15360
    s_nop 0
    buffer_load_dwordx4 v28, s[52:55], s72 offen lds
    s_add_u32 m0, s71, 16384
    s_nop 0
    buffer_load_dwordx4 v29, s[52:55], s72 offen lds
    s_add_u32 m0, s71, 17408
    s_nop 0
    buffer_load_dwordx4 v30, s[52:55], s72 offen lds
    s_add_u32 m0, s71, 18432
    s_nop 0
    buffer_load_dwordx4 v31, s[52:55], s72 offen lds
    s_add_u32 m0, s71, 19456
    s_nop 0
    buffer_load_dwordx4 v19, s[52:55], s72 offen lds
    s_mov_b32 s72, 1179648
    s_add_u32 m0, s71, 29696
    s_nop 0
    buffer_load_dwordx4 v12, s[48:51], s72 offen lds
    s_add_u32 m0, s71, 30720
    s_nop 0
    buffer_load_dwordx4 v13, s[48:51], s72 offen lds
    s_add_u32 m0, s71, 31744
    s_nop 0
    buffer_load_dwordx4 v14, s[48:51], s72 offen lds
    s_mov_b32 s72, 1572864
    s_add_u32 m0, s71, 32768
    s_nop 0
    buffer_load_dwordx4 v12, s[48:51], s72 offen lds
    s_add_u32 m0, s71, 33792
    s_nop 0
    buffer_load_dwordx4 v13, s[48:51], s72 offen lds
    s_add_u32 m0, s71, 34816
    s_nop 0
    buffer_load_dwordx4 v14, s[48:51], s72 offen lds
    s_mov_b32 s72, 1966080
    s_add_u32 m0, s71, 35840
    s_nop 0
    buffer_load_dwordx4 v12, s[48:51], s72 offen lds
    s_add_u32 m0, s71, 36864
    s_nop 0
    buffer_load_dwordx4 v13, s[48:51], s72 offen lds
    s_add_u32 m0, s71, 37888
    s_nop 0
    buffer_load_dwordx4 v14, s[48:51], s72 offen lds
    s_waitcnt vmcnt(28)
    s_barrier
    v_mov_b32 v16, 1
    buffer_atomic_add v16, v11, s[60:63], 0 offen sc1
    ds_read_b64_tr_b16 a[192:193], v10 offset:0
    ds_read_b64_tr_b16 a[194:195], v10 offset:640
    ds_read_b64_tr_b16 a[208:209], v10 offset:32
    ds_read_b64_tr_b16 a[210:211], v10 offset:672
    ds_read_b64_tr_b16 v[144:145], v10 offset:64
    ds_read_b64_tr_b16 v[146:147], v10 offset:704
    ds_read_b64_tr_b16 v[80:81], v10 offset:96
    ds_read_b64_tr_b16 v[82:83], v10 offset:736
    ds_read_b64_tr_b16 v[168:169], v10 offset:128
    ds_read_b64_tr_b16 v[170:171], v10 offset:768
    ds_read_b64_tr_b16 a[232:233], v10 offset:160
    ds_read_b64_tr_b16 a[234:235], v10 offset:800
    ds_read_b64_tr_b16 v[192:193], v10 offset:192
    ds_read_b64_tr_b16 v[194:195], v10 offset:832
    ds_read_b64_tr_b16 a[248:249], v10 offset:224
    ds_read_b64_tr_b16 a[250:251], v10 offset:864
    ds_read_b64_tr_b16 v[112:113], v10 offset:256
    ds_read_b64_tr_b16 v[114:115], v10 offset:896
    ds_read_b64_tr_b16 v[240:241], v10 offset:288
    ds_read_b64_tr_b16 v[242:243], v10 offset:928
    s_waitcnt lgkmcnt(0)
    s_mov_b32 s72, 122880
    s_add_u32 m0, s71, 0
    s_nop 0
    buffer_load_dwordx4 v28, s[52:55], s72 offen lds
    s_add_u32 m0, s71, 1024
    s_nop 0
    buffer_load_dwordx4 v29, s[52:55], s72 offen lds
    s_add_u32 m0, s71, 2048
    s_nop 0
    buffer_load_dwordx4 v30, s[52:55], s72 offen lds
    s_add_u32 m0, s71, 3072
    s_nop 0
    buffer_load_dwordx4 v31, s[52:55], s72 offen lds
    s_add_u32 m0, s71, 4096
    s_nop 0
    buffer_load_dwordx4 v19, s[52:55], s72 offen lds
    s_mov_b32 s72, 143360
    s_add_u32 m0, s71, 5120
    s_nop 0
    buffer_load_dwordx4 v28, s[52:55], s72 offen lds
    s_add_u32 m0, s71, 6144
    s_nop 0
    buffer_load_dwordx4 v29, s[52:55], s72 offen lds
    s_add_u32 m0, s71, 7168
    s_nop 0
    buffer_load_dwordx4 v30, s[52:55], s72 offen lds
    s_add_u32 m0, s71, 8192
    s_nop 0
    buffer_load_dwordx4 v31, s[52:55], s72 offen lds
    s_add_u32 m0, s71, 9216
    s_nop 0
    buffer_load_dwordx4 v19, s[52:55], s72 offen lds
    s_waitcnt vmcnt(35)
    ds_read_b64_tr_b16 a[0:1], v15 offset:20480
    ds_read_b64_tr_b16 a[2:3], v15 offset:20672
    ds_read_b64_tr_b16 a[8:9], v15 offset:20512
    ds_read_b64_tr_b16 a[10:11], v15 offset:20704
    ds_read_b64_tr_b16 a[16:17], v15 offset:20544
    ds_read_b64_tr_b16 a[18:19], v15 offset:20736
    s_waitcnt lgkmcnt(0)
    s_mov_b32 s72, 2359296
    s_add_u32 m0, s71, 20480
    s_nop 0
    buffer_load_dwordx4 v12, s[48:51], s72 offen lds
    s_add_u32 m0, s71, 21504
    s_nop 0
    buffer_load_dwordx4 v13, s[48:51], s72 offen lds
    s_add_u32 m0, s71, 22528
    s_nop 0
    buffer_load_dwordx4 v14, s[48:51], s72 offen lds
    s_waitcnt vmcnt(35)
    ds_read_b64_tr_b16 a[4:5], v15 offset:23552
    ds_read_b64_tr_b16 a[6:7], v15 offset:23744
    ds_read_b64_tr_b16 a[12:13], v15 offset:23584
    ds_read_b64_tr_b16 a[14:15], v15 offset:23776
    ds_read_b64_tr_b16 a[20:21], v15 offset:23616
    ds_read_b64_tr_b16 a[22:23], v15 offset:23808
    s_waitcnt lgkmcnt(0)
    s_mov_b32 s72, 2752512
    s_add_u32 m0, s71, 23552
    s_nop 0
    buffer_load_dwordx4 v12, s[48:51], s72 offen lds
    s_add_u32 m0, s71, 24576
    s_nop 0
    buffer_load_dwordx4 v13, s[48:51], s72 offen lds
    s_add_u32 m0, s71, 25600
    s_nop 0
    buffer_load_dwordx4 v14, s[48:51], s72 offen lds
    s_waitcnt vmcnt(35)
    ds_read_b64_tr_b16 a[24:25], v15 offset:26624
    ds_read_b64_tr_b16 a[26:27], v15 offset:26816
    ds_read_b64_tr_b16 v[32:33], v15 offset:26656
    ds_read_b64_tr_b16 v[34:35], v15 offset:26848
    ds_read_b64_tr_b16 a[32:33], v15 offset:26688
    ds_read_b64_tr_b16 a[34:35], v15 offset:26880
    s_waitcnt lgkmcnt(0)
    s_mov_b32 s72, 3145728
    s_add_u32 m0, s71, 26624
    s_nop 0
    buffer_load_dwordx4 v12, s[48:51], s72 offen lds
    s_add_u32 m0, s71, 27648
    s_nop 0
    buffer_load_dwordx4 v13, s[48:51], s72 offen lds
    s_add_u32 m0, s71, 28672
    s_nop 0
    buffer_load_dwordx4 v14, s[48:51], s72 offen lds
    s_waitcnt vmcnt(28)
    ds_read_b64_tr_b16 a[196:197], v10 offset:10240
    ds_read_b64_tr_b16 a[198:199], v10 offset:10880
    ds_read_b64_tr_b16 a[212:213], v10 offset:10272
    ds_read_b64_tr_b16 a[214:215], v10 offset:10912
    ds_read_b64_tr_b16 v[148:149], v10 offset:10304
    ds_read_b64_tr_b16 v[150:151], v10 offset:10944
    ds_read_b64_tr_b16 v[84:85], v10 offset:10336
    ds_read_b64_tr_b16 v[86:87], v10 offset:10976
    ds_read_b64_tr_b16 v[172:173], v10 offset:10368
    ds_read_b64_tr_b16 v[174:175], v10 offset:11008
    ds_read_b64_tr_b16 a[236:237], v10 offset:10400
    ds_read_b64_tr_b16 a[238:239], v10 offset:11040
    ds_read_b64_tr_b16 v[196:197], v10 offset:10432
    ds_read_b64_tr_b16 v[198:199], v10 offset:11072
    ds_read_b64_tr_b16 a[252:253], v10 offset:10464
    ds_read_b64_tr_b16 a[254:255], v10 offset:11104
    ds_read_b64_tr_b16 v[116:117], v10 offset:10496
    ds_read_b64_tr_b16 v[118:119], v10 offset:11136
    ds_read_b64_tr_b16 v[244:245], v10 offset:10528
    ds_read_b64_tr_b16 v[246:247], v10 offset:11168
    s_waitcnt vmcnt(25)
    ds_read_b64_tr_b16 a[28:29], v15 offset:29696
    ds_read_b64_tr_b16 a[30:31], v15 offset:29888
    ds_read_b64_tr_b16 v[36:37], v15 offset:29728
    ds_read_b64_tr_b16 v[38:39], v15 offset:29920
    ds_read_b64_tr_b16 a[36:37], v15 offset:29760
    ds_read_b64_tr_b16 a[38:39], v15 offset:29952
    s_waitcnt lgkmcnt(0)
    s_mov_b32 s72, 3538944
    s_add_u32 m0, s71, 29696
    s_nop 0
    buffer_load_dwordx4 v12, s[48:51], s72 offen lds
    s_add_u32 m0, s71, 30720
    s_nop 0
    buffer_load_dwordx4 v13, s[48:51], s72 offen lds
    s_add_u32 m0, s71, 31744
    s_nop 0
    buffer_load_dwordx4 v14, s[48:51], s72 offen lds
    s_mov_b32 s72, 184320
    s_add_u32 m0, s71, 10240
    s_nop 0
    buffer_load_dwordx4 v28, s[52:55], s72 offen lds
    s_add_u32 m0, s71, 11264
    s_nop 0
    buffer_load_dwordx4 v29, s[52:55], s72 offen lds
    s_add_u32 m0, s71, 12288
    s_nop 0
    buffer_load_dwordx4 v30, s[52:55], s72 offen lds
    s_add_u32 m0, s71, 13312
    s_nop 0
    buffer_load_dwordx4 v31, s[52:55], s72 offen lds
    s_add_u32 m0, s71, 14336
    s_nop 0
    buffer_load_dwordx4 v19, s[52:55], s72 offen lds
    s_mov_b32 s72, 204800
    s_add_u32 m0, s71, 15360
    s_nop 0
    buffer_load_dwordx4 v28, s[52:55], s72 offen lds
    s_add_u32 m0, s71, 16384
    s_nop 0
    buffer_load_dwordx4 v29, s[52:55], s72 offen lds
    s_add_u32 m0, s71, 17408
    s_nop 0
    buffer_load_dwordx4 v30, s[52:55], s72 offen lds
    s_add_u32 m0, s71, 18432
    s_nop 0
    buffer_load_dwordx4 v31, s[52:55], s72 offen lds
    s_add_u32 m0, s71, 19456
    s_nop 0
    buffer_load_dwordx4 v19, s[52:55], s72 offen lds
    s_waitcnt vmcnt(35)
    ds_read_b64_tr_b16 a[40:41], v15 offset:32768
    ds_read_b64_tr_b16 a[42:43], v15 offset:32960
    ds_read_b64_tr_b16 a[48:49], v15 offset:32800
    ds_read_b64_tr_b16 a[50:51], v15 offset:32992
    ds_read_b64_tr_b16 a[56:57], v15 offset:32832
    ds_read_b64_tr_b16 a[58:59], v15 offset:33024
    s_waitcnt lgkmcnt(0)
    s_mov_b32 s72, 3932160
    s_add_u32 m0, s71, 32768
    s_nop 0
    buffer_load_dwordx4 v12, s[48:51], s72 offen lds
    s_add_u32 m0, s71, 33792
    s_nop 0
    buffer_load_dwordx4 v13, s[48:51], s72 offen lds
    s_add_u32 m0, s71, 34816
    s_nop 0
    buffer_load_dwordx4 v14, s[48:51], s72 offen lds
    s_waitcnt vmcnt(35)
    ds_read_b64_tr_b16 a[44:45], v15 offset:35840
    ds_read_b64_tr_b16 a[46:47], v15 offset:36032
    ds_read_b64_tr_b16 a[52:53], v15 offset:35872
    ds_read_b64_tr_b16 a[54:55], v15 offset:36064
    ds_read_b64_tr_b16 a[60:61], v15 offset:35904
    ds_read_b64_tr_b16 a[62:63], v15 offset:36096
    s_waitcnt lgkmcnt(0)
    s_mov_b32 s72, 4325376
    s_add_u32 m0, s71, 35840
    s_nop 0
    buffer_load_dwordx4 v12, s[48:51], s72 offen lds
    s_add_u32 m0, s71, 36864
    s_nop 0
    buffer_load_dwordx4 v13, s[48:51], s72 offen lds
    s_add_u32 m0, s71, 37888
    s_nop 0
    buffer_load_dwordx4 v14, s[48:51], s72 offen lds
    s_waitcnt vmcnt(28)
    ds_read_b64_tr_b16 a[200:201], v10 offset:0
    ds_read_b64_tr_b16 a[202:203], v10 offset:640
    ds_read_b64_tr_b16 a[216:217], v10 offset:32
    ds_read_b64_tr_b16 a[218:219], v10 offset:672
    ds_read_b64_tr_b16 v[152:153], v10 offset:64
    ds_read_b64_tr_b16 v[154:155], v10 offset:704
    ds_read_b64_tr_b16 a[224:225], v10 offset:96
    ds_read_b64_tr_b16 a[226:227], v10 offset:736
    ds_read_b64_tr_b16 v[176:177], v10 offset:128
    ds_read_b64_tr_b16 v[178:179], v10 offset:768
    ds_read_b64_tr_b16 a[240:241], v10 offset:160
    ds_read_b64_tr_b16 a[242:243], v10 offset:800
    ds_read_b64_tr_b16 v[200:201], v10 offset:192
    ds_read_b64_tr_b16 v[202:203], v10 offset:832
    ds_read_b64_tr_b16 v[88:89], v10 offset:224
    ds_read_b64_tr_b16 v[90:91], v10 offset:864
    ds_read_b64_tr_b16 v[224:225], v10 offset:256
    ds_read_b64_tr_b16 v[226:227], v10 offset:896
    ds_read_b64_tr_b16 v[248:249], v10 offset:288
    ds_read_b64_tr_b16 v[250:251], v10 offset:928
    s_waitcnt vmcnt(25)
    ds_read_b64_tr_b16 v[40:41], v15 offset:20480
    ds_read_b64_tr_b16 v[42:43], v15 offset:20672
    ds_read_b64_tr_b16 a[104:105], v15 offset:20512
    ds_read_b64_tr_b16 a[106:107], v15 offset:20704
    ds_read_b64_tr_b16 a[152:153], v15 offset:20544
    ds_read_b64_tr_b16 a[154:155], v15 offset:20736
    s_waitcnt lgkmcnt(0)
    s_mov_b32 s72, 4718592
    s_add_u32 m0, s71, 20480
    s_nop 0
    buffer_load_dwordx4 v12, s[48:51], s72 offen lds
    s_add_u32 m0, s71, 21504
    s_nop 0
    buffer_load_dwordx4 v13, s[48:51], s72 offen lds
    s_add_u32 m0, s71, 22528
    s_nop 0
    buffer_load_dwordx4 v14, s[48:51], s72 offen lds
    s_mov_b32 s72, 40960
    s_add_u32 m0, s71, 0
    s_nop 0
    buffer_load_dwordx4 v28, s[52:55], s72 offen lds
    s_add_u32 m0, s71, 1024
    s_nop 0
    buffer_load_dwordx4 v29, s[52:55], s72 offen lds
    s_add_u32 m0, s71, 2048
    s_nop 0
    buffer_load_dwordx4 v30, s[52:55], s72 offen lds
    s_add_u32 m0, s71, 3072
    s_nop 0
    buffer_load_dwordx4 v31, s[52:55], s72 offen lds
    s_add_u32 m0, s71, 4096
    s_nop 0
    buffer_load_dwordx4 v19, s[52:55], s72 offen lds
    s_mov_b32 s72, 102400
    s_add_u32 m0, s71, 5120
    s_nop 0
    buffer_load_dwordx4 v28, s[52:55], s72 offen lds
    s_add_u32 m0, s71, 6144
    s_nop 0
    buffer_load_dwordx4 v29, s[52:55], s72 offen lds
    s_add_u32 m0, s71, 7168
    s_nop 0
    buffer_load_dwordx4 v30, s[52:55], s72 offen lds
    s_add_u32 m0, s71, 8192
    s_nop 0
    buffer_load_dwordx4 v31, s[52:55], s72 offen lds
    s_add_u32 m0, s71, 9216
    s_nop 0
    buffer_load_dwordx4 v19, s[52:55], s72 offen lds
    s_waitcnt vmcnt(35)
    ds_read_b64_tr_b16 v[44:45], v15 offset:23552
    ds_read_b64_tr_b16 v[46:47], v15 offset:23744
    ds_read_b64_tr_b16 a[108:109], v15 offset:23584
    ds_read_b64_tr_b16 a[110:111], v15 offset:23776
    ds_read_b64_tr_b16 a[156:157], v15 offset:23616
    ds_read_b64_tr_b16 a[158:159], v15 offset:23808
    s_waitcnt lgkmcnt(0)
    s_mov_b32 s72, 5111808
    s_add_u32 m0, s71, 23552
    s_nop 0
    buffer_load_dwordx4 v12, s[48:51], s72 offen lds
    s_add_u32 m0, s71, 24576
    s_nop 0
    buffer_load_dwordx4 v13, s[48:51], s72 offen lds
    s_add_u32 m0, s71, 25600
    s_nop 0
    buffer_load_dwordx4 v14, s[48:51], s72 offen lds
    s_waitcnt vmcnt(35)
    ds_read_b64_tr_b16 a[64:65], v15 offset:26624
    ds_read_b64_tr_b16 a[66:67], v15 offset:26816
    ds_read_b64_tr_b16 a[112:113], v15 offset:26656
    ds_read_b64_tr_b16 a[114:115], v15 offset:26848
    ds_read_b64_tr_b16 v[64:65], v15 offset:26688
    ds_read_b64_tr_b16 v[66:67], v15 offset:26880
    s_waitcnt lgkmcnt(0)
    s_mov_b32 s72, 5505024
    s_add_u32 m0, s71, 26624
    s_nop 0
    buffer_load_dwordx4 v12, s[48:51], s72 offen lds
    s_add_u32 m0, s71, 27648
    s_nop 0
    buffer_load_dwordx4 v13, s[48:51], s72 offen lds
    s_add_u32 m0, s71, 28672
    s_nop 0
    buffer_load_dwordx4 v14, s[48:51], s72 offen lds
    s_waitcnt vmcnt(35)
    ds_read_b64_tr_b16 a[68:69], v15 offset:29696
    ds_read_b64_tr_b16 a[70:71], v15 offset:29888
    ds_read_b64_tr_b16 a[116:117], v15 offset:29728
    ds_read_b64_tr_b16 a[118:119], v15 offset:29920
    ds_read_b64_tr_b16 v[68:69], v15 offset:29760
    ds_read_b64_tr_b16 v[70:71], v15 offset:29952
    s_waitcnt lgkmcnt(0)
    s_mov_b32 s72, 5898240
    s_add_u32 m0, s71, 29696
    s_nop 0
    buffer_load_dwordx4 v12, s[48:51], s72 offen lds
    s_add_u32 m0, s71, 30720
    s_nop 0
    buffer_load_dwordx4 v13, s[48:51], s72 offen lds
    s_add_u32 m0, s71, 31744
    s_nop 0
    buffer_load_dwordx4 v14, s[48:51], s72 offen lds
    s_waitcnt vmcnt(28)
    ds_read_b64_tr_b16 a[204:205], v10 offset:10240
    ds_read_b64_tr_b16 a[206:207], v10 offset:10880
    ds_read_b64_tr_b16 a[220:221], v10 offset:10272
    ds_read_b64_tr_b16 a[222:223], v10 offset:10912
    ds_read_b64_tr_b16 v[156:157], v10 offset:10304
    ds_read_b64_tr_b16 v[158:159], v10 offset:10944
    ds_read_b64_tr_b16 a[228:229], v10 offset:10336
    ds_read_b64_tr_b16 a[230:231], v10 offset:10976
    ds_read_b64_tr_b16 v[180:181], v10 offset:10368
    ds_read_b64_tr_b16 v[182:183], v10 offset:11008
    ds_read_b64_tr_b16 a[244:245], v10 offset:10400
    ds_read_b64_tr_b16 a[246:247], v10 offset:11040
    ds_read_b64_tr_b16 v[204:205], v10 offset:10432
    ds_read_b64_tr_b16 v[206:207], v10 offset:11072
    ds_read_b64_tr_b16 v[92:93], v10 offset:10464
    ds_read_b64_tr_b16 v[94:95], v10 offset:11104
    ds_read_b64_tr_b16 v[228:229], v10 offset:10496
    ds_read_b64_tr_b16 v[230:231], v10 offset:11136
    ds_read_b64_tr_b16 v[252:253], v10 offset:10528
    ds_read_b64_tr_b16 v[254:255], v10 offset:11168
    s_waitcnt lgkmcnt(0)
    s_mov_b32 s72, 163840
    s_add_u32 m0, s71, 10240
    s_nop 0
    buffer_load_dwordx4 v28, s[52:55], s72 offen lds
    s_add_u32 m0, s71, 11264
    s_nop 0
    buffer_load_dwordx4 v29, s[52:55], s72 offen lds
    s_add_u32 m0, s71, 12288
    s_nop 0
    buffer_load_dwordx4 v30, s[52:55], s72 offen lds
    s_add_u32 m0, s71, 13312
    s_nop 0
    buffer_load_dwordx4 v31, s[52:55], s72 offen lds
    s_add_u32 m0, s71, 14336
    s_nop 0
    buffer_load_dwordx4 v19, s[52:55], s72 offen lds
    s_mov_b32 s72, 225280
    s_add_u32 m0, s71, 15360
    s_nop 0
    buffer_load_dwordx4 v28, s[52:55], s72 offen lds
    s_add_u32 m0, s71, 16384
    s_nop 0
    buffer_load_dwordx4 v29, s[52:55], s72 offen lds
    s_add_u32 m0, s71, 17408
    s_nop 0
    buffer_load_dwordx4 v30, s[52:55], s72 offen lds
    s_add_u32 m0, s71, 18432
    s_nop 0
    buffer_load_dwordx4 v31, s[52:55], s72 offen lds
    s_add_u32 m0, s71, 19456
    s_nop 0
    buffer_load_dwordx4 v19, s[52:55], s72 offen lds
    s_waitcnt vmcnt(35)
    ds_read_b64_tr_b16 a[72:73], v15 offset:32768
    ds_read_b64_tr_b16 a[74:75], v15 offset:32960
    ds_read_b64_tr_b16 a[120:121], v15 offset:32800
    ds_read_b64_tr_b16 a[122:123], v15 offset:32992
    ds_read_b64_tr_b16 a[160:161], v15 offset:32832
    ds_read_b64_tr_b16 a[162:163], v15 offset:33024
    s_waitcnt lgkmcnt(0)
    s_mov_b32 s72, 6291456
    s_add_u32 m0, s71, 32768
    s_nop 0
    buffer_load_dwordx4 v12, s[48:51], s72 offen lds
    s_add_u32 m0, s71, 33792
    s_nop 0
    buffer_load_dwordx4 v13, s[48:51], s72 offen lds
    s_add_u32 m0, s71, 34816
    s_nop 0
    buffer_load_dwordx4 v14, s[48:51], s72 offen lds
    s_waitcnt vmcnt(35)
    ds_read_b64_tr_b16 a[76:77], v15 offset:35840
    ds_read_b64_tr_b16 a[78:79], v15 offset:36032
    ds_read_b64_tr_b16 a[124:125], v15 offset:35872
    ds_read_b64_tr_b16 a[126:127], v15 offset:36064
    ds_read_b64_tr_b16 a[164:165], v15 offset:35904
    ds_read_b64_tr_b16 a[166:167], v15 offset:36096
    s_waitcnt lgkmcnt(0)
    s_mov_b32 s72, 6684672
    s_add_u32 m0, s71, 35840
    s_nop 0
    buffer_load_dwordx4 v12, s[48:51], s72 offen lds
    s_add_u32 m0, s71, 36864
    s_nop 0
    buffer_load_dwordx4 v13, s[48:51], s72 offen lds
    s_add_u32 m0, s71, 37888
    s_nop 0
    buffer_load_dwordx4 v14, s[48:51], s72 offen lds
    s_waitcnt vmcnt(35)
    ds_read_b64_tr_b16 a[80:81], v15 offset:20480
    ds_read_b64_tr_b16 a[82:83], v15 offset:20672
    ds_read_b64_tr_b16 v[56:57], v15 offset:20512
    ds_read_b64_tr_b16 v[58:59], v15 offset:20704
    ds_read_b64_tr_b16 a[168:169], v15 offset:20544
    ds_read_b64_tr_b16 a[170:171], v15 offset:20736
    s_waitcnt lgkmcnt(0)
    s_mov_b32 s72, 7077888
    s_add_u32 m0, s71, 20480
    s_nop 0
    buffer_load_dwordx4 v12, s[48:51], s72 offen lds
    s_add_u32 m0, s71, 21504
    s_nop 0
    buffer_load_dwordx4 v13, s[48:51], s72 offen lds
    s_add_u32 m0, s71, 22528
    s_nop 0
    buffer_load_dwordx4 v14, s[48:51], s72 offen lds
    s_waitcnt vmcnt(28)
    ds_read_b64_tr_b16 v[128:129], v10 offset:0
    ds_read_b64_tr_b16 v[130:131], v10 offset:640
    ds_read_b64_tr_b16 v[136:137], v10 offset:32
    ds_read_b64_tr_b16 v[138:139], v10 offset:672
    ds_read_b64_tr_b16 v[96:97], v10 offset:64
    ds_read_b64_tr_b16 v[98:99], v10 offset:704
    ds_read_b64_tr_b16 v[160:161], v10 offset:96
    ds_read_b64_tr_b16 v[162:163], v10 offset:736
    ds_read_b64_tr_b16 v[184:185], v10 offset:128
    ds_read_b64_tr_b16 v[186:187], v10 offset:768
    ds_read_b64_tr_b16 v[104:105], v10 offset:160
    ds_read_b64_tr_b16 v[106:107], v10 offset:800
    ds_read_b64_tr_b16 v[208:209], v10 offset:192
    ds_read_b64_tr_b16 v[210:211], v10 offset:832
    ds_read_b64_tr_b16 v[216:217], v10 offset:224
    ds_read_b64_tr_b16 v[218:219], v10 offset:864
    ds_read_b64_tr_b16 v[232:233], v10 offset:256
    ds_read_b64_tr_b16 v[234:235], v10 offset:896
    ds_read_b64_tr_b16 v[120:121], v10 offset:288
    ds_read_b64_tr_b16 v[122:123], v10 offset:928
    s_waitcnt vmcnt(25)
    ds_read_b64_tr_b16 a[84:85], v15 offset:23552
    ds_read_b64_tr_b16 a[86:87], v15 offset:23744
    ds_read_b64_tr_b16 v[60:61], v15 offset:23584
    ds_read_b64_tr_b16 v[62:63], v15 offset:23776
    ds_read_b64_tr_b16 a[172:173], v15 offset:23616
    ds_read_b64_tr_b16 a[174:175], v15 offset:23808
    s_waitcnt lgkmcnt(0)
    s_mov_b32 s72, 7471104
    s_add_u32 m0, s71, 23552
    s_nop 0
    buffer_load_dwordx4 v12, s[48:51], s72 offen lds
    s_add_u32 m0, s71, 24576
    s_nop 0
    buffer_load_dwordx4 v13, s[48:51], s72 offen lds
    s_add_u32 m0, s71, 25600
    s_nop 0
    buffer_load_dwordx4 v14, s[48:51], s72 offen lds
    s_waitcnt vmcnt(25)
    ds_read_b64_tr_b16 a[88:89], v15 offset:26624
    ds_read_b64_tr_b16 a[90:91], v15 offset:26816
    ds_read_b64_tr_b16 a[128:129], v15 offset:26656
    ds_read_b64_tr_b16 a[130:131], v15 offset:26848
    ds_read_b64_tr_b16 a[176:177], v15 offset:26688
    ds_read_b64_tr_b16 a[178:179], v15 offset:26880
    s_waitcnt vmcnt(22)
    ds_read_b64_tr_b16 a[92:93], v15 offset:29696
    ds_read_b64_tr_b16 a[94:95], v15 offset:29888
    ds_read_b64_tr_b16 a[132:133], v15 offset:29728
    ds_read_b64_tr_b16 a[134:135], v15 offset:29920
    ds_read_b64_tr_b16 a[180:181], v15 offset:29760
    ds_read_b64_tr_b16 a[182:183], v15 offset:29952
    s_waitcnt vmcnt(12)
    ds_read_b64_tr_b16 v[132:133], v10 offset:10240
    ds_read_b64_tr_b16 v[134:135], v10 offset:10880
    ds_read_b64_tr_b16 v[140:141], v10 offset:10272
    ds_read_b64_tr_b16 v[142:143], v10 offset:10912
    ds_read_b64_tr_b16 v[100:101], v10 offset:10304
    ds_read_b64_tr_b16 v[102:103], v10 offset:10944
    ds_read_b64_tr_b16 v[164:165], v10 offset:10336
    ds_read_b64_tr_b16 v[166:167], v10 offset:10976
    ds_read_b64_tr_b16 v[188:189], v10 offset:10368
    ds_read_b64_tr_b16 v[190:191], v10 offset:11008
    ds_read_b64_tr_b16 v[108:109], v10 offset:10400
    ds_read_b64_tr_b16 v[110:111], v10 offset:11040
    ds_read_b64_tr_b16 v[212:213], v10 offset:10432
    ds_read_b64_tr_b16 v[214:215], v10 offset:11072
    ds_read_b64_tr_b16 v[220:221], v10 offset:10464
    ds_read_b64_tr_b16 v[222:223], v10 offset:11104
    ds_read_b64_tr_b16 v[236:237], v10 offset:10496
    ds_read_b64_tr_b16 v[238:239], v10 offset:11136
    ds_read_b64_tr_b16 v[124:125], v10 offset:10528
    ds_read_b64_tr_b16 v[126:127], v10 offset:11168
    s_waitcnt vmcnt(9)
    ds_read_b64_tr_b16 v[48:49], v15 offset:32768
    ds_read_b64_tr_b16 v[50:51], v15 offset:32960
    ds_read_b64_tr_b16 a[136:137], v15 offset:32800
    ds_read_b64_tr_b16 a[138:139], v15 offset:32992
    ds_read_b64_tr_b16 a[184:185], v15 offset:32832
    ds_read_b64_tr_b16 a[186:187], v15 offset:33024
    s_waitcnt vmcnt(6)
    ds_read_b64_tr_b16 v[52:53], v15 offset:35840
    ds_read_b64_tr_b16 v[54:55], v15 offset:36032
    ds_read_b64_tr_b16 a[140:141], v15 offset:35872
    ds_read_b64_tr_b16 a[142:143], v15 offset:36064
    ds_read_b64_tr_b16 a[188:189], v15 offset:35904
    ds_read_b64_tr_b16 a[190:191], v15 offset:36096
    s_waitcnt vmcnt(3)
    ds_read_b64_tr_b16 a[96:97], v15 offset:20480
    ds_read_b64_tr_b16 a[98:99], v15 offset:20672
    ds_read_b64_tr_b16 a[144:145], v15 offset:20512
    ds_read_b64_tr_b16 a[146:147], v15 offset:20704
    ds_read_b64_tr_b16 v[72:73], v15 offset:20544
    ds_read_b64_tr_b16 v[74:75], v15 offset:20736
    s_waitcnt vmcnt(0)
    ds_read_b64_tr_b16 a[100:101], v15 offset:23552
    ds_read_b64_tr_b16 a[102:103], v15 offset:23744
    ds_read_b64_tr_b16 a[148:149], v15 offset:23584
    ds_read_b64_tr_b16 a[150:151], v15 offset:23776
    ds_read_b64_tr_b16 v[76:77], v15 offset:23616
    ds_read_b64_tr_b16 v[78:79], v15 offset:23808
    s_waitcnt lgkmcnt(0)
    s_branch L_pwj_68
L_pwv_70:
    s_mov_b32 s72, 0
    s_add_u32 m0, s71, 0
    s_nop 0
    buffer_load_dwordx4 v28, s[52:55], s72 offen lds
    s_add_u32 m0, s71, 1024
    s_nop 0
    buffer_load_dwordx4 v29, s[52:55], s72 offen lds
    s_add_u32 m0, s71, 2048
    s_nop 0
    buffer_load_dwordx4 v30, s[52:55], s72 offen lds
    s_add_u32 m0, s71, 3072
    s_nop 0
    buffer_load_dwordx4 v31, s[52:55], s72 offen lds
    s_add_u32 m0, s71, 4096
    s_nop 0
    buffer_load_dwordx4 v19, s[52:55], s72 offen lds
    s_mov_b32 s72, 20480
    s_add_u32 m0, s71, 5120
    s_nop 0
    buffer_load_dwordx4 v28, s[52:55], s72 offen lds
    s_add_u32 m0, s71, 6144
    s_nop 0
    buffer_load_dwordx4 v29, s[52:55], s72 offen lds
    s_add_u32 m0, s71, 7168
    s_nop 0
    buffer_load_dwordx4 v30, s[52:55], s72 offen lds
    s_add_u32 m0, s71, 8192
    s_nop 0
    buffer_load_dwordx4 v31, s[52:55], s72 offen lds
    s_add_u32 m0, s71, 9216
    s_nop 0
    buffer_load_dwordx4 v19, s[52:55], s72 offen lds
    s_mov_b32 s72, 0
    s_add_u32 m0, s71, 20480
    s_nop 0
    buffer_load_dwordx4 v12, s[48:51], s72 offen lds
    s_add_u32 m0, s71, 21504
    s_nop 0
    buffer_load_dwordx4 v13, s[48:51], s72 offen lds
    s_add_u32 m0, s71, 22528
    s_nop 0
    buffer_load_dwordx4 v14, s[48:51], s72 offen lds
    s_mov_b32 s72, 393216
    s_add_u32 m0, s71, 23552
    s_nop 0
    buffer_load_dwordx4 v12, s[48:51], s72 offen lds
    s_add_u32 m0, s71, 24576
    s_nop 0
    buffer_load_dwordx4 v13, s[48:51], s72 offen lds
    s_add_u32 m0, s71, 25600
    s_nop 0
    buffer_load_dwordx4 v14, s[48:51], s72 offen lds
    s_mov_b32 s72, 786432
    s_add_u32 m0, s71, 26624
    s_nop 0
    buffer_load_dwordx4 v12, s[48:51], s72 offen lds
    s_add_u32 m0, s71, 27648
    s_nop 0
    buffer_load_dwordx4 v13, s[48:51], s72 offen lds
    s_add_u32 m0, s71, 28672
    s_nop 0
    buffer_load_dwordx4 v14, s[48:51], s72 offen lds
    s_mov_b32 s72, 61440
    s_add_u32 m0, s71, 10240
    s_nop 0
    buffer_load_dwordx4 v28, s[52:55], s72 offen lds
    s_add_u32 m0, s71, 11264
    s_nop 0
    buffer_load_dwordx4 v29, s[52:55], s72 offen lds
    s_add_u32 m0, s71, 12288
    s_nop 0
    buffer_load_dwordx4 v30, s[52:55], s72 offen lds
    s_add_u32 m0, s71, 13312
    s_nop 0
    buffer_load_dwordx4 v31, s[52:55], s72 offen lds
    s_add_u32 m0, s71, 14336
    s_nop 0
    buffer_load_dwordx4 v19, s[52:55], s72 offen lds
    s_mov_b32 s72, 81920
    s_add_u32 m0, s71, 15360
    s_nop 0
    buffer_load_dwordx4 v28, s[52:55], s72 offen lds
    s_add_u32 m0, s71, 16384
    s_nop 0
    buffer_load_dwordx4 v29, s[52:55], s72 offen lds
    s_add_u32 m0, s71, 17408
    s_nop 0
    buffer_load_dwordx4 v30, s[52:55], s72 offen lds
    s_add_u32 m0, s71, 18432
    s_nop 0
    buffer_load_dwordx4 v31, s[52:55], s72 offen lds
    s_add_u32 m0, s71, 19456
    s_nop 0
    buffer_load_dwordx4 v19, s[52:55], s72 offen lds
    s_mov_b32 s72, 1179648
    s_add_u32 m0, s71, 29696
    s_nop 0
    buffer_load_dwordx4 v12, s[48:51], s72 offen lds
    s_add_u32 m0, s71, 30720
    s_nop 0
    buffer_load_dwordx4 v13, s[48:51], s72 offen lds
    s_add_u32 m0, s71, 31744
    s_nop 0
    buffer_load_dwordx4 v14, s[48:51], s72 offen lds
    s_mov_b32 s72, 1572864
    s_add_u32 m0, s71, 32768
    s_nop 0
    buffer_load_dwordx4 v12, s[48:51], s72 offen lds
    s_add_u32 m0, s71, 33792
    s_nop 0
    buffer_load_dwordx4 v13, s[48:51], s72 offen lds
    s_add_u32 m0, s71, 34816
    s_nop 0
    buffer_load_dwordx4 v14, s[48:51], s72 offen lds
    s_mov_b32 s72, 1966080
    s_add_u32 m0, s71, 35840
    s_nop 0
    buffer_load_dwordx4 v12, s[48:51], s72 offen lds
    s_add_u32 m0, s71, 36864
    s_nop 0
    buffer_load_dwordx4 v13, s[48:51], s72 offen lds
    s_add_u32 m0, s71, 37888
    s_nop 0
    buffer_load_dwordx4 v14, s[48:51], s72 offen lds
    s_waitcnt vmcnt(28)
    s_barrier
    v_mov_b32 v16, 1
    buffer_atomic_add v16, v11, s[60:63], 0 offen sc1
    ds_read_b64_tr_b16 a[192:193], v10 offset:0
    ds_read_b64_tr_b16 a[194:195], v10 offset:640
    ds_read_b64_tr_b16 a[208:209], v10 offset:32
    ds_read_b64_tr_b16 a[210:211], v10 offset:672
    ds_read_b64_tr_b16 v[144:145], v10 offset:64
    ds_read_b64_tr_b16 v[146:147], v10 offset:704
    ds_read_b64_tr_b16 v[80:81], v10 offset:96
    ds_read_b64_tr_b16 v[82:83], v10 offset:736
    ds_read_b64_tr_b16 v[168:169], v10 offset:128
    ds_read_b64_tr_b16 v[170:171], v10 offset:768
    ds_read_b64_tr_b16 a[232:233], v10 offset:160
    ds_read_b64_tr_b16 a[234:235], v10 offset:800
    ds_read_b64_tr_b16 v[192:193], v10 offset:192
    ds_read_b64_tr_b16 v[194:195], v10 offset:832
    ds_read_b64_tr_b16 a[248:249], v10 offset:224
    ds_read_b64_tr_b16 a[250:251], v10 offset:864
    ds_read_b64_tr_b16 v[112:113], v10 offset:256
    ds_read_b64_tr_b16 v[114:115], v10 offset:896
    ds_read_b64_tr_b16 v[240:241], v10 offset:288
    ds_read_b64_tr_b16 v[242:243], v10 offset:928
    s_waitcnt lgkmcnt(0)
    s_mov_b32 s72, 122880
    s_add_u32 m0, s71, 0
    s_nop 0
    buffer_load_dwordx4 v28, s[52:55], s72 offen lds
    s_add_u32 m0, s71, 1024
    s_nop 0
    buffer_load_dwordx4 v29, s[52:55], s72 offen lds
    s_add_u32 m0, s71, 2048
    s_nop 0
    buffer_load_dwordx4 v30, s[52:55], s72 offen lds
    s_add_u32 m0, s71, 3072
    s_nop 0
    buffer_load_dwordx4 v31, s[52:55], s72 offen lds
    s_add_u32 m0, s71, 4096
    s_nop 0
    buffer_load_dwordx4 v19, s[52:55], s72 offen lds
    s_mov_b32 s72, 143360
    s_add_u32 m0, s71, 5120
    s_nop 0
    buffer_load_dwordx4 v28, s[52:55], s72 offen lds
    s_add_u32 m0, s71, 6144
    s_nop 0
    buffer_load_dwordx4 v29, s[52:55], s72 offen lds
    s_add_u32 m0, s71, 7168
    s_nop 0
    buffer_load_dwordx4 v30, s[52:55], s72 offen lds
    s_add_u32 m0, s71, 8192
    s_nop 0
    buffer_load_dwordx4 v31, s[52:55], s72 offen lds
    s_add_u32 m0, s71, 9216
    s_nop 0
    buffer_load_dwordx4 v19, s[52:55], s72 offen lds
    s_waitcnt vmcnt(35)
    ds_read_b64_tr_b16 a[88:89], v15 offset:20480
    ds_read_b64_tr_b16 a[90:91], v15 offset:20672
    ds_read_b64_tr_b16 a[128:129], v15 offset:20512
    ds_read_b64_tr_b16 a[130:131], v15 offset:20704
    ds_read_b64_tr_b16 a[176:177], v15 offset:20544
    ds_read_b64_tr_b16 a[178:179], v15 offset:20736
    s_waitcnt lgkmcnt(0)
    s_mov_b32 s72, 2359296
    s_add_u32 m0, s71, 20480
    s_nop 0
    buffer_load_dwordx4 v12, s[48:51], s72 offen lds
    s_add_u32 m0, s71, 21504
    s_nop 0
    buffer_load_dwordx4 v13, s[48:51], s72 offen lds
    s_add_u32 m0, s71, 22528
    s_nop 0
    buffer_load_dwordx4 v14, s[48:51], s72 offen lds
    s_waitcnt vmcnt(35)
    ds_read_b64_tr_b16 a[92:93], v15 offset:23552
    ds_read_b64_tr_b16 a[94:95], v15 offset:23744
    ds_read_b64_tr_b16 a[132:133], v15 offset:23584
    ds_read_b64_tr_b16 a[134:135], v15 offset:23776
    ds_read_b64_tr_b16 a[180:181], v15 offset:23616
    ds_read_b64_tr_b16 a[182:183], v15 offset:23808
    s_waitcnt lgkmcnt(0)
    s_mov_b32 s72, 2752512
    s_add_u32 m0, s71, 23552
    s_nop 0
    buffer_load_dwordx4 v12, s[48:51], s72 offen lds
    s_add_u32 m0, s71, 24576
    s_nop 0
    buffer_load_dwordx4 v13, s[48:51], s72 offen lds
    s_add_u32 m0, s71, 25600
    s_nop 0
    buffer_load_dwordx4 v14, s[48:51], s72 offen lds
    s_waitcnt vmcnt(35)
    ds_read_b64_tr_b16 v[48:49], v15 offset:26624
    ds_read_b64_tr_b16 v[50:51], v15 offset:26816
    ds_read_b64_tr_b16 a[136:137], v15 offset:26656
    ds_read_b64_tr_b16 a[138:139], v15 offset:26848
    ds_read_b64_tr_b16 a[184:185], v15 offset:26688
    ds_read_b64_tr_b16 a[186:187], v15 offset:26880
    s_waitcnt lgkmcnt(0)
    s_mov_b32 s72, 3145728
    s_add_u32 m0, s71, 26624
    s_nop 0
    buffer_load_dwordx4 v12, s[48:51], s72 offen lds
    s_add_u32 m0, s71, 27648
    s_nop 0
    buffer_load_dwordx4 v13, s[48:51], s72 offen lds
    s_add_u32 m0, s71, 28672
    s_nop 0
    buffer_load_dwordx4 v14, s[48:51], s72 offen lds
    s_waitcnt vmcnt(28)
    ds_read_b64_tr_b16 a[196:197], v10 offset:10240
    ds_read_b64_tr_b16 a[198:199], v10 offset:10880
    ds_read_b64_tr_b16 a[212:213], v10 offset:10272
    ds_read_b64_tr_b16 a[214:215], v10 offset:10912
    ds_read_b64_tr_b16 v[148:149], v10 offset:10304
    ds_read_b64_tr_b16 v[150:151], v10 offset:10944
    ds_read_b64_tr_b16 v[84:85], v10 offset:10336
    ds_read_b64_tr_b16 v[86:87], v10 offset:10976
    ds_read_b64_tr_b16 v[172:173], v10 offset:10368
    ds_read_b64_tr_b16 v[174:175], v10 offset:11008
    ds_read_b64_tr_b16 a[236:237], v10 offset:10400
    ds_read_b64_tr_b16 a[238:239], v10 offset:11040
    ds_read_b64_tr_b16 v[196:197], v10 offset:10432
    ds_read_b64_tr_b16 v[198:199], v10 offset:11072
    ds_read_b64_tr_b16 a[252:253], v10 offset:10464
    ds_read_b64_tr_b16 a[254:255], v10 offset:11104
    ds_read_b64_tr_b16 v[116:117], v10 offset:10496
    ds_read_b64_tr_b16 v[118:119], v10 offset:11136
    ds_read_b64_tr_b16 v[244:245], v10 offset:10528
    ds_read_b64_tr_b16 v[246:247], v10 offset:11168
    s_waitcnt vmcnt(25)
    ds_read_b64_tr_b16 v[52:53], v15 offset:29696
    ds_read_b64_tr_b16 v[54:55], v15 offset:29888
    ds_read_b64_tr_b16 a[140:141], v15 offset:29728
    ds_read_b64_tr_b16 a[142:143], v15 offset:29920
    ds_read_b64_tr_b16 a[188:189], v15 offset:29760
    ds_read_b64_tr_b16 a[190:191], v15 offset:29952
    s_waitcnt lgkmcnt(0)
    s_mov_b32 s72, 3538944
    s_add_u32 m0, s71, 29696
    s_nop 0
    buffer_load_dwordx4 v12, s[48:51], s72 offen lds
    s_add_u32 m0, s71, 30720
    s_nop 0
    buffer_load_dwordx4 v13, s[48:51], s72 offen lds
    s_add_u32 m0, s71, 31744
    s_nop 0
    buffer_load_dwordx4 v14, s[48:51], s72 offen lds
    s_mov_b32 s72, 184320
    s_add_u32 m0, s71, 10240
    s_nop 0
    buffer_load_dwordx4 v28, s[52:55], s72 offen lds
    s_add_u32 m0, s71, 11264
    s_nop 0
    buffer_load_dwordx4 v29, s[52:55], s72 offen lds
    s_add_u32 m0, s71, 12288
    s_nop 0
    buffer_load_dwordx4 v30, s[52:55], s72 offen lds
    s_add_u32 m0, s71, 13312
    s_nop 0
    buffer_load_dwordx4 v31, s[52:55], s72 offen lds
    s_add_u32 m0, s71, 14336
    s_nop 0
    buffer_load_dwordx4 v19, s[52:55], s72 offen lds
    s_mov_b32 s72, 204800
    s_add_u32 m0, s71, 15360
    s_nop 0
    buffer_load_dwordx4 v28, s[52:55], s72 offen lds
    s_add_u32 m0, s71, 16384
    s_nop 0
    buffer_load_dwordx4 v29, s[52:55], s72 offen lds
    s_add_u32 m0, s71, 17408
    s_nop 0
    buffer_load_dwordx4 v30, s[52:55], s72 offen lds
    s_add_u32 m0, s71, 18432
    s_nop 0
    buffer_load_dwordx4 v31, s[52:55], s72 offen lds
    s_add_u32 m0, s71, 19456
    s_nop 0
    buffer_load_dwordx4 v19, s[52:55], s72 offen lds
    s_waitcnt vmcnt(35)
    ds_read_b64_tr_b16 a[96:97], v15 offset:32768
    ds_read_b64_tr_b16 a[98:99], v15 offset:32960
    ds_read_b64_tr_b16 a[144:145], v15 offset:32800
    ds_read_b64_tr_b16 a[146:147], v15 offset:32992
    ds_read_b64_tr_b16 v[72:73], v15 offset:32832
    ds_read_b64_tr_b16 v[74:75], v15 offset:33024
    s_waitcnt lgkmcnt(0)
    s_mov_b32 s72, 3932160
    s_add_u32 m0, s71, 32768
    s_nop 0
    buffer_load_dwordx4 v12, s[48:51], s72 offen lds
    s_add_u32 m0, s71, 33792
    s_nop 0
    buffer_load_dwordx4 v13, s[48:51], s72 offen lds
    s_add_u32 m0, s71, 34816
    s_nop 0
    buffer_load_dwordx4 v14, s[48:51], s72 offen lds
    s_waitcnt vmcnt(35)
    ds_read_b64_tr_b16 a[100:101], v15 offset:35840
    ds_read_b64_tr_b16 a[102:103], v15 offset:36032
    ds_read_b64_tr_b16 a[148:149], v15 offset:35872
    ds_read_b64_tr_b16 a[150:151], v15 offset:36064
    ds_read_b64_tr_b16 v[76:77], v15 offset:35904
    ds_read_b64_tr_b16 v[78:79], v15 offset:36096
    s_waitcnt lgkmcnt(0)
    s_mov_b32 s72, 4325376
    s_add_u32 m0, s71, 35840
    s_nop 0
    buffer_load_dwordx4 v12, s[48:51], s72 offen lds
    s_add_u32 m0, s71, 36864
    s_nop 0
    buffer_load_dwordx4 v13, s[48:51], s72 offen lds
    s_add_u32 m0, s71, 37888
    s_nop 0
    buffer_load_dwordx4 v14, s[48:51], s72 offen lds
    s_waitcnt vmcnt(28)
    ds_read_b64_tr_b16 a[200:201], v10 offset:0
    ds_read_b64_tr_b16 a[202:203], v10 offset:640
    ds_read_b64_tr_b16 a[216:217], v10 offset:32
    ds_read_b64_tr_b16 a[218:219], v10 offset:672
    ds_read_b64_tr_b16 v[152:153], v10 offset:64
    ds_read_b64_tr_b16 v[154:155], v10 offset:704
    ds_read_b64_tr_b16 a[224:225], v10 offset:96
    ds_read_b64_tr_b16 a[226:227], v10 offset:736
    ds_read_b64_tr_b16 v[176:177], v10 offset:128
    ds_read_b64_tr_b16 v[178:179], v10 offset:768
    ds_read_b64_tr_b16 a[240:241], v10 offset:160
    ds_read_b64_tr_b16 a[242:243], v10 offset:800
    ds_read_b64_tr_b16 v[200:201], v10 offset:192
    ds_read_b64_tr_b16 v[202:203], v10 offset:832
    ds_read_b64_tr_b16 v[88:89], v10 offset:224
    ds_read_b64_tr_b16 v[90:91], v10 offset:864
    ds_read_b64_tr_b16 v[224:225], v10 offset:256
    ds_read_b64_tr_b16 v[226:227], v10 offset:896
    ds_read_b64_tr_b16 v[248:249], v10 offset:288
    ds_read_b64_tr_b16 v[250:251], v10 offset:928
    s_waitcnt vmcnt(25)
    ds_read_b64_tr_b16 a[0:1], v15 offset:20480
    ds_read_b64_tr_b16 a[2:3], v15 offset:20672
    ds_read_b64_tr_b16 a[8:9], v15 offset:20512
    ds_read_b64_tr_b16 a[10:11], v15 offset:20704
    ds_read_b64_tr_b16 a[16:17], v15 offset:20544
    ds_read_b64_tr_b16 a[18:19], v15 offset:20736
    s_waitcnt lgkmcnt(0)
    s_mov_b32 s72, 4718592
    s_add_u32 m0, s71, 20480
    s_nop 0
    buffer_load_dwordx4 v12, s[48:51], s72 offen lds
    s_add_u32 m0, s71, 21504
    s_nop 0
    buffer_load_dwordx4 v13, s[48:51], s72 offen lds
    s_add_u32 m0, s71, 22528
    s_nop 0
    buffer_load_dwordx4 v14, s[48:51], s72 offen lds
    s_mov_b32 s72, 40960
    s_add_u32 m0, s71, 0
    s_nop 0
    buffer_load_dwordx4 v28, s[52:55], s72 offen lds
    s_add_u32 m0, s71, 1024
    s_nop 0
    buffer_load_dwordx4 v29, s[52:55], s72 offen lds
    s_add_u32 m0, s71, 2048
    s_nop 0
    buffer_load_dwordx4 v30, s[52:55], s72 offen lds
    s_add_u32 m0, s71, 3072
    s_nop 0
    buffer_load_dwordx4 v31, s[52:55], s72 offen lds
    s_add_u32 m0, s71, 4096
    s_nop 0
    buffer_load_dwordx4 v19, s[52:55], s72 offen lds
    s_mov_b32 s72, 102400
    s_add_u32 m0, s71, 5120
    s_nop 0
    buffer_load_dwordx4 v28, s[52:55], s72 offen lds
    s_add_u32 m0, s71, 6144
    s_nop 0
    buffer_load_dwordx4 v29, s[52:55], s72 offen lds
    s_add_u32 m0, s71, 7168
    s_nop 0
    buffer_load_dwordx4 v30, s[52:55], s72 offen lds
    s_add_u32 m0, s71, 8192
    s_nop 0
    buffer_load_dwordx4 v31, s[52:55], s72 offen lds
    s_add_u32 m0, s71, 9216
    s_nop 0
    buffer_load_dwordx4 v19, s[52:55], s72 offen lds
    s_waitcnt vmcnt(35)
    ds_read_b64_tr_b16 a[4:5], v15 offset:23552
    ds_read_b64_tr_b16 a[6:7], v15 offset:23744
    ds_read_b64_tr_b16 a[12:13], v15 offset:23584
    ds_read_b64_tr_b16 a[14:15], v15 offset:23776
    ds_read_b64_tr_b16 a[20:21], v15 offset:23616
    ds_read_b64_tr_b16 a[22:23], v15 offset:23808
    s_waitcnt lgkmcnt(0)
    s_mov_b32 s72, 5111808
    s_add_u32 m0, s71, 23552
    s_nop 0
    buffer_load_dwordx4 v12, s[48:51], s72 offen lds
    s_add_u32 m0, s71, 24576
    s_nop 0
    buffer_load_dwordx4 v13, s[48:51], s72 offen lds
    s_add_u32 m0, s71, 25600
    s_nop 0
    buffer_load_dwordx4 v14, s[48:51], s72 offen lds
    s_waitcnt vmcnt(35)
    ds_read_b64_tr_b16 a[24:25], v15 offset:26624
    ds_read_b64_tr_b16 a[26:27], v15 offset:26816
    ds_read_b64_tr_b16 v[32:33], v15 offset:26656
    ds_read_b64_tr_b16 v[34:35], v15 offset:26848
    ds_read_b64_tr_b16 a[32:33], v15 offset:26688
    ds_read_b64_tr_b16 a[34:35], v15 offset:26880
    s_waitcnt lgkmcnt(0)
    s_mov_b32 s72, 5505024
    s_add_u32 m0, s71, 26624
    s_nop 0
    buffer_load_dwordx4 v12, s[48:51], s72 offen lds
    s_add_u32 m0, s71, 27648
    s_nop 0
    buffer_load_dwordx4 v13, s[48:51], s72 offen lds
    s_add_u32 m0, s71, 28672
    s_nop 0
    buffer_load_dwordx4 v14, s[48:51], s72 offen lds
    s_waitcnt vmcnt(35)
    ds_read_b64_tr_b16 a[28:29], v15 offset:29696
    ds_read_b64_tr_b16 a[30:31], v15 offset:29888
    ds_read_b64_tr_b16 v[36:37], v15 offset:29728
    ds_read_b64_tr_b16 v[38:39], v15 offset:29920
    ds_read_b64_tr_b16 a[36:37], v15 offset:29760
    ds_read_b64_tr_b16 a[38:39], v15 offset:29952
    s_waitcnt lgkmcnt(0)
    s_mov_b32 s72, 5898240
    s_add_u32 m0, s71, 29696
    s_nop 0
    buffer_load_dwordx4 v12, s[48:51], s72 offen lds
    s_add_u32 m0, s71, 30720
    s_nop 0
    buffer_load_dwordx4 v13, s[48:51], s72 offen lds
    s_add_u32 m0, s71, 31744
    s_nop 0
    buffer_load_dwordx4 v14, s[48:51], s72 offen lds
    s_waitcnt vmcnt(28)
    ds_read_b64_tr_b16 a[204:205], v10 offset:10240
    ds_read_b64_tr_b16 a[206:207], v10 offset:10880
    ds_read_b64_tr_b16 a[220:221], v10 offset:10272
    ds_read_b64_tr_b16 a[222:223], v10 offset:10912
    ds_read_b64_tr_b16 v[156:157], v10 offset:10304
    ds_read_b64_tr_b16 v[158:159], v10 offset:10944
    ds_read_b64_tr_b16 a[228:229], v10 offset:10336
    ds_read_b64_tr_b16 a[230:231], v10 offset:10976
    ds_read_b64_tr_b16 v[180:181], v10 offset:10368
    ds_read_b64_tr_b16 v[182:183], v10 offset:11008
    ds_read_b64_tr_b16 a[244:245], v10 offset:10400
    ds_read_b64_tr_b16 a[246:247], v10 offset:11040
    ds_read_b64_tr_b16 v[204:205], v10 offset:10432
    ds_read_b64_tr_b16 v[206:207], v10 offset:11072
    ds_read_b64_tr_b16 v[92:93], v10 offset:10464
    ds_read_b64_tr_b16 v[94:95], v10 offset:11104
    ds_read_b64_tr_b16 v[228:229], v10 offset:10496
    ds_read_b64_tr_b16 v[230:231], v10 offset:11136
    ds_read_b64_tr_b16 v[252:253], v10 offset:10528
    ds_read_b64_tr_b16 v[254:255], v10 offset:11168
    s_waitcnt lgkmcnt(0)
    s_mov_b32 s72, 163840
    s_add_u32 m0, s71, 10240
    s_nop 0
    buffer_load_dwordx4 v28, s[52:55], s72 offen lds
    s_add_u32 m0, s71, 11264
    s_nop 0
    buffer_load_dwordx4 v29, s[52:55], s72 offen lds
    s_add_u32 m0, s71, 12288
    s_nop 0
    buffer_load_dwordx4 v30, s[52:55], s72 offen lds
    s_add_u32 m0, s71, 13312
    s_nop 0
    buffer_load_dwordx4 v31, s[52:55], s72 offen lds
    s_add_u32 m0, s71, 14336
    s_nop 0
    buffer_load_dwordx4 v19, s[52:55], s72 offen lds
    s_mov_b32 s72, 225280
    s_add_u32 m0, s71, 15360
    s_nop 0
    buffer_load_dwordx4 v28, s[52:55], s72 offen lds
    s_add_u32 m0, s71, 16384
    s_nop 0
    buffer_load_dwordx4 v29, s[52:55], s72 offen lds
    s_add_u32 m0, s71, 17408
    s_nop 0
    buffer_load_dwordx4 v30, s[52:55], s72 offen lds
    s_add_u32 m0, s71, 18432
    s_nop 0
    buffer_load_dwordx4 v31, s[52:55], s72 offen lds
    s_add_u32 m0, s71, 19456
    s_nop 0
    buffer_load_dwordx4 v19, s[52:55], s72 offen lds
    s_waitcnt vmcnt(35)
    ds_read_b64_tr_b16 a[40:41], v15 offset:32768
    ds_read_b64_tr_b16 a[42:43], v15 offset:32960
    ds_read_b64_tr_b16 a[48:49], v15 offset:32800
    ds_read_b64_tr_b16 a[50:51], v15 offset:32992
    ds_read_b64_tr_b16 a[56:57], v15 offset:32832
    ds_read_b64_tr_b16 a[58:59], v15 offset:33024
    s_waitcnt lgkmcnt(0)
    s_mov_b32 s72, 6291456
    s_add_u32 m0, s71, 32768
    s_nop 0
    buffer_load_dwordx4 v12, s[48:51], s72 offen lds
    s_add_u32 m0, s71, 33792
    s_nop 0
    buffer_load_dwordx4 v13, s[48:51], s72 offen lds
    s_add_u32 m0, s71, 34816
    s_nop 0
    buffer_load_dwordx4 v14, s[48:51], s72 offen lds
    s_waitcnt vmcnt(35)
    ds_read_b64_tr_b16 a[44:45], v15 offset:35840
    ds_read_b64_tr_b16 a[46:47], v15 offset:36032
    ds_read_b64_tr_b16 a[52:53], v15 offset:35872
    ds_read_b64_tr_b16 a[54:55], v15 offset:36064
    ds_read_b64_tr_b16 a[60:61], v15 offset:35904
    ds_read_b64_tr_b16 a[62:63], v15 offset:36096
    s_waitcnt lgkmcnt(0)
    s_mov_b32 s72, 6684672
    s_add_u32 m0, s71, 35840
    s_nop 0
    buffer_load_dwordx4 v12, s[48:51], s72 offen lds
    s_add_u32 m0, s71, 36864
    s_nop 0
    buffer_load_dwordx4 v13, s[48:51], s72 offen lds
    s_add_u32 m0, s71, 37888
    s_nop 0
    buffer_load_dwordx4 v14, s[48:51], s72 offen lds
    s_waitcnt vmcnt(35)
    ds_read_b64_tr_b16 v[40:41], v15 offset:20480
    ds_read_b64_tr_b16 v[42:43], v15 offset:20672
    ds_read_b64_tr_b16 a[104:105], v15 offset:20512
    ds_read_b64_tr_b16 a[106:107], v15 offset:20704
    ds_read_b64_tr_b16 a[152:153], v15 offset:20544
    ds_read_b64_tr_b16 a[154:155], v15 offset:20736
    s_waitcnt lgkmcnt(0)
    s_mov_b32 s72, 7077888
    s_add_u32 m0, s71, 20480
    s_nop 0
    buffer_load_dwordx4 v12, s[48:51], s72 offen lds
    s_add_u32 m0, s71, 21504
    s_nop 0
    buffer_load_dwordx4 v13, s[48:51], s72 offen lds
    s_add_u32 m0, s71, 22528
    s_nop 0
    buffer_load_dwordx4 v14, s[48:51], s72 offen lds
    s_waitcnt vmcnt(28)
    ds_read_b64_tr_b16 v[128:129], v10 offset:0
    ds_read_b64_tr_b16 v[130:131], v10 offset:640
    ds_read_b64_tr_b16 v[136:137], v10 offset:32
    ds_read_b64_tr_b16 v[138:139], v10 offset:672
    ds_read_b64_tr_b16 v[96:97], v10 offset:64
    ds_read_b64_tr_b16 v[98:99], v10 offset:704
    ds_read_b64_tr_b16 v[160:161], v10 offset:96
    ds_read_b64_tr_b16 v[162:163], v10 offset:736
    ds_read_b64_tr_b16 v[184:185], v10 offset:128
    ds_read_b64_tr_b16 v[186:187], v10 offset:768
    ds_read_b64_tr_b16 v[104:105], v10 offset:160
    ds_read_b64_tr_b16 v[106:107], v10 offset:800
    ds_read_b64_tr_b16 v[208:209], v10 offset:192
    ds_read_b64_tr_b16 v[210:211], v10 offset:832
    ds_read_b64_tr_b16 v[216:217], v10 offset:224
    ds_read_b64_tr_b16 v[218:219], v10 offset:864
    ds_read_b64_tr_b16 v[232:233], v10 offset:256
    ds_read_b64_tr_b16 v[234:235], v10 offset:896
    ds_read_b64_tr_b16 v[120:121], v10 offset:288
    ds_read_b64_tr_b16 v[122:123], v10 offset:928
    s_waitcnt vmcnt(25)
    ds_read_b64_tr_b16 v[44:45], v15 offset:23552
    ds_read_b64_tr_b16 v[46:47], v15 offset:23744
    ds_read_b64_tr_b16 a[108:109], v15 offset:23584
    ds_read_b64_tr_b16 a[110:111], v15 offset:23776
    ds_read_b64_tr_b16 a[156:157], v15 offset:23616
    ds_read_b64_tr_b16 a[158:159], v15 offset:23808
    s_waitcnt lgkmcnt(0)
    s_mov_b32 s72, 7471104
    s_add_u32 m0, s71, 23552
    s_nop 0
    buffer_load_dwordx4 v12, s[48:51], s72 offen lds
    s_add_u32 m0, s71, 24576
    s_nop 0
    buffer_load_dwordx4 v13, s[48:51], s72 offen lds
    s_add_u32 m0, s71, 25600
    s_nop 0
    buffer_load_dwordx4 v14, s[48:51], s72 offen lds
    s_waitcnt vmcnt(25)
    ds_read_b64_tr_b16 a[64:65], v15 offset:26624
    ds_read_b64_tr_b16 a[66:67], v15 offset:26816
    ds_read_b64_tr_b16 a[112:113], v15 offset:26656
    ds_read_b64_tr_b16 a[114:115], v15 offset:26848
    ds_read_b64_tr_b16 v[64:65], v15 offset:26688
    ds_read_b64_tr_b16 v[66:67], v15 offset:26880
    s_waitcnt vmcnt(22)
    ds_read_b64_tr_b16 a[68:69], v15 offset:29696
    ds_read_b64_tr_b16 a[70:71], v15 offset:29888
    ds_read_b64_tr_b16 a[116:117], v15 offset:29728
    ds_read_b64_tr_b16 a[118:119], v15 offset:29920
    ds_read_b64_tr_b16 v[68:69], v15 offset:29760
    ds_read_b64_tr_b16 v[70:71], v15 offset:29952
    s_waitcnt vmcnt(12)
    ds_read_b64_tr_b16 v[132:133], v10 offset:10240
    ds_read_b64_tr_b16 v[134:135], v10 offset:10880
    ds_read_b64_tr_b16 v[140:141], v10 offset:10272
    ds_read_b64_tr_b16 v[142:143], v10 offset:10912
    ds_read_b64_tr_b16 v[100:101], v10 offset:10304
    ds_read_b64_tr_b16 v[102:103], v10 offset:10944
    ds_read_b64_tr_b16 v[164:165], v10 offset:10336
    ds_read_b64_tr_b16 v[166:167], v10 offset:10976
    ds_read_b64_tr_b16 v[188:189], v10 offset:10368
    ds_read_b64_tr_b16 v[190:191], v10 offset:11008
    ds_read_b64_tr_b16 v[108:109], v10 offset:10400
    ds_read_b64_tr_b16 v[110:111], v10 offset:11040
    ds_read_b64_tr_b16 v[212:213], v10 offset:10432
    ds_read_b64_tr_b16 v[214:215], v10 offset:11072
    ds_read_b64_tr_b16 v[220:221], v10 offset:10464
    ds_read_b64_tr_b16 v[222:223], v10 offset:11104
    ds_read_b64_tr_b16 v[236:237], v10 offset:10496
    ds_read_b64_tr_b16 v[238:239], v10 offset:11136
    ds_read_b64_tr_b16 v[124:125], v10 offset:10528
    ds_read_b64_tr_b16 v[126:127], v10 offset:11168
    s_waitcnt vmcnt(9)
    ds_read_b64_tr_b16 a[72:73], v15 offset:32768
    ds_read_b64_tr_b16 a[74:75], v15 offset:32960
    ds_read_b64_tr_b16 a[120:121], v15 offset:32800
    ds_read_b64_tr_b16 a[122:123], v15 offset:32992
    ds_read_b64_tr_b16 a[160:161], v15 offset:32832
    ds_read_b64_tr_b16 a[162:163], v15 offset:33024
    s_waitcnt vmcnt(6)
    ds_read_b64_tr_b16 a[76:77], v15 offset:35840
    ds_read_b64_tr_b16 a[78:79], v15 offset:36032
    ds_read_b64_tr_b16 a[124:125], v15 offset:35872
    ds_read_b64_tr_b16 a[126:127], v15 offset:36064
    ds_read_b64_tr_b16 a[164:165], v15 offset:35904
    ds_read_b64_tr_b16 a[166:167], v15 offset:36096
    s_waitcnt vmcnt(3)
    ds_read_b64_tr_b16 a[80:81], v15 offset:20480
    ds_read_b64_tr_b16 a[82:83], v15 offset:20672
    ds_read_b64_tr_b16 v[56:57], v15 offset:20512
    ds_read_b64_tr_b16 v[58:59], v15 offset:20704
    ds_read_b64_tr_b16 a[168:169], v15 offset:20544
    ds_read_b64_tr_b16 a[170:171], v15 offset:20736
    s_waitcnt vmcnt(0)
    ds_read_b64_tr_b16 a[84:85], v15 offset:23552
    ds_read_b64_tr_b16 a[86:87], v15 offset:23744
    ds_read_b64_tr_b16 v[60:61], v15 offset:23584
    ds_read_b64_tr_b16 v[62:63], v15 offset:23776
    ds_read_b64_tr_b16 a[172:173], v15 offset:23616
    ds_read_b64_tr_b16 a[174:175], v15 offset:23808
    s_waitcnt lgkmcnt(0)
    s_branch L_pwj_68
L_pwv_71:
    s_mov_b32 s72, 0
    s_add_u32 m0, s71, 0
    s_nop 0
    buffer_load_dwordx4 v28, s[52:55], s72 offen lds
    s_add_u32 m0, s71, 1024
    s_nop 0
    buffer_load_dwordx4 v29, s[52:55], s72 offen lds
    s_add_u32 m0, s71, 2048
    s_nop 0
    buffer_load_dwordx4 v30, s[52:55], s72 offen lds
    s_add_u32 m0, s71, 3072
    s_nop 0
    buffer_load_dwordx4 v31, s[52:55], s72 offen lds
    s_add_u32 m0, s71, 4096
    s_nop 0
    buffer_load_dwordx4 v19, s[52:55], s72 offen lds
    s_mov_b32 s72, 20480
    s_add_u32 m0, s71, 5120
    s_nop 0
    buffer_load_dwordx4 v28, s[52:55], s72 offen lds
    s_add_u32 m0, s71, 6144
    s_nop 0
    buffer_load_dwordx4 v29, s[52:55], s72 offen lds
    s_add_u32 m0, s71, 7168
    s_nop 0
    buffer_load_dwordx4 v30, s[52:55], s72 offen lds
    s_add_u32 m0, s71, 8192
    s_nop 0
    buffer_load_dwordx4 v31, s[52:55], s72 offen lds
    s_add_u32 m0, s71, 9216
    s_nop 0
    buffer_load_dwordx4 v19, s[52:55], s72 offen lds
    s_mov_b32 s72, 0
    s_add_u32 m0, s71, 20480
    s_nop 0
    buffer_load_dwordx4 v12, s[48:51], s72 offen lds
    s_add_u32 m0, s71, 21504
    s_nop 0
    buffer_load_dwordx4 v13, s[48:51], s72 offen lds
    s_add_u32 m0, s71, 22528
    s_nop 0
    buffer_load_dwordx4 v14, s[48:51], s72 offen lds
    s_mov_b32 s72, 393216
    s_add_u32 m0, s71, 23552
    s_nop 0
    buffer_load_dwordx4 v12, s[48:51], s72 offen lds
    s_add_u32 m0, s71, 24576
    s_nop 0
    buffer_load_dwordx4 v13, s[48:51], s72 offen lds
    s_add_u32 m0, s71, 25600
    s_nop 0
    buffer_load_dwordx4 v14, s[48:51], s72 offen lds
    s_mov_b32 s72, 786432
    s_add_u32 m0, s71, 26624
    s_nop 0
    buffer_load_dwordx4 v12, s[48:51], s72 offen lds
    s_add_u32 m0, s71, 27648
    s_nop 0
    buffer_load_dwordx4 v13, s[48:51], s72 offen lds
    s_add_u32 m0, s71, 28672
    s_nop 0
    buffer_load_dwordx4 v14, s[48:51], s72 offen lds
    s_mov_b32 s72, 61440
    s_add_u32 m0, s71, 10240
    s_nop 0
    buffer_load_dwordx4 v28, s[52:55], s72 offen lds
    s_add_u32 m0, s71, 11264
    s_nop 0
    buffer_load_dwordx4 v29, s[52:55], s72 offen lds
    s_add_u32 m0, s71, 12288
    s_nop 0
    buffer_load_dwordx4 v30, s[52:55], s72 offen lds
    s_add_u32 m0, s71, 13312
    s_nop 0
    buffer_load_dwordx4 v31, s[52:55], s72 offen lds
    s_add_u32 m0, s71, 14336
    s_nop 0
    buffer_load_dwordx4 v19, s[52:55], s72 offen lds
    s_mov_b32 s72, 81920
    s_add_u32 m0, s71, 15360
    s_nop 0
    buffer_load_dwordx4 v28, s[52:55], s72 offen lds
    s_add_u32 m0, s71, 16384
    s_nop 0
    buffer_load_dwordx4 v29, s[52:55], s72 offen lds
    s_add_u32 m0, s71, 17408
    s_nop 0
    buffer_load_dwordx4 v30, s[52:55], s72 offen lds
    s_add_u32 m0, s71, 18432
    s_nop 0
    buffer_load_dwordx4 v31, s[52:55], s72 offen lds
    s_add_u32 m0, s71, 19456
    s_nop 0
    buffer_load_dwordx4 v19, s[52:55], s72 offen lds
    s_mov_b32 s72, 1179648
    s_add_u32 m0, s71, 29696
    s_nop 0
    buffer_load_dwordx4 v12, s[48:51], s72 offen lds
    s_add_u32 m0, s71, 30720
    s_nop 0
    buffer_load_dwordx4 v13, s[48:51], s72 offen lds
    s_add_u32 m0, s71, 31744
    s_nop 0
    buffer_load_dwordx4 v14, s[48:51], s72 offen lds
    s_mov_b32 s72, 1572864
    s_add_u32 m0, s71, 32768
    s_nop 0
    buffer_load_dwordx4 v12, s[48:51], s72 offen lds
    s_add_u32 m0, s71, 33792
    s_nop 0
    buffer_load_dwordx4 v13, s[48:51], s72 offen lds
    s_add_u32 m0, s71, 34816
    s_nop 0
    buffer_load_dwordx4 v14, s[48:51], s72 offen lds
    s_mov_b32 s72, 1966080
    s_add_u32 m0, s71, 35840
    s_nop 0
    buffer_load_dwordx4 v12, s[48:51], s72 offen lds
    s_add_u32 m0, s71, 36864
    s_nop 0
    buffer_load_dwordx4 v13, s[48:51], s72 offen lds
    s_add_u32 m0, s71, 37888
    s_nop 0
    buffer_load_dwordx4 v14, s[48:51], s72 offen lds
    s_waitcnt vmcnt(28)
    s_barrier
    v_mov_b32 v16, 1
    buffer_atomic_add v16, v11, s[60:63], 0 offen sc1
    ds_read_b64_tr_b16 a[192:193], v10 offset:0
    ds_read_b64_tr_b16 a[194:195], v10 offset:640
    ds_read_b64_tr_b16 a[208:209], v10 offset:32
    ds_read_b64_tr_b16 a[210:211], v10 offset:672
    ds_read_b64_tr_b16 v[144:145], v10 offset:64
    ds_read_b64_tr_b16 v[146:147], v10 offset:704
    ds_read_b64_tr_b16 v[80:81], v10 offset:96
    ds_read_b64_tr_b16 v[82:83], v10 offset:736
    ds_read_b64_tr_b16 v[168:169], v10 offset:128
    ds_read_b64_tr_b16 v[170:171], v10 offset:768
    ds_read_b64_tr_b16 a[232:233], v10 offset:160
    ds_read_b64_tr_b16 a[234:235], v10 offset:800
    ds_read_b64_tr_b16 v[192:193], v10 offset:192
    ds_read_b64_tr_b16 v[194:195], v10 offset:832
    ds_read_b64_tr_b16 a[248:249], v10 offset:224
    ds_read_b64_tr_b16 a[250:251], v10 offset:864
    ds_read_b64_tr_b16 v[112:113], v10 offset:256
    ds_read_b64_tr_b16 v[114:115], v10 offset:896
    ds_read_b64_tr_b16 v[240:241], v10 offset:288
    ds_read_b64_tr_b16 v[242:243], v10 offset:928
    s_waitcnt lgkmcnt(0)
    s_mov_b32 s72, 122880
    s_add_u32 m0, s71, 0
    s_nop 0
    buffer_load_dwordx4 v28, s[52:55], s72 offen lds
    s_add_u32 m0, s71, 1024
    s_nop 0
    buffer_load_dwordx4 v29, s[52:55], s72 offen lds
    s_add_u32 m0, s71, 2048
    s_nop 0
    buffer_load_dwordx4 v30, s[52:55], s72 offen lds
    s_add_u32 m0, s71, 3072
    s_nop 0
    buffer_load_dwordx4 v31, s[52:55], s72 offen lds
    s_add_u32 m0, s71, 4096
    s_nop 0
    buffer_load_dwordx4 v19, s[52:55], s72 offen lds
    s_mov_b32 s72, 143360
    s_add_u32 m0, s71, 5120
    s_nop 0
    buffer_load_dwordx4 v28, s[52:55], s72 offen lds
    s_add_u32 m0, s71, 6144
    s_nop 0
    buffer_load_dwordx4 v29, s[52:55], s72 offen lds
    s_add_u32 m0, s71, 7168
    s_nop 0
    buffer_load_dwordx4 v30, s[52:55], s72 offen lds
    s_add_u32 m0, s71, 8192
    s_nop 0
    buffer_load_dwordx4 v31, s[52:55], s72 offen lds
    s_add_u32 m0, s71, 9216
    s_nop 0
    buffer_load_dwordx4 v19, s[52:55], s72 offen lds
    s_waitcnt vmcnt(35)
    ds_read_b64_tr_b16 a[64:65], v15 offset:20480
    ds_read_b64_tr_b16 a[66:67], v15 offset:20672
    ds_read_b64_tr_b16 a[112:113], v15 offset:20512
    ds_read_b64_tr_b16 a[114:115], v15 offset:20704
    ds_read_b64_tr_b16 v[64:65], v15 offset:20544
    ds_read_b64_tr_b16 v[66:67], v15 offset:20736
    s_waitcnt lgkmcnt(0)
    s_mov_b32 s72, 2359296
    s_add_u32 m0, s71, 20480
    s_nop 0
    buffer_load_dwordx4 v12, s[48:51], s72 offen lds
    s_add_u32 m0, s71, 21504
    s_nop 0
    buffer_load_dwordx4 v13, s[48:51], s72 offen lds
    s_add_u32 m0, s71, 22528
    s_nop 0
    buffer_load_dwordx4 v14, s[48:51], s72 offen lds
    s_waitcnt vmcnt(35)
    ds_read_b64_tr_b16 a[68:69], v15 offset:23552
    ds_read_b64_tr_b16 a[70:71], v15 offset:23744
    ds_read_b64_tr_b16 a[116:117], v15 offset:23584
    ds_read_b64_tr_b16 a[118:119], v15 offset:23776
    ds_read_b64_tr_b16 v[68:69], v15 offset:23616
    ds_read_b64_tr_b16 v[70:71], v15 offset:23808
    s_waitcnt lgkmcnt(0)
    s_mov_b32 s72, 2752512
    s_add_u32 m0, s71, 23552
    s_nop 0
    buffer_load_dwordx4 v12, s[48:51], s72 offen lds
    s_add_u32 m0, s71, 24576
    s_nop 0
    buffer_load_dwordx4 v13, s[48:51], s72 offen lds
    s_add_u32 m0, s71, 25600
    s_nop 0
    buffer_load_dwordx4 v14, s[48:51], s72 offen lds
    s_waitcnt vmcnt(35)
    ds_read_b64_tr_b16 a[72:73], v15 offset:26624
    ds_read_b64_tr_b16 a[74:75], v15 offset:26816
    ds_read_b64_tr_b16 a[120:121], v15 offset:26656
    ds_read_b64_tr_b16 a[122:123], v15 offset:26848
    ds_read_b64_tr_b16 a[160:161], v15 offset:26688
    ds_read_b64_tr_b16 a[162:163], v15 offset:26880
    s_waitcnt lgkmcnt(0)
    s_mov_b32 s72, 3145728
    s_add_u32 m0, s71, 26624
    s_nop 0
    buffer_load_dwordx4 v12, s[48:51], s72 offen lds
    s_add_u32 m0, s71, 27648
    s_nop 0
    buffer_load_dwordx4 v13, s[48:51], s72 offen lds
    s_add_u32 m0, s71, 28672
    s_nop 0
    buffer_load_dwordx4 v14, s[48:51], s72 offen lds
    s_waitcnt vmcnt(28)
    ds_read_b64_tr_b16 a[196:197], v10 offset:10240
    ds_read_b64_tr_b16 a[198:199], v10 offset:10880
    ds_read_b64_tr_b16 a[212:213], v10 offset:10272
    ds_read_b64_tr_b16 a[214:215], v10 offset:10912
    ds_read_b64_tr_b16 v[148:149], v10 offset:10304
    ds_read_b64_tr_b16 v[150:151], v10 offset:10944
    ds_read_b64_tr_b16 v[84:85], v10 offset:10336
    ds_read_b64_tr_b16 v[86:87], v10 offset:10976
    ds_read_b64_tr_b16 v[172:173], v10 offset:10368
    ds_read_b64_tr_b16 v[174:175], v10 offset:11008
    ds_read_b64_tr_b16 a[236:237], v10 offset:10400
    ds_read_b64_tr_b16 a[238:239], v10 offset:11040
    ds_read_b64_tr_b16 v[196:197], v10 offset:10432
    ds_read_b64_tr_b16 v[198:199], v10 offset:11072
    ds_read_b64_tr_b16 a[252:253], v10 offset:10464
    ds_read_b64_tr_b16 a[254:255], v10 offset:11104
    ds_read_b64_tr_b16 v[116:117], v10 offset:10496
    ds_read_b64_tr_b16 v[118:119], v10 offset:11136
    ds_read_b64_tr_b16 v[244:245], v10 offset:10528
    ds_read_b64_tr_b16 v[246:247], v10 offset:11168
    s_waitcnt vmcnt(25)
    ds_read_b64_tr_b16 a[76:77], v15 offset:29696
    ds_read_b64_tr_b16 a[78:79], v15 offset:29888
    ds_read_b64_tr_b16 a[124:125], v15 offset:29728
    ds_read_b64_tr_b16 a[126:127], v15 offset:29920
    ds_read_b64_tr_b16 a[164:165], v15 offset:29760
    ds_read_b64_tr_b16 a[166:167], v15 offset:29952
    s_waitcnt lgkmcnt(0)
    s_mov_b32 s72, 3538944
    s_add_u32 m0, s71, 29696
    s_nop 0
    buffer_load_dwordx4 v12, s[48:51], s72 offen lds
    s_add_u32 m0, s71, 30720
    s_nop 0
    buffer_load_dwordx4 v13, s[48:51], s72 offen lds
    s_add_u32 m0, s71, 31744
    s_nop 0
    buffer_load_dwordx4 v14, s[48:51], s72 offen lds
    s_mov_b32 s72, 184320
    s_add_u32 m0, s71, 10240
    s_nop 0
    buffer_load_dwordx4 v28, s[52:55], s72 offen lds
    s_add_u32 m0, s71, 11264
    s_nop 0
    buffer_load_dwordx4 v29, s[52:55], s72 offen lds
    s_add_u32 m0, s71, 12288
    s_nop 0
    buffer_load_dwordx4 v30, s[52:55], s72 offen lds
    s_add_u32 m0, s71, 13312
    s_nop 0
    buffer_load_dwordx4 v31, s[52:55], s72 offen lds
    s_add_u32 m0, s71, 14336
    s_nop 0
    buffer_load_dwordx4 v19, s[52:55], s72 offen lds
    s_mov_b32 s72, 204800
    s_add_u32 m0, s71, 15360
    s_nop 0
    buffer_load_dwordx4 v28, s[52:55], s72 offen lds
    s_add_u32 m0, s71, 16384
    s_nop 0
    buffer_load_dwordx4 v29, s[52:55], s72 offen lds
    s_add_u32 m0, s71, 17408
    s_nop 0
    buffer_load_dwordx4 v30, s[52:55], s72 offen lds
    s_add_u32 m0, s71, 18432
    s_nop 0
    buffer_load_dwordx4 v31, s[52:55], s72 offen lds
    s_add_u32 m0, s71, 19456
    s_nop 0
    buffer_load_dwordx4 v19, s[52:55], s72 offen lds
    s_waitcnt vmcnt(35)
    ds_read_b64_tr_b16 a[80:81], v15 offset:32768
    ds_read_b64_tr_b16 a[82:83], v15 offset:32960
    ds_read_b64_tr_b16 v[56:57], v15 offset:32800
    ds_read_b64_tr_b16 v[58:59], v15 offset:32992
    ds_read_b64_tr_b16 a[168:169], v15 offset:32832
    ds_read_b64_tr_b16 a[170:171], v15 offset:33024
    s_waitcnt lgkmcnt(0)
    s_mov_b32 s72, 3932160
    s_add_u32 m0, s71, 32768
    s_nop 0
    buffer_load_dwordx4 v12, s[48:51], s72 offen lds
    s_add_u32 m0, s71, 33792
    s_nop 0
    buffer_load_dwordx4 v13, s[48:51], s72 offen lds
    s_add_u32 m0, s71, 34816
    s_nop 0
    buffer_load_dwordx4 v14, s[48:51], s72 offen lds
    s_waitcnt vmcnt(35)
    ds_read_b64_tr_b16 a[84:85], v15 offset:35840
    ds_read_b64_tr_b16 a[86:87], v15 offset:36032
    ds_read_b64_tr_b16 v[60:61], v15 offset:35872
    ds_read_b64_tr_b16 v[62:63], v15 offset:36064
    ds_read_b64_tr_b16 a[172:173], v15 offset:35904
    ds_read_b64_tr_b16 a[174:175], v15 offset:36096
    s_waitcnt lgkmcnt(0)
    s_mov_b32 s72, 4325376
    s_add_u32 m0, s71, 35840
    s_nop 0
    buffer_load_dwordx4 v12, s[48:51], s72 offen lds
    s_add_u32 m0, s71, 36864
    s_nop 0
    buffer_load_dwordx4 v13, s[48:51], s72 offen lds
    s_add_u32 m0, s71, 37888
    s_nop 0
    buffer_load_dwordx4 v14, s[48:51], s72 offen lds
    s_waitcnt vmcnt(28)
    ds_read_b64_tr_b16 a[200:201], v10 offset:0
    ds_read_b64_tr_b16 a[202:203], v10 offset:640
    ds_read_b64_tr_b16 a[216:217], v10 offset:32
    ds_read_b64_tr_b16 a[218:219], v10 offset:672
    ds_read_b64_tr_b16 v[152:153], v10 offset:64
    ds_read_b64_tr_b16 v[154:155], v10 offset:704
    ds_read_b64_tr_b16 a[224:225], v10 offset:96
    ds_read_b64_tr_b16 a[226:227], v10 offset:736
    ds_read_b64_tr_b16 v[176:177], v10 offset:128
    ds_read_b64_tr_b16 v[178:179], v10 offset:768
    ds_read_b64_tr_b16 a[240:241], v10 offset:160
    ds_read_b64_tr_b16 a[242:243], v10 offset:800
    ds_read_b64_tr_b16 v[200:201], v10 offset:192
    ds_read_b64_tr_b16 v[202:203], v10 offset:832
    ds_read_b64_tr_b16 v[88:89], v10 offset:224
    ds_read_b64_tr_b16 v[90:91], v10 offset:864
    ds_read_b64_tr_b16 v[224:225], v10 offset:256
    ds_read_b64_tr_b16 v[226:227], v10 offset:896
    ds_read_b64_tr_b16 v[248:249], v10 offset:288
    ds_read_b64_tr_b16 v[250:251], v10 offset:928
    s_waitcnt vmcnt(25)
    ds_read_b64_tr_b16 a[88:89], v15 offset:20480
    ds_read_b64_tr_b16 a[90:91], v15 offset:20672
    ds_read_b64_tr_b16 a[128:129], v15 offset:20512
    ds_read_b64_tr_b16 a[130:131], v15 offset:20704
    ds_read_b64_tr_b16 a[176:177], v15 offset:20544
    ds_read_b64_tr_b16 a[178:179], v15 offset:20736
    s_waitcnt lgkmcnt(0)
    s_mov_b32 s72, 4718592
    s_add_u32 m0, s71, 20480
    s_nop 0
    buffer_load_dwordx4 v12, s[48:51], s72 offen lds
    s_add_u32 m0, s71, 21504
    s_nop 0
    buffer_load_dwordx4 v13, s[48:51], s72 offen lds
    s_add_u32 m0, s71, 22528
    s_nop 0
    buffer_load_dwordx4 v14, s[48:51], s72 offen lds
    s_mov_b32 s72, 40960
    s_add_u32 m0, s71, 0
    s_nop 0
    buffer_load_dwordx4 v28, s[52:55], s72 offen lds
    s_add_u32 m0, s71, 1024
    s_nop 0
    buffer_load_dwordx4 v29, s[52:55], s72 offen lds
    s_add_u32 m0, s71, 2048
    s_nop 0
    buffer_load_dwordx4 v30, s[52:55], s72 offen lds
    s_add_u32 m0, s71, 3072
    s_nop 0
    buffer_load_dwordx4 v31, s[52:55], s72 offen lds
    s_add_u32 m0, s71, 4096
    s_nop 0
    buffer_load_dwordx4 v19, s[52:55], s72 offen lds
    s_mov_b32 s72, 102400
    s_add_u32 m0, s71, 5120
    s_nop 0
    buffer_load_dwordx4 v28, s[52:55], s72 offen lds
    s_add_u32 m0, s71, 6144
    s_nop 0
    buffer_load_dwordx4 v29, s[52:55], s72 offen lds
    s_add_u32 m0, s71, 7168
    s_nop 0
    buffer_load_dwordx4 v30, s[52:55], s72 offen lds
    s_add_u32 m0, s71, 8192
    s_nop 0
    buffer_load_dwordx4 v31, s[52:55], s72 offen lds
    s_add_u32 m0, s71, 9216
    s_nop 0
    buffer_load_dwordx4 v19, s[52:55], s72 offen lds
    s_waitcnt vmcnt(35)
    ds_read_b64_tr_b16 a[92:93], v15 offset:23552
    ds_read_b64_tr_b16 a[94:95], v15 offset:23744
    ds_read_b64_tr_b16 a[132:133], v15 offset:23584
    ds_read_b64_tr_b16 a[134:135], v15 offset:23776
    ds_read_b64_tr_b16 a[180:181], v15 offset:23616
    ds_read_b64_tr_b16 a[182:183], v15 offset:23808
    s_waitcnt lgkmcnt(0)
    s_mov_b32 s72, 5111808
    s_add_u32 m0, s71, 23552
    s_nop 0
    buffer_load_dwordx4 v12, s[48:51], s72 offen lds
    s_add_u32 m0, s71, 24576
    s_nop 0
    buffer_load_dwordx4 v13, s[48:51], s72 offen lds
    s_add_u32 m0, s71, 25600
    s_nop 0
    buffer_load_dwordx4 v14, s[48:51], s72 offen lds
    s_waitcnt vmcnt(35)
    ds_read_b64_tr_b16 v[48:49], v15 offset:26624
    ds_read_b64_tr_b16 v[50:51], v15 offset:26816
    ds_read_b64_tr_b16 a[136:137], v15 offset:26656
    ds_read_b64_tr_b16 a[138:139], v15 offset:26848
    ds_read_b64_tr_b16 a[184:185], v15 offset:26688
    ds_read_b64_tr_b16 a[186:187], v15 offset:26880
    s_waitcnt lgkmcnt(0)
    s_mov_b32 s72, 5505024
    s_add_u32 m0, s71, 26624
    s_nop 0
    buffer_load_dwordx4 v12, s[48:51], s72 offen lds
    s_add_u32 m0, s71, 27648
    s_nop 0
    buffer_load_dwordx4 v13, s[48:51], s72 offen lds
    s_add_u32 m0, s71, 28672
    s_nop 0
    buffer_load_dwordx4 v14, s[48:51], s72 offen lds
    s_waitcnt vmcnt(35)
    ds_read_b64_tr_b16 v[52:53], v15 offset:29696
    ds_read_b64_tr_b16 v[54:55], v15 offset:29888
    ds_read_b64_tr_b16 a[140:141], v15 offset:29728
    ds_read_b64_tr_b16 a[142:143], v15 offset:29920
    ds_read_b64_tr_b16 a[188:189], v15 offset:29760
    ds_read_b64_tr_b16 a[190:191], v15 offset:29952
    s_waitcnt lgkmcnt(0)
    s_mov_b32 s72, 5898240
    s_add_u32 m0, s71, 29696
    s_nop 0
    buffer_load_dwordx4 v12, s[48:51], s72 offen lds
    s_add_u32 m0, s71, 30720
    s_nop 0
    buffer_load_dwordx4 v13, s[48:51], s72 offen lds
    s_add_u32 m0, s71, 31744
    s_nop 0
    buffer_load_dwordx4 v14, s[48:51], s72 offen lds
    s_waitcnt vmcnt(28)
    ds_read_b64_tr_b16 a[204:205], v10 offset:10240
    ds_read_b64_tr_b16 a[206:207], v10 offset:10880
    ds_read_b64_tr_b16 a[220:221], v10 offset:10272
    ds_read_b64_tr_b16 a[222:223], v10 offset:10912
    ds_read_b64_tr_b16 v[156:157], v10 offset:10304
    ds_read_b64_tr_b16 v[158:159], v10 offset:10944
    ds_read_b64_tr_b16 a[228:229], v10 offset:10336
    ds_read_b64_tr_b16 a[230:231], v10 offset:10976
    ds_read_b64_tr_b16 v[180:181], v10 offset:10368
    ds_read_b64_tr_b16 v[182:183], v10 offset:11008
    ds_read_b64_tr_b16 a[244:245], v10 offset:10400
    ds_read_b64_tr_b16 a[246:247], v10 offset:11040
    ds_read_b64_tr_b16 v[204:205], v10 offset:10432
    ds_read_b64_tr_b16 v[206:207], v10 offset:11072
    ds_read_b64_tr_b16 v[92:93], v10 offset:10464
    ds_read_b64_tr_b16 v[94:95], v10 offset:11104
    ds_read_b64_tr_b16 v[228:229], v10 offset:10496
    ds_read_b64_tr_b16 v[230:231], v10 offset:11136
    ds_read_b64_tr_b16 v[252:253], v10 offset:10528
    ds_read_b64_tr_b16 v[254:255], v10 offset:11168
    s_waitcnt lgkmcnt(0)
    s_mov_b32 s72, 163840
    s_add_u32 m0, s71, 10240
    s_nop 0
    buffer_load_dwordx4 v28, s[52:55], s72 offen lds
    s_add_u32 m0, s71, 11264
    s_nop 0
    buffer_load_dwordx4 v29, s[52:55], s72 offen lds
    s_add_u32 m0, s71, 12288
    s_nop 0
    buffer_load_dwordx4 v30, s[52:55], s72 offen lds
    s_add_u32 m0, s71, 13312
    s_nop 0
    buffer_load_dwordx4 v31, s[52:55], s72 offen lds
    s_add_u32 m0, s71, 14336
    s_nop 0
    buffer_load_dwordx4 v19, s[52:55], s72 offen lds
    s_mov_b32 s72, 225280
    s_add_u32 m0, s71, 15360
    s_nop 0
    buffer_load_dwordx4 v28, s[52:55], s72 offen lds
    s_add_u32 m0, s71, 16384
    s_nop 0
    buffer_load_dwordx4 v29, s[52:55], s72 offen lds
    s_add_u32 m0, s71, 17408
    s_nop 0
    buffer_load_dwordx4 v30, s[52:55], s72 offen lds
    s_add_u32 m0, s71, 18432
    s_nop 0
    buffer_load_dwordx4 v31, s[52:55], s72 offen lds
    s_add_u32 m0, s71, 19456
    s_nop 0
    buffer_load_dwordx4 v19, s[52:55], s72 offen lds
    s_waitcnt vmcnt(35)
    ds_read_b64_tr_b16 a[96:97], v15 offset:32768
    ds_read_b64_tr_b16 a[98:99], v15 offset:32960
    ds_read_b64_tr_b16 a[144:145], v15 offset:32800
    ds_read_b64_tr_b16 a[146:147], v15 offset:32992
    ds_read_b64_tr_b16 v[72:73], v15 offset:32832
    ds_read_b64_tr_b16 v[74:75], v15 offset:33024
    s_waitcnt lgkmcnt(0)
    s_mov_b32 s72, 6291456
    s_add_u32 m0, s71, 32768
    s_nop 0
    buffer_load_dwordx4 v12, s[48:51], s72 offen lds
    s_add_u32 m0, s71, 33792
    s_nop 0
    buffer_load_dwordx4 v13, s[48:51], s72 offen lds
    s_add_u32 m0, s71, 34816
    s_nop 0
    buffer_load_dwordx4 v14, s[48:51], s72 offen lds
    s_waitcnt vmcnt(35)
    ds_read_b64_tr_b16 a[100:101], v15 offset:35840
    ds_read_b64_tr_b16 a[102:103], v15 offset:36032
    ds_read_b64_tr_b16 a[148:149], v15 offset:35872
    ds_read_b64_tr_b16 a[150:151], v15 offset:36064
    ds_read_b64_tr_b16 v[76:77], v15 offset:35904
    ds_read_b64_tr_b16 v[78:79], v15 offset:36096
    s_waitcnt lgkmcnt(0)
    s_mov_b32 s72, 6684672
    s_add_u32 m0, s71, 35840
    s_nop 0
    buffer_load_dwordx4 v12, s[48:51], s72 offen lds
    s_add_u32 m0, s71, 36864
    s_nop 0
    buffer_load_dwordx4 v13, s[48:51], s72 offen lds
    s_add_u32 m0, s71, 37888
    s_nop 0
    buffer_load_dwordx4 v14, s[48:51], s72 offen lds
    s_waitcnt vmcnt(35)
    ds_read_b64_tr_b16 a[0:1], v15 offset:20480
    ds_read_b64_tr_b16 a[2:3], v15 offset:20672
    ds_read_b64_tr_b16 a[8:9], v15 offset:20512
    ds_read_b64_tr_b16 a[10:11], v15 offset:20704
    ds_read_b64_tr_b16 a[16:17], v15 offset:20544
    ds_read_b64_tr_b16 a[18:19], v15 offset:20736
    s_waitcnt lgkmcnt(0)
    s_mov_b32 s72, 7077888
    s_add_u32 m0, s71, 20480
    s_nop 0
    buffer_load_dwordx4 v12, s[48:51], s72 offen lds
    s_add_u32 m0, s71, 21504
    s_nop 0
    buffer_load_dwordx4 v13, s[48:51], s72 offen lds
    s_add_u32 m0, s71, 22528
    s_nop 0
    buffer_load_dwordx4 v14, s[48:51], s72 offen lds
    s_waitcnt vmcnt(28)
    ds_read_b64_tr_b16 v[128:129], v10 offset:0
    ds_read_b64_tr_b16 v[130:131], v10 offset:640
    ds_read_b64_tr_b16 v[136:137], v10 offset:32
    ds_read_b64_tr_b16 v[138:139], v10 offset:672
    ds_read_b64_tr_b16 v[96:97], v10 offset:64
    ds_read_b64_tr_b16 v[98:99], v10 offset:704
    ds_read_b64_tr_b16 v[160:161], v10 offset:96
    ds_read_b64_tr_b16 v[162:163], v10 offset:736
    ds_read_b64_tr_b16 v[184:185], v10 offset:128
    ds_read_b64_tr_b16 v[186:187], v10 offset:768
    ds_read_b64_tr_b16 v[104:105], v10 offset:160
    ds_read_b64_tr_b16 v[106:107], v10 offset:800
    ds_read_b64_tr_b16 v[208:209], v10 offset:192
    ds_read_b64_tr_b16 v[210:211], v10 offset:832
    ds_read_b64_tr_b16 v[216:217], v10 offset:224
    ds_read_b64_tr_b16 v[218:219], v10 offset:864
    ds_read_b64_tr_b16 v[232:233], v10 offset:256
    ds_read_b64_tr_b16 v[234:235], v10 offset:896
    ds_read_b64_tr_b16 v[120:121], v10 offset:288
    ds_read_b64_tr_b16 v[122:123], v10 offset:928
    s_waitcnt vmcnt(25)
    ds_read_b64_tr_b16 a[4:5], v15 offset:23552
    ds_read_b64_tr_b16 a[6:7], v15 offset:23744
    ds_read_b64_tr_b16 a[12:13], v15 offset:23584
    ds_read_b64_tr_b16 a[14:15], v15 offset:23776
    ds_read_b64_tr_b16 a[20:21], v15 offset:23616
    ds_read_b64_tr_b16 a[22:23], v15 offset:23808
    s_waitcnt lgkmcnt(0)
    s_mov_b32 s72, 7471104
    s_add_u32 m0, s71, 23552
    s_nop 0
    buffer_load_dwordx4 v12, s[48:51], s72 offen lds
    s_add_u32 m0, s71, 24576
    s_nop 0
    buffer_load_dwordx4 v13, s[48:51], s72 offen lds
    s_add_u32 m0, s71, 25600
    s_nop 0
    buffer_load_dwordx4 v14, s[48:51], s72 offen lds
    s_waitcnt vmcnt(25)
    ds_read_b64_tr_b16 a[24:25], v15 offset:26624
    ds_read_b64_tr_b16 a[26:27], v15 offset:26816
    ds_read_b64_tr_b16 v[32:33], v15 offset:26656
    ds_read_b64_tr_b16 v[34:35], v15 offset:26848
    ds_read_b64_tr_b16 a[32:33], v15 offset:26688
    ds_read_b64_tr_b16 a[34:35], v15 offset:26880
    s_waitcnt vmcnt(22)
    ds_read_b64_tr_b16 a[28:29], v15 offset:29696
    ds_read_b64_tr_b16 a[30:31], v15 offset:29888
    ds_read_b64_tr_b16 v[36:37], v15 offset:29728
    ds_read_b64_tr_b16 v[38:39], v15 offset:29920
    ds_read_b64_tr_b16 a[36:37], v15 offset:29760
    ds_read_b64_tr_b16 a[38:39], v15 offset:29952
    s_waitcnt vmcnt(12)
    ds_read_b64_tr_b16 v[132:133], v10 offset:10240
    ds_read_b64_tr_b16 v[134:135], v10 offset:10880
    ds_read_b64_tr_b16 v[140:141], v10 offset:10272
    ds_read_b64_tr_b16 v[142:143], v10 offset:10912
    ds_read_b64_tr_b16 v[100:101], v10 offset:10304
    ds_read_b64_tr_b16 v[102:103], v10 offset:10944
    ds_read_b64_tr_b16 v[164:165], v10 offset:10336
    ds_read_b64_tr_b16 v[166:167], v10 offset:10976
    ds_read_b64_tr_b16 v[188:189], v10 offset:10368
    ds_read_b64_tr_b16 v[190:191], v10 offset:11008
    ds_read_b64_tr_b16 v[108:109], v10 offset:10400
    ds_read_b64_tr_b16 v[110:111], v10 offset:11040
    ds_read_b64_tr_b16 v[212:213], v10 offset:10432
    ds_read_b64_tr_b16 v[214:215], v10 offset:11072
    ds_read_b64_tr_b16 v[220:221], v10 offset:10464
    ds_read_b64_tr_b16 v[222:223], v10 offset:11104
    ds_read_b64_tr_b16 v[236:237], v10 offset:10496
    ds_read_b64_tr_b16 v[238:239], v10 offset:11136
    ds_read_b64_tr_b16 v[124:125], v10 offset:10528
    ds_read_b64_tr_b16 v[126:127], v10 offset:11168
    s_waitcnt vmcnt(9)
    ds_read_b64_tr_b16 a[40:41], v15 offset:32768
    ds_read_b64_tr_b16 a[42:43], v15 offset:32960
    ds_read_b64_tr_b16 a[48:49], v15 offset:32800
    ds_read_b64_tr_b16 a[50:51], v15 offset:32992
    ds_read_b64_tr_b16 a[56:57], v15 offset:32832
    ds_read_b64_tr_b16 a[58:59], v15 offset:33024
    s_waitcnt vmcnt(6)
    ds_read_b64_tr_b16 a[44:45], v15 offset:35840
    ds_read_b64_tr_b16 a[46:47], v15 offset:36032
    ds_read_b64_tr_b16 a[52:53], v15 offset:35872
    ds_read_b64_tr_b16 a[54:55], v15 offset:36064
    ds_read_b64_tr_b16 a[60:61], v15 offset:35904
    ds_read_b64_tr_b16 a[62:63], v15 offset:36096
    s_waitcnt vmcnt(3)
    ds_read_b64_tr_b16 v[40:41], v15 offset:20480
    ds_read_b64_tr_b16 v[42:43], v15 offset:20672
    ds_read_b64_tr_b16 a[104:105], v15 offset:20512
    ds_read_b64_tr_b16 a[106:107], v15 offset:20704
    ds_read_b64_tr_b16 a[152:153], v15 offset:20544
    ds_read_b64_tr_b16 a[154:155], v15 offset:20736
    s_waitcnt vmcnt(0)
    ds_read_b64_tr_b16 v[44:45], v15 offset:23552
    ds_read_b64_tr_b16 v[46:47], v15 offset:23744
    ds_read_b64_tr_b16 a[108:109], v15 offset:23584
    ds_read_b64_tr_b16 a[110:111], v15 offset:23776
    ds_read_b64_tr_b16 a[156:157], v15 offset:23616
    ds_read_b64_tr_b16 a[158:159], v15 offset:23808
    s_waitcnt lgkmcnt(0)
    s_branch L_pwj_68
L_pwv_72:
    s_mov_b32 s72, 0
    s_add_u32 m0, s71, 0
    s_nop 0
    buffer_load_dwordx4 v28, s[52:55], s72 offen lds
    s_add_u32 m0, s71, 1024
    s_nop 0
    buffer_load_dwordx4 v29, s[52:55], s72 offen lds
    s_add_u32 m0, s71, 2048
    s_nop 0
    buffer_load_dwordx4 v30, s[52:55], s72 offen lds
    s_add_u32 m0, s71, 3072
    s_nop 0
    buffer_load_dwordx4 v31, s[52:55], s72 offen lds
    s_add_u32 m0, s71, 4096
    s_nop 0
    buffer_load_dwordx4 v19, s[52:55], s72 offen lds
    s_mov_b32 s72, 20480
    s_add_u32 m0, s71, 5120
    s_nop 0
    buffer_load_dwordx4 v28, s[52:55], s72 offen lds
    s_add_u32 m0, s71, 6144
    s_nop 0
    buffer_load_dwordx4 v29, s[52:55], s72 offen lds
    s_add_u32 m0, s71, 7168
    s_nop 0
    buffer_load_dwordx4 v30, s[52:55], s72 offen lds
    s_add_u32 m0, s71, 8192
    s_nop 0
    buffer_load_dwordx4 v31, s[52:55], s72 offen lds
    s_add_u32 m0, s71, 9216
    s_nop 0
    buffer_load_dwordx4 v19, s[52:55], s72 offen lds
    s_mov_b32 s72, 0
    s_add_u32 m0, s71, 20480
    s_nop 0
    buffer_load_dwordx4 v12, s[48:51], s72 offen lds
    s_add_u32 m0, s71, 21504
    s_nop 0
    buffer_load_dwordx4 v13, s[48:51], s72 offen lds
    s_add_u32 m0, s71, 22528
    s_nop 0
    buffer_load_dwordx4 v14, s[48:51], s72 offen lds
    s_mov_b32 s72, 393216
    s_add_u32 m0, s71, 23552
    s_nop 0
    buffer_load_dwordx4 v12, s[48:51], s72 offen lds
    s_add_u32 m0, s71, 24576
    s_nop 0
    buffer_load_dwordx4 v13, s[48:51], s72 offen lds
    s_add_u32 m0, s71, 25600
    s_nop 0
    buffer_load_dwordx4 v14, s[48:51], s72 offen lds
    s_mov_b32 s72, 786432
    s_add_u32 m0, s71, 26624
    s_nop 0
    buffer_load_dwordx4 v12, s[48:51], s72 offen lds
    s_add_u32 m0, s71, 27648
    s_nop 0
    buffer_load_dwordx4 v13, s[48:51], s72 offen lds
    s_add_u32 m0, s71, 28672
    s_nop 0
    buffer_load_dwordx4 v14, s[48:51], s72 offen lds
    s_mov_b32 s72, 61440
    s_add_u32 m0, s71, 10240
    s_nop 0
    buffer_load_dwordx4 v28, s[52:55], s72 offen lds
    s_add_u32 m0, s71, 11264
    s_nop 0
    buffer_load_dwordx4 v29, s[52:55], s72 offen lds
    s_add_u32 m0, s71, 12288
    s_nop 0
    buffer_load_dwordx4 v30, s[52:55], s72 offen lds
    s_add_u32 m0, s71, 13312
    s_nop 0
    buffer_load_dwordx4 v31, s[52:55], s72 offen lds
    s_add_u32 m0, s71, 14336
    s_nop 0
    buffer_load_dwordx4 v19, s[52:55], s72 offen lds
    s_mov_b32 s72, 81920
    s_add_u32 m0, s71, 15360
    s_nop 0
    buffer_load_dwordx4 v28, s[52:55], s72 offen lds
    s_add_u32 m0, s71, 16384
    s_nop 0
    buffer_load_dwordx4 v29, s[52:55], s72 offen lds
    s_add_u32 m0, s71, 17408
    s_nop 0
    buffer_load_dwordx4 v30, s[52:55], s72 offen lds
    s_add_u32 m0, s71, 18432
    s_nop 0
    buffer_load_dwordx4 v31, s[52:55], s72 offen lds
    s_add_u32 m0, s71, 19456
    s_nop 0
    buffer_load_dwordx4 v19, s[52:55], s72 offen lds
    s_mov_b32 s72, 1179648
    s_add_u32 m0, s71, 29696
    s_nop 0
    buffer_load_dwordx4 v12, s[48:51], s72 offen lds
    s_add_u32 m0, s71, 30720
    s_nop 0
    buffer_load_dwordx4 v13, s[48:51], s72 offen lds
    s_add_u32 m0, s71, 31744
    s_nop 0
    buffer_load_dwordx4 v14, s[48:51], s72 offen lds
    s_mov_b32 s72, 1572864
    s_add_u32 m0, s71, 32768
    s_nop 0
    buffer_load_dwordx4 v12, s[48:51], s72 offen lds
    s_add_u32 m0, s71, 33792
    s_nop 0
    buffer_load_dwordx4 v13, s[48:51], s72 offen lds
    s_add_u32 m0, s71, 34816
    s_nop 0
    buffer_load_dwordx4 v14, s[48:51], s72 offen lds
    s_mov_b32 s72, 1966080
    s_add_u32 m0, s71, 35840
    s_nop 0
    buffer_load_dwordx4 v12, s[48:51], s72 offen lds
    s_add_u32 m0, s71, 36864
    s_nop 0
    buffer_load_dwordx4 v13, s[48:51], s72 offen lds
    s_add_u32 m0, s71, 37888
    s_nop 0
    buffer_load_dwordx4 v14, s[48:51], s72 offen lds
    s_waitcnt vmcnt(28)
    s_barrier
    v_mov_b32 v16, 1
    buffer_atomic_add v16, v11, s[60:63], 0 offen sc1
    ds_read_b64_tr_b16 a[192:193], v10 offset:0
    ds_read_b64_tr_b16 a[194:195], v10 offset:640
    ds_read_b64_tr_b16 a[208:209], v10 offset:32
    ds_read_b64_tr_b16 a[210:211], v10 offset:672
    ds_read_b64_tr_b16 v[144:145], v10 offset:64
    ds_read_b64_tr_b16 v[146:147], v10 offset:704
    ds_read_b64_tr_b16 v[80:81], v10 offset:96
    ds_read_b64_tr_b16 v[82:83], v10 offset:736
    ds_read_b64_tr_b16 v[168:169], v10 offset:128
    ds_read_b64_tr_b16 v[170:171], v10 offset:768
    ds_read_b64_tr_b16 a[232:233], v10 offset:160
    ds_read_b64_tr_b16 a[234:235], v10 offset:800
    ds_read_b64_tr_b16 v[192:193], v10 offset:192
    ds_read_b64_tr_b16 v[194:195], v10 offset:832
    ds_read_b64_tr_b16 a[248:249], v10 offset:224
    ds_read_b64_tr_b16 a[250:251], v10 offset:864
    ds_read_b64_tr_b16 v[112:113], v10 offset:256
    ds_read_b64_tr_b16 v[114:115], v10 offset:896
    ds_read_b64_tr_b16 v[240:241], v10 offset:288
    ds_read_b64_tr_b16 v[242:243], v10 offset:928
    s_waitcnt lgkmcnt(0)
    s_mov_b32 s72, 122880
    s_add_u32 m0, s71, 0
    s_nop 0
    buffer_load_dwordx4 v28, s[52:55], s72 offen lds
    s_add_u32 m0, s71, 1024
    s_nop 0
    buffer_load_dwordx4 v29, s[52:55], s72 offen lds
    s_add_u32 m0, s71, 2048
    s_nop 0
    buffer_load_dwordx4 v30, s[52:55], s72 offen lds
    s_add_u32 m0, s71, 3072
    s_nop 0
    buffer_load_dwordx4 v31, s[52:55], s72 offen lds
    s_add_u32 m0, s71, 4096
    s_nop 0
    buffer_load_dwordx4 v19, s[52:55], s72 offen lds
    s_mov_b32 s72, 143360
    s_add_u32 m0, s71, 5120
    s_nop 0
    buffer_load_dwordx4 v28, s[52:55], s72 offen lds
    s_add_u32 m0, s71, 6144
    s_nop 0
    buffer_load_dwordx4 v29, s[52:55], s72 offen lds
    s_add_u32 m0, s71, 7168
    s_nop 0
    buffer_load_dwordx4 v30, s[52:55], s72 offen lds
    s_add_u32 m0, s71, 8192
    s_nop 0
    buffer_load_dwordx4 v31, s[52:55], s72 offen lds
    s_add_u32 m0, s71, 9216
    s_nop 0
    buffer_load_dwordx4 v19, s[52:55], s72 offen lds
    s_waitcnt vmcnt(35)
    ds_read_b64_tr_b16 a[24:25], v15 offset:20480
    ds_read_b64_tr_b16 a[26:27], v15 offset:20672
    ds_read_b64_tr_b16 v[32:33], v15 offset:20512
    ds_read_b64_tr_b16 v[34:35], v15 offset:20704
    ds_read_b64_tr_b16 a[32:33], v15 offset:20544
    ds_read_b64_tr_b16 a[34:35], v15 offset:20736
    s_waitcnt lgkmcnt(0)
    s_mov_b32 s72, 2359296
    s_add_u32 m0, s71, 20480
    s_nop 0
    buffer_load_dwordx4 v12, s[48:51], s72 offen lds
    s_add_u32 m0, s71, 21504
    s_nop 0
    buffer_load_dwordx4 v13, s[48:51], s72 offen lds
    s_add_u32 m0, s71, 22528
    s_nop 0
    buffer_load_dwordx4 v14, s[48:51], s72 offen lds
    s_waitcnt vmcnt(35)
    ds_read_b64_tr_b16 a[28:29], v15 offset:23552
    ds_read_b64_tr_b16 a[30:31], v15 offset:23744
    ds_read_b64_tr_b16 v[36:37], v15 offset:23584
    ds_read_b64_tr_b16 v[38:39], v15 offset:23776
    ds_read_b64_tr_b16 a[36:37], v15 offset:23616
    ds_read_b64_tr_b16 a[38:39], v15 offset:23808
    s_waitcnt lgkmcnt(0)
    s_mov_b32 s72, 2752512
    s_add_u32 m0, s71, 23552
    s_nop 0
    buffer_load_dwordx4 v12, s[48:51], s72 offen lds
    s_add_u32 m0, s71, 24576
    s_nop 0
    buffer_load_dwordx4 v13, s[48:51], s72 offen lds
    s_add_u32 m0, s71, 25600
    s_nop 0
    buffer_load_dwordx4 v14, s[48:51], s72 offen lds
    s_waitcnt vmcnt(35)
    ds_read_b64_tr_b16 a[40:41], v15 offset:26624
    ds_read_b64_tr_b16 a[42:43], v15 offset:26816
    ds_read_b64_tr_b16 a[48:49], v15 offset:26656
    ds_read_b64_tr_b16 a[50:51], v15 offset:26848
    ds_read_b64_tr_b16 a[56:57], v15 offset:26688
    ds_read_b64_tr_b16 a[58:59], v15 offset:26880
    s_waitcnt lgkmcnt(0)
    s_mov_b32 s72, 3145728
    s_add_u32 m0, s71, 26624
    s_nop 0
    buffer_load_dwordx4 v12, s[48:51], s72 offen lds
    s_add_u32 m0, s71, 27648
    s_nop 0
    buffer_load_dwordx4 v13, s[48:51], s72 offen lds
    s_add_u32 m0, s71, 28672
    s_nop 0
    buffer_load_dwordx4 v14, s[48:51], s72 offen lds
    s_waitcnt vmcnt(28)
    ds_read_b64_tr_b16 a[196:197], v10 offset:10240
    ds_read_b64_tr_b16 a[198:199], v10 offset:10880
    ds_read_b64_tr_b16 a[212:213], v10 offset:10272
    ds_read_b64_tr_b16 a[214:215], v10 offset:10912
    ds_read_b64_tr_b16 v[148:149], v10 offset:10304
    ds_read_b64_tr_b16 v[150:151], v10 offset:10944
    ds_read_b64_tr_b16 v[84:85], v10 offset:10336
    ds_read_b64_tr_b16 v[86:87], v10 offset:10976
    ds_read_b64_tr_b16 v[172:173], v10 offset:10368
    ds_read_b64_tr_b16 v[174:175], v10 offset:11008
    ds_read_b64_tr_b16 a[236:237], v10 offset:10400
    ds_read_b64_tr_b16 a[238:239], v10 offset:11040
    ds_read_b64_tr_b16 v[196:197], v10 offset:10432
    ds_read_b64_tr_b16 v[198:199], v10 offset:11072
    ds_read_b64_tr_b16 a[252:253], v10 offset:10464
    ds_read_b64_tr_b16 a[254:255], v10 offset:11104
    ds_read_b64_tr_b16 v[116:117], v10 offset:10496
    ds_read_b64_tr_b16 v[118:119], v10 offset:11136
    ds_read_b64_tr_b16 v[244:245], v10 offset:10528
    ds_read_b64_tr_b16 v[246:247], v10 offset:11168
    s_waitcnt vmcnt(25)
    ds_read_b64_tr_b16 a[44:45], v15 offset:29696
    ds_read_b64_tr_b16 a[46:47], v15 offset:29888
    ds_read_b64_tr_b16 a[52:53], v15 offset:29728
    ds_read_b64_tr_b16 a[54:55], v15 offset:29920
    ds_read_b64_tr_b16 a[60:61], v15 offset:29760
    ds_read_b64_tr_b16 a[62:63], v15 offset:29952
    s_waitcnt lgkmcnt(0)
    s_mov_b32 s72, 3538944
    s_add_u32 m0, s71, 29696
    s_nop 0
    buffer_load_dwordx4 v12, s[48:51], s72 offen lds
    s_add_u32 m0, s71, 30720
    s_nop 0
    buffer_load_dwordx4 v13, s[48:51], s72 offen lds
    s_add_u32 m0, s71, 31744
    s_nop 0
    buffer_load_dwordx4 v14, s[48:51], s72 offen lds
    s_mov_b32 s72, 184320
    s_add_u32 m0, s71, 10240
    s_nop 0
    buffer_load_dwordx4 v28, s[52:55], s72 offen lds
    s_add_u32 m0, s71, 11264
    s_nop 0
    buffer_load_dwordx4 v29, s[52:55], s72 offen lds
    s_add_u32 m0, s71, 12288
    s_nop 0
    buffer_load_dwordx4 v30, s[52:55], s72 offen lds
    s_add_u32 m0, s71, 13312
    s_nop 0
    buffer_load_dwordx4 v31, s[52:55], s72 offen lds
    s_add_u32 m0, s71, 14336
    s_nop 0
    buffer_load_dwordx4 v19, s[52:55], s72 offen lds
    s_mov_b32 s72, 204800
    s_add_u32 m0, s71, 15360
    s_nop 0
    buffer_load_dwordx4 v28, s[52:55], s72 offen lds
    s_add_u32 m0, s71, 16384
    s_nop 0
    buffer_load_dwordx4 v29, s[52:55], s72 offen lds
    s_add_u32 m0, s71, 17408
    s_nop 0
    buffer_load_dwordx4 v30, s[52:55], s72 offen lds
    s_add_u32 m0, s71, 18432
    s_nop 0
    buffer_load_dwordx4 v31, s[52:55], s72 offen lds
    s_add_u32 m0, s71, 19456
    s_nop 0
    buffer_load_dwordx4 v19, s[52:55], s72 offen lds
    s_waitcnt vmcnt(35)
    ds_read_b64_tr_b16 v[40:41], v15 offset:32768
    ds_read_b64_tr_b16 v[42:43], v15 offset:32960
    ds_read_b64_tr_b16 a[104:105], v15 offset:32800
    ds_read_b64_tr_b16 a[106:107], v15 offset:32992
    ds_read_b64_tr_b16 a[152:153], v15 offset:32832
    ds_read_b64_tr_b16 a[154:155], v15 offset:33024
    s_waitcnt lgkmcnt(0)
    s_mov_b32 s72, 3932160
    s_add_u32 m0, s71, 32768
    s_nop 0
    buffer_load_dwordx4 v12, s[48:51], s72 offen lds
    s_add_u32 m0, s71, 33792
    s_nop 0
    buffer_load_dwordx4 v13, s[48:51], s72 offen lds
    s_add_u32 m0, s71, 34816
    s_nop 0
    buffer_load_dwordx4 v14, s[48:51], s72 offen lds
    s_waitcnt vmcnt(35)
    ds_read_b64_tr_b16 v[44:45], v15 offset:35840
    ds_read_b64_tr_b16 v[46:47], v15 offset:36032
    ds_read_b64_tr_b16 a[108:109], v15 offset:35872
    ds_read_b64_tr_b16 a[110:111], v15 offset:36064
    ds_read_b64_tr_b16 a[156:157], v15 offset:35904
    ds_read_b64_tr_b16 a[158:159], v15 offset:36096
    s_waitcnt lgkmcnt(0)
    s_mov_b32 s72, 4325376
    s_add_u32 m0, s71, 35840
    s_nop 0
    buffer_load_dwordx4 v12, s[48:51], s72 offen lds
    s_add_u32 m0, s71, 36864
    s_nop 0
    buffer_load_dwordx4 v13, s[48:51], s72 offen lds
    s_add_u32 m0, s71, 37888
    s_nop 0
    buffer_load_dwordx4 v14, s[48:51], s72 offen lds
    s_waitcnt vmcnt(28)
    ds_read_b64_tr_b16 a[200:201], v10 offset:0
    ds_read_b64_tr_b16 a[202:203], v10 offset:640
    ds_read_b64_tr_b16 a[216:217], v10 offset:32
    ds_read_b64_tr_b16 a[218:219], v10 offset:672
    ds_read_b64_tr_b16 v[152:153], v10 offset:64
    ds_read_b64_tr_b16 v[154:155], v10 offset:704
    ds_read_b64_tr_b16 a[224:225], v10 offset:96
    ds_read_b64_tr_b16 a[226:227], v10 offset:736
    ds_read_b64_tr_b16 v[176:177], v10 offset:128
    ds_read_b64_tr_b16 v[178:179], v10 offset:768
    ds_read_b64_tr_b16 a[240:241], v10 offset:160
    ds_read_b64_tr_b16 a[242:243], v10 offset:800
    ds_read_b64_tr_b16 v[200:201], v10 offset:192
    ds_read_b64_tr_b16 v[202:203], v10 offset:832
    ds_read_b64_tr_b16 v[88:89], v10 offset:224
    ds_read_b64_tr_b16 v[90:91], v10 offset:864
    ds_read_b64_tr_b16 v[224:225], v10 offset:256
    ds_read_b64_tr_b16 v[226:227], v10 offset:896
    ds_read_b64_tr_b16 v[248:249], v10 offset:288
    ds_read_b64_tr_b16 v[250:251], v10 offset:928
    s_waitcnt vmcnt(25)
    ds_read_b64_tr_b16 a[64:65], v15 offset:20480
    ds_read_b64_tr_b16 a[66:67], v15 offset:20672
    ds_read_b64_tr_b16 a[112:113], v15 offset:20512
    ds_read_b64_tr_b16 a[114:115], v15 offset:20704
    ds_read_b64_tr_b16 v[64:65], v15 offset:20544
    ds_read_b64_tr_b16 v[66:67], v15 offset:20736
    s_waitcnt lgkmcnt(0)
    s_mov_b32 s72, 4718592
    s_add_u32 m0, s71, 20480
    s_nop 0
    buffer_load_dwordx4 v12, s[48:51], s72 offen lds
    s_add_u32 m0, s71, 21504
    s_nop 0
    buffer_load_dwordx4 v13, s[48:51], s72 offen lds
    s_add_u32 m0, s71, 22528
    s_nop 0
    buffer_load_dwordx4 v14, s[48:51], s72 offen lds
    s_mov_b32 s72, 40960
    s_add_u32 m0, s71, 0
    s_nop 0
    buffer_load_dwordx4 v28, s[52:55], s72 offen lds
    s_add_u32 m0, s71, 1024
    s_nop 0
    buffer_load_dwordx4 v29, s[52:55], s72 offen lds
    s_add_u32 m0, s71, 2048
    s_nop 0
    buffer_load_dwordx4 v30, s[52:55], s72 offen lds
    s_add_u32 m0, s71, 3072
    s_nop 0
    buffer_load_dwordx4 v31, s[52:55], s72 offen lds
    s_add_u32 m0, s71, 4096
    s_nop 0
    buffer_load_dwordx4 v19, s[52:55], s72 offen lds
    s_mov_b32 s72, 102400
    s_add_u32 m0, s71, 5120
    s_nop 0
    buffer_load_dwordx4 v28, s[52:55], s72 offen lds
    s_add_u32 m0, s71, 6144
    s_nop 0
    buffer_load_dwordx4 v29, s[52:55], s72 offen lds
    s_add_u32 m0, s71, 7168
    s_nop 0
    buffer_load_dwordx4 v30, s[52:55], s72 offen lds
    s_add_u32 m0, s71, 8192
    s_nop 0
    buffer_load_dwordx4 v31, s[52:55], s72 offen lds
    s_add_u32 m0, s71, 9216
    s_nop 0
    buffer_load_dwordx4 v19, s[52:55], s72 offen lds
    s_waitcnt vmcnt(35)
    ds_read_b64_tr_b16 a[68:69], v15 offset:23552
    ds_read_b64_tr_b16 a[70:71], v15 offset:23744
    ds_read_b64_tr_b16 a[116:117], v15 offset:23584
    ds_read_b64_tr_b16 a[118:119], v15 offset:23776
    ds_read_b64_tr_b16 v[68:69], v15 offset:23616
    ds_read_b64_tr_b16 v[70:71], v15 offset:23808
    s_waitcnt lgkmcnt(0)
    s_mov_b32 s72, 5111808
    s_add_u32 m0, s71, 23552
    s_nop 0
    buffer_load_dwordx4 v12, s[48:51], s72 offen lds
    s_add_u32 m0, s71, 24576
    s_nop 0
    buffer_load_dwordx4 v13, s[48:51], s72 offen lds
    s_add_u32 m0, s71, 25600
    s_nop 0
    buffer_load_dwordx4 v14, s[48:51], s72 offen lds
    s_waitcnt vmcnt(35)
    ds_read_b64_tr_b16 a[72:73], v15 offset:26624
    ds_read_b64_tr_b16 a[74:75], v15 offset:26816
    ds_read_b64_tr_b16 a[120:121], v15 offset:26656
    ds_read_b64_tr_b16 a[122:123], v15 offset:26848
    ds_read_b64_tr_b16 a[160:161], v15 offset:26688
    ds_read_b64_tr_b16 a[162:163], v15 offset:26880
    s_waitcnt lgkmcnt(0)
    s_mov_b32 s72, 5505024
    s_add_u32 m0, s71, 26624
    s_nop 0
    buffer_load_dwordx4 v12, s[48:51], s72 offen lds
    s_add_u32 m0, s71, 27648
    s_nop 0
    buffer_load_dwordx4 v13, s[48:51], s72 offen lds
    s_add_u32 m0, s71, 28672
    s_nop 0
    buffer_load_dwordx4 v14, s[48:51], s72 offen lds
    s_waitcnt vmcnt(35)
    ds_read_b64_tr_b16 a[76:77], v15 offset:29696
    ds_read_b64_tr_b16 a[78:79], v15 offset:29888
    ds_read_b64_tr_b16 a[124:125], v15 offset:29728
    ds_read_b64_tr_b16 a[126:127], v15 offset:29920
    ds_read_b64_tr_b16 a[164:165], v15 offset:29760
    ds_read_b64_tr_b16 a[166:167], v15 offset:29952
    s_waitcnt lgkmcnt(0)
    s_mov_b32 s72, 5898240
    s_add_u32 m0, s71, 29696
    s_nop 0
    buffer_load_dwordx4 v12, s[48:51], s72 offen lds
    s_add_u32 m0, s71, 30720
    s_nop 0
    buffer_load_dwordx4 v13, s[48:51], s72 offen lds
    s_add_u32 m0, s71, 31744
    s_nop 0
    buffer_load_dwordx4 v14, s[48:51], s72 offen lds
    s_waitcnt vmcnt(28)
    ds_read_b64_tr_b16 a[204:205], v10 offset:10240
    ds_read_b64_tr_b16 a[206:207], v10 offset:10880
    ds_read_b64_tr_b16 a[220:221], v10 offset:10272
    ds_read_b64_tr_b16 a[222:223], v10 offset:10912
    ds_read_b64_tr_b16 v[156:157], v10 offset:10304
    ds_read_b64_tr_b16 v[158:159], v10 offset:10944
    ds_read_b64_tr_b16 a[228:229], v10 offset:10336
    ds_read_b64_tr_b16 a[230:231], v10 offset:10976
    ds_read_b64_tr_b16 v[180:181], v10 offset:10368
    ds_read_b64_tr_b16 v[182:183], v10 offset:11008
    ds_read_b64_tr_b16 a[244:245], v10 offset:10400
    ds_read_b64_tr_b16 a[246:247], v10 offset:11040
    ds_read_b64_tr_b16 v[204:205], v10 offset:10432
    ds_read_b64_tr_b16 v[206:207], v10 offset:11072
    ds_read_b64_tr_b16 v[92:93], v10 offset:10464
    ds_read_b64_tr_b16 v[94:95], v10 offset:11104
    ds_read_b64_tr_b16 v[228:229], v10 offset:10496
    ds_read_b64_tr_b16 v[230:231], v10 offset:11136
    ds_read_b64_tr_b16 v[252:253], v10 offset:10528
    ds_read_b64_tr_b16 v[254:255], v10 offset:11168
    s_waitcnt lgkmcnt(0)
    s_mov_b32 s72, 163840
    s_add_u32 m0, s71, 10240
    s_nop 0
    buffer_load_dwordx4 v28, s[52:55], s72 offen lds
    s_add_u32 m0, s71, 11264
    s_nop 0
    buffer_load_dwordx4 v29, s[52:55], s72 offen lds
    s_add_u32 m0, s71, 12288
    s_nop 0
    buffer_load_dwordx4 v30, s[52:55], s72 offen lds
    s_add_u32 m0, s71, 13312
    s_nop 0
    buffer_load_dwordx4 v31, s[52:55], s72 offen lds
    s_add_u32 m0, s71, 14336
    s_nop 0
    buffer_load_dwordx4 v19, s[52:55], s72 offen lds
    s_mov_b32 s72, 225280
    s_add_u32 m0, s71, 15360
    s_nop 0
    buffer_load_dwordx4 v28, s[52:55], s72 offen lds
    s_add_u32 m0, s71, 16384
    s_nop 0
    buffer_load_dwordx4 v29, s[52:55], s72 offen lds
    s_add_u32 m0, s71, 17408
    s_nop 0
    buffer_load_dwordx4 v30, s[52:55], s72 offen lds
    s_add_u32 m0, s71, 18432
    s_nop 0
    buffer_load_dwordx4 v31, s[52:55], s72 offen lds
    s_add_u32 m0, s71, 19456
    s_nop 0
    buffer_load_dwordx4 v19, s[52:55], s72 offen lds
    s_waitcnt vmcnt(35)
    ds_read_b64_tr_b16 a[80:81], v15 offset:32768
    ds_read_b64_tr_b16 a[82:83], v15 offset:32960
    ds_read_b64_tr_b16 v[56:57], v15 offset:32800
    ds_read_b64_tr_b16 v[58:59], v15 offset:32992
    ds_read_b64_tr_b16 a[168:169], v15 offset:32832
    ds_read_b64_tr_b16 a[170:171], v15 offset:33024
    s_waitcnt lgkmcnt(0)
    s_mov_b32 s72, 6291456
    s_add_u32 m0, s71, 32768
    s_nop 0
    buffer_load_dwordx4 v12, s[48:51], s72 offen lds
    s_add_u32 m0, s71, 33792
    s_nop 0
    buffer_load_dwordx4 v13, s[48:51], s72 offen lds
    s_add_u32 m0, s71, 34816
    s_nop 0
    buffer_load_dwordx4 v14, s[48:51], s72 offen lds
    s_waitcnt vmcnt(35)
    ds_read_b64_tr_b16 a[84:85], v15 offset:35840
    ds_read_b64_tr_b16 a[86:87], v15 offset:36032
    ds_read_b64_tr_b16 v[60:61], v15 offset:35872
    ds_read_b64_tr_b16 v[62:63], v15 offset:36064
    ds_read_b64_tr_b16 a[172:173], v15 offset:35904
    ds_read_b64_tr_b16 a[174:175], v15 offset:36096
    s_waitcnt lgkmcnt(0)
    s_mov_b32 s72, 6684672
    s_add_u32 m0, s71, 35840
    s_nop 0
    buffer_load_dwordx4 v12, s[48:51], s72 offen lds
    s_add_u32 m0, s71, 36864
    s_nop 0
    buffer_load_dwordx4 v13, s[48:51], s72 offen lds
    s_add_u32 m0, s71, 37888
    s_nop 0
    buffer_load_dwordx4 v14, s[48:51], s72 offen lds
    s_waitcnt vmcnt(35)
    ds_read_b64_tr_b16 a[88:89], v15 offset:20480
    ds_read_b64_tr_b16 a[90:91], v15 offset:20672
    ds_read_b64_tr_b16 a[128:129], v15 offset:20512
    ds_read_b64_tr_b16 a[130:131], v15 offset:20704
    ds_read_b64_tr_b16 a[176:177], v15 offset:20544
    ds_read_b64_tr_b16 a[178:179], v15 offset:20736
    s_waitcnt lgkmcnt(0)
    s_mov_b32 s72, 7077888
    s_add_u32 m0, s71, 20480
    s_nop 0
    buffer_load_dwordx4 v12, s[48:51], s72 offen lds
    s_add_u32 m0, s71, 21504
    s_nop 0
    buffer_load_dwordx4 v13, s[48:51], s72 offen lds
    s_add_u32 m0, s71, 22528
    s_nop 0
    buffer_load_dwordx4 v14, s[48:51], s72 offen lds
    s_waitcnt vmcnt(28)
    ds_read_b64_tr_b16 v[128:129], v10 offset:0
    ds_read_b64_tr_b16 v[130:131], v10 offset:640
    ds_read_b64_tr_b16 v[136:137], v10 offset:32
    ds_read_b64_tr_b16 v[138:139], v10 offset:672
    ds_read_b64_tr_b16 v[96:97], v10 offset:64
    ds_read_b64_tr_b16 v[98:99], v10 offset:704
    ds_read_b64_tr_b16 v[160:161], v10 offset:96
    ds_read_b64_tr_b16 v[162:163], v10 offset:736
    ds_read_b64_tr_b16 v[184:185], v10 offset:128
    ds_read_b64_tr_b16 v[186:187], v10 offset:768
    ds_read_b64_tr_b16 v[104:105], v10 offset:160
    ds_read_b64_tr_b16 v[106:107], v10 offset:800
    ds_read_b64_tr_b16 v[208:209], v10 offset:192
    ds_read_b64_tr_b16 v[210:211], v10 offset:832
    ds_read_b64_tr_b16 v[216:217], v10 offset:224
    ds_read_b64_tr_b16 v[218:219], v10 offset:864
    ds_read_b64_tr_b16 v[232:233], v10 offset:256
    ds_read_b64_tr_b16 v[234:235], v10 offset:896
    ds_read_b64_tr_b16 v[120:121], v10 offset:288
    ds_read_b64_tr_b16 v[122:123], v10 offset:928
    s_waitcnt vmcnt(25)
    ds_read_b64_tr_b16 a[92:93], v15 offset:23552
    ds_read_b64_tr_b16 a[94:95], v15 offset:23744
    ds_read_b64_tr_b16 a[132:133], v15 offset:23584
    ds_read_b64_tr_b16 a[134:135], v15 offset:23776
    ds_read_b64_tr_b16 a[180:181], v15 offset:23616
    ds_read_b64_tr_b16 a[182:183], v15 offset:23808
    s_waitcnt lgkmcnt(0)
    s_mov_b32 s72, 7471104
    s_add_u32 m0, s71, 23552
    s_nop 0
    buffer_load_dwordx4 v12, s[48:51], s72 offen lds
    s_add_u32 m0, s71, 24576
    s_nop 0
    buffer_load_dwordx4 v13, s[48:51], s72 offen lds
    s_add_u32 m0, s71, 25600
    s_nop 0
    buffer_load_dwordx4 v14, s[48:51], s72 offen lds
    s_waitcnt vmcnt(25)
    ds_read_b64_tr_b16 v[48:49], v15 offset:26624
    ds_read_b64_tr_b16 v[50:51], v15 offset:26816
    ds_read_b64_tr_b16 a[136:137], v15 offset:26656
    ds_read_b64_tr_b16 a[138:139], v15 offset:26848
    ds_read_b64_tr_b16 a[184:185], v15 offset:26688
    ds_read_b64_tr_b16 a[186:187], v15 offset:26880
    s_waitcnt vmcnt(22)
    ds_read_b64_tr_b16 v[52:53], v15 offset:29696
    ds_read_b64_tr_b16 v[54:55], v15 offset:29888
    ds_read_b64_tr_b16 a[140:141], v15 offset:29728
    ds_read_b64_tr_b16 a[142:143], v15 offset:29920
    ds_read_b64_tr_b16 a[188:189], v15 offset:29760
    ds_read_b64_tr_b16 a[190:191], v15 offset:29952
    s_waitcnt vmcnt(12)
    ds_read_b64_tr_b16 v[132:133], v10 offset:10240
    ds_read_b64_tr_b16 v[134:135], v10 offset:10880
    ds_read_b64_tr_b16 v[140:141], v10 offset:10272
    ds_read_b64_tr_b16 v[142:143], v10 offset:10912
    ds_read_b64_tr_b16 v[100:101], v10 offset:10304
    ds_read_b64_tr_b16 v[102:103], v10 offset:10944
    ds_read_b64_tr_b16 v[164:165], v10 offset:10336
    ds_read_b64_tr_b16 v[166:167], v10 offset:10976
    ds_read_b64_tr_b16 v[188:189], v10 offset:10368
    ds_read_b64_tr_b16 v[190:191], v10 offset:11008
    ds_read_b64_tr_b16 v[108:109], v10 offset:10400
    ds_read_b64_tr_b16 v[110:111], v10 offset:11040
    ds_read_b64_tr_b16 v[212:213], v10 offset:10432
    ds_read_b64_tr_b16 v[214:215], v10 offset:11072
    ds_read_b64_tr_b16 v[220:221], v10 offset:10464
    ds_read_b64_tr_b16 v[222:223], v10 offset:11104
    ds_read_b64_tr_b16 v[236:237], v10 offset:10496
    ds_read_b64_tr_b16 v[238:239], v10 offset:11136
    ds_read_b64_tr_b16 v[124:125], v10 offset:10528
    ds_read_b64_tr_b16 v[126:127], v10 offset:11168
    s_waitcnt vmcnt(9)
    ds_read_b64_tr_b16 a[96:97], v15 offset:32768
    ds_read_b64_tr_b16 a[98:99], v15 offset:32960
    ds_read_b64_tr_b16 a[144:145], v15 offset:32800
    ds_read_b64_tr_b16 a[146:147], v15 offset:32992
    ds_read_b64_tr_b16 v[72:73], v15 offset:32832
    ds_read_b64_tr_b16 v[74:75], v15 offset:33024
    s_waitcnt vmcnt(6)
    ds_read_b64_tr_b16 a[100:101], v15 offset:35840
    ds_read_b64_tr_b16 a[102:103], v15 offset:36032
    ds_read_b64_tr_b16 a[148:149], v15 offset:35872
    ds_read_b64_tr_b16 a[150:151], v15 offset:36064
    ds_read_b64_tr_b16 v[76:77], v15 offset:35904
    ds_read_b64_tr_b16 v[78:79], v15 offset:36096
    s_waitcnt vmcnt(3)
    ds_read_b64_tr_b16 a[0:1], v15 offset:20480
    ds_read_b64_tr_b16 a[2:3], v15 offset:20672
    ds_read_b64_tr_b16 a[8:9], v15 offset:20512
    ds_read_b64_tr_b16 a[10:11], v15 offset:20704
    ds_read_b64_tr_b16 a[16:17], v15 offset:20544
    ds_read_b64_tr_b16 a[18:19], v15 offset:20736
    s_waitcnt vmcnt(0)
    ds_read_b64_tr_b16 a[4:5], v15 offset:23552
    ds_read_b64_tr_b16 a[6:7], v15 offset:23744
    ds_read_b64_tr_b16 a[12:13], v15 offset:23584
    ds_read_b64_tr_b16 a[14:15], v15 offset:23776
    ds_read_b64_tr_b16 a[20:21], v15 offset:23616
    ds_read_b64_tr_b16 a[22:23], v15 offset:23808
    s_waitcnt lgkmcnt(0)
L_pwj_68:
    s_barrier
    ds_write_b128 v3, v[32:35] offset:0
    ds_write_b128 v3, v[36:39] offset:1024
    ds_write_b128 v3, v[40:43] offset:2048
    ds_write_b128 v3, v[44:47] offset:3072
    ds_write_b128 v3, v[48:51] offset:4096
    ds_write_b128 v3, v[52:55] offset:5120
    ds_write_b128 v3, v[56:59] offset:6144
    ds_write_b128 v3, v[60:63] offset:7168
    ds_write_b128 v3, v[64:67] offset:8192
    ds_write_b128 v3, v[68:71] offset:9216
    ds_write_b128 v3, v[72:75] offset:10240
    ds_write_b128 v3, v[76:79] offset:11264
    ds_write_b128 v3, v[80:83] offset:12288
    ds_write_b128 v3, v[84:87] offset:13312
    ds_write_b128 v3, v[88:91] offset:14336
    ds_write_b128 v3, v[92:95] offset:15360
    ds_write_b128 v3, v[96:99] offset:16384
    ds_write_b128 v3, v[100:103] offset:17408
    ds_write_b128 v3, v[104:107] offset:18432
    ds_write_b128 v3, v[108:111] offset:19456
    ds_write_b128 v3, v[112:115] offset:20480
    ds_write_b128 v3, v[116:119] offset:21504
    ds_write_b128 v3, v[120:123] offset:22528
    ds_write_b128 v3, v[124:127] offset:23552
    s_waitcnt lgkmcnt(0)
    v_mov_b32 v108, -1
    v_mov_b32 v109, -1
    v_mov_b32 v110, -1
    v_mov_b32 v111, -1
    s_mov_b32 s78, 0xc000000
    v_and_b32 v17, 15, v0
    v_lshrrev_b32 v18, 4, v0
    s_mul_i32 s7, s3, 81920
    s_add_u32 s7, s7, s76
    v_lshlrev_b32 v16, 4, v17
    v_add_u32 v16, s7, v16
    v_and_b32 v17, 1, v18
    v_lshl_add_u32 v122, v17, 13, v16
    v_lshrrev_b32 v17, 1, v18
    v_lshl_add_u32 v122, v17, 3, v122
    s_cmp_lg_u32 s3, 0
    s_cbranch_scc1 L_wsd_74
L_ws_73:
    buffer_load_dword v16, off, s[60:63], 0 sc1
    buffer_load_dword v17, off, s[60:63], 0 offset:128 sc1
    s_waitcnt vmcnt(0)
    v_cmp_gt_u32 vcc, 256, v16
    s_cbranch_vccnz L_ws_73_r
    v_cmp_gt_u32 vcc, 0x28000000, v17
    s_cbranch_vccz L_wsd_74
L_ws_73_r:
    s_sleep 16
    s_add_u32 s6, s6, 1
    s_cmp_gt_u32 s6, 200000
    s_cbranch_scc1 L_timeout
    s_branch L_ws_73
L_wsd_74:
    s_barrier
    buffer_load_dword v16, off, s[60:63], 0 offset:128 sc1
    s_waitcnt vmcnt(0)
    v_readfirstlane_b32 s68, v16
    s_nop 0
    s_bfe_u32 s7, s68, 0xc0000
    s_cmp_gt_u32 s7, 40
    s_cselect_b32 s7, 8192, 0
    s_add_u32 s38, s38, s7
    s_bfe_u32 s7, s68, 0xc000c
    s_cmp_gt_u32 s7, 40
    s_cselect_b32 s7, 8192, 0
    s_add_u32 s39, s39, s7
    s_add_u32 s68, s39, 1179648
    s_add_u32 s69, s39, 655360
    s_add_u32 s77, s77, s39
    v_mov_b64 v[24:25], 0
    v_mov_b64 v[26:27], 0
    v_mov_b64 v[28:29], 0
    v_mov_b64 v[30:31], 0
    v_mov_b64 v[32:33], 0
    v_mov_b64 v[34:35], 0
    ds_read_b128 v[92:95], v3 offset:0
    ds_read_b128 v[96:99], v3 offset:1024
    ds_read_b128 v[100:103], v3 offset:2048
    ds_read_b128 v[104:107], v3 offset:3072
    s_and_b32 s70, s5, 3
    s_lshl_b32 s70, s70, 16
    s_add_u32 s70, s70, s68
    s_add_u32 s86, s70, s64
    s_add_u32 s87, s70, s65
    s_add_u32 s88, s70, s66
    s_and_b32 s74, s5, 3
    s_mul_i32 s7, s74, 655360
    s_add_u32 s7, s7, s38
    s_cmp_eq_u32 s74, 3
    s_cselect_b32 s74, s39, s7
    s_add_u32 s44, s74, 0
    s_add_u32 s45, s74, 16384
    s_add_u32 s46, s74, 32768
    s_add_u32 s47, s74, 49152
    s_add_u32 s48, s74, 65536
    s_add_u32 s49, s74, 81920
    s_add_u32 s50, s74, 98304
    s_add_u32 s51, s74, 114688
    s_add_u32 s52, s74, 131072
    s_add_u32 s53, s74, 147456
    s_waitcnt lgkmcnt(0)
.p2align 6
L_v_loop_75:
L_pm_76:
    buffer_load_dwordx4 v[52:55], v2, s[40:43], s86 offen sc1
    buffer_load_dwordx4 v[56:59], v2, s[40:43], s87 offen sc1
    buffer_load_dwordx4 v[60:63], v2, s[40:43], s88 offen sc1
    s_waitcnt vmcnt(2)
    ds_write_b128 v20, v[52:55] offset:0
    v_max3_u32 v16, v52, v53, v54
    v_max_u32 v16, v16, v55
    s_waitcnt vmcnt(1)
    ds_write_b128 v21, v[56:59] offset:1024
    v_max3_u32 v16, v16, v56, v57
    v_max3_u32 v16, v16, v58, v59
    s_waitcnt vmcnt(0)
    ds_write_b128 v21, v[60:63] offset:2048
    v_max3_u32 v16, v16, v60, v61
    v_max3_u32 v16, v16, v62, v63
    v_cmp_eq_u32 vcc, -1, v16
    s_cbranch_vccnz L_rt_77
    v_smfmac_f32_16x16x64_bf16 v[24:27], v[52:55], a[0:7], v1
    s_waitcnt lgkmcnt(0)
    s_barrier
    ds_read_b128 v[64:67], v21 offset:3072
    ds_read_b128 v[68:71], v22 offset:4096
    v_smfmac_f32_16x16x64_bf16 v[28:31], v[52:55], a[8:15], v1
    ds_read_b128 v[72:75], v22 offset:5120
    ds_read_b128 v[76:79], v22 offset:6144
    v_smfmac_f32_16x16x64_bf16 v[32:35], v[52:55], a[16:23], v1
    ds_read_b128 v[80:83], v23 offset:7168
    ds_read_b128 v[84:87], v23 offset:8192
    v_smfmac_f32_16x16x64_bf16 v[24:27], v[56:59], a[24:31], v1
    ds_read_b128 v[88:91], v23 offset:9216
    v_smfmac_f32_16x16x64_bf16 v[28:31], v[56:59], v[92:99], v1
    ds_read_b128 v[92:95], v3 offset:4096
    ds_read_b128 v[96:99], v3 offset:5120
    v_smfmac_f32_16x16x64_bf16 v[32:35], v[56:59], a[32:39], v1
    v_smfmac_f32_16x16x64_bf16 v[24:27], v[60:63], a[40:47], v1
    v_smfmac_f32_16x16x64_bf16 v[28:31], v[60:63], a[48:55], v1
    v_smfmac_f32_16x16x64_bf16 v[32:35], v[60:63], a[56:63], v1
    s_waitcnt lgkmcnt(5)
    v_smfmac_f32_16x16x64_bf16 v[24:27], v[64:67], v[100:107], v1
    ds_read_b128 v[100:103], v3 offset:6144
    ds_read_b128 v[104:107], v3 offset:7168
    v_smfmac_f32_16x16x64_bf16 v[24:27], v[68:71], a[64:71], v1
    v_mov_b64 v[52:53], 0
    v_mov_b64 v[54:55], 0
    v_smfmac_f32_16x16x64_bf16 v[24:27], v[72:75], a[72:79], v1
    v_mov_b64 v[56:57], 0
    v_mov_b64 v[58:59], 0
    v_smfmac_f32_16x16x64_bf16 v[24:27], v[76:79], a[80:87], v1
    v_mov_b64 v[60:61], 0
    s_waitcnt lgkmcnt(4)
    v_smfmac_f32_16x16x64_bf16 v[24:27], v[80:83], a[88:95], v1
    v_mov_b64 v[62:63], 0
    s_waitcnt lgkmcnt(2)
    v_smfmac_f32_16x16x64_bf16 v[24:27], v[84:87], v[92:99], v1
    ds_read_b128 v[92:95], v3 offset:8192
    v_smfmac_f32_16x16x64_bf16 v[24:27], v[88:91], a[96:103], v1
    ds_read_b128 v[96:99], v3 offset:9216
    v_smfmac_f32_16x16x64_bf16 v[28:31], v[64:67], a[104:111], v1
    v_smfmac_f32_16x16x64_bf16 v[28:31], v[68:71], a[112:119], v1
    v_add_f32 v24, v24, v25
    v_smfmac_f32_16x16x64_bf16 v[28:31], v[72:75], a[120:127], v1
    v_add_f32 v26, v26, v27
    s_waitcnt lgkmcnt(2)
    v_smfmac_f32_16x16x64_bf16 v[28:31], v[76:79], v[100:107], v1
    ds_read_b128 v[100:103], v3 offset:10240
    v_smfmac_f32_16x16x64_bf16 v[28:31], v[80:83], a[128:135], v1
    ds_read_b128 v[104:107], v3 offset:11264
    v_smfmac_f32_16x16x64_bf16 v[28:31], v[84:87], a[136:143], v1
    v_smfmac_f32_16x16x64_bf16 v[28:31], v[88:91], a[144:151], v1
    v_smfmac_f32_16x16x64_bf16 v[32:35], v[64:67], a[152:159], v1
    s_waitcnt lgkmcnt(2)
    v_smfmac_f32_16x16x64_bf16 v[32:35], v[68:71], v[92:99], v1
    v_add_f32 v28, v28, v29
    v_add_f32 v30, v30, v31
    v_cvt_pk_bf16_f32 v24, v24, v28
    v_cvt_pk_bf16_f32 v25, v26, v30
    v_smfmac_f32_16x16x64_bf16 v[32:35], v[72:75], a[160:167], v1
    ds_write_b64 v4, v[24:25]
    ds_read_b128 v[92:95], v3 offset:12288
    v_smfmac_f32_16x16x64_bf16 v[32:35], v[76:79], a[168:175], v1
    ds_read_b128 v[96:99], v3 offset:13312
    v_mov_b64 v[64:65], 0
    v_smfmac_f32_16x16x64_bf16 v[32:35], v[80:83], a[176:183], v1
    v_mov_b64 v[66:67], 0
    v_mov_b64 v[68:69], 0
    v_smfmac_f32_16x16x64_bf16 v[32:35], v[84:87], a[184:191], v1
    s_waitcnt lgkmcnt(2)
    s_barrier
    ds_read_b64_tr_b16 v[36:37], v7 offset:0
    ds_read_b64_tr_b16 v[38:39], v7 offset:128
    ds_read_b64_tr_b16 v[40:41], v7 offset:1024
    ds_read_b64_tr_b16 v[42:43], v7 offset:1152
    v_mov_b64 v[70:71], 0
    v_smfmac_f32_16x16x64_bf16 v[32:35], v[88:91], v[100:107], v1
    ds_read_b128 v[100:103], v3 offset:14336
    s_waitcnt lgkmcnt(3)
    v_smfmac_f32_16x16x64_bf16 v[52:55], v[36:39], a[192:199], v1
    ds_read_b128 v[104:107], v3 offset:15360
    s_waitcnt lgkmcnt(2)
    v_smfmac_f32_16x16x64_bf16 v[52:55], v[40:43], a[200:207], v1
    v_add_f32 v32, v32, v33
    v_add_f32 v34, v34, v35
    v_cvt_pk_bf16_f32 v32, v32, v34
    v_smfmac_f32_16x16x64_bf16 v[56:59], v[36:39], a[208:215], v1
    ds_write_b16 v5, v32
    v_smfmac_f32_16x16x64_bf16 v[56:59], v[40:43], a[216:223], v1
    ds_write_b16_d16_hi v5, v32 offset:4
    v_mov_b64 v[72:73], 0
    v_smfmac_f32_16x16x64_bf16 v[60:63], v[36:39], v[92:99], v1
    v_mov_b64 v[74:75], 0
    v_mov_b64 v[76:77], 0
    v_smfmac_f32_16x16x64_bf16 v[60:63], v[40:43], a[224:231], v1
    s_waitcnt lgkmcnt(0)
    s_barrier
    ds_read_b64_tr_b16 v[44:45], v7 offset:2048
    ds_read_b64_tr_b16 v[46:47], v7 offset:2176
    v_mov_b64 v[78:79], 0
    v_mov_b64 v[80:81], 0
    v_smfmac_f32_16x16x64_bf16 v[64:67], v[36:39], a[232:239], v1
    v_mov_b64 v[82:83], 0
    v_mov_b64 v[84:85], 0
    v_smfmac_f32_16x16x64_bf16 v[64:67], v[40:43], a[240:247], v1
    v_mov_b64 v[86:87], 0
    v_mov_b64 v[88:89], 0
    v_smfmac_f32_16x16x64_bf16 v[68:71], v[36:39], a[248:255], v1
    v_mov_b64 v[90:91], 0
    ds_read_b128 v[92:95], v3 offset:16384
    v_smfmac_f32_16x16x64_bf16 v[68:71], v[40:43], v[100:107], v1
    ds_read_b128 v[96:99], v3 offset:17408
    ds_read_b128 v[100:103], v3 offset:18432
    s_waitcnt lgkmcnt(3)
    v_smfmac_f32_16x16x64_bf16 v[52:55], v[44:47], v[128:135], v1
    ds_read_b128 v[104:107], v3 offset:19456
    v_smfmac_f32_16x16x64_bf16 v[56:59], v[44:47], v[136:143], v1
    v_smfmac_f32_16x16x64_bf16 v[72:75], v[36:39], v[144:151], v1
    v_add_f32 v52, v52, v53
    v_add_f32 v54, v54, v55
    v_smfmac_f32_16x16x64_bf16 v[72:75], v[40:43], v[152:159], v1
    v_cvt_pk_bf16_f32 v112, v52, v54
    v_add_f32 v56, v56, v57
    s_waitcnt lgkmcnt(2)
    v_smfmac_f32_16x16x64_bf16 v[72:75], v[44:47], v[92:99], v1
    v_add_f32 v58, v58, v59
    v_cvt_pk_bf16_f32 v113, v56, v58
    v_smfmac_f32_16x16x64_bf16 v[60:63], v[44:47], v[160:167], v1
    s_nop 0
    v_permlane16_swap_b32 v112, v113
    buffer_store_dwordx2 v[112:113], v6, s[40:43], s44 offen sc1
    v_smfmac_f32_16x16x64_bf16 v[76:79], v[36:39], v[168:175], v1
    ds_read_b128 v[92:95], v3 offset:20480
    ds_read_b128 v[96:99], v3 offset:21504
    v_smfmac_f32_16x16x64_bf16 v[76:79], v[40:43], v[176:183], v1
    v_add_f32 v72, v72, v73
    v_add_f32 v74, v74, v75
    v_smfmac_f32_16x16x64_bf16 v[76:79], v[44:47], v[184:191], v1
    v_cvt_pk_bf16_f32 v114, v72, v74
    v_add_f32 v60, v60, v61
    s_waitcnt lgkmcnt(2)
    v_smfmac_f32_16x16x64_bf16 v[64:67], v[44:47], v[100:107], v1
    v_add_f32 v62, v62, v63
    v_cvt_pk_bf16_f32 v115, v60, v62
    v_smfmac_f32_16x16x64_bf16 v[80:83], v[36:39], v[192:199], v1
    s_nop 0
    v_permlane16_swap_b32 v114, v115
    buffer_store_dwordx2 v[114:115], v6, s[40:43], s46 offen sc1
    v_smfmac_f32_16x16x64_bf16 v[80:83], v[40:43], v[200:207], v1
    ds_read_b128 v[100:103], v3 offset:22528
    ds_read_b128 v[104:107], v3 offset:23552
    v_smfmac_f32_16x16x64_bf16 v[80:83], v[44:47], v[208:215], v1
    v_add_f32 v76, v76, v77
    v_add_f32 v78, v78, v79
    v_smfmac_f32_16x16x64_bf16 v[68:71], v[44:47], v[216:223], v1
    v_cvt_pk_bf16_f32 v116, v76, v78
    v_add_f32 v64, v64, v65
    s_waitcnt lgkmcnt(2)
    v_smfmac_f32_16x16x64_bf16 v[84:87], v[36:39], v[92:99], v1
    v_add_f32 v66, v66, v67
    v_cvt_pk_bf16_f32 v117, v64, v66
    v_smfmac_f32_16x16x64_bf16 v[84:87], v[40:43], v[224:231], v1
    s_nop 0
    v_permlane16_swap_b32 v116, v117
    buffer_store_dwordx2 v[116:117], v6, s[40:43], s48 offen sc1
    v_smfmac_f32_16x16x64_bf16 v[84:87], v[44:47], v[232:239], v1
    v_add_f32 v80, v80, v81
    v_add_f32 v82, v82, v83
    v_smfmac_f32_16x16x64_bf16 v[88:91], v[36:39], v[240:247], v1
    v_cvt_pk_bf16_f32 v118, v80, v82
    v_add_f32 v68, v68, v69
    v_smfmac_f32_16x16x64_bf16 v[88:91], v[40:43], v[248:255], v1
    v_add_f32 v70, v70, v71
    v_cvt_pk_bf16_f32 v119, v68, v70
    s_waitcnt lgkmcnt(0)
    v_smfmac_f32_16x16x64_bf16 v[88:91], v[44:47], v[100:107], v1
    v_permlane16_swap_b32 v118, v119
    buffer_store_dwordx2 v[118:119], v6, s[40:43], s50 offen sc1
    v_add_f32 v84, v84, v85
    v_add_f32 v86, v86, v87
    v_cvt_pk_bf16_f32 v120, v84, v86
    s_nop 2
    v_add_f32 v88, v88, v89
    v_add_f32 v90, v90, v91
    v_cvt_pk_bf16_f32 v121, v88, v90
    s_nop 1
    v_permlane16_swap_b32 v120, v121
    buffer_store_dwordx2 v[120:121], v6, s[40:43], s52 offen sc1
    s_add_u32 s75, s78, 0
    buffer_store_dwordx2 v[112:113], v122, s[40:43], s75 offen sc1
    s_add_u32 s75, s78, 16384
    buffer_store_dwordx2 v[114:115], v122, s[40:43], s75 offen sc1
    s_add_u32 s75, s78, 32768
    buffer_store_dwordx2 v[116:117], v122, s[40:43], s75 offen sc1
    s_add_u32 s75, s78, 49152
    buffer_store_dwordx2 v[118:119], v122, s[40:43], s75 offen sc1
    s_add_u32 s75, s78, 65536
    buffer_store_dwordx2 v[120:121], v122, s[40:43], s75 offen sc1
    s_add_u32 s78, s78, 327680
    s_add_u32 s74, s5, 3
    s_and_b32 s74, s74, 3
    s_mul_i32 s7, s74, 655360
    s_add_u32 s7, s7, s38
    s_cmp_eq_u32 s74, 3
    s_cselect_b32 s74, s39, s7
    buffer_store_dwordx4 v[108:111], v8, s[40:43], s74 offen sc1
    s_add_u32 s75, s74, 65536
    buffer_store_dwordx4 v[108:111], v8, s[40:43], s75 offen sc1
    buffer_store_dwordx2 v[108:109], v9, s[40:43], s74 offen sc1
    s_add_u32 s5, s5, 1
    s_cmp_ge_u32 s5, 64
    s_cbranch_scc1 L_v_fin_78
    v_mov_b64 v[24:25], 0
    v_mov_b64 v[26:27], 0
    v_mov_b64 v[28:29], 0
    v_mov_b64 v[30:31], 0
    v_mov_b64 v[32:33], 0
    v_mov_b64 v[34:35], 0
    ds_read_b128 v[92:95], v3 offset:0
    ds_read_b128 v[96:99], v3 offset:1024
    ds_read_b128 v[100:103], v3 offset:2048
    ds_read_b128 v[104:107], v3 offset:3072
    s_and_b32 s70, s5, 3
    s_lshl_b32 s70, s70, 16
    s_add_u32 s70, s70, s68
    s_add_u32 s86, s70, s64
    s_add_u32 s87, s70, s65
    s_add_u32 s88, s70, s66
    s_and_b32 s74, s5, 3
    s_mul_i32 s7, s74, 655360
    s_add_u32 s7, s7, s38
    s_cmp_eq_u32 s74, 3
    s_cselect_b32 s74, s39, s7
    s_add_u32 s44, s74, 0
    s_add_u32 s45, s74, 16384
    s_add_u32 s46, s74, 32768
    s_add_u32 s47, s74, 49152
    s_add_u32 s48, s74, 65536
    s_add_u32 s49, s74, 81920
    s_add_u32 s50, s74, 98304
    s_add_u32 s51, s74, 114688
    s_add_u32 s52, s74, 131072
    s_add_u32 s53, s74, 147456
    s_waitcnt lgkmcnt(0)
    s_waitcnt vmcnt(3)
    s_barrier
    v_mov_b32 v16, s5
    buffer_store_dword v16, v11, s[40:43], s77 offen sc1
    s_branch L_v_loop_75
L_v_fin_78:
    s_waitcnt vmcnt(0)
    s_barrier
    v_mov_b32 v16, s5
    buffer_store_dword v16, v11, s[40:43], s77 offen sc1
    s_endpgm
L_rt_77:
    s_add_u32 s6, s6, 1
    s_cmp_gt_u32 s6, 200000
    s_cbranch_scc1 L_timeout
    s_nop 3
    s_branch L_pm_76
L_O:
    s_mov_b32 s48, s10
    s_mov_b32 s49, s11
    s_mov_b32 s50, 0x2800
    s_mov_b32 s51, 0x20000
    v_and_b32 v1, 15, v0
    v_lshrrev_b32 v2, 4, v0
    v_lshrrev_b32 v3, 2, v1
    v_and_b32 v4, 3, v0
    v_and_b32 v16, 1, v0
    v_cmp_eq_u32 vcc, 0, v16
    v_mov_b32 v16, 0xeeee
    v_mov_b32 v17, 0x4444
    v_cndmask_b32 v6, v16, v17, vcc
    v_lshlrev_b32 v7, 4, v0
    v_mov_b32 v15, -1
    s_and_b32 s92, s3, 1
    s_cmp_eq_u32 s92, 0
    s_cselect_b32 s90, s38, s39
    s_lshl_b32 s7, s4, 1
    s_lshr_b32 s79, s3, 1
    s_add_u32 s7, s7, s79
    s_lshr_b32 s79, s7, 6
    s_lshl_b32 s79, s79, 14
    s_and_b32 s7, s7, 63
    s_lshl_b32 s7, s7, 7
    s_add_u32 s90, s90, s7
    s_add_u32 s90, s90, s79
    s_add_u32 s90, s90, 1966080
    s_add_u32 s91, s90, 8192
    v_cmp_eq_u32 vcc, 0, v0
    v_mov_b32 v21, 0x80000000
    s_nop 0
    v_cndmask_b32_e64 v21, v21, 0, vcc
    s_mov_b32 s84, -1
    s_mov_b32 s85, -1
    s_waitcnt vmcnt(0)
    s_memtime s[86:87]
    s_waitcnt lgkmcnt(0)
    buffer_store_dword v15, v21, s[40:43], s90 offen sc1
    s_waitcnt vmcnt(0)
    s_memtime s[88:89]
    s_waitcnt lgkmcnt(0)
    s_sub_u32 s88, s88, s86
    s_min_u32 s84, s84, s88
    s_memtime s[86:87]
    s_waitcnt lgkmcnt(0)
    buffer_store_dword v15, v21, s[40:43], s91 offen sc1
    s_waitcnt vmcnt(0)
    s_memtime s[88:89]
    s_waitcnt lgkmcnt(0)
    s_sub_u32 s88, s88, s86
    s_min_u32 s85, s85, s88
    s_memtime s[86:87]
    s_waitcnt lgkmcnt(0)
    buffer_store_dword v15, v21, s[40:43], s90 offen sc1
    s_waitcnt vmcnt(0)
    s_memtime s[88:89]
    s_waitcnt lgkmcnt(0)
    s_sub_u32 s88, s88, s86
    s_min_u32 s84, s84, s88
    s_memtime s[86:87]
    s_waitcnt lgkmcnt(0)
    buffer_store_dword v15, v21, s[40:43], s91 offen sc1
    s_waitcnt vmcnt(0)
    s_memtime s[88:89]
    s_waitcnt lgkmcnt(0)
    s_sub_u32 s88, s88, s86
    s_min_u32 s85, s85, s88
    s_memtime s[86:87]
    s_waitcnt lgkmcnt(0)
    buffer_store_dword v15, v21, s[40:43], s90 offen sc1
    s_waitcnt vmcnt(0)
    s_memtime s[88:89]
    s_waitcnt lgkmcnt(0)
    s_sub_u32 s88, s88, s86
    s_min_u32 s84, s84, s88
    s_memtime s[86:87]
    s_waitcnt lgkmcnt(0)
    buffer_store_dword v15, v21, s[40:43], s91 offen sc1
    s_waitcnt vmcnt(0)
    s_memtime s[88:89]
    s_waitcnt lgkmcnt(0)
    s_sub_u32 s88, s88, s86
    s_min_u32 s85, s85, s88
    s_cmp_lt_u32 s85, s84
    s_cselect_b32 s84, 1, 0
    s_mul_i32 s92, s92, 12
    s_lshl_b32 s84, s84, s92
    v_mov_b32 v19, s84
    s_lshl_b32 s7, s3, 2
    v_mov_b32 v18, s7
    ds_write_b32 v18, v19
    v_mov_b32 v18, 0
    s_waitcnt lgkmcnt(0)
    s_barrier
    ds_read_b128 v[32:35], v18
    v_mov_b32 v5, s3
    v_or_b32 v5, v5, v0
    v_cmp_eq_u32 vcc, 0, v5
    v_mov_b32 v5, 0x80000000
    s_nop 0
    v_cndmask_b32_e64 v5, v5, 0, vcc
    s_waitcnt lgkmcnt(0)
    v_add3_u32 v32, v32, v33, v34
    v_add_u32 v32, v32, v35
    v_add_u32 v32, 0x1000000, v32
    buffer_atomic_add v32, v5, s[60:63], 0 offen offset:128 sc1
    s_nop 1
    s_cmp_eq_u32 s3, 0
    s_cselect_b32 s7, 0, 0x80000000
    s_lshl_b32 s79, s4, 8
    s_or_b32 s7, s7, s79
    s_cmp_ge_u32 s4, 32
    s_cselect_b32 s79, 24576, 0
    s_add_u32 s7, s7, s79
    v_lshlrev_b32 v13, 2, v0
    v_add_u32 v13, s7, v13
    v_lshrrev_b32 v16, 3, v0
    v_and_b32 v17, 7, v0
    v_mul_u32_u24 v18, 1280, v16
    v_lshl_add_u32 v18, v17, 2, v18
    s_lshl_b32 s7, s4, 5
    buffer_load_dword v19, v18, s[48:51], s7 offen
    v_lshlrev_b32 v12, 3, v0
    v_lshlrev_b32 v11, 7, v2
    v_lshl_add_u32 v11, v1, 2, v11
    s_lshl_b32 s7, s3, 9
    v_add_u32 v11, s7, v11
    v_mov_b32 v32, -1
    v_mov_b32 v33, -1
    v_mov_b32 v34, -1
    v_mov_b32 v35, -1
    s_lshl_b32 s71, s4, 14
    s_lshl_b32 s79, s3, 12
    s_add_u32 s71, s71, s79
    s_add_u32 s71, s71, s38
    s_add_u32 s7, s71, 0
    buffer_store_dwordx4 v[32:35], v7, s[40:43], s7 offen offset:0 sc1
    buffer_store_dwordx4 v[32:35], v7, s[40:43], s7 offen offset:1024 sc1
    buffer_store_dwordx4 v[32:35], v7, s[40:43], s7 offen offset:2048 sc1
    buffer_store_dwordx4 v[32:35], v7, s[40:43], s7 offen offset:3072 sc1
    s_add_u32 s7, s71, 655360
    buffer_store_dwordx4 v[32:35], v7, s[40:43], s7 offen offset:0 sc1
    buffer_store_dwordx4 v[32:35], v7, s[40:43], s7 offen offset:1024 sc1
    buffer_store_dwordx4 v[32:35], v7, s[40:43], s7 offen offset:2048 sc1
    buffer_store_dwordx4 v[32:35], v7, s[40:43], s7 offen offset:3072 sc1
    s_add_u32 s7, s71, 1310720
    buffer_store_dwordx4 v[32:35], v7, s[40:43], s7 offen offset:0 sc1
    buffer_store_dwordx4 v[32:35], v7, s[40:43], s7 offen offset:1024 sc1
    buffer_store_dwordx4 v[32:35], v7, s[40:43], s7 offen offset:2048 sc1
    buffer_store_dwordx4 v[32:35], v7, s[40:43], s7 offen offset:3072 sc1
    s_add_u32 s7, s39, 1245184
    buffer_store_dword v15, v13, s[40:43], s7 offen sc1
    s_add_u32 s7, s39, 1253376
    buffer_store_dword v15, v13, s[40:43], s7 offen sc1
    s_add_u32 s7, s39, 1261568
    buffer_store_dword v15, v13, s[40:43], s7 offen sc1
    s_add_u32 s7, s39, 1269760
    buffer_store_dword v15, v13, s[40:43], s7 offen sc1
    s_add_u32 s7, s39, 1310720
    buffer_store_dword v15, v13, s[40:43], s7 offen sc1
    s_add_u32 s7, s39, 1318912
    buffer_store_dword v15, v13, s[40:43], s7 offen sc1
    s_add_u32 s7, s39, 1327104
    buffer_store_dword v15, v13, s[40:43], s7 offen sc1
    s_add_u32 s7, s39, 1335296
    buffer_store_dword v15, v13, s[40:43], s7 offen sc1
    s_add_u32 s7, s39, 1376256
    buffer_store_dword v15, v13, s[40:43], s7 offen sc1
    s_add_u32 s7, s39, 1384448
    buffer_store_dword v15, v13, s[40:43], s7 offen sc1
    s_add_u32 s7, s39, 1392640
    buffer_store_dword v15, v13, s[40:43], s7 offen sc1
    s_add_u32 s7, s39, 1400832
    buffer_store_dword v15, v13, s[40:43], s7 offen sc1
    s_waitcnt vmcnt(24)
    v_min_u32 v19, -2, v19
    s_add_u32 s7, s39, 1179648
    buffer_store_dword v19, v13, s[40:43], s7 offen sc1
    s_add_u32 s7, s39, 1187840
    buffer_store_dword v19, v13, s[40:43], s7 offen sc1
    s_add_u32 s7, s39, 1196032
    buffer_store_dword v19, v13, s[40:43], s7 offen sc1
    s_add_u32 s7, s39, 1204224
    buffer_store_dword v19, v13, s[40:43], s7 offen sc1
    v_mov_b32 v5, s3
    v_or_b32 v5, v5, v0
    v_cmp_eq_u32 vcc, 0, v5
    v_mov_b32 v5, 0x80000000
    s_nop 0
    v_cndmask_b32_e64 v5, v5, 0, vcc
    s_waitcnt vmcnt(0)
    s_barrier
    v_mov_b32 v16, 1
    buffer_atomic_add v16, v5, s[60:63], 0 offen sc1
    s_lshl_b32 s7, s3, 15
    v_and_b32 v16, 31, v0
    v_lshlrev_b32 v16, 4, v16
    v_lshrrev_b32 v17, 5, v0
    v_mul_u32_u24 v8, 640, v17
    v_add3_u32 v8, v8, v16, s7
    v_mul_u32_u24 v9, 1280, v2
    v_lshl_add_u32 v9, v1, 3, v9
    s_add_u32 s7, s7, 512
    v_add_u32 v9, s7, v9
    s_lshl_b32 s7, s4, 14
    s_lshl_b32 s79, s3, 11
    s_add_u32 s7, s7, s79
    v_add_u32 v10, s7, v7
    s_lshl_b32 s7, s3, 3
    s_add_u32 s7, s7, 72
    v_and_b32 v16, 7, v0
    v_add_u32 v14, s7, v16
    v_lshlrev_b32 v14, 7, v14
    s_mov_b32 s81, 0
    s_lshl_b32 s73, s4, 15
    s_lshl_b32 s7, s3, 13
    s_add_u32 s73, s73, s7
    s_add_u32 s73, s73, 0x6800000
    s_cmp_lg_u32 s3, 0
    s_cbranch_scc1 L_wsd_80
L_ws_79:
    buffer_load_dword v16, off, s[60:63], 0 sc1
    buffer_load_dword v17, off, s[60:63], 0 offset:128 sc1
    s_waitcnt vmcnt(0)
    v_cmp_gt_u32 vcc, 256, v16
    s_cbranch_vccnz L_ws_79_r
    v_cmp_gt_u32 vcc, 0x28000000, v17
    s_cbranch_vccz L_wsd_80
L_ws_79_r:
    s_sleep 16
    s_add_u32 s6, s6, 1
    s_cmp_gt_u32 s6, 200000
    s_cbranch_scc1 L_timeout
    s_branch L_ws_79
L_wsd_80:
    s_barrier
    buffer_load_dword v16, off, s[60:63], 0 offset:128 sc1
    s_waitcnt vmcnt(0)
    v_readfirstlane_b32 s68, v16
    s_nop 0
    s_bfe_u32 s7, s68, 0xc0000
    s_cmp_gt_u32 s7, 40
    s_cselect_b32 s7, 8192, 0
    s_add_u32 s38, s38, s7
    s_bfe_u32 s7, s68, 0xc000c
    s_cmp_gt_u32 s7, 40
    s_cselect_b32 s7, 8192, 0
    s_add_u32 s39, s39, s7
    s_add_u32 s68, s39, 1179648
    s_add_u32 s69, s39, 655360
    s_mov_b32 s78, 1
    s_cmp_ge_u32 s81, s78
    s_cbranch_scc1 L_wNd_81
L_wf_82:
    buffer_load_dword v16, v14, s[40:43], 0 offen sc1
    s_waitcnt vmcnt(0)
    v_cmp_gt_u32 vcc, s78, v16
    s_cbranch_vccz L_wfd_83
    s_sleep 2
    s_add_u32 s6, s6, 1
    s_cmp_gt_u32 s6, 200000
    s_cbranch_scc1 L_timeout
    s_branch L_wf_82
L_wfd_83:
    s_mov_b32 s81, s78
    s_add_u32 s79, s78, 1
    v_cmp_gt_u32 vcc, s79, v16
    s_cbranch_vccnz L_wNd_81
    s_mov_b32 s81, s79
    s_add_u32 s79, s78, 2
    v_cmp_gt_u32 vcc, s79, v16
    s_cbranch_vccnz L_wNd_81
    s_mov_b32 s81, s79
    s_add_u32 s79, s78, 4
    v_cmp_gt_u32 vcc, s79, v16
    s_cbranch_vccnz L_wNd_81
    s_mov_b32 s81, s79
    s_add_u32 s79, s78, 8
    v_cmp_gt_u32 vcc, s79, v16
    s_cbranch_vccnz L_wNd_81
    s_mov_b32 s81, s79
    s_add_u32 s79, s78, 16
    v_cmp_gt_u32 vcc, s79, v16
    s_cbranch_vccnz L_wNd_81
    s_mov_b32 s81, s79
L_wNd_81:
    buffer_load_dwordx4 v[60:63], v7, s[40:43], s73 offen offset:0 sc1
    buffer_load_dwordx4 v[64:67], v7, s[40:43], s73 offen offset:1024 sc1
    buffer_load_dwordx4 v[68:71], v7, s[40:43], s73 offen offset:2048 sc1
    buffer_load_dwordx4 v[72:75], v7, s[40:43], s73 offen offset:3072 sc1
    s_add_u32 s79, s73, 4096
    buffer_load_dwordx4 v[76:79], v7, s[40:43], s79 offen offset:0 sc1
    buffer_load_dwordx4 v[80:83], v7, s[40:43], s79 offen offset:1024 sc1
    buffer_load_dwordx4 v[84:87], v7, s[40:43], s79 offen offset:2048 sc1
    buffer_load_dwordx4 v[88:91], v7, s[40:43], s79 offen offset:3072 sc1
    s_add_u32 s73, s73, 1310720
.p2align 6
L_o_loop_84:
    s_and_b32 s70, s5, 3
    s_lshl_b32 s70, s70, 17
    s_add_u32 s70, s70, s69
    s_and_b32 s71, s5, 3
    s_mul_i32 s7, s71, 655360
    s_add_u32 s7, s7, s38
    s_cmp_eq_u32 s71, 3
    s_cselect_b32 s71, s39, s7
    s_add_u32 s72, s5, 1
    s_and_b32 s72, s72, 3
    s_lshl_b32 s72, s72, 16
    s_add_u32 s72, s72, s68
L_oy_85:
    buffer_load_dwordx4 v[52:55], v10, s[40:43], s71 offen offset:0 sc1
    buffer_load_dwordx4 v[56:59], v10, s[40:43], s71 offen offset:1024 sc1
    s_waitcnt vmcnt(0)
    v_max3_u32 v16, v52, v53, v54
    v_max3_u32 v16, v16, v55, v56
    v_max3_u32 v16, v16, v57, v58
    v_max_u32 v16, v16, v59
    v_cmp_eq_u32 vcc, -1, v16
    s_cbranch_vccnz L_rt_86
L_op_87:
    buffer_load_dwordx4 v[32:35], v8, s[40:43], s70 offen offset:0 sc1
    buffer_load_dwordx4 v[36:39], v8, s[40:43], s70 offen offset:1280 sc1
    buffer_load_dwordx4 v[40:43], v8, s[40:43], s70 offen offset:2560 sc1
    buffer_load_dwordx4 v[44:47], v8, s[40:43], s70 offen offset:3840 sc1
    buffer_load_dwordx2 v[48:49], v9, s[40:43], s70 offen offset:0 sc1
    buffer_load_dwordx2 v[50:51], v9, s[40:43], s70 offen offset:640 sc1
    v_mov_b64 v[28:29], 0
    v_mov_b64 v[30:31], 0
    s_waitcnt vmcnt(5)
    s_nop 0
    v_smfmac_f32_16x16x64_bf16 v[28:31], v[32:35], v[60:67], v6
    v_max3_u32 v16, v32, v33, v34
    v_max_u32 v16, v16, v35
    s_waitcnt vmcnt(4)
    v_smfmac_f32_16x16x64_bf16 v[28:31], v[36:39], v[68:75], v6
    v_max3_u32 v16, v16, v36, v37
    v_max3_u32 v16, v16, v38, v39
    s_waitcnt vmcnt(3)
    v_smfmac_f32_16x16x64_bf16 v[28:31], v[40:43], v[76:83], v6
    v_max3_u32 v16, v16, v40, v41
    v_max3_u32 v16, v16, v42, v43
    s_waitcnt vmcnt(2)
    v_smfmac_f32_16x16x64_bf16 v[28:31], v[44:47], v[84:91], v6
    v_max3_u32 v16, v16, v44, v45
    v_max3_u32 v16, v16, v46, v47
    s_waitcnt vmcnt(0)
    v_smfmac_f32_16x16x64_bf16 v[28:31], v[48:51], v[52:59], v6
    v_max3_u32 v16, v16, v48, v49
    v_max3_u32 v16, v16, v50, v51
    v_cmp_eq_u32 vcc, -1, v16
    s_cbranch_vccnz L_rt_88
    s_nop 3
    v_add_f32 v28, v28, v29
    v_add_f32 v30, v30, v31
    ds_write2_b32 v11, v28, v30 offset0:0 offset1:16
    s_waitcnt lgkmcnt(0)
    s_barrier
    ds_read2st64_b64 v[32:35], v12 offset0:0 offset1:1
    ds_read2st64_b64 v[36:39], v12 offset0:2 offset1:3
    s_waitcnt lgkmcnt(1)
    v_pk_add_f32 v[32:33], v[32:33], v[34:35]
    s_waitcnt lgkmcnt(0)
    v_pk_add_f32 v[36:37], v[36:37], v[38:39]
    v_pk_add_f32 v[32:33], v[32:33], v[36:37]
    v_cvt_pk_bf16_f32 v19, v32, v33
    buffer_store_dword v19, v13, s[40:43], s72 offen sc1
    s_barrier
    s_and_b32 s79, s5, 3
    s_lshl_b32 s79, s79, 16
    s_add_u32 s79, s79, s68
    buffer_store_dword v15, v13, s[40:43], s79 offen sc1
    s_add_u32 s5, s5, 1
    s_add_u32 s78, s5, 1
    s_cmp_ge_u32 s78, 64
    s_cbranch_scc1 L_end2
    s_cmp_ge_u32 s81, s78
    s_cbranch_scc1 L_wNd_89
L_wf_90:
    buffer_load_dword v16, v14, s[40:43], 0 offen sc1
    s_waitcnt vmcnt(0)
    v_cmp_gt_u32 vcc, s78, v16
    s_cbranch_vccz L_wfd_91
    s_sleep 2
    s_add_u32 s6, s6, 1
    s_cmp_gt_u32 s6, 200000
    s_cbranch_scc1 L_timeout
    s_branch L_wf_90
L_wfd_91:
    s_mov_b32 s81, s78
    s_add_u32 s79, s78, 1
    v_cmp_gt_u32 vcc, s79, v16
    s_cbranch_vccnz L_wNd_89
    s_mov_b32 s81, s79
    s_add_u32 s79, s78, 2
    v_cmp_gt_u32 vcc, s79, v16
    s_cbranch_vccnz L_wNd_89
    s_mov_b32 s81, s79
    s_add_u32 s79, s78, 4
    v_cmp_gt_u32 vcc, s79, v16
    s_cbranch_vccnz L_wNd_89
    s_mov_b32 s81, s79
    s_add_u32 s79, s78, 8
    v_cmp_gt_u32 vcc, s79, v16
    s_cbranch_vccnz L_wNd_89
    s_mov_b32 s81, s79
    s_add_u32 s79, s78, 16
    v_cmp_gt_u32 vcc, s79, v16
    s_cbranch_vccnz L_wNd_89
    s_mov_b32 s81, s79
L_wNd_89:
    buffer_load_dwordx4 v[92:95], v7, s[40:43], s73 offen offset:0 sc1
    buffer_load_dwordx4 v[96:99], v7, s[40:43], s73 offen offset:1024 sc1
    buffer_load_dwordx4 v[100:103], v7, s[40:43], s73 offen offset:2048 sc1
    buffer_load_dwordx4 v[104:107], v7, s[40:43], s73 offen offset:3072 sc1
    s_add_u32 s79, s73, 4096
    buffer_load_dwordx4 v[108:111], v7, s[40:43], s79 offen offset:0 sc1
    buffer_load_dwordx4 v[112:115], v7, s[40:43], s79 offen offset:1024 sc1
    buffer_load_dwordx4 v[116:119], v7, s[40:43], s79 offen offset:2048 sc1
    buffer_load_dwordx4 v[120:123], v7, s[40:43], s79 offen offset:3072 sc1
    s_add_u32 s73, s73, 1310720
    s_and_b32 s70, s5, 3
    s_lshl_b32 s70, s70, 17
    s_add_u32 s70, s70, s69
    s_and_b32 s71, s5, 3
    s_mul_i32 s7, s71, 655360
    s_add_u32 s7, s7, s38
    s_cmp_eq_u32 s71, 3
    s_cselect_b32 s71, s39, s7
    s_add_u32 s72, s5, 1
    s_and_b32 s72, s72, 3
    s_lshl_b32 s72, s72, 16
    s_add_u32 s72, s72, s68
L_oy_92:
    buffer_load_dwordx4 v[52:55], v10, s[40:43], s71 offen offset:0 sc1
    buffer_load_dwordx4 v[56:59], v10, s[40:43], s71 offen offset:1024 sc1
    s_waitcnt vmcnt(0)
    v_max3_u32 v16, v52, v53, v54
    v_max3_u32 v16, v16, v55, v56
    v_max3_u32 v16, v16, v57, v58
    v_max_u32 v16, v16, v59
    v_cmp_eq_u32 vcc, -1, v16
    s_cbranch_vccnz L_rt_93
L_op_94:
    buffer_load_dwordx4 v[32:35], v8, s[40:43], s70 offen offset:0 sc1
    buffer_load_dwordx4 v[36:39], v8, s[40:43], s70 offen offset:1280 sc1
    buffer_load_dwordx4 v[40:43], v8, s[40:43], s70 offen offset:2560 sc1
    buffer_load_dwordx4 v[44:47], v8, s[40:43], s70 offen offset:3840 sc1
    buffer_load_dwordx2 v[48:49], v9, s[40:43], s70 offen offset:0 sc1
    buffer_load_dwordx2 v[50:51], v9, s[40:43], s70 offen offset:640 sc1
    v_mov_b64 v[28:29], 0
    v_mov_b64 v[30:31], 0
    s_waitcnt vmcnt(5)
    s_nop 0
    v_smfmac_f32_16x16x64_bf16 v[28:31], v[32:35], v[92:99], v6
    v_max3_u32 v16, v32, v33, v34
    v_max_u32 v16, v16, v35
    s_waitcnt vmcnt(4)
    v_smfmac_f32_16x16x64_bf16 v[28:31], v[36:39], v[100:107], v6
    v_max3_u32 v16, v16, v36, v37
    v_max3_u32 v16, v16, v38, v39
    s_waitcnt vmcnt(3)
    v_smfmac_f32_16x16x64_bf16 v[28:31], v[40:43], v[108:115], v6
    v_max3_u32 v16, v16, v40, v41
    v_max3_u32 v16, v16, v42, v43
    s_waitcnt vmcnt(2)
    v_smfmac_f32_16x16x64_bf16 v[28:31], v[44:47], v[116:123], v6
    v_max3_u32 v16, v16, v44, v45
    v_max3_u32 v16, v16, v46, v47
    s_waitcnt vmcnt(0)
    v_smfmac_f32_16x16x64_bf16 v[28:31], v[48:51], v[52:59], v6
    v_max3_u32 v16, v16, v48, v49
    v_max3_u32 v16, v16, v50, v51
    v_cmp_eq_u32 vcc, -1, v16
    s_cbranch_vccnz L_rt_95
    s_nop 3
    v_add_f32 v28, v28, v29
    v_add_f32 v30, v30, v31
    ds_write2_b32 v11, v28, v30 offset0:0 offset1:16
    s_waitcnt lgkmcnt(0)
    s_barrier
    ds_read2st64_b64 v[32:35], v12 offset0:0 offset1:1
    ds_read2st64_b64 v[36:39], v12 offset0:2 offset1:3
    s_waitcnt lgkmcnt(1)
    v_pk_add_f32 v[32:33], v[32:33], v[34:35]
    s_waitcnt lgkmcnt(0)
    v_pk_add_f32 v[36:37], v[36:37], v[38:39]
    v_pk_add_f32 v[32:33], v[32:33], v[36:37]
    v_cvt_pk_bf16_f32 v19, v32, v33
    buffer_store_dword v19, v13, s[40:43], s72 offen sc1
    s_barrier
    s_and_b32 s79, s5, 3
    s_lshl_b32 s79, s79, 16
    s_add_u32 s79, s79, s68
    buffer_store_dword v15, v13, s[40:43], s79 offen sc1
    s_add_u32 s5, s5, 1
    s_add_u32 s78, s5, 1
    s_cmp_ge_u32 s78, 64
    s_cbranch_scc1 L_end2
    s_cmp_ge_u32 s81, s78
    s_cbranch_scc1 L_wNd_96
L_wf_97:
    buffer_load_dword v16, v14, s[40:43], 0 offen sc1
    s_waitcnt vmcnt(0)
    v_cmp_gt_u32 vcc, s78, v16
    s_cbranch_vccz L_wfd_98
    s_sleep 2
    s_add_u32 s6, s6, 1
    s_cmp_gt_u32 s6, 200000
    s_cbranch_scc1 L_timeout
    s_branch L_wf_97
L_wfd_98:
    s_mov_b32 s81, s78
    s_add_u32 s79, s78, 1
    v_cmp_gt_u32 vcc, s79, v16
    s_cbranch_vccnz L_wNd_96
    s_mov_b32 s81, s79
    s_add_u32 s79, s78, 2
    v_cmp_gt_u32 vcc, s79, v16
    s_cbranch_vccnz L_wNd_96
    s_mov_b32 s81, s79
    s_add_u32 s79, s78, 4
    v_cmp_gt_u32 vcc, s79, v16
    s_cbranch_vccnz L_wNd_96
    s_mov_b32 s81, s79
    s_add_u32 s79, s78, 8
    v_cmp_gt_u32 vcc, s79, v16
    s_cbranch_vccnz L_wNd_96
    s_mov_b32 s81, s79
    s_add_u32 s79, s78, 16
    v_cmp_gt_u32 vcc, s79, v16
    s_cbranch_vccnz L_wNd_96
    s_mov_b32 s81, s79
L_wNd_96:
    buffer_load_dwordx4 v[60:63], v7, s[40:43], s73 offen offset:0 sc1
    buffer_load_dwordx4 v[64:67], v7, s[40:43], s73 offen offset:1024 sc1
    buffer_load_dwordx4 v[68:71], v7, s[40:43], s73 offen offset:2048 sc1
    buffer_load_dwordx4 v[72:75], v7, s[40:43], s73 offen offset:3072 sc1
    s_add_u32 s79, s73, 4096
    buffer_load_dwordx4 v[76:79], v7, s[40:43], s79 offen offset:0 sc1
    buffer_load_dwordx4 v[80:83], v7, s[40:43], s79 offen offset:1024 sc1
    buffer_load_dwordx4 v[84:87], v7, s[40:43], s79 offen offset:2048 sc1
    buffer_load_dwordx4 v[88:91], v7, s[40:43], s79 offen offset:3072 sc1
    s_add_u32 s73, s73, 1310720
    s_branch L_o_loop_84
L_rt_86:
    s_add_u32 s6, s6, 1
    s_cmp_gt_u32 s6, 200000
    s_cbranch_scc1 L_timeout
    s_nop 3
    s_branch L_oy_85
L_rt_88:
    s_add_u32 s6, s6, 1
    s_cmp_gt_u32 s6, 200000
    s_cbranch_scc1 L_timeout
    s_nop 3
    s_branch L_op_87
L_rt_93:
    s_add_u32 s6, s6, 1
    s_cmp_gt_u32 s6, 200000
    s_cbranch_scc1 L_timeout
    s_nop 3
    s_branch L_oy_92
L_rt_95:
    s_add_u32 s6, s6, 1
    s_cmp_gt_u32 s6, 200000
    s_cbranch_scc1 L_timeout
    s_nop 3
    s_branch L_op_94
L_end2:
    s_endpgm
L_timeout:
    v_mov_b32 v1, s2
    v_mov_b32 v2, 32
    v_lshlrev_b32 v1, 8, v1
    v_or_b32 v1, s5, v1
    v_or_b32 v1, 0x10000, v1
    buffer_store_dword v1, v2, s[60:63], 0 offen sc1
L_end:
    s_endpgm
.section .rodata,"a"
.p2align 6
.amdhsa_kernel gated_mix__memory_aug_recurrent_mem_tr__glu_gated_geglu__prompt_kernel
  .amdhsa_next_free_vgpr 512
  .amdhsa_next_free_sgpr 102
  .amdhsa_accum_offset 256
  .amdhsa_group_segment_fixed_size 0
  .amdhsa_kernarg_size 120
  .amdhsa_user_sgpr_count 2
  .amdhsa_user_sgpr_kernarg_segment_ptr 1
  .amdhsa_system_sgpr_workgroup_id_x 1
.end_amdhsa_kernel
```
